```python
import torch

def _softmax(x, axis=-1):
    return torch.softmax(x, dim=axis)
def _gelu(x):
    return torch.nn.functional.gelu(x, approximate="tanh")
def _silu(x):
    return torch.nn.functional.silu(x)
def _sigmoid(x):
    return torch.sigmoid(x)
def _layernorm(x, axis=-1, eps=1e-5):
    m = x.mean(dim=axis, keepdim=True)
    v = x.var(dim=axis, keepdim=True, unbiased=False)
    return (x - m) / torch.sqrt(v + eps)
def _scatter_add(tgt, idx, src, axis=0):
    return tgt.clone().index_add_(axis, idx, src)
def _segment_sum(src, seg, n):
    out = torch.zeros((n,) + src.shape[1:], dtype=src.dtype)
    return out.index_add_(0, seg, src)
def _pad(x, pw):
    flat = tuple(v for pair in reversed(pw) for v in pair)
    return torch.nn.functional.pad(x, flat)

kernel_name = 'gated_mix__linear_kernel_hedgehog__geglu_ffn__prompt'

def setup_inputs():

    _w = (lambda a: (lambda t: t.to(torch.bfloat16) if t.is_floating_point() else t)(torch.as_tensor(a)))
    def _A_setup():
        B, S, D, H = 1, 2048, 640, 32
        Dh = D // H
        return {
            "x": _w((lambda *s: torch.randn(*s, dtype=torch.bfloat16) * 0.05)(B, S, D)),
            "wqkv": _w((lambda *s: torch.randn(*s, dtype=torch.bfloat16) * 0.8)(D, 3 * D)),
            "w_phi": _w((lambda *s: torch.randn(*s, dtype=torch.bfloat16) * 0.8)(H, Dh, Dh) * (Dh ** -0.5)),
            "wo": _w((lambda *s: torch.randn(*s, dtype=torch.bfloat16) * 0.05)(D, D)),
        }
    _A_in = _A_setup()

    def _B_setup():
        B, S, D, F = 1, 2048, 640, 1728
        return {
            "x": _w((lambda *s: torch.randn(*s, dtype=torch.bfloat16) * 0.05)(B, S, D)),
            "w_gate": _w((lambda *s: torch.randn(*s, dtype=torch.bfloat16) * 0.05)(D, F)),
            "w_up": _w((lambda *s: torch.randn(*s, dtype=torch.bfloat16) * 0.05)(D, F)),
            "w_down": _w((lambda *s: torch.randn(*s, dtype=torch.bfloat16) * 0.05)(F, D)),
        }
    _B_in = _B_setup()

    return {
        "A_x": _A_in["x"],
        "A_wqkv": _A_in["wqkv"],
        "A_w_phi": _A_in["w_phi"],
        "A_wo": _A_in["wo"],
        "B_x": _B_in["x"],
        "B_w_gate": _B_in["w_gate"],
        "B_w_up": _B_in["w_up"],
        "B_w_down": _B_in["w_down"],
        "gate_w": _w((lambda *s: torch.randn(*s, dtype=torch.bfloat16) * 0.05)(640) * 16.0),
    }

def reference(A_x, A_wqkv, A_w_phi, A_wo, B_x, B_w_gate, B_w_up, B_w_down, gate_w):
    def _A_ref(x, wqkv, w_phi, wo):
        B, S, D = x.shape
        H = 32; Dh = D // H
        qkv = (lambda x, *d: x.permute(*d))((x @ wqkv).reshape(B, S, 3, H, Dh), 2, 0, 3, 1, 4)
        q, k, v = qkv[0], qkv[1], qkv[2]
        pq = torch.einsum("bhsd,hdf->bhsf", q, w_phi)
        pk = torch.einsum("bhsd,hdf->bhsf", k, w_phi)
        phi_q = torch.concatenate([_softmax(pq, axis=-1), _softmax(-pq, axis=-1)], axis=-1)
        phi_k = torch.concatenate([_softmax(pk, axis=-1), _softmax(-pk, axis=-1)], axis=-1)
        kv = torch.einsum("bhsf,bhsd->bhfd", phi_k, v)
        z  = torch.einsum("bhsf->bhf", phi_k)
        num = torch.einsum("bhqf,bhfd->bhqd", phi_q, kv)
        den = torch.einsum("bhqf,bhf->bhq", phi_q, z)[..., None] + 1e-6
        o = num / den
        return (lambda x, *d: x.permute(*d))(o, 0, 2, 1, 3).reshape(B, S, D) @ wo

    def _B_ref(x, w_gate, w_up, w_down):
        return (_gelu(x @ w_gate) * (x @ w_up)) @ w_down

    x = A_x
    g = _sigmoid((x * gate_w).sum(-1, keepdims=True))
    a = _A_ref(x, A_wqkv, A_w_phi, A_wo)
    b = _B_ref(x, B_w_gate, B_w_up, B_w_down)
    return g * a + (1 - g) * b
```

```asm
; @launch kernel=k1_kernel grid=(256,1,1) block=(512,1,1) lds=163840
; @launch kernel=k2_kernel grid=(256,1,1) block=(512,1,1) lds=163840
.amdgcn_target "amdgcn-amd-amdhsa--gfx950"
.text
.globl k1_kernel
.p2align 8
.type k1_kernel,@function
k1_kernel:
 s_cmp_ge_u32 s2, 256
 s_cbranch_scc1 L_k1_done
 s_load_dwordx4 s[40:43], s[0:1], 0
 s_load_dwordx4 s[44:47], s[0:1], 16
 s_load_dwordx4 s[48:51], s[0:1], 40
 s_load_dwordx4 s[52:55], s[0:1], 56
 s_load_dwordx4 s[56:59], s[0:1], 80
 v_lshrrev_b32 v1, 6, v0
 v_and_b32 v0, 255, v0
 v_readfirstlane_b32 s98, v1
 s_and_b32 s24, s2, 1
 s_bfe_u32 s25, s2, 0x20001
 s_lshr_b32 s26, s2, 3
 s_lshl_b32 s21, s24, 3
 s_and_b32 s20, s98, 3
 s_and_b32 s27, s26, 7
 s_add_u32 s21, s21, s27
 s_lshr_b32 s26, s26, 3
 s_getpc_b64 s[28:29]
 s_lshr_b32 s30, s2, 3
 s_mul_i32 s30, s30, ((L_text_end - k1_kernel) / 4096) * 128
 s_and_b32 s28, s28, 0xffffff00
 s_add_u32 s28, s28, s30
 s_addc_u32 s29, s29, 0
 v_and_b32 v2, 63, v0
 v_min_u32 v2, ((L_text_end - k1_kernel) / 4096) - 1, v2
 v_lshlrev_b32 v2, 7, v2
 s_cmp_lg_u32 s98, 7
 s_cbranch_scc1 L_k1_nocp
 global_load_dword v250, v2, s[28:29]
L_k1_nocp:
 s_waitcnt lgkmcnt(0)
 s_mov_b32 s4, s40
 s_mov_b32 s5, s41
 s_mov_b32 s6, 2621440
 s_mov_b32 s7, 0x00020000
 s_mov_b32 s16, s58
 s_mov_b32 s17, s59
 s_mov_b32 s18, 22020096
 s_mov_b32 s19, 0x00020000
 s_mov_b32 s92, s56
 s_mov_b32 s93, s57
 s_mov_b32 s94, 256
 s_mov_b32 s95, 0x00020000
 s_mov_b32 s8, s48
 s_mov_b32 s9, s49
 s_mov_b32 s10, 2211840
 s_mov_b32 s11, 0x00020000
 s_mov_b32 s12, s50
 s_mov_b32 s13, s51
 s_mov_b32 s14, 2211840
 s_mov_b32 s15, 0x00020000
 s_mov_b32 s64, s42
 s_mov_b32 s65, s43
 s_mov_b32 s66, 2457600
 s_mov_b32 s67, 0x00020000
 s_mov_b32 s68, s44
 s_mov_b32 s69, s45
 s_mov_b32 s70, 25600
 s_mov_b32 s71, 0x00020000
 s_cmp_eq_u32 s26, 3
 s_cbranch_scc1 L_k1_F
 s_lshl_b32 s28, s25, 1
 s_add_u32 s28, s28, s26
 s_sub_u32 s22, s28, 1
 s_add_u32 s28, s28, 3
 s_cmp_eq_u32 s26, 0
 s_cselect_b32 s22, s25, s22
 s_cselect_b32 s23, s25, s28
 s_lshr_b32 s96, s23, 1
 s_add_u32 s96, s96, 20
 s_and_b32 s97, s23, 1
 s_lshl_b32 s97, s97, 1
 s_cmp_lg_u32 s26, 0
 s_cbranch_scc1 L_k1_KV
 v_and_b32 v1, 63, v0
 v_lshrrev_b32 v35, 3, v1
 v_and_b32 v36, 7, v1
 v_lshrrev_b32 v37, 4, v1
 v_xor_b32 v37, v36, v37
 v_lshlrev_b32 v37, 4, v37
 s_lshl_b32 s24, s21, 7
 s_lshl_b32 s25, s98, 4
 s_add_u32 s24, s24, s25
 v_add_u32 v38, s24, v35
 v_mul_u32_u24 v38, 1280, v38
 v_add_u32 v2, v38, v37
 v_xor_b32 v37, 64, v37
 v_add_u32 v3, v38, v37
 v_add_u32 v3, 10240, v3
 s_lshl_b32 s36, s98, 11
 s_add_u32 s36, s36, 112640
 s_lshl_b32 s35, s98, 10
 s_lshl_b32 s24, s98, 6
 s_add_u32 s24, s24, 0
 v_add_u32 v35, s24, v1
 v_mul_u32_u24 v36, 3277, v35
 v_lshrrev_b32 v36, 16, v36
 v_mul_u32_u24 v37, 20, v36
 v_sub_u32 v37, v35, v37
 v_mul_u32_u24 v36, 3840, v36
 v_lshl_add_u32 v8, v37, 4, v36
 s_mul_i32 s88, s22, 320
 s_mov_b32 s40, s64
 s_mov_b32 s41, s65
 s_mov_b32 s42, 2457600
 s_mov_b32 s43, 0x00020000
 v_lshrrev_b32 v35, 3, v1
 v_and_b32 v36, 7, v1
 v_bfe_u32 v37, v1, 4, 1
 v_lshlrev_b32 v37, 1, v37
 v_xor_b32 v37, v37, v36
 s_and_b32 s24, s98, 4
 v_xor_b32 v37, s24, v37
 v_lshlrev_b32 v37, 4, v37
 s_lshl_b32 s24, s20, 3
 v_add_u32 v35, s24, v35
 v_mul_u32_u24 v35, 3456, v35
 v_add_u32 v9, v35, v37
 s_lshl_b32 s89, s23, 7
 s_cmp_lt_u32 s98, 4
 s_cselect_b32 s56, s8, s12
 s_cselect_b32 s57, s9, s13
 s_mov_b32 s58, 2211840
 s_mov_b32 s59, 0x00020000
 v_lshrrev_b32 v35, 2, v1
 v_and_b32 v36, 3, v1
 s_and_b32 s24, s98, 2
 v_xor_b32 v36, s24, v36
 s_and_b32 s24, s98, 1
 s_lshl_b32 s24, s24, 4
 v_add_u32 v35, s24, v35
 v_mul_u32_u24 v35, 3456, v35
 v_lshl_add_u32 v10, v36, 4, v35
 s_lshl_b32 s90, s96, 7
 s_lshl_b32 s24, s97, 5
 s_add_u32 s90, s90, s24
 s_mov_b32 s63, 110592
 s_add_u32 s62, s35, 18432
 s_cmp_lt_u32 s98, 2
 s_cselect_b32 s80, s8, s12
 s_cselect_b32 s81, s9, s13
 s_mov_b32 s82, 2211840
 s_mov_b32 s83, 0x00020000
 s_lshl_b32 s24, s98, 6
 s_add_u32 s24, s24, 256
 v_add_u32 v35, s24, v1
 v_mul_u32_u24 v36, 3277, v35
 v_lshrrev_b32 v36, 16, v36
 v_mul_u32_u24 v37, 20, v36
 v_sub_u32 v37, v35, v37
 v_mul_u32_u24 v36, 3840, v36
 v_lshl_add_u32 v38, v37, 4, v36
 s_cmp_ge_u32 s98, 4
 s_cselect_b64 vcc, -1, 0
 s_cselect_b32 s80, s64, s80
 s_cselect_b32 s81, s65, s81
 s_cselect_b32 s82, 2457600, s82
 s_cselect_b32 s90, s88, s90
 s_cselect_b32 s63, 122880, s63
 s_add_u32 s24, s35, 4096
 s_cmp_ge_u32 s98, 4
 s_cselect_b32 s62, s24, s62
 v_cndmask_b32 v10, v10, v38, vcc
 s_cmp_ge_u32 s98, 6
 s_cselect_b64 vcc, -1, 0
 v_mov_b32 v36, 0x80000000
 s_nop 0
 v_cndmask_b32 v10, v10, v36, vcc
 s_cmp_ge_u32 s98, 4
 s_cbranch_scc1 L3_Q_h1
 s_and_b32 s74, s35, 1024
 s_add_u32 s74, s74, 161792
 s_add_u32 m0, s36, 0
 s_movk_i32 s37, 0
 buffer_load_dwordx4 v2, s[4:7], s37 offen lds
 s_add_u32 m0, s36, 1024
 s_movk_i32 s37, 0
 buffer_load_dwordx4 v3, s[4:7], s37 offen lds
 s_add_u32 m0, s35, 0
 s_add_u32 s37, s88, 0
 buffer_load_dwordx4 v8, s[40:43], s37 offen lds
 s_add_u32 m0, s35, 10240
 s_add_u32 s37, s89, 0
 buffer_load_dwordx4 v9, s[56:59], s37 offen lds
 s_add_u32 s37, s62, 0
 s_cmp_lt_u32 s98, 6
 s_cselect_b32 m0, s37, s74
 s_nop 0
 buffer_load_dwordx4 v10, s[80:83], s90 offen lds
 s_add_u32 s90, s90, s63
 s_add_u32 m0, s35, 22528
 s_add_u32 s37, s88, 122880
 buffer_load_dwordx4 v8, s[40:43], s37 offen lds
 s_add_u32 m0, s35, 32768
 s_add_u32 s37, s89, 110592
 buffer_load_dwordx4 v9, s[56:59], s37 offen lds
 s_add_u32 s37, s62, 22528
 s_cmp_lt_u32 s98, 6
 s_cselect_b32 m0, s37, s74
 s_nop 0
 buffer_load_dwordx4 v10, s[80:83], s90 offen lds
 s_add_u32 s90, s90, s63
 s_add_u32 m0, s36, 16384
 s_movk_i32 s37, 128
 buffer_load_dwordx4 v2, s[4:7], s37 offen lds
 s_add_u32 m0, s36, 17408
 s_movk_i32 s37, 128
 buffer_load_dwordx4 v3, s[4:7], s37 offen lds
 s_add_u32 m0, s35, 45056
 s_add_u32 s37, s88, 245760
 buffer_load_dwordx4 v8, s[40:43], s37 offen lds
 s_add_u32 m0, s35, 55296
 s_add_u32 s37, s89, 221184
 buffer_load_dwordx4 v9, s[56:59], s37 offen lds
 s_add_u32 s37, s62, 45056
 s_cmp_lt_u32 s98, 6
 s_cselect_b32 m0, s37, s74
 s_nop 0
 buffer_load_dwordx4 v10, s[80:83], s90 offen lds
 s_add_u32 s90, s90, s63
 v_and_b32 v35, 31, v1
 v_lshrrev_b32 v36, 5, v1
 v_bfe_u32 v37, v1, 1, 3
 v_xor_b32 v37, v37, v36
 v_lshlrev_b32 v38, 7, v35
 s_lshl_b32 s24, s20, 12
 s_add_u32 s24, s24, 112640
 v_add_u32 v38, s24, v38
 v_xor_b32 v39, 0, v37
 v_lshl_add_u32 v4, v39, 4, v38
 v_xor_b32 v39, 2, v37
 v_lshl_add_u32 v5, v39, 4, v38
 v_xor_b32 v39, 4, v37
 v_lshl_add_u32 v6, v39, 4, v38
 v_xor_b32 v39, 6, v37
 v_lshl_add_u32 v7, v39, 4, v38
 v_and_b32 v35, 31, v1
 v_lshrrev_b32 v36, 5, v1
 s_mul_i32 s24, s20, 10752
 s_add_u32 s24, s24, 20480
 v_mul_u32_u24 v38, 336, v35
 v_add_u32 v38, s24, v38
 v_lshl_add_u32 v28, v36, 3, v38
 v_and_b32 v35, 15, v1
 v_lshrrev_b32 v36, 4, v1
 v_mul_u32_u24 v37, 336, v35
 v_add_u32 v37, s24, v37
 v_mul_u32_u24 v38, 40, v36
 v_add_u32 v29, v37, v38
 v_mul_u32_u24 v38, 1280, v36
 v_lshl_add_u32 v30, v35, 4, v38
 v_bfe_u32 v35, v1, 4, 1
 v_lshrrev_b32 v36, 5, v1
 v_bfe_u32 v37, v1, 2, 2
 v_and_b32 v38, 3, v1
 v_lshlrev_b32 v35, 5, v35
 v_lshl_add_u32 v35, v38, 3, v35
 v_lshl_add_u32 v39, v36, 3, v37
 v_mul_u32_u24 v39, 320, v39
 v_add_u32 v13, v39, v35
 v_add_u32 v14, 0x10000, v13
 v_lshl_add_u32 v39, v36, 2, v37
 v_lshl_add_u32 v39, v39, 6, v35
 v_add_u32 v27, 0, v39
 s_mov_b32 s72, 0x3fb8aa3b
 s_waitcnt vmcnt(8)
 s_barrier
 ds_read_b128 v[176:179], v4 offset:0
 ds_read_b128 v[180:183], v5 offset:0
 ds_read_b64_tr_b16 v[40:41], v13 offset:0
 ds_read_b64_tr_b16 v[42:43], v13 offset:1280
 s_add_u32 m0, s35, 67584
 s_add_u32 s37, s88, 368640
 buffer_load_dwordx4 v8, s[40:43], s37 offen lds
 ds_read_b64_tr_b16 v[44:45], v13 offset:64
 ds_read_b64_tr_b16 v[46:47], v13 offset:1344
 s_add_u32 m0, s35, 77824
 s_add_u32 s37, s89, 331776
 buffer_load_dwordx4 v9, s[56:59], s37 offen lds
 ds_read_b64_tr_b16 v[48:49], v13 offset:128
 ds_read_b64_tr_b16 v[50:51], v13 offset:1408
 s_add_u32 s37, s62, 67584
 s_cmp_lt_u32 s98, 6
 s_cselect_b32 m0, s37, s74
 s_nop 0
 buffer_load_dwordx4 v10, s[80:83], s90 offen lds
 s_add_u32 s90, s90, s63
 s_waitcnt lgkmcnt(4)
 v_mfma_f32_32x32x16_bf16 v[64:79], v[40:43], v[176:179], 0
 ds_read_b64_tr_b16 v[52:53], v13 offset:192
 ds_read_b64_tr_b16 v[54:55], v13 offset:1472
 s_lshl_b32 s32, s22, 3
 s_mul_i32 s38, s32, 800
 v_add_u32 v200, 0, v0
 s_waitcnt lgkmcnt(4)
 v_mfma_f32_32x32x16_bf16 v[80:95], v[44:47], v[176:179], 0
 ds_read_b64_tr_b16 v[56:57], v13 offset:256
 ds_read_b64_tr_b16 v[58:59], v13 offset:1536
 v_lshrrev_b32 v201, 7, v200
 v_add_u32 v202, 1, v201
 v_lshrrev_b32 v202, 2, v202
 s_waitcnt lgkmcnt(4)
 v_mfma_f32_32x32x16_bf16 v[96:111], v[48:51], v[176:179], 0
 ds_read_b64_tr_b16 v[60:61], v13 offset:5120
 ds_read_b64_tr_b16 v[62:63], v13 offset:6400
 v_lshlrev_b32 v203, 1, v202
 v_sub_u32 v201, v201, v203
 v_bfe_u32 v203, v200, 3, 4
 s_waitcnt lgkmcnt(4)
 v_mfma_f32_32x32x16_bf16 v[112:127], v[52:55], v[176:179], 0
 ds_read_b64_tr_b16 v[40:41], v13 offset:5184
 ds_read_b64_tr_b16 v[42:43], v13 offset:6464
 v_lshl_add_u32 v201, v201, 4, v203
 v_and_b32 v203, 7, v200
 v_lshlrev_b32 v203, 2, v203
 s_waitcnt lgkmcnt(4)
 v_mfma_f32_32x32x16_bf16 v[128:143], v[56:59], v[176:179], 0
 ds_read_b64_tr_b16 v[44:45], v13 offset:5248
 ds_read_b64_tr_b16 v[46:47], v13 offset:6528
 v_lshl_add_u32 v202, v202, 5, v203
 v_mul_u32_u24 v203, 3277, v201
 v_lshrrev_b32 v203, 16, v203
 s_waitcnt lgkmcnt(4)
 v_mfma_f32_32x32x16_bf16 v[64:79], v[60:63], v[180:183], v[64:79]
 ds_read_b64_tr_b16 v[48:49], v13 offset:5312
 ds_read_b64_tr_b16 v[50:51], v13 offset:6592
 v_mul_u32_u24 v204, 3277, v202
 v_lshrrev_b32 v204, 16, v204
 v_cmp_eq_u32 vcc, v203, v204
 s_waitcnt lgkmcnt(4)
 v_mfma_f32_32x32x16_bf16 v[80:95], v[40:43], v[180:183], v[80:95]
 ds_read_b64_tr_b16 v[52:53], v13 offset:5376
 ds_read_b64_tr_b16 v[54:55], v13 offset:6656
 v_mul_u32_u24 v201, 40, v201
 v_lshl_add_u32 v201, v202, 1, v201
 v_mul_u32_u24 v204, 40, v204
 s_waitcnt lgkmcnt(4)
 v_mfma_f32_32x32x16_bf16 v[96:111], v[44:47], v[180:183], v[96:111]
 s_waitcnt vmcnt(8)
 s_barrier
 ds_read_b128 v[184:187], v6 offset:0
 ds_read_b128 v[188:191], v7 offset:0
 ds_read_b64_tr_b16 v[56:57], v13 offset:22528
 ds_read_b64_tr_b16 v[58:59], v13 offset:23808
 s_add_u32 m0, s35, 90112
 s_add_u32 s37, s88, 491520
 buffer_load_dwordx4 v8, s[40:43], s37 offen lds
 s_waitcnt lgkmcnt(6)
 v_mfma_f32_32x32x16_bf16 v[112:127], v[48:51], v[180:183], v[112:127]
 ds_read_b64_tr_b16 v[60:61], v13 offset:22592
 ds_read_b64_tr_b16 v[62:63], v13 offset:23872
 s_add_u32 m0, s35, 100352
 s_add_u32 s37, s89, 442368
 buffer_load_dwordx4 v9, s[56:59], s37 offen lds
 s_waitcnt lgkmcnt(6)
 v_mfma_f32_32x32x16_bf16 v[128:143], v[52:55], v[180:183], v[128:143]
 ds_read_b64_tr_b16 v[40:41], v13 offset:22656
 ds_read_b64_tr_b16 v[42:43], v13 offset:23936
 s_add_u32 s37, s62, 90112
 s_cmp_lt_u32 s98, 6
 s_cselect_b32 m0, s37, s74
 s_nop 0
 buffer_load_dwordx4 v10, s[80:83], s90 offen lds
 s_add_u32 s90, s90, s63
 s_waitcnt lgkmcnt(4)
 v_mfma_f32_32x32x16_bf16 v[64:79], v[56:59], v[184:187], v[64:79]
 ds_read_b64_tr_b16 v[44:45], v13 offset:22720
 ds_read_b64_tr_b16 v[46:47], v13 offset:24000
 s_add_u32 m0, s36, 32768
 s_movk_i32 s37, 256
 buffer_load_dwordx4 v2, s[4:7], s37 offen lds
 s_waitcnt lgkmcnt(4)
 v_mfma_f32_32x32x16_bf16 v[80:95], v[60:63], v[184:187], v[80:95]
 ds_read_b64_tr_b16 v[48:49], v13 offset:22784
 ds_read_b64_tr_b16 v[50:51], v13 offset:24064
 s_add_u32 m0, s36, 33792
 s_movk_i32 s37, 256
 buffer_load_dwordx4 v3, s[4:7], s37 offen lds
 s_waitcnt lgkmcnt(4)
 v_mfma_f32_32x32x16_bf16 v[96:111], v[40:43], v[184:187], v[96:111]
 ds_read_b64_tr_b16 v[52:53], v13 offset:27648
 ds_read_b64_tr_b16 v[54:55], v13 offset:28928
 v_sub_u32 v201, v201, v204
 v_mov_b32 v204, 0x80000000
 v_cndmask_b32 v201, v204, v201, vcc
 s_waitcnt lgkmcnt(4)
 v_mfma_f32_32x32x16_bf16 v[112:127], v[44:47], v[184:187], v[112:127]
 ds_read_b64_tr_b16 v[56:57], v13 offset:27712
 ds_read_b64_tr_b16 v[58:59], v13 offset:28992
 buffer_load_dwordx2 v[144:145], v201, s[68:71], s38 offen
 s_waitcnt lgkmcnt(4)
 v_mfma_f32_32x32x16_bf16 v[128:143], v[48:51], v[184:187], v[128:143]
 ds_read_b64_tr_b16 v[60:61], v13 offset:27776
 ds_read_b64_tr_b16 v[62:63], v13 offset:29056
 v_add_u32 v200, 256, v0
 v_lshrrev_b32 v201, 7, v200
 v_add_u32 v202, 1, v201
 s_waitcnt lgkmcnt(4)
 v_mfma_f32_32x32x16_bf16 v[64:79], v[52:55], v[188:191], v[64:79]
 ds_read_b64_tr_b16 v[40:41], v13 offset:27840
 ds_read_b64_tr_b16 v[42:43], v13 offset:29120
 v_lshrrev_b32 v202, 2, v202
 v_lshlrev_b32 v203, 1, v202
 v_sub_u32 v201, v201, v203
 s_waitcnt lgkmcnt(4)
 v_mfma_f32_32x32x16_bf16 v[80:95], v[56:59], v[188:191], v[80:95]
 ds_read_b64_tr_b16 v[44:45], v13 offset:27904
 ds_read_b64_tr_b16 v[46:47], v13 offset:29184
 v_bfe_u32 v203, v200, 3, 4
 v_lshl_add_u32 v201, v201, 4, v203
 v_and_b32 v203, 7, v200
 s_waitcnt lgkmcnt(4)
 v_mfma_f32_32x32x16_bf16 v[96:111], v[60:63], v[188:191], v[96:111]
 s_waitcnt vmcnt(9)
 s_barrier
 ds_read_b128 v[176:179], v4 offset:16384
 ds_read_b128 v[180:183], v5 offset:16384
 ds_read_b64_tr_b16 v[48:49], v13 offset:45056
 ds_read_b64_tr_b16 v[50:51], v13 offset:46336
 s_add_u32 m0, s35, 0
 s_add_u32 s37, s88, 614400
 buffer_load_dwordx4 v8, s[40:43], s37 offen lds
 s_waitcnt lgkmcnt(6)
 v_mfma_f32_32x32x16_bf16 v[112:127], v[40:43], v[188:191], v[112:127]
 ds_read_b64_tr_b16 v[52:53], v13 offset:45120
 ds_read_b64_tr_b16 v[54:55], v13 offset:46400
 s_add_u32 m0, s35, 10240
 s_add_u32 s37, s89, 552960
 buffer_load_dwordx4 v9, s[56:59], s37 offen lds
 s_waitcnt lgkmcnt(6)
 v_mfma_f32_32x32x16_bf16 v[128:143], v[44:47], v[188:191], v[128:143]
 ds_read_b64_tr_b16 v[56:57], v13 offset:45184
 ds_read_b64_tr_b16 v[58:59], v13 offset:46464
 s_add_u32 s37, s62, 0
 s_cmp_lt_u32 s98, 6
 s_cselect_b32 m0, s37, s74
 s_nop 0
 buffer_load_dwordx4 v10, s[80:83], s90 offen lds
 s_add_u32 s90, s90, s63
 s_waitcnt lgkmcnt(4)
 v_mfma_f32_32x32x16_bf16 v[64:79], v[48:51], v[176:179], v[64:79]
 ds_read_b64_tr_b16 v[60:61], v13 offset:45248
 ds_read_b64_tr_b16 v[62:63], v13 offset:46528
 v_lshlrev_b32 v203, 2, v203
 v_lshl_add_u32 v202, v202, 5, v203
 v_mul_u32_u24 v203, 3277, v201
 s_waitcnt lgkmcnt(4)
 v_mfma_f32_32x32x16_bf16 v[80:95], v[52:55], v[176:179], v[80:95]
 ds_read_b64_tr_b16 v[40:41], v13 offset:45312
 ds_read_b64_tr_b16 v[42:43], v13 offset:46592
 v_lshrrev_b32 v203, 16, v203
 v_mul_u32_u24 v204, 3277, v202
 v_lshrrev_b32 v204, 16, v204
 s_waitcnt lgkmcnt(4)
 v_mfma_f32_32x32x16_bf16 v[96:111], v[56:59], v[176:179], v[96:111]
 ds_read_b64_tr_b16 v[44:45], v13 offset:50176
 ds_read_b64_tr_b16 v[46:47], v13 offset:51456
 v_cmp_eq_u32 vcc, v203, v204
 v_mul_u32_u24 v201, 40, v201
 v_lshl_add_u32 v201, v202, 1, v201
 s_waitcnt lgkmcnt(4)
 v_mfma_f32_32x32x16_bf16 v[112:127], v[60:63], v[176:179], v[112:127]
 ds_read_b64_tr_b16 v[48:49], v13 offset:50240
 ds_read_b64_tr_b16 v[50:51], v13 offset:51520
 v_mul_u32_u24 v204, 40, v204
 v_sub_u32 v201, v201, v204
 v_mov_b32 v204, 0x80000000
 s_waitcnt lgkmcnt(4)
 v_mfma_f32_32x32x16_bf16 v[128:143], v[40:43], v[176:179], v[128:143]
 ds_read_b64_tr_b16 v[52:53], v13 offset:50304
 ds_read_b64_tr_b16 v[54:55], v13 offset:51584
 v_cndmask_b32 v201, v204, v201, vcc
 buffer_load_dwordx2 v[146:147], v201, s[68:71], s38 offen
 s_waitcnt lgkmcnt(4)
 v_mfma_f32_32x32x16_bf16 v[64:79], v[44:47], v[180:183], v[64:79]
 ds_read_b64_tr_b16 v[56:57], v13 offset:50368
 ds_read_b64_tr_b16 v[58:59], v13 offset:51648
 v_add_u32 v200, 512, v0
 v_lshrrev_b32 v201, 7, v200
 v_add_u32 v202, 1, v201
 s_waitcnt lgkmcnt(4)
 v_mfma_f32_32x32x16_bf16 v[80:95], v[48:51], v[180:183], v[80:95]
 ds_read_b64_tr_b16 v[60:61], v13 offset:50432
 ds_read_b64_tr_b16 v[62:63], v13 offset:51712
 v_lshrrev_b32 v202, 2, v202
 v_lshlrev_b32 v203, 1, v202
 v_sub_u32 v201, v201, v203
 s_waitcnt lgkmcnt(4)
 v_mfma_f32_32x32x16_bf16 v[96:111], v[52:55], v[180:183], v[96:111]
 s_waitcnt vmcnt(10)
 s_barrier
 ds_read_b128 v[184:187], v6 offset:16384
 ds_read_b128 v[188:191], v7 offset:16384
 ds_read_b64_tr_b16 v[40:41], v14 offset:2048
 ds_read_b64_tr_b16 v[42:43], v14 offset:3328
 s_add_u32 m0, s35, 22528
 s_add_u32 s37, s88, 737280
 buffer_load_dwordx4 v8, s[40:43], s37 offen lds
 s_waitcnt lgkmcnt(6)
 v_mfma_f32_32x32x16_bf16 v[112:127], v[56:59], v[180:183], v[112:127]
 ds_read_b64_tr_b16 v[44:45], v14 offset:2112
 ds_read_b64_tr_b16 v[46:47], v14 offset:3392
 s_add_u32 m0, s35, 32768
 s_add_u32 s37, s89, 663552
 buffer_load_dwordx4 v9, s[56:59], s37 offen lds
 s_waitcnt lgkmcnt(6)
 v_mfma_f32_32x32x16_bf16 v[128:143], v[60:63], v[180:183], v[128:143]
 ds_read_b64_tr_b16 v[48:49], v14 offset:2176
 ds_read_b64_tr_b16 v[50:51], v14 offset:3456
 s_add_u32 s37, s62, 22528
 s_cmp_lt_u32 s98, 6
 s_cselect_b32 m0, s37, s74
 s_nop 0
 buffer_load_dwordx4 v10, s[80:83], s90 offen lds
 s_add_u32 s90, s90, s63
 s_waitcnt lgkmcnt(4)
 v_mfma_f32_32x32x16_bf16 v[64:79], v[40:43], v[184:187], v[64:79]
 ds_read_b64_tr_b16 v[52:53], v14 offset:2240
 ds_read_b64_tr_b16 v[54:55], v14 offset:3520
 s_add_u32 m0, s36, 0
 s_movk_i32 s37, 384
 buffer_load_dwordx4 v2, s[4:7], s37 offen lds
 s_waitcnt lgkmcnt(4)
 v_mfma_f32_32x32x16_bf16 v[80:95], v[44:47], v[184:187], v[80:95]
 ds_read_b64_tr_b16 v[56:57], v14 offset:2304
 ds_read_b64_tr_b16 v[58:59], v14 offset:3584
 s_add_u32 m0, s36, 1024
 s_movk_i32 s37, 384
 buffer_load_dwordx4 v3, s[4:7], s37 offen lds
 s_waitcnt lgkmcnt(4)
 v_mfma_f32_32x32x16_bf16 v[96:111], v[48:51], v[184:187], v[96:111]
 ds_read_b64_tr_b16 v[60:61], v14 offset:7168
 ds_read_b64_tr_b16 v[62:63], v14 offset:8448
 v_bfe_u32 v203, v200, 3, 4
 v_lshl_add_u32 v201, v201, 4, v203
 v_and_b32 v203, 7, v200
 s_waitcnt lgkmcnt(4)
 v_mfma_f32_32x32x16_bf16 v[112:127], v[52:55], v[184:187], v[112:127]
 ds_read_b64_tr_b16 v[40:41], v14 offset:7232
 ds_read_b64_tr_b16 v[42:43], v14 offset:8512
 v_lshlrev_b32 v203, 2, v203
 v_lshl_add_u32 v202, v202, 5, v203
 v_mul_u32_u24 v203, 3277, v201
 s_waitcnt lgkmcnt(4)
 v_mfma_f32_32x32x16_bf16 v[128:143], v[56:59], v[184:187], v[128:143]
 ds_read_b64_tr_b16 v[44:45], v14 offset:7296
 ds_read_b64_tr_b16 v[46:47], v14 offset:8576
 v_lshrrev_b32 v203, 16, v203
 v_mul_u32_u24 v204, 3277, v202
 v_lshrrev_b32 v204, 16, v204
 s_waitcnt lgkmcnt(4)
 v_mfma_f32_32x32x16_bf16 v[64:79], v[60:63], v[188:191], v[64:79]
 ds_read_b64_tr_b16 v[48:49], v14 offset:7360
 ds_read_b64_tr_b16 v[50:51], v14 offset:8640
 v_cmp_eq_u32 vcc, v203, v204
 v_mul_u32_u24 v201, 40, v201
 v_lshl_add_u32 v201, v202, 1, v201
 s_waitcnt lgkmcnt(4)
 v_mfma_f32_32x32x16_bf16 v[80:95], v[40:43], v[188:191], v[80:95]
 ds_read_b64_tr_b16 v[52:53], v14 offset:7424
 ds_read_b64_tr_b16 v[54:55], v14 offset:8704
 v_mul_u32_u24 v204, 40, v204
 v_sub_u32 v201, v201, v204
 v_mov_b32 v204, 0x80000000
 s_waitcnt lgkmcnt(4)
 v_mfma_f32_32x32x16_bf16 v[96:111], v[44:47], v[188:191], v[96:111]
 s_waitcnt vmcnt(10)
 s_barrier
 ds_read_b128 v[176:179], v4 offset:32768
 ds_read_b128 v[180:183], v5 offset:32768
 ds_read_b64_tr_b16 v[56:57], v14 offset:24576
 ds_read_b64_tr_b16 v[58:59], v14 offset:25856
 s_add_u32 m0, s35, 45056
 s_add_u32 s37, s88, 860160
 buffer_load_dwordx4 v8, s[40:43], s37 offen lds
 s_waitcnt lgkmcnt(6)
 v_mfma_f32_32x32x16_bf16 v[112:127], v[48:51], v[188:191], v[112:127]
 ds_read_b64_tr_b16 v[60:61], v14 offset:24640
 ds_read_b64_tr_b16 v[62:63], v14 offset:25920
 s_add_u32 m0, s35, 55296
 s_add_u32 s37, s89, 774144
 buffer_load_dwordx4 v9, s[56:59], s37 offen lds
 s_waitcnt lgkmcnt(6)
 v_mfma_f32_32x32x16_bf16 v[128:143], v[52:55], v[188:191], v[128:143]
 ds_read_b64_tr_b16 v[40:41], v14 offset:24704
 ds_read_b64_tr_b16 v[42:43], v14 offset:25984
 s_add_u32 s37, s62, 45056
 s_cmp_lt_u32 s98, 6
 s_cselect_b32 m0, s37, s74
 s_nop 0
 buffer_load_dwordx4 v10, s[80:83], s90 offen lds
 s_add_u32 s90, s90, s63
 s_waitcnt lgkmcnt(4)
 v_mfma_f32_32x32x16_bf16 v[64:79], v[56:59], v[176:179], v[64:79]
 ds_read_b64_tr_b16 v[44:45], v14 offset:24768
 ds_read_b64_tr_b16 v[46:47], v14 offset:26048
 v_cndmask_b32 v201, v204, v201, vcc
 buffer_load_dwordx2 v[148:149], v201, s[68:71], s38 offen
 s_waitcnt lgkmcnt(4)
 v_mfma_f32_32x32x16_bf16 v[80:95], v[60:63], v[176:179], v[80:95]
 ds_read_b64_tr_b16 v[48:49], v14 offset:24832
 ds_read_b64_tr_b16 v[50:51], v14 offset:26112
 v_add_u32 v200, 768, v0
 v_lshrrev_b32 v201, 7, v200
 v_add_u32 v202, 1, v201
 s_waitcnt lgkmcnt(4)
 v_mfma_f32_32x32x16_bf16 v[96:111], v[40:43], v[176:179], v[96:111]
 ds_read_b64_tr_b16 v[52:53], v14 offset:29696
 ds_read_b64_tr_b16 v[54:55], v14 offset:30976
 v_lshrrev_b32 v202, 2, v202
 v_lshlrev_b32 v203, 1, v202
 v_sub_u32 v201, v201, v203
 s_waitcnt lgkmcnt(4)
 v_mfma_f32_32x32x16_bf16 v[112:127], v[44:47], v[176:179], v[112:127]
 ds_read_b64_tr_b16 v[56:57], v14 offset:29760
 ds_read_b64_tr_b16 v[58:59], v14 offset:31040
 v_bfe_u32 v203, v200, 3, 4
 v_lshl_add_u32 v201, v201, 4, v203
 v_and_b32 v203, 7, v200
 s_waitcnt lgkmcnt(4)
 v_mfma_f32_32x32x16_bf16 v[128:143], v[48:51], v[176:179], v[128:143]
 ds_read_b64_tr_b16 v[60:61], v14 offset:29824
 ds_read_b64_tr_b16 v[62:63], v14 offset:31104
 v_lshlrev_b32 v203, 2, v203
 v_lshl_add_u32 v202, v202, 5, v203
 v_mul_u32_u24 v203, 3277, v201
 s_waitcnt lgkmcnt(4)
 v_mfma_f32_32x32x16_bf16 v[64:79], v[52:55], v[180:183], v[64:79]
 ds_read_b64_tr_b16 v[40:41], v14 offset:29888
 ds_read_b64_tr_b16 v[42:43], v14 offset:31168
 v_lshrrev_b32 v203, 16, v203
 v_mul_u32_u24 v204, 3277, v202
 v_lshrrev_b32 v204, 16, v204
 s_waitcnt lgkmcnt(4)
 v_mfma_f32_32x32x16_bf16 v[80:95], v[56:59], v[180:183], v[80:95]
 ds_read_b64_tr_b16 v[44:45], v14 offset:29952
 ds_read_b64_tr_b16 v[46:47], v14 offset:31232
 v_cmp_eq_u32 vcc, v203, v204
 v_mul_u32_u24 v201, 40, v201
 v_lshl_add_u32 v201, v202, 1, v201
 s_waitcnt lgkmcnt(4)
 v_mfma_f32_32x32x16_bf16 v[96:111], v[60:63], v[180:183], v[96:111]
 s_waitcnt vmcnt(10)
 s_barrier
 ds_read_b128 v[184:187], v6 offset:32768
 ds_read_b128 v[188:191], v7 offset:32768
 ds_read_b64_tr_b16 v[48:49], v13 offset:0
 ds_read_b64_tr_b16 v[50:51], v13 offset:1280
 s_add_u32 m0, s35, 67584
 s_add_u32 s37, s88, 983040
 buffer_load_dwordx4 v8, s[40:43], s37 offen lds
 s_waitcnt lgkmcnt(6)
 v_mfma_f32_32x32x16_bf16 v[112:127], v[40:43], v[180:183], v[112:127]
 ds_read_b64_tr_b16 v[52:53], v13 offset:64
 ds_read_b64_tr_b16 v[54:55], v13 offset:1344
 s_add_u32 m0, s35, 77824
 s_add_u32 s37, s89, 884736
 buffer_load_dwordx4 v9, s[56:59], s37 offen lds
 s_waitcnt lgkmcnt(6)
 v_mfma_f32_32x32x16_bf16 v[128:143], v[44:47], v[180:183], v[128:143]
 ds_read_b64_tr_b16 v[56:57], v13 offset:128
 ds_read_b64_tr_b16 v[58:59], v13 offset:1408
 s_add_u32 s37, s62, 67584
 s_cmp_lt_u32 s98, 6
 s_cselect_b32 m0, s37, s74
 s_nop 0
 buffer_load_dwordx4 v10, s[80:83], s90 offen lds
 s_add_u32 s90, s90, s63
 s_waitcnt lgkmcnt(4)
 v_mfma_f32_32x32x16_bf16 v[64:79], v[48:51], v[184:187], v[64:79]
 ds_read_b64_tr_b16 v[60:61], v13 offset:192
 ds_read_b64_tr_b16 v[62:63], v13 offset:1472
 s_add_u32 m0, s36, 16384
 s_movk_i32 s37, 512
 buffer_load_dwordx4 v2, s[4:7], s37 offen lds
 s_waitcnt lgkmcnt(4)
 v_mfma_f32_32x32x16_bf16 v[80:95], v[52:55], v[184:187], v[80:95]
 ds_read_b64_tr_b16 v[40:41], v13 offset:256
 ds_read_b64_tr_b16 v[42:43], v13 offset:1536
 s_add_u32 m0, s36, 17408
 s_movk_i32 s37, 512
 buffer_load_dwordx4 v3, s[4:7], s37 offen lds
 s_waitcnt lgkmcnt(4)
 v_mfma_f32_32x32x16_bf16 v[96:111], v[56:59], v[184:187], v[96:111]
 ds_read_b64_tr_b16 v[44:45], v13 offset:5120
 ds_read_b64_tr_b16 v[46:47], v13 offset:6400
 v_mul_u32_u24 v204, 40, v204
 v_sub_u32 v201, v201, v204
 v_mov_b32 v204, 0x80000000
 s_waitcnt lgkmcnt(4)
 v_mfma_f32_32x32x16_bf16 v[112:127], v[60:63], v[184:187], v[112:127]
 ds_read_b64_tr_b16 v[48:49], v13 offset:5184
 ds_read_b64_tr_b16 v[50:51], v13 offset:6464
 v_cndmask_b32 v201, v204, v201, vcc
 buffer_load_dwordx2 v[150:151], v201, s[68:71], s38 offen
 s_waitcnt lgkmcnt(4)
 v_mfma_f32_32x32x16_bf16 v[128:143], v[40:43], v[184:187], v[128:143]
 ds_read_b64_tr_b16 v[52:53], v13 offset:5248
 ds_read_b64_tr_b16 v[54:55], v13 offset:6528
 v_add_u32 v200, 1024, v0
 v_lshrrev_b32 v201, 7, v200
 v_add_u32 v202, 1, v201
 s_waitcnt lgkmcnt(4)
 v_mfma_f32_32x32x16_bf16 v[64:79], v[44:47], v[188:191], v[64:79]
 ds_read_b64_tr_b16 v[56:57], v13 offset:5312
 ds_read_b64_tr_b16 v[58:59], v13 offset:6592
 v_lshrrev_b32 v202, 2, v202
 v_lshlrev_b32 v203, 1, v202
 v_sub_u32 v201, v201, v203
 s_waitcnt lgkmcnt(4)
 v_mfma_f32_32x32x16_bf16 v[80:95], v[48:51], v[188:191], v[80:95]
 ds_read_b64_tr_b16 v[60:61], v13 offset:5376
 ds_read_b64_tr_b16 v[62:63], v13 offset:6656
 v_bfe_u32 v203, v200, 3, 4
 v_lshl_add_u32 v201, v201, 4, v203
 v_and_b32 v203, 7, v200
 s_waitcnt lgkmcnt(4)
 v_mfma_f32_32x32x16_bf16 v[96:111], v[52:55], v[188:191], v[96:111]
 s_waitcnt vmcnt(10)
 s_barrier
 ds_read_b128 v[176:179], v4 offset:0
 ds_read_b128 v[180:183], v5 offset:0
 ds_read_b64_tr_b16 v[40:41], v13 offset:22528
 ds_read_b64_tr_b16 v[42:43], v13 offset:23808
 s_add_u32 m0, s35, 90112
 s_add_u32 s37, s88, 1105920
 buffer_load_dwordx4 v8, s[40:43], s37 offen lds
 s_waitcnt lgkmcnt(6)
 v_mfma_f32_32x32x16_bf16 v[112:127], v[56:59], v[188:191], v[112:127]
 ds_read_b64_tr_b16 v[44:45], v13 offset:22592
 ds_read_b64_tr_b16 v[46:47], v13 offset:23872
 s_add_u32 m0, s35, 100352
 s_add_u32 s37, s89, 995328
 buffer_load_dwordx4 v9, s[56:59], s37 offen lds
 s_waitcnt lgkmcnt(6)
 v_mfma_f32_32x32x16_bf16 v[128:143], v[60:63], v[188:191], v[128:143]
 ds_read_b64_tr_b16 v[48:49], v13 offset:22656
 ds_read_b64_tr_b16 v[50:51], v13 offset:23936
 s_add_u32 s37, s62, 90112
 s_cmp_lt_u32 s98, 6
 s_cselect_b32 m0, s37, s74
 s_nop 0
 buffer_load_dwordx4 v10, s[80:83], s90 offen lds
 s_add_u32 s90, s90, s63
 s_waitcnt lgkmcnt(4)
 v_mfma_f32_32x32x16_bf16 v[64:79], v[40:43], v[176:179], v[64:79]
 ds_read_b64_tr_b16 v[52:53], v13 offset:22720
 ds_read_b64_tr_b16 v[54:55], v13 offset:24000
 v_lshlrev_b32 v203, 2, v203
 v_lshl_add_u32 v202, v202, 5, v203
 v_mul_u32_u24 v203, 3277, v201
 s_waitcnt lgkmcnt(4)
 v_mfma_f32_32x32x16_bf16 v[80:95], v[44:47], v[176:179], v[80:95]
 ds_read_b64_tr_b16 v[56:57], v13 offset:22784
 ds_read_b64_tr_b16 v[58:59], v13 offset:24064
 v_lshrrev_b32 v203, 16, v203
 v_mul_u32_u24 v204, 3277, v202
 v_lshrrev_b32 v204, 16, v204
 s_waitcnt lgkmcnt(4)
 v_mfma_f32_32x32x16_bf16 v[96:111], v[48:51], v[176:179], v[96:111]
 ds_read_b64_tr_b16 v[60:61], v13 offset:27648
 ds_read_b64_tr_b16 v[62:63], v13 offset:28928
 v_cmp_eq_u32 vcc, v203, v204
 v_mul_u32_u24 v201, 40, v201
 v_lshl_add_u32 v201, v202, 1, v201
 s_waitcnt lgkmcnt(4)
 v_mfma_f32_32x32x16_bf16 v[112:127], v[52:55], v[176:179], v[112:127]
 ds_read_b64_tr_b16 v[40:41], v13 offset:27712
 ds_read_b64_tr_b16 v[42:43], v13 offset:28992
 v_mul_u32_u24 v204, 40, v204
 v_sub_u32 v201, v201, v204
 v_mov_b32 v204, 0x80000000
 s_waitcnt lgkmcnt(4)
 v_mfma_f32_32x32x16_bf16 v[128:143], v[56:59], v[176:179], v[128:143]
 ds_read_b64_tr_b16 v[44:45], v13 offset:27776
 ds_read_b64_tr_b16 v[46:47], v13 offset:29056
 v_cndmask_b32 v201, v204, v201, vcc
 buffer_load_dwordx2 v[152:153], v201, s[68:71], s38 offen
 s_waitcnt lgkmcnt(4)
 v_mfma_f32_32x32x16_bf16 v[64:79], v[60:63], v[180:183], v[64:79]
 ds_read_b64_tr_b16 v[48:49], v13 offset:27840
 ds_read_b64_tr_b16 v[50:51], v13 offset:29120
 v_add_u32 v200, 1280, v0
 v_lshrrev_b32 v201, 7, v200
 v_add_u32 v202, 1, v201
 s_waitcnt lgkmcnt(4)
 v_mfma_f32_32x32x16_bf16 v[80:95], v[40:43], v[180:183], v[80:95]
 ds_read_b64_tr_b16 v[52:53], v13 offset:27904
 ds_read_b64_tr_b16 v[54:55], v13 offset:29184
 v_lshrrev_b32 v202, 2, v202
 v_lshlrev_b32 v203, 1, v202
 v_sub_u32 v201, v201, v203
 s_waitcnt lgkmcnt(4)
 v_mfma_f32_32x32x16_bf16 v[96:111], v[44:47], v[180:183], v[96:111]
 s_waitcnt vmcnt(11)
 s_barrier
 ds_read_b128 v[184:187], v6 offset:0
 ds_read_b128 v[188:191], v7 offset:0
 ds_read_b64_tr_b16 v[56:57], v13 offset:45056
 ds_read_b64_tr_b16 v[58:59], v13 offset:46336
 s_add_u32 m0, s35, 0
 s_add_u32 s37, s88, 1228800
 buffer_load_dwordx4 v8, s[40:43], s37 offen lds
 s_waitcnt lgkmcnt(6)
 v_mfma_f32_32x32x16_bf16 v[112:127], v[48:51], v[180:183], v[112:127]
 ds_read_b64_tr_b16 v[60:61], v13 offset:45120
 ds_read_b64_tr_b16 v[62:63], v13 offset:46400
 s_add_u32 m0, s35, 10240
 s_add_u32 s37, s89, 1105920
 buffer_load_dwordx4 v9, s[56:59], s37 offen lds
 s_waitcnt lgkmcnt(6)
 v_mfma_f32_32x32x16_bf16 v[128:143], v[52:55], v[180:183], v[128:143]
 ds_read_b64_tr_b16 v[40:41], v13 offset:45184
 ds_read_b64_tr_b16 v[42:43], v13 offset:46464
 s_add_u32 s37, s62, 0
 s_cmp_lt_u32 s98, 6
 s_cselect_b32 m0, s37, s74
 s_nop 0
 buffer_load_dwordx4 v10, s[80:83], s90 offen lds
 s_add_u32 s90, s90, s63
 s_waitcnt lgkmcnt(4)
 v_mfma_f32_32x32x16_bf16 v[64:79], v[56:59], v[184:187], v[64:79]
 ds_read_b64_tr_b16 v[44:45], v13 offset:45248
 ds_read_b64_tr_b16 v[46:47], v13 offset:46528
 s_add_u32 m0, s36, 32768
 s_movk_i32 s37, 640
 buffer_load_dwordx4 v2, s[4:7], s37 offen lds
 s_waitcnt lgkmcnt(4)
 v_mfma_f32_32x32x16_bf16 v[80:95], v[60:63], v[184:187], v[80:95]
 ds_read_b64_tr_b16 v[48:49], v13 offset:45312
 ds_read_b64_tr_b16 v[50:51], v13 offset:46592
 s_add_u32 m0, s36, 33792
 s_movk_i32 s37, 640
 buffer_load_dwordx4 v3, s[4:7], s37 offen lds
 s_waitcnt lgkmcnt(4)
 v_mfma_f32_32x32x16_bf16 v[96:111], v[40:43], v[184:187], v[96:111]
 ds_read_b64_tr_b16 v[52:53], v13 offset:50176
 ds_read_b64_tr_b16 v[54:55], v13 offset:51456
 v_bfe_u32 v203, v200, 3, 4
 v_lshl_add_u32 v201, v201, 4, v203
 v_and_b32 v203, 7, v200
 s_waitcnt lgkmcnt(4)
 v_mfma_f32_32x32x16_bf16 v[112:127], v[44:47], v[184:187], v[112:127]
 ds_read_b64_tr_b16 v[56:57], v13 offset:50240
 ds_read_b64_tr_b16 v[58:59], v13 offset:51520
 v_lshlrev_b32 v203, 2, v203
 v_lshl_add_u32 v202, v202, 5, v203
 v_mul_u32_u24 v203, 3277, v201
 s_waitcnt lgkmcnt(4)
 v_mfma_f32_32x32x16_bf16 v[128:143], v[48:51], v[184:187], v[128:143]
 ds_read_b64_tr_b16 v[60:61], v13 offset:50304
 ds_read_b64_tr_b16 v[62:63], v13 offset:51584
 v_lshrrev_b32 v203, 16, v203
 v_mul_u32_u24 v204, 3277, v202
 v_lshrrev_b32 v204, 16, v204
 s_waitcnt lgkmcnt(4)
 v_mfma_f32_32x32x16_bf16 v[64:79], v[52:55], v[188:191], v[64:79]
 ds_read_b64_tr_b16 v[40:41], v13 offset:50368
 ds_read_b64_tr_b16 v[42:43], v13 offset:51648
 v_cmp_eq_u32 vcc, v203, v204
 v_mul_u32_u24 v201, 40, v201
 v_lshl_add_u32 v201, v202, 1, v201
 s_waitcnt lgkmcnt(4)
 v_mfma_f32_32x32x16_bf16 v[80:95], v[56:59], v[188:191], v[80:95]
 ds_read_b64_tr_b16 v[44:45], v13 offset:50432
 ds_read_b64_tr_b16 v[46:47], v13 offset:51712
 v_mul_u32_u24 v204, 40, v204
 v_sub_u32 v201, v201, v204
 v_mov_b32 v204, 0x80000000
 s_waitcnt lgkmcnt(4)
 v_mfma_f32_32x32x16_bf16 v[96:111], v[60:63], v[188:191], v[96:111]
 s_waitcnt vmcnt(10)
 s_barrier
 ds_read_b128 v[176:179], v4 offset:16384
 ds_read_b128 v[180:183], v5 offset:16384
 ds_read_b64_tr_b16 v[48:49], v14 offset:2048
 ds_read_b64_tr_b16 v[50:51], v14 offset:3328
 s_add_u32 m0, s35, 22528
 s_add_u32 s37, s88, 1351680
 buffer_load_dwordx4 v8, s[40:43], s37 offen lds
 s_waitcnt lgkmcnt(6)
 v_mfma_f32_32x32x16_bf16 v[112:127], v[40:43], v[188:191], v[112:127]
 ds_read_b64_tr_b16 v[52:53], v14 offset:2112
 ds_read_b64_tr_b16 v[54:55], v14 offset:3392
 s_add_u32 m0, s35, 32768
 s_add_u32 s37, s89, 1216512
 buffer_load_dwordx4 v9, s[56:59], s37 offen lds
 s_waitcnt lgkmcnt(6)
 v_mfma_f32_32x32x16_bf16 v[128:143], v[44:47], v[188:191], v[128:143]
 ds_read_b64_tr_b16 v[56:57], v14 offset:2176
 ds_read_b64_tr_b16 v[58:59], v14 offset:3456
 s_add_u32 s37, s62, 22528
 s_cmp_lt_u32 s98, 6
 s_cselect_b32 m0, s37, s74
 s_nop 0
 buffer_load_dwordx4 v10, s[80:83], s90 offen lds
 s_add_u32 s90, s90, s63
 s_waitcnt lgkmcnt(4)
 v_mfma_f32_32x32x16_bf16 v[64:79], v[48:51], v[176:179], v[64:79]
 ds_read_b64_tr_b16 v[60:61], v14 offset:2240
 ds_read_b64_tr_b16 v[62:63], v14 offset:3520
 v_cndmask_b32 v201, v204, v201, vcc
 buffer_load_dwordx2 v[154:155], v201, s[68:71], s38 offen
 s_waitcnt lgkmcnt(4)
 v_mfma_f32_32x32x16_bf16 v[80:95], v[52:55], v[176:179], v[80:95]
 ds_read_b64_tr_b16 v[40:41], v14 offset:2304
 ds_read_b64_tr_b16 v[42:43], v14 offset:3584
 v_add_u32 v200, 1536, v0
 v_lshrrev_b32 v201, 7, v200
 v_add_u32 v202, 1, v201
 s_waitcnt lgkmcnt(4)
 v_mfma_f32_32x32x16_bf16 v[96:111], v[56:59], v[176:179], v[96:111]
 ds_read_b64_tr_b16 v[44:45], v14 offset:7168
 ds_read_b64_tr_b16 v[46:47], v14 offset:8448
 v_lshrrev_b32 v202, 2, v202
 v_lshlrev_b32 v203, 1, v202
 v_sub_u32 v201, v201, v203
 s_waitcnt lgkmcnt(4)
 v_mfma_f32_32x32x16_bf16 v[112:127], v[60:63], v[176:179], v[112:127]
 ds_read_b64_tr_b16 v[48:49], v14 offset:7232
 ds_read_b64_tr_b16 v[50:51], v14 offset:8512
 v_bfe_u32 v203, v200, 3, 4
 v_lshl_add_u32 v201, v201, 4, v203
 v_and_b32 v203, 7, v200
 s_waitcnt lgkmcnt(4)
 v_mfma_f32_32x32x16_bf16 v[128:143], v[40:43], v[176:179], v[128:143]
 ds_read_b64_tr_b16 v[52:53], v14 offset:7296
 ds_read_b64_tr_b16 v[54:55], v14 offset:8576
 v_lshlrev_b32 v203, 2, v203
 v_lshl_add_u32 v202, v202, 5, v203
 v_mul_u32_u24 v203, 3277, v201
 s_waitcnt lgkmcnt(4)
 v_mfma_f32_32x32x16_bf16 v[64:79], v[44:47], v[180:183], v[64:79]
 ds_read_b64_tr_b16 v[56:57], v14 offset:7360
 ds_read_b64_tr_b16 v[58:59], v14 offset:8640
 v_lshrrev_b32 v203, 16, v203
 v_mul_u32_u24 v204, 3277, v202
 v_lshrrev_b32 v204, 16, v204
 s_waitcnt lgkmcnt(4)
 v_mfma_f32_32x32x16_bf16 v[80:95], v[48:51], v[180:183], v[80:95]
 ds_read_b64_tr_b16 v[60:61], v14 offset:7424
 ds_read_b64_tr_b16 v[62:63], v14 offset:8704
 v_cmp_eq_u32 vcc, v203, v204
 v_mul_u32_u24 v201, 40, v201
 v_lshl_add_u32 v201, v202, 1, v201
 s_waitcnt lgkmcnt(4)
 v_mfma_f32_32x32x16_bf16 v[96:111], v[52:55], v[180:183], v[96:111]
 s_waitcnt vmcnt(10)
 s_barrier
 ds_read_b128 v[184:187], v6 offset:16384
 ds_read_b128 v[188:191], v7 offset:16384
 ds_read_b64_tr_b16 v[40:41], v14 offset:24576
 ds_read_b64_tr_b16 v[42:43], v14 offset:25856
 s_add_u32 m0, s35, 45056
 s_add_u32 s37, s88, 1474560
 buffer_load_dwordx4 v8, s[40:43], s37 offen lds
 s_waitcnt lgkmcnt(6)
 v_mfma_f32_32x32x16_bf16 v[112:127], v[56:59], v[180:183], v[112:127]
 ds_read_b64_tr_b16 v[44:45], v14 offset:24640
 ds_read_b64_tr_b16 v[46:47], v14 offset:25920
 s_add_u32 m0, s35, 55296
 s_add_u32 s37, s89, 1327104
 buffer_load_dwordx4 v9, s[56:59], s37 offen lds
 s_waitcnt lgkmcnt(6)
 v_mfma_f32_32x32x16_bf16 v[128:143], v[60:63], v[180:183], v[128:143]
 ds_read_b64_tr_b16 v[48:49], v14 offset:24704
 ds_read_b64_tr_b16 v[50:51], v14 offset:25984
 s_add_u32 s37, s62, 45056
 s_cmp_lt_u32 s98, 6
 s_cselect_b32 m0, s37, s74
 s_nop 0
 buffer_load_dwordx4 v10, s[80:83], s90 offen lds
 s_add_u32 s90, s90, s63
 s_waitcnt lgkmcnt(4)
 v_mfma_f32_32x32x16_bf16 v[64:79], v[40:43], v[184:187], v[64:79]
 ds_read_b64_tr_b16 v[52:53], v14 offset:24768
 ds_read_b64_tr_b16 v[54:55], v14 offset:26048
 s_add_u32 m0, s36, 0
 s_movk_i32 s37, 768
 buffer_load_dwordx4 v2, s[4:7], s37 offen lds
 s_waitcnt lgkmcnt(4)
 v_mfma_f32_32x32x16_bf16 v[80:95], v[44:47], v[184:187], v[80:95]
 ds_read_b64_tr_b16 v[56:57], v14 offset:24832
 ds_read_b64_tr_b16 v[58:59], v14 offset:26112
 s_add_u32 m0, s36, 1024
 s_movk_i32 s37, 768
 buffer_load_dwordx4 v3, s[4:7], s37 offen lds
 s_waitcnt lgkmcnt(4)
 v_mfma_f32_32x32x16_bf16 v[96:111], v[48:51], v[184:187], v[96:111]
 ds_read_b64_tr_b16 v[60:61], v14 offset:29696
 ds_read_b64_tr_b16 v[62:63], v14 offset:30976
 v_mul_u32_u24 v204, 40, v204
 v_sub_u32 v201, v201, v204
 v_mov_b32 v204, 0x80000000
 s_waitcnt lgkmcnt(4)
 v_mfma_f32_32x32x16_bf16 v[112:127], v[52:55], v[184:187], v[112:127]
 ds_read_b64_tr_b16 v[40:41], v14 offset:29760
 ds_read_b64_tr_b16 v[42:43], v14 offset:31040
 v_cndmask_b32 v201, v204, v201, vcc
 buffer_load_dwordx2 v[156:157], v201, s[68:71], s38 offen
 s_waitcnt lgkmcnt(4)
 v_mfma_f32_32x32x16_bf16 v[128:143], v[56:59], v[184:187], v[128:143]
 ds_read_b64_tr_b16 v[44:45], v14 offset:29824
 ds_read_b64_tr_b16 v[46:47], v14 offset:31104
 v_add_u32 v200, 1792, v0
 v_lshrrev_b32 v201, 7, v200
 v_add_u32 v202, 1, v201
 s_waitcnt lgkmcnt(4)
 v_mfma_f32_32x32x16_bf16 v[64:79], v[60:63], v[188:191], v[64:79]
 ds_read_b64_tr_b16 v[48:49], v14 offset:29888
 ds_read_b64_tr_b16 v[50:51], v14 offset:31168
 v_lshrrev_b32 v202, 2, v202
 v_lshlrev_b32 v203, 1, v202
 v_sub_u32 v201, v201, v203
 s_waitcnt lgkmcnt(4)
 v_mfma_f32_32x32x16_bf16 v[80:95], v[40:43], v[188:191], v[80:95]
 ds_read_b64_tr_b16 v[52:53], v14 offset:29952
 ds_read_b64_tr_b16 v[54:55], v14 offset:31232
 v_bfe_u32 v203, v200, 3, 4
 v_lshl_add_u32 v201, v201, 4, v203
 v_and_b32 v203, 7, v200
 s_waitcnt lgkmcnt(4)
 v_mfma_f32_32x32x16_bf16 v[96:111], v[44:47], v[188:191], v[96:111]
 s_waitcnt vmcnt(10)
 s_barrier
 ds_read_b128 v[176:179], v4 offset:32768
 ds_read_b128 v[180:183], v5 offset:32768
 ds_read_b64_tr_b16 v[56:57], v13 offset:0
 ds_read_b64_tr_b16 v[58:59], v13 offset:1280
 s_add_u32 m0, s35, 67584
 s_add_u32 s37, s88, 1597440
 buffer_load_dwordx4 v8, s[40:43], s37 offen lds
 s_waitcnt lgkmcnt(6)
 v_mfma_f32_32x32x16_bf16 v[112:127], v[48:51], v[188:191], v[112:127]
 ds_read_b64_tr_b16 v[60:61], v13 offset:64
 ds_read_b64_tr_b16 v[62:63], v13 offset:1344
 s_add_u32 m0, s35, 77824
 s_add_u32 s37, s89, 1437696
 buffer_load_dwordx4 v9, s[56:59], s37 offen lds
 s_waitcnt lgkmcnt(6)
 v_mfma_f32_32x32x16_bf16 v[128:143], v[52:55], v[188:191], v[128:143]
 ds_read_b64_tr_b16 v[40:41], v13 offset:128
 ds_read_b64_tr_b16 v[42:43], v13 offset:1408
 s_add_u32 s37, s62, 67584
 s_cmp_lt_u32 s98, 6
 s_cselect_b32 m0, s37, s74
 s_nop 0
 buffer_load_dwordx4 v10, s[80:83], s90 offen lds
 s_add_u32 s90, s90, s63
 s_waitcnt lgkmcnt(4)
 v_mfma_f32_32x32x16_bf16 v[64:79], v[56:59], v[176:179], v[64:79]
 ds_read_b64_tr_b16 v[44:45], v13 offset:192
 ds_read_b64_tr_b16 v[46:47], v13 offset:1472
 v_lshlrev_b32 v203, 2, v203
 v_lshl_add_u32 v202, v202, 5, v203
 v_mul_u32_u24 v203, 3277, v201
 s_waitcnt lgkmcnt(4)
 v_mfma_f32_32x32x16_bf16 v[80:95], v[60:63], v[176:179], v[80:95]
 ds_read_b64_tr_b16 v[48:49], v13 offset:256
 ds_read_b64_tr_b16 v[50:51], v13 offset:1536
 v_lshrrev_b32 v203, 16, v203
 v_mul_u32_u24 v204, 3277, v202
 v_lshrrev_b32 v204, 16, v204
 s_waitcnt lgkmcnt(4)
 v_mfma_f32_32x32x16_bf16 v[96:111], v[40:43], v[176:179], v[96:111]
 ds_read_b64_tr_b16 v[52:53], v13 offset:5120
 ds_read_b64_tr_b16 v[54:55], v13 offset:6400
 v_cmp_eq_u32 vcc, v203, v204
 v_mul_u32_u24 v201, 40, v201
 v_lshl_add_u32 v201, v202, 1, v201
 s_waitcnt lgkmcnt(4)
 v_mfma_f32_32x32x16_bf16 v[112:127], v[44:47], v[176:179], v[112:127]
 ds_read_b64_tr_b16 v[56:57], v13 offset:5184
 ds_read_b64_tr_b16 v[58:59], v13 offset:6464
 v_mul_u32_u24 v204, 40, v204
 v_sub_u32 v201, v201, v204
 v_mov_b32 v204, 0x80000000
 s_waitcnt lgkmcnt(4)
 v_mfma_f32_32x32x16_bf16 v[128:143], v[48:51], v[176:179], v[128:143]
 ds_read_b64_tr_b16 v[60:61], v13 offset:5248
 ds_read_b64_tr_b16 v[62:63], v13 offset:6528
 v_cndmask_b32 v201, v204, v201, vcc
 buffer_load_dwordx2 v[158:159], v201, s[68:71], s38 offen
 s_waitcnt lgkmcnt(4)
 v_mfma_f32_32x32x16_bf16 v[64:79], v[52:55], v[180:183], v[64:79]
 ds_read_b64_tr_b16 v[40:41], v13 offset:5312
 ds_read_b64_tr_b16 v[42:43], v13 offset:6592
 v_add_u32 v200, 2048, v0
 v_lshrrev_b32 v201, 7, v200
 v_add_u32 v202, 1, v201
 s_waitcnt lgkmcnt(4)
 v_mfma_f32_32x32x16_bf16 v[80:95], v[56:59], v[180:183], v[80:95]
 ds_read_b64_tr_b16 v[44:45], v13 offset:5376
 ds_read_b64_tr_b16 v[46:47], v13 offset:6656
 v_lshrrev_b32 v202, 2, v202
 v_lshlrev_b32 v203, 1, v202
 v_sub_u32 v201, v201, v203
 s_waitcnt lgkmcnt(4)
 v_mfma_f32_32x32x16_bf16 v[96:111], v[60:63], v[180:183], v[96:111]
 s_waitcnt vmcnt(11)
 s_barrier
 ds_read_b128 v[184:187], v6 offset:32768
 ds_read_b128 v[188:191], v7 offset:32768
 ds_read_b64_tr_b16 v[48:49], v13 offset:22528
 ds_read_b64_tr_b16 v[50:51], v13 offset:23808
 s_add_u32 m0, s35, 90112
 s_add_u32 s37, s88, 1720320
 buffer_load_dwordx4 v8, s[40:43], s37 offen lds
 s_waitcnt lgkmcnt(6)
 v_mfma_f32_32x32x16_bf16 v[112:127], v[40:43], v[180:183], v[112:127]
 ds_read_b64_tr_b16 v[52:53], v13 offset:22592
 ds_read_b64_tr_b16 v[54:55], v13 offset:23872
 s_add_u32 m0, s35, 100352
 s_add_u32 s37, s89, 1548288
 buffer_load_dwordx4 v9, s[56:59], s37 offen lds
 s_waitcnt lgkmcnt(6)
 v_mfma_f32_32x32x16_bf16 v[128:143], v[44:47], v[180:183], v[128:143]
 ds_read_b64_tr_b16 v[56:57], v13 offset:22656
 ds_read_b64_tr_b16 v[58:59], v13 offset:23936
 s_add_u32 s37, s62, 90112
 s_cmp_lt_u32 s98, 6
 s_cselect_b32 m0, s37, s74
 s_nop 0
 buffer_load_dwordx4 v10, s[80:83], s90 offen lds
 s_add_u32 s90, s90, s63
 s_waitcnt lgkmcnt(4)
 v_mfma_f32_32x32x16_bf16 v[64:79], v[48:51], v[184:187], v[64:79]
 ds_read_b64_tr_b16 v[60:61], v13 offset:22720
 ds_read_b64_tr_b16 v[62:63], v13 offset:24000
 s_add_u32 m0, s36, 16384
 s_movk_i32 s37, 896
 buffer_load_dwordx4 v2, s[4:7], s37 offen lds
 s_waitcnt lgkmcnt(4)
 v_mfma_f32_32x32x16_bf16 v[80:95], v[52:55], v[184:187], v[80:95]
 ds_read_b64_tr_b16 v[40:41], v13 offset:22784
 ds_read_b64_tr_b16 v[42:43], v13 offset:24064
 s_add_u32 m0, s36, 17408
 s_movk_i32 s37, 896
 buffer_load_dwordx4 v3, s[4:7], s37 offen lds
 s_waitcnt lgkmcnt(4)
 v_mfma_f32_32x32x16_bf16 v[96:111], v[56:59], v[184:187], v[96:111]
 ds_read_b64_tr_b16 v[44:45], v13 offset:27648
 ds_read_b64_tr_b16 v[46:47], v13 offset:28928
 v_bfe_u32 v203, v200, 3, 4
 v_lshl_add_u32 v201, v201, 4, v203
 v_and_b32 v203, 7, v200
 s_waitcnt lgkmcnt(4)
 v_mfma_f32_32x32x16_bf16 v[112:127], v[60:63], v[184:187], v[112:127]
 ds_read_b64_tr_b16 v[48:49], v13 offset:27712
 ds_read_b64_tr_b16 v[50:51], v13 offset:28992
 v_lshlrev_b32 v203, 2, v203
 v_lshl_add_u32 v202, v202, 5, v203
 v_mul_u32_u24 v203, 3277, v201
 s_waitcnt lgkmcnt(4)
 v_mfma_f32_32x32x16_bf16 v[128:143], v[40:43], v[184:187], v[128:143]
 ds_read_b64_tr_b16 v[52:53], v13 offset:27776
 ds_read_b64_tr_b16 v[54:55], v13 offset:29056
 v_lshrrev_b32 v203, 16, v203
 v_mul_u32_u24 v204, 3277, v202
 v_lshrrev_b32 v204, 16, v204
 s_waitcnt lgkmcnt(4)
 v_mfma_f32_32x32x16_bf16 v[64:79], v[44:47], v[188:191], v[64:79]
 ds_read_b64_tr_b16 v[56:57], v13 offset:27840
 ds_read_b64_tr_b16 v[58:59], v13 offset:29120
 v_cmp_eq_u32 vcc, v203, v204
 v_mul_u32_u24 v201, 40, v201
 v_lshl_add_u32 v201, v202, 1, v201
 s_waitcnt lgkmcnt(4)
 v_mfma_f32_32x32x16_bf16 v[80:95], v[48:51], v[188:191], v[80:95]
 ds_read_b64_tr_b16 v[60:61], v13 offset:27904
 ds_read_b64_tr_b16 v[62:63], v13 offset:29184
 v_mul_u32_u24 v204, 40, v204
 v_sub_u32 v201, v201, v204
 v_mov_b32 v204, 0x80000000
 s_waitcnt lgkmcnt(4)
 v_mfma_f32_32x32x16_bf16 v[96:111], v[52:55], v[188:191], v[96:111]
 s_waitcnt vmcnt(10)
 s_barrier
 ds_read_b128 v[176:179], v4 offset:0
 ds_read_b128 v[180:183], v5 offset:0
 ds_read_b64_tr_b16 v[40:41], v13 offset:45056
 ds_read_b64_tr_b16 v[42:43], v13 offset:46336
 s_add_u32 m0, s35, 0
 s_add_u32 s37, s88, 1843200
 buffer_load_dwordx4 v8, s[40:43], s37 offen lds
 s_waitcnt lgkmcnt(6)
 v_mfma_f32_32x32x16_bf16 v[112:127], v[56:59], v[188:191], v[112:127]
 ds_read_b64_tr_b16 v[44:45], v13 offset:45120
 ds_read_b64_tr_b16 v[46:47], v13 offset:46400
 s_add_u32 m0, s35, 10240
 s_add_u32 s37, s89, 1658880
 buffer_load_dwordx4 v9, s[56:59], s37 offen lds
 s_waitcnt lgkmcnt(6)
 v_mfma_f32_32x32x16_bf16 v[128:143], v[60:63], v[188:191], v[128:143]
 ds_read_b64_tr_b16 v[48:49], v13 offset:45184
 ds_read_b64_tr_b16 v[50:51], v13 offset:46464
 s_add_u32 s37, s62, 0
 s_cmp_lt_u32 s98, 6
 s_cselect_b32 m0, s37, s74
 s_nop 0
 buffer_load_dwordx4 v10, s[80:83], s90 offen lds
 s_add_u32 s90, s90, s63
 s_waitcnt lgkmcnt(4)
 v_mfma_f32_32x32x16_bf16 v[64:79], v[40:43], v[176:179], v[64:79]
 ds_read_b64_tr_b16 v[52:53], v13 offset:45248
 ds_read_b64_tr_b16 v[54:55], v13 offset:46528
 v_cndmask_b32 v201, v204, v201, vcc
 buffer_load_dwordx2 v[160:161], v201, s[68:71], s38 offen
 s_waitcnt lgkmcnt(4)
 v_mfma_f32_32x32x16_bf16 v[80:95], v[44:47], v[176:179], v[80:95]
 ds_read_b64_tr_b16 v[56:57], v13 offset:45312
 ds_read_b64_tr_b16 v[58:59], v13 offset:46592
 s_waitcnt lgkmcnt(4)
 v_mfma_f32_32x32x16_bf16 v[96:111], v[48:51], v[176:179], v[96:111]
 ds_read_b64_tr_b16 v[60:61], v13 offset:50176
 ds_read_b64_tr_b16 v[62:63], v13 offset:51456
 s_waitcnt lgkmcnt(4)
 v_mfma_f32_32x32x16_bf16 v[112:127], v[52:55], v[176:179], v[112:127]
 ds_read_b64_tr_b16 v[40:41], v13 offset:50240
 ds_read_b64_tr_b16 v[42:43], v13 offset:51520
 s_waitcnt lgkmcnt(4)
 v_mfma_f32_32x32x16_bf16 v[128:143], v[56:59], v[176:179], v[128:143]
 ds_read_b64_tr_b16 v[44:45], v13 offset:50304
 ds_read_b64_tr_b16 v[46:47], v13 offset:51584
 s_waitcnt lgkmcnt(4)
 v_mfma_f32_32x32x16_bf16 v[64:79], v[60:63], v[180:183], v[64:79]
 ds_read_b64_tr_b16 v[48:49], v13 offset:50368
 ds_read_b64_tr_b16 v[50:51], v13 offset:51648
 s_waitcnt lgkmcnt(4)
 v_mfma_f32_32x32x16_bf16 v[80:95], v[40:43], v[180:183], v[80:95]
 ds_read_b64_tr_b16 v[52:53], v13 offset:50432
 ds_read_b64_tr_b16 v[54:55], v13 offset:51712
 s_waitcnt lgkmcnt(4)
 v_mfma_f32_32x32x16_bf16 v[96:111], v[44:47], v[180:183], v[96:111]
 s_waitcnt vmcnt(10)
 s_barrier
 ds_read_b128 v[184:187], v6 offset:0
 ds_read_b128 v[188:191], v7 offset:0
 ds_read_b64_tr_b16 v[56:57], v14 offset:2048
 ds_read_b64_tr_b16 v[58:59], v14 offset:3328
 s_add_u32 m0, s35, 22528
 s_add_u32 s37, s88, 1966080
 buffer_load_dwordx4 v8, s[40:43], s37 offen lds
 s_waitcnt lgkmcnt(6)
 v_mfma_f32_32x32x16_bf16 v[112:127], v[48:51], v[180:183], v[112:127]
 ds_read_b64_tr_b16 v[60:61], v14 offset:2112
 ds_read_b64_tr_b16 v[62:63], v14 offset:3392
 s_add_u32 m0, s35, 32768
 s_add_u32 s37, s89, 1769472
 buffer_load_dwordx4 v9, s[56:59], s37 offen lds
 s_waitcnt lgkmcnt(6)
 v_mfma_f32_32x32x16_bf16 v[128:143], v[52:55], v[180:183], v[128:143]
 ds_read_b64_tr_b16 v[40:41], v14 offset:2176
 ds_read_b64_tr_b16 v[42:43], v14 offset:3456
 s_add_u32 s37, s62, 22528
 s_cmp_lt_u32 s98, 6
 s_cselect_b32 m0, s37, s74
 s_nop 0
 buffer_load_dwordx4 v10, s[80:83], s90 offen lds
 s_add_u32 s90, s90, s63
 s_waitcnt lgkmcnt(4)
 v_mfma_f32_32x32x16_bf16 v[64:79], v[56:59], v[184:187], v[64:79]
 ds_read_b64_tr_b16 v[44:45], v14 offset:2240
 ds_read_b64_tr_b16 v[46:47], v14 offset:3520
 s_add_u32 m0, s36, 32768
 s_movk_i32 s37, 1024
 buffer_load_dwordx4 v2, s[4:7], s37 offen lds
 s_waitcnt lgkmcnt(4)
 v_mfma_f32_32x32x16_bf16 v[80:95], v[60:63], v[184:187], v[80:95]
 ds_read_b64_tr_b16 v[48:49], v14 offset:2304
 ds_read_b64_tr_b16 v[50:51], v14 offset:3584
 s_add_u32 m0, s36, 33792
 s_movk_i32 s37, 1024
 buffer_load_dwordx4 v3, s[4:7], s37 offen lds
 s_waitcnt lgkmcnt(4)
 v_mfma_f32_32x32x16_bf16 v[96:111], v[40:43], v[184:187], v[96:111]
 ds_read_b64_tr_b16 v[52:53], v14 offset:7168
 ds_read_b64_tr_b16 v[54:55], v14 offset:8448
 s_waitcnt lgkmcnt(4)
 v_mfma_f32_32x32x16_bf16 v[112:127], v[44:47], v[184:187], v[112:127]
 ds_read_b64_tr_b16 v[56:57], v14 offset:7232
 ds_read_b64_tr_b16 v[58:59], v14 offset:8512
 s_waitcnt lgkmcnt(4)
 v_mfma_f32_32x32x16_bf16 v[128:143], v[48:51], v[184:187], v[128:143]
 ds_read_b64_tr_b16 v[60:61], v14 offset:7296
 ds_read_b64_tr_b16 v[62:63], v14 offset:8576
 s_waitcnt lgkmcnt(4)
 v_mfma_f32_32x32x16_bf16 v[64:79], v[52:55], v[188:191], v[64:79]
 ds_read_b64_tr_b16 v[40:41], v14 offset:7360
 ds_read_b64_tr_b16 v[42:43], v14 offset:8640
 s_waitcnt lgkmcnt(4)
 v_mfma_f32_32x32x16_bf16 v[80:95], v[56:59], v[188:191], v[80:95]
 ds_read_b64_tr_b16 v[44:45], v14 offset:7424
 ds_read_b64_tr_b16 v[46:47], v14 offset:8704
 s_waitcnt lgkmcnt(4)
 v_mfma_f32_32x32x16_bf16 v[96:111], v[60:63], v[188:191], v[96:111]
 s_waitcnt vmcnt(9)
 s_barrier
 ds_read_b128 v[176:179], v4 offset:16384
 ds_read_b128 v[180:183], v5 offset:16384
 ds_read_b64_tr_b16 v[48:49], v14 offset:24576
 ds_read_b64_tr_b16 v[50:51], v14 offset:25856
 s_add_u32 m0, s35, 45056
 s_add_u32 s37, s88, 2088960
 buffer_load_dwordx4 v8, s[40:43], s37 offen lds
 s_waitcnt lgkmcnt(6)
 v_mfma_f32_32x32x16_bf16 v[112:127], v[40:43], v[188:191], v[112:127]
 ds_read_b64_tr_b16 v[52:53], v14 offset:24640
 ds_read_b64_tr_b16 v[54:55], v14 offset:25920
 s_add_u32 m0, s35, 55296
 s_add_u32 s37, s89, 1880064
 buffer_load_dwordx4 v9, s[56:59], s37 offen lds
 s_waitcnt lgkmcnt(6)
 v_mfma_f32_32x32x16_bf16 v[128:143], v[44:47], v[188:191], v[128:143]
 ds_read_b64_tr_b16 v[56:57], v14 offset:24704
 ds_read_b64_tr_b16 v[58:59], v14 offset:25984
 s_add_u32 s37, s62, 45056
 s_cmp_lt_u32 s98, 6
 s_cselect_b32 m0, s37, s74
 s_nop 0
 buffer_load_dwordx4 v10, s[80:83], s90 offen lds
 s_add_u32 s90, s90, s63
 s_waitcnt lgkmcnt(4)
 v_mfma_f32_32x32x16_bf16 v[64:79], v[48:51], v[176:179], v[64:79]
 ds_read_b64_tr_b16 v[60:61], v14 offset:24768
 ds_read_b64_tr_b16 v[62:63], v14 offset:26048
 s_waitcnt lgkmcnt(4)
 v_mfma_f32_32x32x16_bf16 v[80:95], v[52:55], v[176:179], v[80:95]
 ds_read_b64_tr_b16 v[40:41], v14 offset:24832
 ds_read_b64_tr_b16 v[42:43], v14 offset:26112
 s_waitcnt lgkmcnt(4)
 v_mfma_f32_32x32x16_bf16 v[96:111], v[56:59], v[176:179], v[96:111]
 ds_read_b64_tr_b16 v[44:45], v14 offset:29696
 ds_read_b64_tr_b16 v[46:47], v14 offset:30976
 s_waitcnt lgkmcnt(4)
 v_mfma_f32_32x32x16_bf16 v[112:127], v[60:63], v[176:179], v[112:127]
 ds_read_b64_tr_b16 v[48:49], v14 offset:29760
 ds_read_b64_tr_b16 v[50:51], v14 offset:31040
 s_waitcnt lgkmcnt(4)
 v_mfma_f32_32x32x16_bf16 v[128:143], v[40:43], v[176:179], v[128:143]
 ds_read_b64_tr_b16 v[52:53], v14 offset:29824
 ds_read_b64_tr_b16 v[54:55], v14 offset:31104
 s_waitcnt lgkmcnt(4)
 v_mfma_f32_32x32x16_bf16 v[64:79], v[44:47], v[180:183], v[64:79]
 ds_read_b64_tr_b16 v[56:57], v14 offset:29888
 ds_read_b64_tr_b16 v[58:59], v14 offset:31168
 s_waitcnt lgkmcnt(4)
 v_mfma_f32_32x32x16_bf16 v[80:95], v[48:51], v[180:183], v[80:95]
 ds_read_b64_tr_b16 v[60:61], v14 offset:29952
 ds_read_b64_tr_b16 v[62:63], v14 offset:31232
 s_waitcnt lgkmcnt(4)
 v_mfma_f32_32x32x16_bf16 v[96:111], v[52:55], v[180:183], v[96:111]
 s_waitcnt vmcnt(9)
 s_barrier
 ds_read_b128 v[184:187], v6 offset:16384
 ds_read_b128 v[188:191], v7 offset:16384
 ds_read_b64_tr_b16 v[40:41], v13 offset:0
 ds_read_b64_tr_b16 v[42:43], v13 offset:1280
 s_add_u32 m0, s35, 67584
 s_add_u32 s37, s88, 2211840
 buffer_load_dwordx4 v8, s[40:43], s37 offen lds
 s_waitcnt lgkmcnt(6)
 v_mfma_f32_32x32x16_bf16 v[112:127], v[56:59], v[180:183], v[112:127]
 ds_read_b64_tr_b16 v[44:45], v13 offset:64
 ds_read_b64_tr_b16 v[46:47], v13 offset:1344
 s_add_u32 m0, s35, 77824
 s_add_u32 s37, s89, 1990656
 buffer_load_dwordx4 v9, s[56:59], s37 offen lds
 s_waitcnt lgkmcnt(6)
 v_mfma_f32_32x32x16_bf16 v[128:143], v[60:63], v[180:183], v[128:143]
 ds_read_b64_tr_b16 v[48:49], v13 offset:128
 ds_read_b64_tr_b16 v[50:51], v13 offset:1408
 s_add_u32 s37, s62, 67584
 s_cmp_lt_u32 s98, 6
 s_cselect_b32 m0, s37, s74
 s_nop 0
 buffer_load_dwordx4 v10, s[80:83], s90 offen lds
 s_add_u32 s90, s90, s63
 s_waitcnt lgkmcnt(4)
 v_mfma_f32_32x32x16_bf16 v[64:79], v[40:43], v[184:187], v[64:79]
 ds_read_b64_tr_b16 v[52:53], v13 offset:192
 ds_read_b64_tr_b16 v[54:55], v13 offset:1472
 s_add_u32 m0, s36, 0
 s_movk_i32 s37, 1152
 buffer_load_dwordx4 v2, s[4:7], s37 offen lds
 s_waitcnt lgkmcnt(4)
 v_mfma_f32_32x32x16_bf16 v[80:95], v[44:47], v[184:187], v[80:95]
 ds_read_b64_tr_b16 v[56:57], v13 offset:256
 ds_read_b64_tr_b16 v[58:59], v13 offset:1536
 s_add_u32 m0, s36, 1024
 s_movk_i32 s37, 1152
 buffer_load_dwordx4 v3, s[4:7], s37 offen lds
 s_waitcnt lgkmcnt(4)
 v_mfma_f32_32x32x16_bf16 v[96:111], v[48:51], v[184:187], v[96:111]
 ds_read_b64_tr_b16 v[60:61], v13 offset:5120
 ds_read_b64_tr_b16 v[62:63], v13 offset:6400
 s_waitcnt lgkmcnt(4)
 v_mfma_f32_32x32x16_bf16 v[112:127], v[52:55], v[184:187], v[112:127]
 ds_read_b64_tr_b16 v[40:41], v13 offset:5184
 ds_read_b64_tr_b16 v[42:43], v13 offset:6464
 s_waitcnt lgkmcnt(4)
 v_mfma_f32_32x32x16_bf16 v[128:143], v[56:59], v[184:187], v[128:143]
 ds_read_b64_tr_b16 v[44:45], v13 offset:5248
 ds_read_b64_tr_b16 v[46:47], v13 offset:6528
 s_waitcnt lgkmcnt(4)
 v_mfma_f32_32x32x16_bf16 v[64:79], v[60:63], v[188:191], v[64:79]
 ds_read_b64_tr_b16 v[48:49], v13 offset:5312
 ds_read_b64_tr_b16 v[50:51], v13 offset:6592
 s_waitcnt lgkmcnt(4)
 v_mfma_f32_32x32x16_bf16 v[80:95], v[40:43], v[188:191], v[80:95]
 ds_read_b64_tr_b16 v[52:53], v13 offset:5376
 ds_read_b64_tr_b16 v[54:55], v13 offset:6656
 s_waitcnt lgkmcnt(4)
 v_mfma_f32_32x32x16_bf16 v[96:111], v[44:47], v[188:191], v[96:111]
 s_waitcnt vmcnt(8)
 s_barrier
 ds_read_b128 v[176:179], v4 offset:32768
 ds_read_b128 v[180:183], v5 offset:32768
 ds_read_b64_tr_b16 v[56:57], v13 offset:22528
 ds_read_b64_tr_b16 v[58:59], v13 offset:23808
 s_add_u32 m0, s35, 90112
 s_add_u32 s37, s88, 2334720
 buffer_load_dwordx4 v8, s[40:43], s37 offen lds
 s_waitcnt lgkmcnt(6)
 v_mfma_f32_32x32x16_bf16 v[112:127], v[48:51], v[188:191], v[112:127]
 ds_read_b64_tr_b16 v[60:61], v13 offset:22592
 ds_read_b64_tr_b16 v[62:63], v13 offset:23872
 s_add_u32 m0, s35, 100352
 s_add_u32 s37, s89, 2101248
 buffer_load_dwordx4 v9, s[56:59], s37 offen lds
 s_waitcnt lgkmcnt(6)
 v_mfma_f32_32x32x16_bf16 v[128:143], v[52:55], v[188:191], v[128:143]
 ds_read_b64_tr_b16 v[40:41], v13 offset:22656
 ds_read_b64_tr_b16 v[42:43], v13 offset:23936
 s_add_u32 s37, s62, 90112
 s_cmp_lt_u32 s98, 6
 s_cselect_b32 m0, s37, s74
 s_nop 0
 buffer_load_dwordx4 v10, s[80:83], s90 offen lds
 s_add_u32 s90, s90, s63
 s_waitcnt lgkmcnt(4)
 v_mfma_f32_32x32x16_bf16 v[64:79], v[56:59], v[176:179], v[64:79]
 ds_read_b64_tr_b16 v[44:45], v13 offset:22720
 ds_read_b64_tr_b16 v[46:47], v13 offset:24000
 s_waitcnt lgkmcnt(4)
 v_mfma_f32_32x32x16_bf16 v[80:95], v[60:63], v[176:179], v[80:95]
 ds_read_b64_tr_b16 v[48:49], v13 offset:22784
 ds_read_b64_tr_b16 v[50:51], v13 offset:24064
 s_waitcnt lgkmcnt(4)
 v_mfma_f32_32x32x16_bf16 v[96:111], v[40:43], v[176:179], v[96:111]
 ds_read_b64_tr_b16 v[52:53], v13 offset:27648
 ds_read_b64_tr_b16 v[54:55], v13 offset:28928
 s_waitcnt lgkmcnt(4)
 v_mfma_f32_32x32x16_bf16 v[112:127], v[44:47], v[176:179], v[112:127]
 ds_read_b64_tr_b16 v[56:57], v13 offset:27712
 ds_read_b64_tr_b16 v[58:59], v13 offset:28992
 s_waitcnt lgkmcnt(4)
 v_mfma_f32_32x32x16_bf16 v[128:143], v[48:51], v[176:179], v[128:143]
 ds_read_b64_tr_b16 v[60:61], v13 offset:27776
 ds_read_b64_tr_b16 v[62:63], v13 offset:29056
 s_waitcnt lgkmcnt(4)
 v_mfma_f32_32x32x16_bf16 v[64:79], v[52:55], v[180:183], v[64:79]
 ds_read_b64_tr_b16 v[40:41], v13 offset:27840
 ds_read_b64_tr_b16 v[42:43], v13 offset:29120
 s_waitcnt lgkmcnt(4)
 v_mfma_f32_32x32x16_bf16 v[80:95], v[56:59], v[180:183], v[80:95]
 ds_read_b64_tr_b16 v[44:45], v13 offset:27904
 ds_read_b64_tr_b16 v[46:47], v13 offset:29184
 s_waitcnt lgkmcnt(4)
 v_mfma_f32_32x32x16_bf16 v[96:111], v[60:63], v[180:183], v[96:111]
 s_waitcnt vmcnt(8)
 s_barrier
 ds_read_b128 v[184:187], v6 offset:32768
 ds_read_b128 v[188:191], v7 offset:32768
 ds_read_b64_tr_b16 v[48:49], v13 offset:45056
 ds_read_b64_tr_b16 v[50:51], v13 offset:46336
 s_waitcnt lgkmcnt(6)
 v_mfma_f32_32x32x16_bf16 v[112:127], v[40:43], v[180:183], v[112:127]
 ds_read_b64_tr_b16 v[52:53], v13 offset:45120
 ds_read_b64_tr_b16 v[54:55], v13 offset:46400
 s_waitcnt lgkmcnt(6)
 v_mfma_f32_32x32x16_bf16 v[128:143], v[44:47], v[180:183], v[128:143]
 ds_read_b64_tr_b16 v[56:57], v13 offset:45184
 ds_read_b64_tr_b16 v[58:59], v13 offset:46464
 s_waitcnt lgkmcnt(4)
 v_mfma_f32_32x32x16_bf16 v[64:79], v[48:51], v[184:187], v[64:79]
 ds_read_b64_tr_b16 v[60:61], v13 offset:45248
 ds_read_b64_tr_b16 v[62:63], v13 offset:46528
 s_waitcnt lgkmcnt(4)
 v_mfma_f32_32x32x16_bf16 v[80:95], v[52:55], v[184:187], v[80:95]
 ds_read_b64_tr_b16 v[40:41], v13 offset:45312
 ds_read_b64_tr_b16 v[42:43], v13 offset:46592
 s_waitcnt lgkmcnt(4)
 v_mfma_f32_32x32x16_bf16 v[96:111], v[56:59], v[184:187], v[96:111]
 ds_read_b64_tr_b16 v[44:45], v13 offset:50176
 ds_read_b64_tr_b16 v[46:47], v13 offset:51456
 s_waitcnt lgkmcnt(4)
 v_mfma_f32_32x32x16_bf16 v[112:127], v[60:63], v[184:187], v[112:127]
 ds_read_b64_tr_b16 v[48:49], v13 offset:50240
 ds_read_b64_tr_b16 v[50:51], v13 offset:51520
 s_waitcnt lgkmcnt(4)
 v_mfma_f32_32x32x16_bf16 v[128:143], v[40:43], v[184:187], v[128:143]
 ds_read_b64_tr_b16 v[52:53], v13 offset:50304
 ds_read_b64_tr_b16 v[54:55], v13 offset:51584
 s_waitcnt lgkmcnt(4)
 v_mfma_f32_32x32x16_bf16 v[64:79], v[44:47], v[188:191], v[64:79]
 ds_read_b64_tr_b16 v[56:57], v13 offset:50368
 ds_read_b64_tr_b16 v[58:59], v13 offset:51648
 s_waitcnt lgkmcnt(4)
 v_mfma_f32_32x32x16_bf16 v[80:95], v[48:51], v[188:191], v[80:95]
 ds_read_b64_tr_b16 v[60:61], v13 offset:50432
 ds_read_b64_tr_b16 v[62:63], v13 offset:51712
 s_waitcnt lgkmcnt(4)
 v_mfma_f32_32x32x16_bf16 v[96:111], v[52:55], v[188:191], v[96:111]
 s_waitcnt vmcnt(3)
 s_barrier
 ds_read_b128 v[176:179], v4 offset:0
 ds_read_b128 v[180:183], v5 offset:0
 ds_read_b64_tr_b16 v[40:41], v14 offset:2048
 ds_read_b64_tr_b16 v[42:43], v14 offset:3328
 s_waitcnt lgkmcnt(6)
 v_mfma_f32_32x32x16_bf16 v[112:127], v[56:59], v[188:191], v[112:127]
 ds_read_b64_tr_b16 v[44:45], v14 offset:2112
 ds_read_b64_tr_b16 v[46:47], v14 offset:3392
 s_waitcnt lgkmcnt(6)
 v_mfma_f32_32x32x16_bf16 v[128:143], v[60:63], v[188:191], v[128:143]
 ds_read_b64_tr_b16 v[48:49], v14 offset:2176
 ds_read_b64_tr_b16 v[50:51], v14 offset:3456
 s_waitcnt lgkmcnt(4)
 v_mfma_f32_32x32x16_bf16 v[64:79], v[40:43], v[176:179], v[64:79]
 ds_read_b64_tr_b16 v[52:53], v14 offset:2240
 ds_read_b64_tr_b16 v[54:55], v14 offset:3520
 s_waitcnt lgkmcnt(4)
 v_mfma_f32_32x32x16_bf16 v[80:95], v[44:47], v[176:179], v[80:95]
 ds_read_b64_tr_b16 v[56:57], v14 offset:2304
 ds_read_b64_tr_b16 v[58:59], v14 offset:3584
 s_waitcnt lgkmcnt(4)
 v_mfma_f32_32x32x16_bf16 v[96:111], v[48:51], v[176:179], v[96:111]
 ds_read_b64_tr_b16 v[60:61], v14 offset:7168
 ds_read_b64_tr_b16 v[62:63], v14 offset:8448
 s_waitcnt lgkmcnt(4)
 v_mfma_f32_32x32x16_bf16 v[112:127], v[52:55], v[176:179], v[112:127]
 ds_read_b64_tr_b16 v[40:41], v14 offset:7232
 ds_read_b64_tr_b16 v[42:43], v14 offset:8512
 s_waitcnt lgkmcnt(4)
 v_mfma_f32_32x32x16_bf16 v[128:143], v[56:59], v[176:179], v[128:143]
 ds_read_b64_tr_b16 v[44:45], v14 offset:7296
 ds_read_b64_tr_b16 v[46:47], v14 offset:8576
 s_waitcnt lgkmcnt(4)
 v_mfma_f32_32x32x16_bf16 v[64:79], v[60:63], v[180:183], v[64:79]
 ds_read_b64_tr_b16 v[48:49], v14 offset:7360
 ds_read_b64_tr_b16 v[50:51], v14 offset:8640
 s_waitcnt lgkmcnt(4)
 v_mfma_f32_32x32x16_bf16 v[80:95], v[40:43], v[180:183], v[80:95]
 ds_read_b64_tr_b16 v[52:53], v14 offset:7424
 ds_read_b64_tr_b16 v[54:55], v14 offset:8704
 s_waitcnt lgkmcnt(4)
 v_mfma_f32_32x32x16_bf16 v[96:111], v[44:47], v[180:183], v[96:111]
 s_waitcnt vmcnt(0)
 s_barrier
 ds_read_b128 v[184:187], v6 offset:0
 ds_read_b128 v[188:191], v7 offset:0
 ds_read_b64_tr_b16 v[56:57], v14 offset:24576
 ds_read_b64_tr_b16 v[58:59], v14 offset:25856
 s_waitcnt lgkmcnt(6)
 v_mfma_f32_32x32x16_bf16 v[112:127], v[48:51], v[180:183], v[112:127]
 ds_read_b64_tr_b16 v[60:61], v14 offset:24640
 ds_read_b64_tr_b16 v[62:63], v14 offset:25920
 s_waitcnt lgkmcnt(6)
 v_mfma_f32_32x32x16_bf16 v[128:143], v[52:55], v[180:183], v[128:143]
 ds_read_b64_tr_b16 v[40:41], v14 offset:24704
 ds_read_b64_tr_b16 v[42:43], v14 offset:25984
 s_waitcnt lgkmcnt(4)
 v_mfma_f32_32x32x16_bf16 v[64:79], v[56:59], v[184:187], v[64:79]
 ds_read_b64_tr_b16 v[44:45], v14 offset:24768
 ds_read_b64_tr_b16 v[46:47], v14 offset:26048
 s_waitcnt lgkmcnt(4)
 v_mfma_f32_32x32x16_bf16 v[80:95], v[60:63], v[184:187], v[80:95]
 ds_read_b64_tr_b16 v[48:49], v14 offset:24832
 ds_read_b64_tr_b16 v[50:51], v14 offset:26112
 s_waitcnt lgkmcnt(4)
 v_mfma_f32_32x32x16_bf16 v[96:111], v[40:43], v[184:187], v[96:111]
 ds_read_b64_tr_b16 v[52:53], v14 offset:29696
 ds_read_b64_tr_b16 v[54:55], v14 offset:30976
 s_waitcnt lgkmcnt(4)
 v_mfma_f32_32x32x16_bf16 v[112:127], v[44:47], v[184:187], v[112:127]
 ds_read_b64_tr_b16 v[56:57], v14 offset:29760
 ds_read_b64_tr_b16 v[58:59], v14 offset:31040
 s_waitcnt lgkmcnt(4)
 v_mfma_f32_32x32x16_bf16 v[128:143], v[48:51], v[184:187], v[128:143]
 ds_read_b64_tr_b16 v[60:61], v14 offset:29824
 ds_read_b64_tr_b16 v[62:63], v14 offset:31104
 s_waitcnt lgkmcnt(4)
 v_mfma_f32_32x32x16_bf16 v[64:79], v[52:55], v[188:191], v[64:79]
 ds_read_b64_tr_b16 v[40:41], v14 offset:29888
 ds_read_b64_tr_b16 v[42:43], v14 offset:31168
 s_waitcnt lgkmcnt(4)
 v_mfma_f32_32x32x16_bf16 v[80:95], v[56:59], v[188:191], v[80:95]
 ds_read_b64_tr_b16 v[44:45], v14 offset:29952
 ds_read_b64_tr_b16 v[46:47], v14 offset:31232
 s_waitcnt lgkmcnt(4)
 v_mfma_f32_32x32x16_bf16 v[96:111], v[60:63], v[188:191], v[96:111]
 s_waitcnt lgkmcnt(2)
 v_mfma_f32_32x32x16_bf16 v[112:127], v[40:43], v[188:191], v[112:127]
 s_waitcnt lgkmcnt(0)
 v_mfma_f32_32x32x16_bf16 v[128:143], v[44:47], v[188:191], v[128:143]
 s_waitcnt lgkmcnt(0)
 s_barrier
 v_lshlrev_b32 v176, 3, v0
 v_add_u32 v176, 0, v176
 ds_write_b64 v176, v[144:145] offset:0
 ds_write_b64 v176, v[146:147] offset:2048
 ds_write_b64 v176, v[148:149] offset:4096
 ds_write_b64 v176, v[150:151] offset:6144
 ds_write_b64 v176, v[152:153] offset:8192
 ds_write_b64 v176, v[154:155] offset:10240
 ds_write_b64 v176, v[156:157] offset:12288
 ds_write_b64 v176, v[158:159] offset:14336
 ds_write_b64 v176, v[160:161] offset:16384
 s_waitcnt lgkmcnt(0)
 v_cvt_pk_bf16_f32 v64, v64, v65
 v_cvt_pk_bf16_f32 v65, v66, v67
 v_cvt_pk_bf16_f32 v66, v68, v69
 v_cvt_pk_bf16_f32 v67, v70, v71
 v_cvt_pk_bf16_f32 v72, v72, v73
 v_cvt_pk_bf16_f32 v73, v74, v75
 v_cvt_pk_bf16_f32 v74, v76, v77
 v_cvt_pk_bf16_f32 v75, v78, v79
 v_cvt_pk_bf16_f32 v80, v80, v81
 v_cvt_pk_bf16_f32 v81, v82, v83
 v_cvt_pk_bf16_f32 v82, v84, v85
 v_cvt_pk_bf16_f32 v83, v86, v87
 v_cvt_pk_bf16_f32 v88, v88, v89
 v_cvt_pk_bf16_f32 v89, v90, v91
 v_cvt_pk_bf16_f32 v90, v92, v93
 v_cvt_pk_bf16_f32 v91, v94, v95
 v_cvt_pk_bf16_f32 v96, v96, v97
 v_cvt_pk_bf16_f32 v97, v98, v99
 v_cvt_pk_bf16_f32 v98, v100, v101
 v_cvt_pk_bf16_f32 v99, v102, v103
 v_cvt_pk_bf16_f32 v104, v104, v105
 v_cvt_pk_bf16_f32 v105, v106, v107
 v_cvt_pk_bf16_f32 v106, v108, v109
 v_cvt_pk_bf16_f32 v107, v110, v111
 v_cvt_pk_bf16_f32 v112, v112, v113
 v_cvt_pk_bf16_f32 v113, v114, v115
 v_cvt_pk_bf16_f32 v114, v116, v117
 v_cvt_pk_bf16_f32 v115, v118, v119
 v_cvt_pk_bf16_f32 v120, v120, v121
 v_cvt_pk_bf16_f32 v121, v122, v123
 v_cvt_pk_bf16_f32 v122, v124, v125
 v_cvt_pk_bf16_f32 v123, v126, v127
 v_cvt_pk_bf16_f32 v128, v128, v129
 v_cvt_pk_bf16_f32 v129, v130, v131
 v_cvt_pk_bf16_f32 v130, v132, v133
 v_cvt_pk_bf16_f32 v131, v134, v135
 v_cvt_pk_bf16_f32 v136, v136, v137
 v_cvt_pk_bf16_f32 v137, v138, v139
 v_cvt_pk_bf16_f32 v138, v140, v141
 v_cvt_pk_bf16_f32 v139, v142, v143
 s_barrier
 ds_read_b64_tr_b16 v[232:233], v27 offset:0
 ds_read_b64_tr_b16 v[234:235], v27 offset:512
 ds_read_b64_tr_b16 v[236:237], v27 offset:1024
 ds_read_b64_tr_b16 v[238:239], v27 offset:1536
 ds_read_b64_tr_b16 v[240:241], v27 offset:2048
 ds_read_b64_tr_b16 v[242:243], v27 offset:2560
 s_waitcnt lgkmcnt(4)
 v_mfma_f32_32x32x16_bf16 v[144:159], v[232:235], v[64:67], 0
 ds_read_b64_tr_b16 v[232:233], v27 offset:3072
 ds_read_b64_tr_b16 v[234:235], v27 offset:3584
 s_waitcnt lgkmcnt(4)
 v_mfma_f32_32x32x16_bf16 v[144:159], v[236:239], v[72:75], v[144:159]
 ds_read_b64_tr_b16 v[236:237], v27 offset:4096
 ds_read_b64_tr_b16 v[238:239], v27 offset:4608
 s_waitcnt lgkmcnt(4)
 v_mfma_f32_32x32x16_bf16 v[144:159], v[240:243], v[80:83], v[144:159]
 ds_read_b64_tr_b16 v[240:241], v27 offset:5120
 ds_read_b64_tr_b16 v[242:243], v27 offset:5632
 s_waitcnt lgkmcnt(4)
 v_mfma_f32_32x32x16_bf16 v[160:175], v[232:235], v[72:75], 0
 ds_read_b64_tr_b16 v[232:233], v27 offset:6144
 ds_read_b64_tr_b16 v[234:235], v27 offset:6656
 s_waitcnt lgkmcnt(4)
 v_mfma_f32_32x32x16_bf16 v[160:175], v[236:239], v[80:83], v[160:175]
 s_nop 3
 v_cvt_pk_bf16_f32 v144, v144, v145
 v_cvt_pk_bf16_f32 v145, v146, v147
 v_cvt_pk_bf16_f32 v148, v148, v149
 v_cvt_pk_bf16_f32 v149, v150, v151
 v_cvt_pk_bf16_f32 v152, v152, v153
 v_cvt_pk_bf16_f32 v153, v154, v155
 v_cvt_pk_bf16_f32 v156, v156, v157
 v_cvt_pk_bf16_f32 v157, v158, v159
 ds_write_b64 v28, v[144:145] offset:0
 ds_write_b64 v28, v[148:149] offset:16
 ds_write_b64 v28, v[152:153] offset:32
 ds_write_b64 v28, v[156:157] offset:48
 ds_read_b64_tr_b16 v[236:237], v27 offset:7168
 ds_read_b64_tr_b16 v[238:239], v27 offset:7680
 s_waitcnt lgkmcnt(8)
 v_mfma_f32_32x32x16_bf16 v[160:175], v[240:243], v[88:91], v[160:175]
 ds_read_b64_tr_b16 v[240:241], v27 offset:8192
 ds_read_b64_tr_b16 v[242:243], v27 offset:8704
 s_waitcnt lgkmcnt(8)
 v_mfma_f32_32x32x16_bf16 v[160:175], v[232:235], v[96:99], v[160:175]
 ds_read_b64_tr_b16 v[232:233], v27 offset:9216
 ds_read_b64_tr_b16 v[234:235], v27 offset:9728
 s_waitcnt lgkmcnt(4)
 v_mfma_f32_32x32x16_bf16 v[144:159], v[236:239], v[88:91], 0
 ds_read_b64_tr_b16 v[236:237], v27 offset:10240
 ds_read_b64_tr_b16 v[238:239], v27 offset:10752
 s_waitcnt lgkmcnt(4)
 v_mfma_f32_32x32x16_bf16 v[144:159], v[240:243], v[96:99], v[144:159]
 s_nop 3
 v_cvt_pk_bf16_f32 v160, v160, v161
 v_cvt_pk_bf16_f32 v161, v162, v163
 v_cvt_pk_bf16_f32 v164, v164, v165
 v_cvt_pk_bf16_f32 v165, v166, v167
 v_cvt_pk_bf16_f32 v168, v168, v169
 v_cvt_pk_bf16_f32 v169, v170, v171
 v_cvt_pk_bf16_f32 v172, v172, v173
 v_cvt_pk_bf16_f32 v173, v174, v175
 ds_write_b64 v28, v[160:161] offset:64
 ds_write_b64 v28, v[164:165] offset:80
 ds_write_b64 v28, v[168:169] offset:96
 ds_write_b64 v28, v[172:173] offset:112
 ds_read_b64_tr_b16 v[240:241], v27 offset:11264
 ds_read_b64_tr_b16 v[242:243], v27 offset:11776
 s_waitcnt lgkmcnt(8)
 v_mfma_f32_32x32x16_bf16 v[144:159], v[232:235], v[104:107], v[144:159]
 ds_read_b64_tr_b16 v[232:233], v27 offset:12288
 ds_read_b64_tr_b16 v[234:235], v27 offset:12800
 s_waitcnt lgkmcnt(8)
 v_mfma_f32_32x32x16_bf16 v[144:159], v[236:239], v[112:115], v[144:159]
 ds_read_b64_tr_b16 v[236:237], v27 offset:13312
 ds_read_b64_tr_b16 v[238:239], v27 offset:13824
 s_waitcnt lgkmcnt(4)
 v_mfma_f32_32x32x16_bf16 v[160:175], v[240:243], v[104:107], 0
 ds_read_b64_tr_b16 v[240:241], v27 offset:14336
 ds_read_b64_tr_b16 v[242:243], v27 offset:14848
 s_waitcnt lgkmcnt(4)
 v_mfma_f32_32x32x16_bf16 v[160:175], v[232:235], v[112:115], v[160:175]
 s_nop 3
 v_cvt_pk_bf16_f32 v144, v144, v145
 v_cvt_pk_bf16_f32 v145, v146, v147
 v_cvt_pk_bf16_f32 v148, v148, v149
 v_cvt_pk_bf16_f32 v149, v150, v151
 v_cvt_pk_bf16_f32 v152, v152, v153
 v_cvt_pk_bf16_f32 v153, v154, v155
 v_cvt_pk_bf16_f32 v156, v156, v157
 v_cvt_pk_bf16_f32 v157, v158, v159
 ds_write_b64 v28, v[144:145] offset:128
 ds_write_b64 v28, v[148:149] offset:144
 ds_write_b64 v28, v[152:153] offset:160
 ds_write_b64 v28, v[156:157] offset:176
 ds_read_b64_tr_b16 v[232:233], v27 offset:15360
 ds_read_b64_tr_b16 v[234:235], v27 offset:15872
 s_waitcnt lgkmcnt(8)
 v_mfma_f32_32x32x16_bf16 v[160:175], v[236:239], v[120:123], v[160:175]
 ds_read_b64_tr_b16 v[236:237], v27 offset:16384
 ds_read_b64_tr_b16 v[238:239], v27 offset:16896
 s_waitcnt lgkmcnt(8)
 v_mfma_f32_32x32x16_bf16 v[160:175], v[240:243], v[128:131], v[160:175]
 ds_read_b64_tr_b16 v[240:241], v27 offset:17408
 ds_read_b64_tr_b16 v[242:243], v27 offset:17920
 s_waitcnt lgkmcnt(4)
 v_mfma_f32_32x32x16_bf16 v[144:159], v[232:235], v[120:123], 0
 s_waitcnt lgkmcnt(2)
 v_mfma_f32_32x32x16_bf16 v[144:159], v[236:239], v[128:131], v[144:159]
 s_nop 5
 v_cvt_pk_bf16_f32 v160, v160, v161
 v_cvt_pk_bf16_f32 v161, v162, v163
 v_cvt_pk_bf16_f32 v164, v164, v165
 v_cvt_pk_bf16_f32 v165, v166, v167
 v_cvt_pk_bf16_f32 v168, v168, v169
 v_cvt_pk_bf16_f32 v169, v170, v171
 v_cvt_pk_bf16_f32 v172, v172, v173
 v_cvt_pk_bf16_f32 v173, v174, v175
 ds_write_b64 v28, v[160:161] offset:192
 ds_write_b64 v28, v[164:165] offset:208
 ds_write_b64 v28, v[168:169] offset:224
 ds_write_b64 v28, v[172:173] offset:240
 s_waitcnt lgkmcnt(4)
 v_mfma_f32_32x32x16_bf16 v[144:159], v[240:243], v[136:139], v[144:159]
 s_nop 11
 v_cvt_pk_bf16_f32 v144, v144, v145
 v_cvt_pk_bf16_f32 v145, v146, v147
 v_cvt_pk_bf16_f32 v148, v148, v149
 v_cvt_pk_bf16_f32 v149, v150, v151
 v_cvt_pk_bf16_f32 v152, v152, v153
 v_cvt_pk_bf16_f32 v153, v154, v155
 v_cvt_pk_bf16_f32 v156, v156, v157
 v_cvt_pk_bf16_f32 v157, v158, v159
 ds_write_b64 v28, v[144:145] offset:256
 ds_write_b64 v28, v[148:149] offset:272
 ds_write_b64 v28, v[152:153] offset:288
 ds_write_b64 v28, v[156:157] offset:304
 s_lshl_b32 s24, s21, 1
 s_lshr_b32 s25, s20, 1
 s_add_u32 s24, s24, s25
 s_mul_i32 s73, s24, 81920
 s_and_b32 s25, s20, 1
 s_mul_i32 s25, s25, 1280
 s_add_u32 s73, s73, s25
 s_mul_i32 s24, s22, 20480
 s_add_u32 s73, s73, s24
 s_add_u32 s73, s73, 7340032
 s_mul_i32 s24, s20, 10752
 s_add_u32 s24, s24, 20480
 v_add_u32 v35, 0, v1
 v_min_u32 v36, 159, v35
 v_mul_u32_u24 v37, 13108, v36
 v_lshrrev_b32 v37, 16, v37
 v_mul_u32_u24 v226, 5, v37
 v_sub_u32 v36, v36, v226
 v_mul_u32_u24 v37, 336, v37
 v_lshl_add_u32 v37, v36, 3, v37
 v_add_u32 v226, s24, v37
 v_lshlrev_b32 v229, 3, v35
 v_add_u32 v35, 64, v1
 v_min_u32 v36, 159, v35
 v_mul_u32_u24 v37, 13108, v36
 v_lshrrev_b32 v37, 16, v37
 v_mul_u32_u24 v227, 5, v37
 v_sub_u32 v36, v36, v227
 v_mul_u32_u24 v37, 336, v37
 v_lshl_add_u32 v37, v36, 3, v37
 v_add_u32 v227, s24, v37
 v_lshlrev_b32 v230, 3, v35
 v_add_u32 v35, 128, v1
 v_min_u32 v36, 159, v35
 v_mul_u32_u24 v37, 13108, v36
 v_lshrrev_b32 v37, 16, v37
 v_mul_u32_u24 v228, 5, v37
 v_sub_u32 v36, v36, v228
 v_mul_u32_u24 v37, 336, v37
 v_lshl_add_u32 v37, v36, 3, v37
 v_add_u32 v228, s24, v37
 v_lshlrev_b32 v231, 3, v35
 v_mov_b32 v36, 0x80000000
 v_cmp_gt_u32 vcc, 160, v35
 s_nop 1
 v_cndmask_b32 v231, v36, v231, vcc
 s_waitcnt lgkmcnt(0)
 ds_read_b64 v[176:177], v226 offset:0
 ds_read_b64 v[178:179], v227 offset:0
 ds_read_b64 v[180:181], v228 offset:0
 ds_read_b64 v[182:183], v226 offset:40
 ds_read_b64 v[184:185], v227 offset:40
 ds_read_b64 v[186:187], v228 offset:40
 ds_read_b64 v[188:189], v226 offset:80
 ds_read_b64 v[190:191], v227 offset:80
 ds_read_b64 v[192:193], v228 offset:80
 ds_read_b64 v[194:195], v226 offset:120
 ds_read_b64 v[196:197], v227 offset:120
 ds_read_b64 v[198:199], v228 offset:120
 ds_read_b64 v[200:201], v226 offset:160
 ds_read_b64 v[202:203], v227 offset:160
 ds_read_b64 v[204:205], v228 offset:160
 ds_read_b64 v[206:207], v226 offset:200
 ds_read_b64 v[208:209], v227 offset:200
 ds_read_b64 v[210:211], v228 offset:200
 ds_read_b64 v[212:213], v226 offset:240
 ds_read_b64 v[214:215], v227 offset:240
 ds_read_b64 v[216:217], v228 offset:240
 ds_read_b64 v[218:219], v226 offset:280
 ds_read_b64 v[220:221], v227 offset:280
 ds_read_b64 v[222:223], v228 offset:280
 s_add_u32 s38, s73, 0
 s_waitcnt lgkmcnt(15)
 buffer_store_dwordx2 v[176:177], v229, s[16:19], s38 offen sc0 sc1
 buffer_store_dwordx2 v[178:179], v230, s[16:19], s38 offen sc0 sc1
 buffer_store_dwordx2 v[180:181], v231, s[16:19], s38 offen sc0 sc1
 s_add_u32 s38, s73, 2560
 buffer_store_dwordx2 v[182:183], v229, s[16:19], s38 offen sc0 sc1
 buffer_store_dwordx2 v[184:185], v230, s[16:19], s38 offen sc0 sc1
 buffer_store_dwordx2 v[186:187], v231, s[16:19], s38 offen sc0 sc1
 s_add_u32 s38, s73, 5120
 buffer_store_dwordx2 v[188:189], v229, s[16:19], s38 offen sc0 sc1
 buffer_store_dwordx2 v[190:191], v230, s[16:19], s38 offen sc0 sc1
 buffer_store_dwordx2 v[192:193], v231, s[16:19], s38 offen sc0 sc1
 s_add_u32 s38, s73, 7680
 s_waitcnt lgkmcnt(14)
 buffer_store_dwordx2 v[194:195], v229, s[16:19], s38 offen sc0 sc1
 s_waitcnt lgkmcnt(13)
 buffer_store_dwordx2 v[196:197], v230, s[16:19], s38 offen sc0 sc1
 s_waitcnt lgkmcnt(12)
 buffer_store_dwordx2 v[198:199], v231, s[16:19], s38 offen sc0 sc1
 s_add_u32 s38, s73, 10240
 s_waitcnt lgkmcnt(11)
 buffer_store_dwordx2 v[200:201], v229, s[16:19], s38 offen sc0 sc1
 s_waitcnt lgkmcnt(10)
 buffer_store_dwordx2 v[202:203], v230, s[16:19], s38 offen sc0 sc1
 s_waitcnt lgkmcnt(9)
 buffer_store_dwordx2 v[204:205], v231, s[16:19], s38 offen sc0 sc1
 s_add_u32 s38, s73, 12800
 s_waitcnt lgkmcnt(8)
 buffer_store_dwordx2 v[206:207], v229, s[16:19], s38 offen sc0 sc1
 s_waitcnt lgkmcnt(7)
 buffer_store_dwordx2 v[208:209], v230, s[16:19], s38 offen sc0 sc1
 s_waitcnt lgkmcnt(6)
 buffer_store_dwordx2 v[210:211], v231, s[16:19], s38 offen sc0 sc1
 s_add_u32 s38, s73, 15360
 s_waitcnt lgkmcnt(5)
 buffer_store_dwordx2 v[212:213], v229, s[16:19], s38 offen sc0 sc1
 s_waitcnt lgkmcnt(4)
 buffer_store_dwordx2 v[214:215], v230, s[16:19], s38 offen sc0 sc1
 s_waitcnt lgkmcnt(3)
 buffer_store_dwordx2 v[216:217], v231, s[16:19], s38 offen sc0 sc1
 s_add_u32 s38, s73, 17920
 s_waitcnt lgkmcnt(2)
 buffer_store_dwordx2 v[218:219], v229, s[16:19], s38 offen sc0 sc1
 s_waitcnt lgkmcnt(1)
 buffer_store_dwordx2 v[220:221], v230, s[16:19], s38 offen sc0 sc1
 s_waitcnt lgkmcnt(0)
 buffer_store_dwordx2 v[222:223], v231, s[16:19], s38 offen sc0 sc1
 s_endpgm
L3_Q_h1:
 s_and_b32 s74, s35, 1024
 s_add_u32 s74, s74, 161792
 s_add_u32 m0, s36, 0
 s_movk_i32 s37, 0
 buffer_load_dwordx4 v2, s[4:7], s37 offen lds
 s_add_u32 m0, s36, 1024
 s_movk_i32 s37, 0
 buffer_load_dwordx4 v3, s[4:7], s37 offen lds
 s_add_u32 m0, s35, 0
 s_add_u32 s37, s88, 0
 buffer_load_dwordx4 v8, s[40:43], s37 offen lds
 s_add_u32 m0, s35, 10240
 s_add_u32 s37, s89, 0
 buffer_load_dwordx4 v9, s[56:59], s37 offen lds
 s_add_u32 s37, s62, 0
 s_cmp_lt_u32 s98, 6
 s_cselect_b32 m0, s37, s74
 s_nop 0
 buffer_load_dwordx4 v10, s[80:83], s90 offen lds
 s_add_u32 s90, s90, s63
 s_add_u32 m0, s35, 22528
 s_add_u32 s37, s88, 122880
 buffer_load_dwordx4 v8, s[40:43], s37 offen lds
 s_add_u32 m0, s35, 32768
 s_add_u32 s37, s89, 110592
 buffer_load_dwordx4 v9, s[56:59], s37 offen lds
 s_add_u32 s37, s62, 22528
 s_cmp_lt_u32 s98, 6
 s_cselect_b32 m0, s37, s74
 s_nop 0
 buffer_load_dwordx4 v10, s[80:83], s90 offen lds
 s_add_u32 s90, s90, s63
 s_add_u32 m0, s36, 16384
 s_movk_i32 s37, 128
 buffer_load_dwordx4 v2, s[4:7], s37 offen lds
 s_add_u32 m0, s36, 17408
 s_movk_i32 s37, 128
 buffer_load_dwordx4 v3, s[4:7], s37 offen lds
 s_add_u32 m0, s35, 45056
 s_add_u32 s37, s88, 245760
 buffer_load_dwordx4 v8, s[40:43], s37 offen lds
 s_add_u32 m0, s35, 55296
 s_add_u32 s37, s89, 221184
 buffer_load_dwordx4 v9, s[56:59], s37 offen lds
 s_add_u32 s37, s62, 45056
 s_cmp_lt_u32 s98, 6
 s_cselect_b32 m0, s37, s74
 s_nop 0
 buffer_load_dwordx4 v10, s[80:83], s90 offen lds
 s_add_u32 s90, s90, s63
 v_and_b32 v35, 31, v1
 v_lshrrev_b32 v36, 5, v1
 v_bfe_u32 v37, v1, 1, 3
 v_xor_b32 v37, v37, v36
 v_lshlrev_b32 v38, 7, v35
 s_lshl_b32 s24, s20, 12
 s_add_u32 s24, s24, 112640
 v_add_u32 v38, s24, v38
 v_xor_b32 v39, 0, v37
 v_lshl_add_u32 v4, v39, 4, v38
 v_xor_b32 v39, 2, v37
 v_lshl_add_u32 v5, v39, 4, v38
 v_xor_b32 v39, 4, v37
 v_lshl_add_u32 v6, v39, 4, v38
 v_xor_b32 v39, 6, v37
 v_lshl_add_u32 v7, v39, 4, v38
 v_bfe_u32 v35, v1, 4, 1
 v_lshrrev_b32 v36, 5, v1
 v_bfe_u32 v37, v1, 2, 2
 v_and_b32 v38, 3, v1
 v_lshlrev_b32 v39, 12, v35
 v_lshl_add_u32 v39, v36, 10, v39
 v_lshl_add_u32 v39, v37, 7, v39
 v_lshl_add_u32 v39, v38, 3, v39
 v_lshrrev_b32 v37, 1, v37
 v_lshl_or_b32 v37, v35, 1, v37
 v_xor_b32 v38, 0, v37
 v_lshl_add_u32 v17, v38, 5, v39
 v_add_u32 v21, 0x10000, v17
 v_xor_b32 v38, 1, v37
 v_lshl_add_u32 v18, v38, 5, v39
 v_add_u32 v22, 0x10000, v18
 v_xor_b32 v38, 2, v37
 v_lshl_add_u32 v19, v38, 5, v39
 v_add_u32 v23, 0x10000, v19
 v_xor_b32 v38, 3, v37
 v_lshl_add_u32 v20, v38, 5, v39
 v_add_u32 v24, 0x10000, v20
 s_lshl_b32 s24, s20, 1
 v_add_u32 v35, s24, v35
 s_mov_b32 s25, 55296
 v_mul_lo_u32 v35, v35, s25
 v_and_b32 v37, 15, v1
 v_lshl_add_u32 v37, v36, 4, v37
 v_lshl_add_u32 v25, v37, 4, v35
 s_mul_i32 s34, s21, 442368
 s_add_u32 s34, s34, 0
 s_lshl_b32 s24, s96, 11
 s_add_u32 s33, s34, s24
 s_lshl_b32 s24, s97, 9
 s_add_u32 s33, s33, s24
 s_lshl_b32 s24, s23, 11
 s_add_u32 s34, s34, s24
 v_mov_b32 v26, 0xc0135761
 v_mov_b32 v244, 0xbdd2d3e8
 v_mov_b32 v245, 0xbdd2d3e8
 v_mov_b32 v246, 0xc0135761
 v_mov_b32 v247, 0xc0135761
 v_bfe_u32 v35, v1, 4, 1
 v_bfe_u32 v37, v1, 2, 2
 v_and_b32 v38, 3, v1
 v_lshlrev_b32 v39, 11, v35
 v_lshl_add_u32 v39, v36, 9, v39
 v_lshl_add_u32 v39, v37, 6, v39
 v_lshl_add_u32 v39, v38, 3, v39
 v_lshl_add_u32 v252, v35, 5, v39
 v_xor_b32 v253, 32, v252
 v_add_u32 v254, 0x10000, v252
 v_add_u32 v255, 0x10000, v253
 s_cmp_eq_u32 s20, 0
 s_cselect_b32 s76, s8, s12
 s_cselect_b32 s77, s9, s13
 s_mov_b32 s78, 2211840
 s_mov_b32 s61, 221184
 s_mul_i32 s60, s2, 864
 s_cmp_eq_u32 s20, 2
 s_cselect_b32 s76, s64, s76
 s_cselect_b32 s77, s65, s77
 s_cselect_b32 s78, 2457600, s78
 s_cselect_b32 s61, 245760, s61
 s_mul_i32 s24, s2, 960
 s_cselect_b32 s60, s24, s60
 s_cmp_eq_u32 s20, 3
 s_cselect_b32 s76, s4, s76
 s_cselect_b32 s77, s5, s77
 s_cselect_b32 s78, 2621440, s78
 s_cselect_b32 s61, 128, s61
 s_mul_i32 s24, s2, 10240
 s_cselect_b32 s60, s24, s60
 s_mov_b32 s79, 0x00020000
 s_movk_i32 s24, 128
 s_cselect_b32 s24, 1280, s24
 v_mul_lo_u32 v35, v1, s24
 v_mov_b32 v36, 0x80000000
 v_cmp_gt_u32 vcc, 8, v1
 s_nop 1
 v_cndmask_b32 v251, v36, v35, vcc
 s_add_u32 s60, s60, s61
 buffer_load_dword v250, v251, s[76:79], s60 offen
 s_add_u32 s60, s60, s61
 buffer_load_dword v250, v251, s[76:79], s60 offen
 s_add_u32 s60, s60, s61
 s_setprio 1
 s_waitcnt vmcnt(10)
 s_barrier
 buffer_load_dword v250, v251, s[76:79], s60 offen
 s_add_u32 s60, s60, s61
 ds_read_b128 v[176:179], v4 offset:0
 ds_read_b128 v[180:183], v5 offset:0
 ds_read_b64_tr_b16 v[40:41], v17 offset:10240
 ds_read_b64_tr_b16 v[42:43], v17 offset:10752
 s_add_u32 m0, s35, 67584
 s_add_u32 s37, s88, 368640
 buffer_load_dwordx4 v8, s[40:43], s37 offen lds
 ds_read_b64_tr_b16 v[44:45], v18 offset:10240
 ds_read_b64_tr_b16 v[46:47], v18 offset:10752
 s_add_u32 m0, s35, 77824
 s_add_u32 s37, s89, 331776
 buffer_load_dwordx4 v9, s[56:59], s37 offen lds
 ds_read_b64_tr_b16 v[48:49], v19 offset:10240
 ds_read_b64_tr_b16 v[50:51], v19 offset:10752
 s_add_u32 s37, s62, 67584
 s_cmp_lt_u32 s98, 6
 s_cselect_b32 m0, s37, s74
 s_nop 0
 buffer_load_dwordx4 v10, s[80:83], s90 offen lds
 s_add_u32 s90, s90, s63
 s_waitcnt lgkmcnt(4)
 v_mfma_f32_32x32x16_bf16 v[64:79], v[40:43], v[176:179], 0
 ds_read_b64_tr_b16 v[52:53], v20 offset:10240
 ds_read_b64_tr_b16 v[54:55], v20 offset:10752
 s_mov_b32 s84, s54
 s_mov_b32 s85, s55
 s_mov_b32 s86, 1280
 s_waitcnt lgkmcnt(4)
 v_mfma_f32_32x32x16_bf16 v[80:95], v[44:47], v[176:179], 0
 ds_read_b64_tr_b16 v[56:57], v252 offset:18432
 ds_read_b64_tr_b16 v[58:59], v252 offset:18688
 s_mov_b32 s87, 0x00020000
 s_lshl_b32 s24, s2, 3
 s_lshl_b32 s25, s20, 1
 s_waitcnt lgkmcnt(4)
 v_mfma_f32_32x32x16_bf16 v[96:111], v[48:51], v[176:179], 0
 ds_read_b64_tr_b16 v[60:61], v253 offset:18432
 ds_read_b64_tr_b16 v[62:63], v253 offset:18688
 s_add_u32 s24, s24, s25
 v_lshrrev_b32 v35, 5, v1
 v_add_u32 v216, s24, v35
 s_waitcnt lgkmcnt(4)
 v_mfma_f32_32x32x16_bf16 v[112:127], v[52:55], v[176:179], 0
 ds_read_b64_tr_b16 v[40:41], v17 offset:12288
 ds_read_b64_tr_b16 v[42:43], v17 offset:12800
 v_mul_u32_u24 v35, 1280, v216
 v_and_b32 v36, 31, v1
 v_lshlrev_b32 v36, 4, v36
 s_waitcnt lgkmcnt(4)
 v_mfma_f32_32x32x16_bf16 v[128:143], v[56:59], v[176:179], 0
 ds_read_b64_tr_b16 v[44:45], v18 offset:12288
 ds_read_b64_tr_b16 v[46:47], v18 offset:12800
 v_add_u32 v35, v35, v36
 v_mov_b32 v37, 0x80000000
 v_cmp_gt_u32 vcc, 256, v36
 s_waitcnt lgkmcnt(4)
 v_mfma_f32_32x32x16_bf16 v[144:159], v[60:63], v[176:179], 0
 ds_read_b64_tr_b16 v[48:49], v19 offset:12288
 ds_read_b64_tr_b16 v[50:51], v19 offset:12800
 s_nop 1
 v_cndmask_b32 v38, v37, v35, vcc
 v_cndmask_b32 v39, v37, v36, vcc
 s_waitcnt lgkmcnt(4)
 v_mfma_f32_32x32x16_bf16 v[64:79], v[40:43], v[180:183], v[64:79]
 ds_read_b64_tr_b16 v[52:53], v20 offset:12288
 ds_read_b64_tr_b16 v[54:55], v20 offset:12800
 buffer_load_dwordx4 v[192:195], v35, s[4:7], 0 offen offset:0
 s_waitcnt lgkmcnt(4)
 v_mfma_f32_32x32x16_bf16 v[80:95], v[44:47], v[180:183], v[80:95]
 ds_read_b64_tr_b16 v[56:57], v252 offset:19456
 ds_read_b64_tr_b16 v[58:59], v252 offset:19712
 buffer_load_dwordx4 v[196:199], v36, s[84:87], 0 offen offset:0
 s_waitcnt lgkmcnt(4)
 v_mfma_f32_32x32x16_bf16 v[96:111], v[48:51], v[180:183], v[96:111]
 ds_read_b64_tr_b16 v[60:61], v253 offset:19456
 ds_read_b64_tr_b16 v[62:63], v253 offset:19712
 buffer_load_dwordx4 v[200:203], v35, s[4:7], 0 offen offset:512
 s_waitcnt lgkmcnt(4)
 v_mfma_f32_32x32x16_bf16 v[112:127], v[52:55], v[180:183], v[112:127]
 s_waitcnt vmcnt(14)
 s_barrier
 ds_read_b128 v[184:187], v6 offset:0
 ds_read_b128 v[188:191], v7 offset:0
 ds_read_b64_tr_b16 v[40:41], v17 offset:32768
 ds_read_b64_tr_b16 v[42:43], v17 offset:33280
 s_add_u32 m0, s35, 90112
 s_add_u32 s37, s88, 491520
 buffer_load_dwordx4 v8, s[40:43], s37 offen lds
 s_waitcnt lgkmcnt(6)
 v_mfma_f32_32x32x16_bf16 v[128:143], v[56:59], v[180:183], v[128:143]
 ds_read_b64_tr_b16 v[44:45], v18 offset:32768
 ds_read_b64_tr_b16 v[46:47], v18 offset:33280
 s_add_u32 m0, s35, 100352
 s_add_u32 s37, s89, 442368
 buffer_load_dwordx4 v9, s[56:59], s37 offen lds
 s_waitcnt lgkmcnt(6)
 v_mfma_f32_32x32x16_bf16 v[144:159], v[60:63], v[180:183], v[144:159]
 ds_read_b64_tr_b16 v[48:49], v19 offset:32768
 ds_read_b64_tr_b16 v[50:51], v19 offset:33280
 s_add_u32 s37, s62, 90112
 s_cmp_lt_u32 s98, 6
 s_cselect_b32 m0, s37, s74
 s_nop 0
 buffer_load_dwordx4 v10, s[80:83], s90 offen lds
 s_add_u32 s90, s90, s63
 s_waitcnt lgkmcnt(4)
 v_mfma_f32_32x32x16_bf16 v[64:79], v[40:43], v[184:187], v[64:79]
 ds_read_b64_tr_b16 v[52:53], v20 offset:32768
 ds_read_b64_tr_b16 v[54:55], v20 offset:33280
 s_add_u32 m0, s36, 32768
 s_movk_i32 s37, 256
 buffer_load_dwordx4 v2, s[4:7], s37 offen lds
 s_waitcnt lgkmcnt(4)
 v_mfma_f32_32x32x16_bf16 v[80:95], v[44:47], v[184:187], v[80:95]
 ds_read_b64_tr_b16 v[56:57], v252 offset:40960
 ds_read_b64_tr_b16 v[58:59], v252 offset:41216
 s_add_u32 m0, s36, 33792
 s_movk_i32 s37, 256
 buffer_load_dwordx4 v3, s[4:7], s37 offen lds
 s_waitcnt lgkmcnt(4)
 v_mfma_f32_32x32x16_bf16 v[96:111], v[48:51], v[184:187], v[96:111]
 ds_read_b64_tr_b16 v[60:61], v253 offset:40960
 ds_read_b64_tr_b16 v[62:63], v253 offset:41216
 buffer_load_dwordx4 v[204:207], v36, s[84:87], 0 offen offset:512
 s_waitcnt lgkmcnt(4)
 v_mfma_f32_32x32x16_bf16 v[112:127], v[52:55], v[184:187], v[112:127]
 ds_read_b64_tr_b16 v[40:41], v17 offset:34816
 ds_read_b64_tr_b16 v[42:43], v17 offset:35328
 buffer_load_dwordx4 v[208:211], v38, s[4:7], 0 offen offset:1024
 s_waitcnt lgkmcnt(4)
 v_mfma_f32_32x32x16_bf16 v[128:143], v[56:59], v[184:187], v[128:143]
 ds_read_b64_tr_b16 v[44:45], v18 offset:34816
 ds_read_b64_tr_b16 v[46:47], v18 offset:35328
 buffer_load_dwordx4 v[212:215], v39, s[84:87], 0 offen offset:1024
 s_waitcnt lgkmcnt(4)
 v_mfma_f32_32x32x16_bf16 v[144:159], v[60:63], v[184:187], v[144:159]
 ds_read_b64_tr_b16 v[48:49], v19 offset:34816
 ds_read_b64_tr_b16 v[50:51], v19 offset:35328
 s_mul_i32 s24, s2, 10240
 s_add_u32 s24, s24, 15728640
 s_add_u32 s25, s24, 4096
 s_waitcnt lgkmcnt(4)
 v_mfma_f32_32x32x16_bf16 v[64:79], v[40:43], v[188:191], v[64:79]
 ds_read_b64_tr_b16 v[52:53], v20 offset:34816
 ds_read_b64_tr_b16 v[54:55], v20 offset:35328
 s_add_u32 s26, s24, 8192
 v_lshlrev_b32 v35, 4, v0
 v_cmp_gt_u32 vcc, 128, v0
 s_waitcnt lgkmcnt(4)
 v_mfma_f32_32x32x16_bf16 v[80:95], v[44:47], v[188:191], v[80:95]
 ds_read_b64_tr_b16 v[56:57], v252 offset:41984
 ds_read_b64_tr_b16 v[58:59], v252 offset:42240
 v_mov_b32 v218, -1
 v_mov_b32 v219, -1
 v_mov_b32 v220, -1
 s_waitcnt lgkmcnt(4)
 v_mfma_f32_32x32x16_bf16 v[96:111], v[48:51], v[188:191], v[96:111]
 ds_read_b64_tr_b16 v[60:61], v253 offset:41984
 ds_read_b64_tr_b16 v[62:63], v253 offset:42240
 v_mov_b32 v221, -1
 v_cndmask_b32 v36, v37, v35, vcc
 buffer_store_dwordx4 v[218:221], v35, s[16:19], s24 offen
 s_waitcnt lgkmcnt(4)
 v_mfma_f32_32x32x16_bf16 v[112:127], v[52:55], v[188:191], v[112:127]
 s_waitcnt vmcnt(18)
 s_barrier
 buffer_load_dword v250, v251, s[76:79], s60 offen
 s_add_u32 s60, s60, s61
 ds_read_b128 v[176:179], v4 offset:16384
 ds_read_b128 v[180:183], v5 offset:16384
 ds_read_b64_tr_b16 v[40:41], v17 offset:55296
 ds_read_b64_tr_b16 v[42:43], v17 offset:55808
 s_add_u32 m0, s35, 0
 s_add_u32 s37, s88, 614400
 buffer_load_dwordx4 v8, s[40:43], s37 offen lds
 s_waitcnt lgkmcnt(6)
 v_mfma_f32_32x32x16_bf16 v[128:143], v[56:59], v[188:191], v[128:143]
 ds_read_b64_tr_b16 v[44:45], v18 offset:55296
 ds_read_b64_tr_b16 v[46:47], v18 offset:55808
 s_add_u32 m0, s35, 10240
 s_add_u32 s37, s89, 552960
 buffer_load_dwordx4 v9, s[56:59], s37 offen lds
 s_waitcnt lgkmcnt(6)
 v_mfma_f32_32x32x16_bf16 v[144:159], v[60:63], v[188:191], v[144:159]
 ds_read_b64_tr_b16 v[48:49], v19 offset:55296
 ds_read_b64_tr_b16 v[50:51], v19 offset:55808
 s_add_u32 s37, s62, 0
 s_cmp_lt_u32 s98, 6
 s_cselect_b32 m0, s37, s74
 s_nop 0
 buffer_load_dwordx4 v10, s[80:83], s90 offen lds
 s_add_u32 s90, s90, s63
 s_waitcnt lgkmcnt(4)
 v_mfma_f32_32x32x16_bf16 v[64:79], v[40:43], v[176:179], v[64:79]
 ds_read_b64_tr_b16 v[52:53], v20 offset:55296
 ds_read_b64_tr_b16 v[54:55], v20 offset:55808
 buffer_store_dwordx4 v[218:221], v35, s[16:19], s25 offen
 s_waitcnt lgkmcnt(4)
 v_mfma_f32_32x32x16_bf16 v[80:95], v[44:47], v[176:179], v[80:95]
 ds_read_b64_tr_b16 v[56:57], v252 offset:63488
 ds_read_b64_tr_b16 v[58:59], v252 offset:63744
 buffer_store_dwordx4 v[218:221], v36, s[16:19], s26 offen
 s_waitcnt lgkmcnt(4)
 v_mfma_f32_32x32x16_bf16 v[96:111], v[48:51], v[176:179], v[96:111]
 ds_read_b64_tr_b16 v[60:61], v253 offset:63488
 ds_read_b64_tr_b16 v[62:63], v253 offset:63744
 s_waitcnt lgkmcnt(4)
 v_mfma_f32_32x32x16_bf16 v[112:127], v[52:55], v[176:179], v[112:127]
 ds_read_b64_tr_b16 v[40:41], v17 offset:57344
 ds_read_b64_tr_b16 v[42:43], v17 offset:57856
 s_waitcnt lgkmcnt(4)
 v_mfma_f32_32x32x16_bf16 v[128:143], v[56:59], v[176:179], v[128:143]
 ds_read_b64_tr_b16 v[44:45], v18 offset:57344
 ds_read_b64_tr_b16 v[46:47], v18 offset:57856
 s_waitcnt lgkmcnt(4)
 v_mfma_f32_32x32x16_bf16 v[144:159], v[60:63], v[176:179], v[144:159]
 ds_read_b64_tr_b16 v[48:49], v19 offset:57344
 ds_read_b64_tr_b16 v[50:51], v19 offset:57856
 s_waitcnt lgkmcnt(4)
 v_mfma_f32_32x32x16_bf16 v[64:79], v[40:43], v[180:183], v[64:79]
 ds_read_b64_tr_b16 v[52:53], v20 offset:57344
 ds_read_b64_tr_b16 v[54:55], v20 offset:57856
 s_waitcnt lgkmcnt(4)
 v_mfma_f32_32x32x16_bf16 v[80:95], v[44:47], v[180:183], v[80:95]
 ds_read_b64_tr_b16 v[56:57], v252 offset:64512
 ds_read_b64_tr_b16 v[58:59], v252 offset:64768
 s_waitcnt lgkmcnt(4)
 v_mfma_f32_32x32x16_bf16 v[96:111], v[48:51], v[180:183], v[96:111]
 ds_read_b64_tr_b16 v[60:61], v253 offset:64512
 ds_read_b64_tr_b16 v[62:63], v253 offset:64768
 s_waitcnt lgkmcnt(4)
 v_mfma_f32_32x32x16_bf16 v[112:127], v[52:55], v[180:183], v[112:127]
 s_waitcnt vmcnt(18)
 s_barrier
 ds_read_b128 v[184:187], v6 offset:16384
 ds_read_b128 v[188:191], v7 offset:16384
 ds_read_b64_tr_b16 v[40:41], v21 offset:12288
 ds_read_b64_tr_b16 v[42:43], v21 offset:12800
 s_add_u32 m0, s35, 22528
 s_add_u32 s37, s88, 737280
 buffer_load_dwordx4 v8, s[40:43], s37 offen lds
 s_waitcnt lgkmcnt(6)
 v_mfma_f32_32x32x16_bf16 v[128:143], v[56:59], v[180:183], v[128:143]
 ds_read_b64_tr_b16 v[44:45], v22 offset:12288
 ds_read_b64_tr_b16 v[46:47], v22 offset:12800
 s_add_u32 m0, s35, 32768
 s_add_u32 s37, s89, 663552
 buffer_load_dwordx4 v9, s[56:59], s37 offen lds
 s_waitcnt lgkmcnt(6)
 v_mfma_f32_32x32x16_bf16 v[144:159], v[60:63], v[180:183], v[144:159]
 ds_read_b64_tr_b16 v[48:49], v23 offset:12288
 ds_read_b64_tr_b16 v[50:51], v23 offset:12800
 s_add_u32 s37, s62, 22528
 s_cmp_lt_u32 s98, 6
 s_cselect_b32 m0, s37, s74
 s_nop 0
 buffer_load_dwordx4 v10, s[80:83], s90 offen lds
 s_add_u32 s90, s90, s63
 s_waitcnt lgkmcnt(4)
 v_mfma_f32_32x32x16_bf16 v[64:79], v[40:43], v[184:187], v[64:79]
 ds_read_b64_tr_b16 v[52:53], v24 offset:12288
 ds_read_b64_tr_b16 v[54:55], v24 offset:12800
 s_add_u32 m0, s36, 0
 s_movk_i32 s37, 384
 buffer_load_dwordx4 v2, s[4:7], s37 offen lds
 s_waitcnt lgkmcnt(4)
 v_mfma_f32_32x32x16_bf16 v[80:95], v[44:47], v[184:187], v[80:95]
 ds_read_b64_tr_b16 v[56:57], v254 offset:20480
 ds_read_b64_tr_b16 v[58:59], v254 offset:20736
 s_add_u32 m0, s36, 1024
 s_movk_i32 s37, 384
 buffer_load_dwordx4 v3, s[4:7], s37 offen lds
 s_waitcnt lgkmcnt(4)
 v_mfma_f32_32x32x16_bf16 v[96:111], v[48:51], v[184:187], v[96:111]
 ds_read_b64_tr_b16 v[60:61], v255 offset:20480
 ds_read_b64_tr_b16 v[62:63], v255 offset:20736
 s_waitcnt lgkmcnt(4)
 v_mfma_f32_32x32x16_bf16 v[112:127], v[52:55], v[184:187], v[112:127]
 ds_read_b64_tr_b16 v[40:41], v21 offset:14336
 ds_read_b64_tr_b16 v[42:43], v21 offset:14848
 s_waitcnt lgkmcnt(4)
 v_mfma_f32_32x32x16_bf16 v[128:143], v[56:59], v[184:187], v[128:143]
 ds_read_b64_tr_b16 v[44:45], v22 offset:14336
 ds_read_b64_tr_b16 v[46:47], v22 offset:14848
 s_waitcnt lgkmcnt(4)
 v_mfma_f32_32x32x16_bf16 v[144:159], v[60:63], v[184:187], v[144:159]
 ds_read_b64_tr_b16 v[48:49], v23 offset:14336
 ds_read_b64_tr_b16 v[50:51], v23 offset:14848
 s_waitcnt lgkmcnt(4)
 v_mfma_f32_32x32x16_bf16 v[64:79], v[40:43], v[188:191], v[64:79]
 ds_read_b64_tr_b16 v[52:53], v24 offset:14336
 ds_read_b64_tr_b16 v[54:55], v24 offset:14848
 s_waitcnt lgkmcnt(4)
 v_mfma_f32_32x32x16_bf16 v[80:95], v[44:47], v[188:191], v[80:95]
 ds_read_b64_tr_b16 v[56:57], v254 offset:21504
 ds_read_b64_tr_b16 v[58:59], v254 offset:21760
 s_waitcnt lgkmcnt(4)
 v_mfma_f32_32x32x16_bf16 v[96:111], v[48:51], v[188:191], v[96:111]
 ds_read_b64_tr_b16 v[60:61], v255 offset:21504
 ds_read_b64_tr_b16 v[62:63], v255 offset:21760
 s_waitcnt lgkmcnt(4)
 v_mfma_f32_32x32x16_bf16 v[112:127], v[52:55], v[188:191], v[112:127]
 s_waitcnt vmcnt(15)
 s_barrier
 buffer_load_dword v250, v251, s[76:79], s60 offen
 s_add_u32 s60, s60, s61
 ds_read_b128 v[176:179], v4 offset:32768
 ds_read_b128 v[180:183], v5 offset:32768
 ds_read_b64_tr_b16 v[40:41], v21 offset:34816
 ds_read_b64_tr_b16 v[42:43], v21 offset:35328
 s_add_u32 m0, s35, 45056
 s_add_u32 s37, s88, 860160
 buffer_load_dwordx4 v8, s[40:43], s37 offen lds
 s_waitcnt lgkmcnt(6)
 v_mfma_f32_32x32x16_bf16 v[128:143], v[56:59], v[188:191], v[128:143]
 ds_read_b64_tr_b16 v[44:45], v22 offset:34816
 ds_read_b64_tr_b16 v[46:47], v22 offset:35328
 s_add_u32 m0, s35, 55296
 s_add_u32 s37, s89, 774144
 buffer_load_dwordx4 v9, s[56:59], s37 offen lds
 s_waitcnt lgkmcnt(6)
 v_mfma_f32_32x32x16_bf16 v[144:159], v[60:63], v[188:191], v[144:159]
 ds_read_b64_tr_b16 v[48:49], v23 offset:34816
 ds_read_b64_tr_b16 v[50:51], v23 offset:35328
 s_add_u32 s37, s62, 45056
 s_cmp_lt_u32 s98, 6
 s_cselect_b32 m0, s37, s74
 s_nop 0
 buffer_load_dwordx4 v10, s[80:83], s90 offen lds
 s_add_u32 s90, s90, s63
 s_waitcnt lgkmcnt(4)
 v_mfma_f32_32x32x16_bf16 v[64:79], v[40:43], v[176:179], v[64:79]
 ds_read_b64_tr_b16 v[52:53], v24 offset:34816
 ds_read_b64_tr_b16 v[54:55], v24 offset:35328
 s_waitcnt lgkmcnt(4)
 v_mfma_f32_32x32x16_bf16 v[80:95], v[44:47], v[176:179], v[80:95]
 ds_read_b64_tr_b16 v[56:57], v254 offset:43008
 ds_read_b64_tr_b16 v[58:59], v254 offset:43264
 s_waitcnt lgkmcnt(4)
 v_mfma_f32_32x32x16_bf16 v[96:111], v[48:51], v[176:179], v[96:111]
 ds_read_b64_tr_b16 v[60:61], v255 offset:43008
 ds_read_b64_tr_b16 v[62:63], v255 offset:43264
 s_waitcnt lgkmcnt(4)
 v_mfma_f32_32x32x16_bf16 v[112:127], v[52:55], v[176:179], v[112:127]
 ds_read_b64_tr_b16 v[40:41], v21 offset:36864
 ds_read_b64_tr_b16 v[42:43], v21 offset:37376
 s_waitcnt lgkmcnt(4)
 v_mfma_f32_32x32x16_bf16 v[128:143], v[56:59], v[176:179], v[128:143]
 ds_read_b64_tr_b16 v[44:45], v22 offset:36864
 ds_read_b64_tr_b16 v[46:47], v22 offset:37376
 s_waitcnt lgkmcnt(4)
 v_mfma_f32_32x32x16_bf16 v[144:159], v[60:63], v[176:179], v[144:159]
 ds_read_b64_tr_b16 v[48:49], v23 offset:36864
 ds_read_b64_tr_b16 v[50:51], v23 offset:37376
 s_waitcnt lgkmcnt(4)
 v_mfma_f32_32x32x16_bf16 v[64:79], v[40:43], v[180:183], v[64:79]
 ds_read_b64_tr_b16 v[52:53], v24 offset:36864
 ds_read_b64_tr_b16 v[54:55], v24 offset:37376
 s_waitcnt lgkmcnt(4)
 v_mfma_f32_32x32x16_bf16 v[80:95], v[44:47], v[180:183], v[80:95]
 ds_read_b64_tr_b16 v[56:57], v254 offset:44032
 ds_read_b64_tr_b16 v[58:59], v254 offset:44288
 s_waitcnt lgkmcnt(4)
 v_mfma_f32_32x32x16_bf16 v[96:111], v[48:51], v[180:183], v[96:111]
 ds_read_b64_tr_b16 v[60:61], v255 offset:44032
 ds_read_b64_tr_b16 v[62:63], v255 offset:44288
 s_waitcnt lgkmcnt(4)
 v_mfma_f32_32x32x16_bf16 v[112:127], v[52:55], v[180:183], v[112:127]
 s_waitcnt vmcnt(11)
 s_barrier
 ds_read_b128 v[184:187], v6 offset:32768
 ds_read_b128 v[188:191], v7 offset:32768
 ds_read_b64_tr_b16 v[40:41], v17 offset:10240
 ds_read_b64_tr_b16 v[42:43], v17 offset:10752
 s_add_u32 m0, s35, 67584
 s_add_u32 s37, s88, 983040
 buffer_load_dwordx4 v8, s[40:43], s37 offen lds
 s_waitcnt lgkmcnt(6)
 v_mfma_f32_32x32x16_bf16 v[128:143], v[56:59], v[180:183], v[128:143]
 ds_read_b64_tr_b16 v[44:45], v18 offset:10240
 ds_read_b64_tr_b16 v[46:47], v18 offset:10752
 s_add_u32 m0, s35, 77824
 s_add_u32 s37, s89, 884736
 buffer_load_dwordx4 v9, s[56:59], s37 offen lds
 s_waitcnt lgkmcnt(6)
 v_mfma_f32_32x32x16_bf16 v[144:159], v[60:63], v[180:183], v[144:159]
 ds_read_b64_tr_b16 v[48:49], v19 offset:10240
 ds_read_b64_tr_b16 v[50:51], v19 offset:10752
 s_add_u32 s37, s62, 67584
 s_cmp_lt_u32 s98, 6
 s_cselect_b32 m0, s37, s74
 s_nop 0
 buffer_load_dwordx4 v10, s[80:83], s90 offen lds
 s_add_u32 s90, s90, s63
 s_waitcnt lgkmcnt(4)
 v_mfma_f32_32x32x16_bf16 v[64:79], v[40:43], v[184:187], v[64:79]
 ds_read_b64_tr_b16 v[52:53], v20 offset:10240
 ds_read_b64_tr_b16 v[54:55], v20 offset:10752
 s_add_u32 m0, s36, 16384
 s_movk_i32 s37, 512
 buffer_load_dwordx4 v2, s[4:7], s37 offen lds
 s_waitcnt lgkmcnt(4)
 v_mfma_f32_32x32x16_bf16 v[80:95], v[44:47], v[184:187], v[80:95]
 ds_read_b64_tr_b16 v[56:57], v252 offset:18432
 ds_read_b64_tr_b16 v[58:59], v252 offset:18688
 s_add_u32 m0, s36, 17408
 s_movk_i32 s37, 512
 buffer_load_dwordx4 v3, s[4:7], s37 offen lds
 s_waitcnt lgkmcnt(4)
 v_mfma_f32_32x32x16_bf16 v[96:111], v[48:51], v[184:187], v[96:111]
 ds_read_b64_tr_b16 v[60:61], v253 offset:18432
 ds_read_b64_tr_b16 v[62:63], v253 offset:18688
 s_waitcnt lgkmcnt(4)
 v_mfma_f32_32x32x16_bf16 v[112:127], v[52:55], v[184:187], v[112:127]
 ds_read_b64_tr_b16 v[40:41], v17 offset:12288
 ds_read_b64_tr_b16 v[42:43], v17 offset:12800
 s_waitcnt lgkmcnt(4)
 v_mfma_f32_32x32x16_bf16 v[128:143], v[56:59], v[184:187], v[128:143]
 ds_read_b64_tr_b16 v[44:45], v18 offset:12288
 ds_read_b64_tr_b16 v[46:47], v18 offset:12800
 s_waitcnt lgkmcnt(4)
 v_mfma_f32_32x32x16_bf16 v[144:159], v[60:63], v[184:187], v[144:159]
 ds_read_b64_tr_b16 v[48:49], v19 offset:12288
 ds_read_b64_tr_b16 v[50:51], v19 offset:12800
 s_waitcnt lgkmcnt(4)
 v_mfma_f32_32x32x16_bf16 v[64:79], v[40:43], v[188:191], v[64:79]
 ds_read_b64_tr_b16 v[52:53], v20 offset:12288
 ds_read_b64_tr_b16 v[54:55], v20 offset:12800
 s_waitcnt lgkmcnt(4)
 v_mfma_f32_32x32x16_bf16 v[80:95], v[44:47], v[188:191], v[80:95]
 ds_read_b64_tr_b16 v[56:57], v252 offset:19456
 ds_read_b64_tr_b16 v[58:59], v252 offset:19712
 s_waitcnt lgkmcnt(4)
 v_mfma_f32_32x32x16_bf16 v[96:111], v[48:51], v[188:191], v[96:111]
 ds_read_b64_tr_b16 v[60:61], v253 offset:19456
 ds_read_b64_tr_b16 v[62:63], v253 offset:19712
 s_waitcnt lgkmcnt(4)
 v_mfma_f32_32x32x16_bf16 v[112:127], v[52:55], v[188:191], v[112:127]
 s_waitcnt vmcnt(9)
 s_barrier
 buffer_load_dword v250, v251, s[76:79], s60 offen
 s_add_u32 s60, s60, s61
 ds_read_b128 v[176:179], v4 offset:0
 ds_read_b128 v[180:183], v5 offset:0
 ds_read_b64_tr_b16 v[40:41], v17 offset:32768
 ds_read_b64_tr_b16 v[42:43], v17 offset:33280
 s_add_u32 m0, s35, 90112
 s_add_u32 s37, s88, 1105920
 buffer_load_dwordx4 v8, s[40:43], s37 offen lds
 s_waitcnt lgkmcnt(6)
 v_mfma_f32_32x32x16_bf16 v[128:143], v[56:59], v[188:191], v[128:143]
 ds_read_b64_tr_b16 v[44:45], v18 offset:32768
 ds_read_b64_tr_b16 v[46:47], v18 offset:33280
 s_add_u32 m0, s35, 100352
 s_add_u32 s37, s89, 995328
 buffer_load_dwordx4 v9, s[56:59], s37 offen lds
 s_waitcnt lgkmcnt(6)
 v_mfma_f32_32x32x16_bf16 v[144:159], v[60:63], v[188:191], v[144:159]
 ds_read_b64_tr_b16 v[48:49], v19 offset:32768
 ds_read_b64_tr_b16 v[50:51], v19 offset:33280
 s_add_u32 s37, s62, 90112
 s_cmp_lt_u32 s98, 6
 s_cselect_b32 m0, s37, s74
 s_nop 0
 buffer_load_dwordx4 v10, s[80:83], s90 offen lds
 s_add_u32 s90, s90, s63
 s_waitcnt lgkmcnt(4)
 v_mfma_f32_32x32x16_bf16 v[64:79], v[40:43], v[176:179], v[64:79]
 ds_read_b64_tr_b16 v[52:53], v20 offset:32768
 ds_read_b64_tr_b16 v[54:55], v20 offset:33280
 s_waitcnt lgkmcnt(4)
 v_mfma_f32_32x32x16_bf16 v[80:95], v[44:47], v[176:179], v[80:95]
 ds_read_b64_tr_b16 v[56:57], v252 offset:40960
 ds_read_b64_tr_b16 v[58:59], v252 offset:41216
 s_waitcnt lgkmcnt(4)
 v_mfma_f32_32x32x16_bf16 v[96:111], v[48:51], v[176:179], v[96:111]
 ds_read_b64_tr_b16 v[60:61], v253 offset:40960
 ds_read_b64_tr_b16 v[62:63], v253 offset:41216
 s_waitcnt lgkmcnt(4)
 v_mfma_f32_32x32x16_bf16 v[112:127], v[52:55], v[176:179], v[112:127]
 ds_read_b64_tr_b16 v[40:41], v17 offset:34816
 ds_read_b64_tr_b16 v[42:43], v17 offset:35328
 s_waitcnt lgkmcnt(4)
 v_mfma_f32_32x32x16_bf16 v[128:143], v[56:59], v[176:179], v[128:143]
 ds_read_b64_tr_b16 v[44:45], v18 offset:34816
 ds_read_b64_tr_b16 v[46:47], v18 offset:35328
 s_waitcnt lgkmcnt(4)
 v_mfma_f32_32x32x16_bf16 v[144:159], v[60:63], v[176:179], v[144:159]
 ds_read_b64_tr_b16 v[48:49], v19 offset:34816
 ds_read_b64_tr_b16 v[50:51], v19 offset:35328
 s_waitcnt lgkmcnt(4)
 v_mfma_f32_32x32x16_bf16 v[64:79], v[40:43], v[180:183], v[64:79]
 ds_read_b64_tr_b16 v[52:53], v20 offset:34816
 ds_read_b64_tr_b16 v[54:55], v20 offset:35328
 s_waitcnt lgkmcnt(4)
 v_mfma_f32_32x32x16_bf16 v[80:95], v[44:47], v[180:183], v[80:95]
 ds_read_b64_tr_b16 v[56:57], v252 offset:41984
 ds_read_b64_tr_b16 v[58:59], v252 offset:42240
 s_waitcnt lgkmcnt(4)
 v_mfma_f32_32x32x16_bf16 v[96:111], v[48:51], v[180:183], v[96:111]
 ds_read_b64_tr_b16 v[60:61], v253 offset:41984
 ds_read_b64_tr_b16 v[62:63], v253 offset:42240
 s_waitcnt lgkmcnt(4)
 v_mfma_f32_32x32x16_bf16 v[112:127], v[52:55], v[180:183], v[112:127]
 s_waitcnt vmcnt(9)
 s_barrier
 ds_read_b128 v[184:187], v6 offset:0
 ds_read_b128 v[188:191], v7 offset:0
 ds_read_b64_tr_b16 v[40:41], v17 offset:55296
 ds_read_b64_tr_b16 v[42:43], v17 offset:55808
 s_add_u32 m0, s35, 0
 s_add_u32 s37, s88, 1228800
 buffer_load_dwordx4 v8, s[40:43], s37 offen lds
 s_waitcnt lgkmcnt(6)
 v_mfma_f32_32x32x16_bf16 v[128:143], v[56:59], v[180:183], v[128:143]
 ds_read_b64_tr_b16 v[44:45], v18 offset:55296
 ds_read_b64_tr_b16 v[46:47], v18 offset:55808
 s_add_u32 m0, s35, 10240
 s_add_u32 s37, s89, 1105920
 buffer_load_dwordx4 v9, s[56:59], s37 offen lds
 s_waitcnt lgkmcnt(6)
 v_mfma_f32_32x32x16_bf16 v[144:159], v[60:63], v[180:183], v[144:159]
 ds_read_b64_tr_b16 v[48:49], v19 offset:55296
 ds_read_b64_tr_b16 v[50:51], v19 offset:55808
 s_add_u32 s37, s62, 0
 s_cmp_lt_u32 s98, 6
 s_cselect_b32 m0, s37, s74
 s_nop 0
 buffer_load_dwordx4 v10, s[80:83], s90 offen lds
 s_add_u32 s90, s90, s63
 s_waitcnt lgkmcnt(4)
 v_mfma_f32_32x32x16_bf16 v[64:79], v[40:43], v[184:187], v[64:79]
 ds_read_b64_tr_b16 v[52:53], v20 offset:55296
 ds_read_b64_tr_b16 v[54:55], v20 offset:55808
 s_add_u32 m0, s36, 32768
 s_movk_i32 s37, 640
 buffer_load_dwordx4 v2, s[4:7], s37 offen lds
 s_waitcnt lgkmcnt(4)
 v_mfma_f32_32x32x16_bf16 v[80:95], v[44:47], v[184:187], v[80:95]
 ds_read_b64_tr_b16 v[56:57], v252 offset:63488
 ds_read_b64_tr_b16 v[58:59], v252 offset:63744
 s_add_u32 m0, s36, 33792
 s_movk_i32 s37, 640
 buffer_load_dwordx4 v3, s[4:7], s37 offen lds
 s_waitcnt lgkmcnt(4)
 v_mfma_f32_32x32x16_bf16 v[96:111], v[48:51], v[184:187], v[96:111]
 ds_read_b64_tr_b16 v[60:61], v253 offset:63488
 ds_read_b64_tr_b16 v[62:63], v253 offset:63744
 s_waitcnt lgkmcnt(4)
 v_mfma_f32_32x32x16_bf16 v[112:127], v[52:55], v[184:187], v[112:127]
 ds_read_b64_tr_b16 v[40:41], v17 offset:57344
 ds_read_b64_tr_b16 v[42:43], v17 offset:57856
 v_mov_b32 v217, 0
 v_mov_b32 v218, 0
 v_lshlrev_b32 v219, 16, v192
 s_waitcnt lgkmcnt(4)
 v_mfma_f32_32x32x16_bf16 v[128:143], v[56:59], v[184:187], v[128:143]
 ds_read_b64_tr_b16 v[44:45], v18 offset:57344
 ds_read_b64_tr_b16 v[46:47], v18 offset:57856
 v_and_b32 v220, 0xffff0000, v192
 v_lshlrev_b32 v221, 16, v196
 v_and_b32 v222, 0xffff0000, v196
 s_waitcnt lgkmcnt(4)
 v_mfma_f32_32x32x16_bf16 v[144:159], v[60:63], v[184:187], v[144:159]
 ds_read_b64_tr_b16 v[48:49], v19 offset:57344
 ds_read_b64_tr_b16 v[50:51], v19 offset:57856
 v_mul_f32 v219, v219, v221
 v_mul_f32 v220, v220, v222
 v_cvt_pk_bf16_f32 v219, v219, v220
 s_waitcnt lgkmcnt(4)
 v_mfma_f32_32x32x16_bf16 v[64:79], v[40:43], v[188:191], v[64:79]
 ds_read_b64_tr_b16 v[52:53], v20 offset:57344
 ds_read_b64_tr_b16 v[54:55], v20 offset:57856
 v_lshlrev_b32 v220, 16, v219
 v_and_b32 v219, 0xffff0000, v219
 v_add_f32 v217, v217, v220
 s_waitcnt lgkmcnt(4)
 v_mfma_f32_32x32x16_bf16 v[80:95], v[44:47], v[188:191], v[80:95]
 ds_read_b64_tr_b16 v[56:57], v252 offset:64512
 ds_read_b64_tr_b16 v[58:59], v252 offset:64768
 v_add_f32 v218, v218, v219
 v_lshlrev_b32 v219, 16, v193
 v_and_b32 v220, 0xffff0000, v193
 s_waitcnt lgkmcnt(4)
 v_mfma_f32_32x32x16_bf16 v[96:111], v[48:51], v[188:191], v[96:111]
 ds_read_b64_tr_b16 v[60:61], v253 offset:64512
 ds_read_b64_tr_b16 v[62:63], v253 offset:64768
 v_lshlrev_b32 v221, 16, v197
 v_and_b32 v222, 0xffff0000, v197
 v_mul_f32 v219, v219, v221
 s_waitcnt lgkmcnt(4)
 v_mfma_f32_32x32x16_bf16 v[112:127], v[52:55], v[188:191], v[112:127]
 s_waitcnt vmcnt(9)
 s_barrier
 buffer_load_dword v250, v251, s[76:79], s60 offen
 s_add_u32 s60, s60, s61
 ds_read_b128 v[176:179], v4 offset:16384
 ds_read_b128 v[180:183], v5 offset:16384
 ds_read_b64_tr_b16 v[40:41], v21 offset:12288
 ds_read_b64_tr_b16 v[42:43], v21 offset:12800
 s_add_u32 m0, s35, 22528
 s_add_u32 s37, s88, 1351680
 buffer_load_dwordx4 v8, s[40:43], s37 offen lds
 s_waitcnt lgkmcnt(6)
 v_mfma_f32_32x32x16_bf16 v[128:143], v[56:59], v[188:191], v[128:143]
 ds_read_b64_tr_b16 v[44:45], v22 offset:12288
 ds_read_b64_tr_b16 v[46:47], v22 offset:12800
 s_add_u32 m0, s35, 32768
 s_add_u32 s37, s89, 1216512
 buffer_load_dwordx4 v9, s[56:59], s37 offen lds
 s_waitcnt lgkmcnt(6)
 v_mfma_f32_32x32x16_bf16 v[144:159], v[60:63], v[188:191], v[144:159]
 ds_read_b64_tr_b16 v[48:49], v23 offset:12288
 ds_read_b64_tr_b16 v[50:51], v23 offset:12800
 s_add_u32 s37, s62, 22528
 s_cmp_lt_u32 s98, 6
 s_cselect_b32 m0, s37, s74
 s_nop 0
 buffer_load_dwordx4 v10, s[80:83], s90 offen lds
 s_add_u32 s90, s90, s63
 s_waitcnt lgkmcnt(4)
 v_mfma_f32_32x32x16_bf16 v[64:79], v[40:43], v[176:179], v[64:79]
 ds_read_b64_tr_b16 v[52:53], v24 offset:12288
 ds_read_b64_tr_b16 v[54:55], v24 offset:12800
 v_mul_f32 v220, v220, v222
 v_cvt_pk_bf16_f32 v219, v219, v220
 v_lshlrev_b32 v220, 16, v219
 s_waitcnt lgkmcnt(4)
 v_mfma_f32_32x32x16_bf16 v[80:95], v[44:47], v[176:179], v[80:95]
 ds_read_b64_tr_b16 v[56:57], v254 offset:20480
 ds_read_b64_tr_b16 v[58:59], v254 offset:20736
 v_and_b32 v219, 0xffff0000, v219
 v_add_f32 v217, v217, v220
 v_add_f32 v218, v218, v219
 s_waitcnt lgkmcnt(4)
 v_mfma_f32_32x32x16_bf16 v[96:111], v[48:51], v[176:179], v[96:111]
 ds_read_b64_tr_b16 v[60:61], v255 offset:20480
 ds_read_b64_tr_b16 v[62:63], v255 offset:20736
 v_lshlrev_b32 v219, 16, v194
 v_and_b32 v220, 0xffff0000, v194
 v_lshlrev_b32 v221, 16, v198
 s_waitcnt lgkmcnt(4)
 v_mfma_f32_32x32x16_bf16 v[112:127], v[52:55], v[176:179], v[112:127]
 ds_read_b64_tr_b16 v[40:41], v21 offset:14336
 ds_read_b64_tr_b16 v[42:43], v21 offset:14848
 v_and_b32 v222, 0xffff0000, v198
 v_mul_f32 v219, v219, v221
 v_mul_f32 v220, v220, v222
 s_waitcnt lgkmcnt(4)
 v_mfma_f32_32x32x16_bf16 v[128:143], v[56:59], v[176:179], v[128:143]
 ds_read_b64_tr_b16 v[44:45], v22 offset:14336
 ds_read_b64_tr_b16 v[46:47], v22 offset:14848
 v_cvt_pk_bf16_f32 v219, v219, v220
 v_lshlrev_b32 v220, 16, v219
 v_and_b32 v219, 0xffff0000, v219
 s_waitcnt lgkmcnt(4)
 v_mfma_f32_32x32x16_bf16 v[144:159], v[60:63], v[176:179], v[144:159]
 ds_read_b64_tr_b16 v[48:49], v23 offset:14336
 ds_read_b64_tr_b16 v[50:51], v23 offset:14848
 v_add_f32 v217, v217, v220
 v_add_f32 v218, v218, v219
 v_lshlrev_b32 v219, 16, v195
 s_waitcnt lgkmcnt(4)
 v_mfma_f32_32x32x16_bf16 v[64:79], v[40:43], v[180:183], v[64:79]
 ds_read_b64_tr_b16 v[52:53], v24 offset:14336
 ds_read_b64_tr_b16 v[54:55], v24 offset:14848
 v_and_b32 v220, 0xffff0000, v195
 v_lshlrev_b32 v221, 16, v199
 v_and_b32 v222, 0xffff0000, v199
 s_waitcnt lgkmcnt(4)
 v_mfma_f32_32x32x16_bf16 v[80:95], v[44:47], v[180:183], v[80:95]
 ds_read_b64_tr_b16 v[56:57], v254 offset:21504
 ds_read_b64_tr_b16 v[58:59], v254 offset:21760
 v_mul_f32 v219, v219, v221
 v_mul_f32 v220, v220, v222
 v_cvt_pk_bf16_f32 v219, v219, v220
 s_waitcnt lgkmcnt(4)
 v_mfma_f32_32x32x16_bf16 v[96:111], v[48:51], v[180:183], v[96:111]
 ds_read_b64_tr_b16 v[60:61], v255 offset:21504
 ds_read_b64_tr_b16 v[62:63], v255 offset:21760
 v_lshlrev_b32 v220, 16, v219
 v_and_b32 v219, 0xffff0000, v219
 v_add_f32 v217, v217, v220
 s_waitcnt lgkmcnt(4)
 v_mfma_f32_32x32x16_bf16 v[112:127], v[52:55], v[180:183], v[112:127]
 s_waitcnt vmcnt(9)
 s_barrier
 ds_read_b128 v[184:187], v6 offset:16384
 ds_read_b128 v[188:191], v7 offset:16384
 ds_read_b64_tr_b16 v[40:41], v21 offset:34816
 ds_read_b64_tr_b16 v[42:43], v21 offset:35328
 s_add_u32 m0, s35, 45056
 s_add_u32 s37, s88, 1474560
 buffer_load_dwordx4 v8, s[40:43], s37 offen lds
 s_waitcnt lgkmcnt(6)
 v_mfma_f32_32x32x16_bf16 v[128:143], v[56:59], v[180:183], v[128:143]
 ds_read_b64_tr_b16 v[44:45], v22 offset:34816
 ds_read_b64_tr_b16 v[46:47], v22 offset:35328
 s_add_u32 m0, s35, 55296
 s_add_u32 s37, s89, 1327104
 buffer_load_dwordx4 v9, s[56:59], s37 offen lds
 s_waitcnt lgkmcnt(6)
 v_mfma_f32_32x32x16_bf16 v[144:159], v[60:63], v[180:183], v[144:159]
 ds_read_b64_tr_b16 v[48:49], v23 offset:34816
 ds_read_b64_tr_b16 v[50:51], v23 offset:35328
 s_add_u32 s37, s62, 45056
 s_cmp_lt_u32 s98, 6
 s_cselect_b32 m0, s37, s74
 s_nop 0
 buffer_load_dwordx4 v10, s[80:83], s90 offen lds
 s_add_u32 s90, s90, s63
 s_waitcnt lgkmcnt(4)
 v_mfma_f32_32x32x16_bf16 v[64:79], v[40:43], v[184:187], v[64:79]
 ds_read_b64_tr_b16 v[52:53], v24 offset:34816
 ds_read_b64_tr_b16 v[54:55], v24 offset:35328
 s_add_u32 m0, s36, 0
 s_movk_i32 s37, 768
 buffer_load_dwordx4 v2, s[4:7], s37 offen lds
 s_waitcnt lgkmcnt(4)
 v_mfma_f32_32x32x16_bf16 v[80:95], v[44:47], v[184:187], v[80:95]
 ds_read_b64_tr_b16 v[56:57], v254 offset:43008
 ds_read_b64_tr_b16 v[58:59], v254 offset:43264
 s_add_u32 m0, s36, 1024
 s_movk_i32 s37, 768
 buffer_load_dwordx4 v3, s[4:7], s37 offen lds
 s_waitcnt lgkmcnt(4)
 v_mfma_f32_32x32x16_bf16 v[96:111], v[48:51], v[184:187], v[96:111]
 ds_read_b64_tr_b16 v[60:61], v255 offset:43008
 ds_read_b64_tr_b16 v[62:63], v255 offset:43264
 v_add_f32 v218, v218, v219
 v_lshlrev_b32 v219, 16, v200
 v_and_b32 v220, 0xffff0000, v200
 s_waitcnt lgkmcnt(4)
 v_mfma_f32_32x32x16_bf16 v[112:127], v[52:55], v[184:187], v[112:127]
 ds_read_b64_tr_b16 v[40:41], v21 offset:36864
 ds_read_b64_tr_b16 v[42:43], v21 offset:37376
 v_lshlrev_b32 v221, 16, v204
 v_and_b32 v222, 0xffff0000, v204
 v_mul_f32 v219, v219, v221
 s_waitcnt lgkmcnt(4)
 v_mfma_f32_32x32x16_bf16 v[128:143], v[56:59], v[184:187], v[128:143]
 ds_read_b64_tr_b16 v[44:45], v22 offset:36864
 ds_read_b64_tr_b16 v[46:47], v22 offset:37376
 v_mul_f32 v220, v220, v222
 v_cvt_pk_bf16_f32 v219, v219, v220
 v_lshlrev_b32 v220, 16, v219
 s_waitcnt lgkmcnt(4)
 v_mfma_f32_32x32x16_bf16 v[144:159], v[60:63], v[184:187], v[144:159]
 ds_read_b64_tr_b16 v[48:49], v23 offset:36864
 ds_read_b64_tr_b16 v[50:51], v23 offset:37376
 v_and_b32 v219, 0xffff0000, v219
 v_add_f32 v217, v217, v220
 v_add_f32 v218, v218, v219
 s_waitcnt lgkmcnt(4)
 v_mfma_f32_32x32x16_bf16 v[64:79], v[40:43], v[188:191], v[64:79]
 ds_read_b64_tr_b16 v[52:53], v24 offset:36864
 ds_read_b64_tr_b16 v[54:55], v24 offset:37376
 v_lshlrev_b32 v219, 16, v201
 v_and_b32 v220, 0xffff0000, v201
 v_lshlrev_b32 v221, 16, v205
 s_waitcnt lgkmcnt(4)
 v_mfma_f32_32x32x16_bf16 v[80:95], v[44:47], v[188:191], v[80:95]
 ds_read_b64_tr_b16 v[56:57], v254 offset:44032
 ds_read_b64_tr_b16 v[58:59], v254 offset:44288
 v_and_b32 v222, 0xffff0000, v205
 v_mul_f32 v219, v219, v221
 v_mul_f32 v220, v220, v222
 s_waitcnt lgkmcnt(4)
 v_mfma_f32_32x32x16_bf16 v[96:111], v[48:51], v[188:191], v[96:111]
 ds_read_b64_tr_b16 v[60:61], v255 offset:44032
 ds_read_b64_tr_b16 v[62:63], v255 offset:44288
 v_cvt_pk_bf16_f32 v219, v219, v220
 v_lshlrev_b32 v220, 16, v219
 v_and_b32 v219, 0xffff0000, v219
 s_waitcnt lgkmcnt(4)
 v_mfma_f32_32x32x16_bf16 v[112:127], v[52:55], v[188:191], v[112:127]
 s_waitcnt vmcnt(9)
 s_barrier
 buffer_load_dword v250, v251, s[76:79], s60 offen
 s_add_u32 s60, s60, s61
 ds_read_b128 v[176:179], v4 offset:32768
 ds_read_b128 v[180:183], v5 offset:32768
 ds_read_b64_tr_b16 v[40:41], v17 offset:10240
 ds_read_b64_tr_b16 v[42:43], v17 offset:10752
 s_add_u32 m0, s35, 67584
 s_add_u32 s37, s88, 1597440
 buffer_load_dwordx4 v8, s[40:43], s37 offen lds
 s_waitcnt lgkmcnt(6)
 v_mfma_f32_32x32x16_bf16 v[128:143], v[56:59], v[188:191], v[128:143]
 ds_read_b64_tr_b16 v[44:45], v18 offset:10240
 ds_read_b64_tr_b16 v[46:47], v18 offset:10752
 s_add_u32 m0, s35, 77824
 s_add_u32 s37, s89, 1437696
 buffer_load_dwordx4 v9, s[56:59], s37 offen lds
 s_waitcnt lgkmcnt(6)
 v_mfma_f32_32x32x16_bf16 v[144:159], v[60:63], v[188:191], v[144:159]
 ds_read_b64_tr_b16 v[48:49], v19 offset:10240
 ds_read_b64_tr_b16 v[50:51], v19 offset:10752
 s_add_u32 s37, s62, 67584
 s_cmp_lt_u32 s98, 6
 s_cselect_b32 m0, s37, s74
 s_nop 0
 buffer_load_dwordx4 v10, s[80:83], s90 offen lds
 s_add_u32 s90, s90, s63
 s_waitcnt lgkmcnt(4)
 v_mfma_f32_32x32x16_bf16 v[64:79], v[40:43], v[176:179], v[64:79]
 ds_read_b64_tr_b16 v[52:53], v20 offset:10240
 ds_read_b64_tr_b16 v[54:55], v20 offset:10752
 v_add_f32 v217, v217, v220
 v_add_f32 v218, v218, v219
 v_lshlrev_b32 v219, 16, v202
 s_waitcnt lgkmcnt(4)
 v_mfma_f32_32x32x16_bf16 v[80:95], v[44:47], v[176:179], v[80:95]
 ds_read_b64_tr_b16 v[56:57], v252 offset:18432
 ds_read_b64_tr_b16 v[58:59], v252 offset:18688
 v_and_b32 v220, 0xffff0000, v202
 v_lshlrev_b32 v221, 16, v206
 v_and_b32 v222, 0xffff0000, v206
 s_waitcnt lgkmcnt(4)
 v_mfma_f32_32x32x16_bf16 v[96:111], v[48:51], v[176:179], v[96:111]
 ds_read_b64_tr_b16 v[60:61], v253 offset:18432
 ds_read_b64_tr_b16 v[62:63], v253 offset:18688
 v_mul_f32 v219, v219, v221
 v_mul_f32 v220, v220, v222
 v_cvt_pk_bf16_f32 v219, v219, v220
 s_waitcnt lgkmcnt(4)
 v_mfma_f32_32x32x16_bf16 v[112:127], v[52:55], v[176:179], v[112:127]
 ds_read_b64_tr_b16 v[40:41], v17 offset:12288
 ds_read_b64_tr_b16 v[42:43], v17 offset:12800
 v_lshlrev_b32 v220, 16, v219
 v_and_b32 v219, 0xffff0000, v219
 v_add_f32 v217, v217, v220
 s_waitcnt lgkmcnt(4)
 v_mfma_f32_32x32x16_bf16 v[128:143], v[56:59], v[176:179], v[128:143]
 ds_read_b64_tr_b16 v[44:45], v18 offset:12288
 ds_read_b64_tr_b16 v[46:47], v18 offset:12800
 v_add_f32 v218, v218, v219
 v_lshlrev_b32 v219, 16, v203
 v_and_b32 v220, 0xffff0000, v203
 s_waitcnt lgkmcnt(4)
 v_mfma_f32_32x32x16_bf16 v[144:159], v[60:63], v[176:179], v[144:159]
 ds_read_b64_tr_b16 v[48:49], v19 offset:12288
 ds_read_b64_tr_b16 v[50:51], v19 offset:12800
 v_lshlrev_b32 v221, 16, v207
 v_and_b32 v222, 0xffff0000, v207
 v_mul_f32 v219, v219, v221
 s_waitcnt lgkmcnt(4)
 v_mfma_f32_32x32x16_bf16 v[64:79], v[40:43], v[180:183], v[64:79]
 ds_read_b64_tr_b16 v[52:53], v20 offset:12288
 ds_read_b64_tr_b16 v[54:55], v20 offset:12800
 v_mul_f32 v220, v220, v222
 v_cvt_pk_bf16_f32 v219, v219, v220
 v_lshlrev_b32 v220, 16, v219
 s_waitcnt lgkmcnt(4)
 v_mfma_f32_32x32x16_bf16 v[80:95], v[44:47], v[180:183], v[80:95]
 ds_read_b64_tr_b16 v[56:57], v252 offset:19456
 ds_read_b64_tr_b16 v[58:59], v252 offset:19712
 v_and_b32 v219, 0xffff0000, v219
 v_add_f32 v217, v217, v220
 v_add_f32 v218, v218, v219
 s_waitcnt lgkmcnt(4)
 v_mfma_f32_32x32x16_bf16 v[96:111], v[48:51], v[180:183], v[96:111]
 ds_read_b64_tr_b16 v[60:61], v253 offset:19456
 ds_read_b64_tr_b16 v[62:63], v253 offset:19712
 v_lshlrev_b32 v219, 16, v208
 v_and_b32 v220, 0xffff0000, v208
 v_lshlrev_b32 v221, 16, v212
 s_waitcnt lgkmcnt(4)
 v_mfma_f32_32x32x16_bf16 v[112:127], v[52:55], v[180:183], v[112:127]
 s_waitcnt vmcnt(9)
 s_barrier
 ds_read_b128 v[184:187], v6 offset:32768
 ds_read_b128 v[188:191], v7 offset:32768
 ds_read_b64_tr_b16 v[40:41], v17 offset:32768
 ds_read_b64_tr_b16 v[42:43], v17 offset:33280
 s_add_u32 m0, s35, 90112
 s_add_u32 s37, s88, 1720320
 buffer_load_dwordx4 v8, s[40:43], s37 offen lds
 s_waitcnt lgkmcnt(6)
 v_mfma_f32_32x32x16_bf16 v[128:143], v[56:59], v[180:183], v[128:143]
 ds_read_b64_tr_b16 v[44:45], v18 offset:32768
 ds_read_b64_tr_b16 v[46:47], v18 offset:33280
 s_add_u32 m0, s35, 100352
 s_add_u32 s37, s89, 1548288
 buffer_load_dwordx4 v9, s[56:59], s37 offen lds
 s_waitcnt lgkmcnt(6)
 v_mfma_f32_32x32x16_bf16 v[144:159], v[60:63], v[180:183], v[144:159]
 ds_read_b64_tr_b16 v[48:49], v19 offset:32768
 ds_read_b64_tr_b16 v[50:51], v19 offset:33280
 s_add_u32 s37, s62, 90112
 s_cmp_lt_u32 s98, 6
 s_cselect_b32 m0, s37, s74
 s_nop 0
 buffer_load_dwordx4 v10, s[80:83], s90 offen lds
 s_add_u32 s90, s90, s63
 s_waitcnt lgkmcnt(4)
 v_mfma_f32_32x32x16_bf16 v[64:79], v[40:43], v[184:187], v[64:79]
 ds_read_b64_tr_b16 v[52:53], v20 offset:32768
 ds_read_b64_tr_b16 v[54:55], v20 offset:33280
 s_add_u32 m0, s36, 16384
 s_movk_i32 s37, 896
 buffer_load_dwordx4 v2, s[4:7], s37 offen lds
 s_waitcnt lgkmcnt(4)
 v_mfma_f32_32x32x16_bf16 v[80:95], v[44:47], v[184:187], v[80:95]
 ds_read_b64_tr_b16 v[56:57], v252 offset:40960
 ds_read_b64_tr_b16 v[58:59], v252 offset:41216
 s_add_u32 m0, s36, 17408
 s_movk_i32 s37, 896
 buffer_load_dwordx4 v3, s[4:7], s37 offen lds
 s_waitcnt lgkmcnt(4)
 v_mfma_f32_32x32x16_bf16 v[96:111], v[48:51], v[184:187], v[96:111]
 ds_read_b64_tr_b16 v[60:61], v253 offset:40960
 ds_read_b64_tr_b16 v[62:63], v253 offset:41216
 v_and_b32 v222, 0xffff0000, v212
 v_mul_f32 v219, v219, v221
 v_mul_f32 v220, v220, v222
 s_waitcnt lgkmcnt(4)
 v_mfma_f32_32x32x16_bf16 v[112:127], v[52:55], v[184:187], v[112:127]
 ds_read_b64_tr_b16 v[40:41], v17 offset:34816
 ds_read_b64_tr_b16 v[42:43], v17 offset:35328
 v_cvt_pk_bf16_f32 v219, v219, v220
 v_lshlrev_b32 v220, 16, v219
 v_and_b32 v219, 0xffff0000, v219
 s_waitcnt lgkmcnt(4)
 v_mfma_f32_32x32x16_bf16 v[128:143], v[56:59], v[184:187], v[128:143]
 ds_read_b64_tr_b16 v[44:45], v18 offset:34816
 ds_read_b64_tr_b16 v[46:47], v18 offset:35328
 v_add_f32 v217, v217, v220
 v_add_f32 v218, v218, v219
 v_lshlrev_b32 v219, 16, v209
 s_waitcnt lgkmcnt(4)
 v_mfma_f32_32x32x16_bf16 v[144:159], v[60:63], v[184:187], v[144:159]
 ds_read_b64_tr_b16 v[48:49], v19 offset:34816
 ds_read_b64_tr_b16 v[50:51], v19 offset:35328
 v_and_b32 v220, 0xffff0000, v209
 v_lshlrev_b32 v221, 16, v213
 v_and_b32 v222, 0xffff0000, v213
 s_waitcnt lgkmcnt(4)
 v_mfma_f32_32x32x16_bf16 v[64:79], v[40:43], v[188:191], v[64:79]
 ds_read_b64_tr_b16 v[52:53], v20 offset:34816
 ds_read_b64_tr_b16 v[54:55], v20 offset:35328
 v_mul_f32 v219, v219, v221
 v_mul_f32 v220, v220, v222
 v_cvt_pk_bf16_f32 v219, v219, v220
 s_waitcnt lgkmcnt(4)
 v_mfma_f32_32x32x16_bf16 v[80:95], v[44:47], v[188:191], v[80:95]
 ds_read_b64_tr_b16 v[56:57], v252 offset:41984
 ds_read_b64_tr_b16 v[58:59], v252 offset:42240
 v_lshlrev_b32 v220, 16, v219
 v_and_b32 v219, 0xffff0000, v219
 v_add_f32 v217, v217, v220
 s_waitcnt lgkmcnt(4)
 v_mfma_f32_32x32x16_bf16 v[96:111], v[48:51], v[188:191], v[96:111]
 ds_read_b64_tr_b16 v[60:61], v253 offset:41984
 ds_read_b64_tr_b16 v[62:63], v253 offset:42240
 v_add_f32 v218, v218, v219
 v_lshlrev_b32 v219, 16, v210
 v_and_b32 v220, 0xffff0000, v210
 s_waitcnt lgkmcnt(4)
 v_mfma_f32_32x32x16_bf16 v[112:127], v[52:55], v[188:191], v[112:127]
 s_waitcnt vmcnt(9)
 s_barrier
 buffer_load_dword v250, v251, s[76:79], s60 offen
 s_add_u32 s60, s60, s61
 ds_read_b128 v[176:179], v4 offset:0
 ds_read_b128 v[180:183], v5 offset:0
 ds_read_b64_tr_b16 v[40:41], v17 offset:55296
 ds_read_b64_tr_b16 v[42:43], v17 offset:55808
 s_add_u32 m0, s35, 0
 s_add_u32 s37, s88, 1843200
 buffer_load_dwordx4 v8, s[40:43], s37 offen lds
 s_waitcnt lgkmcnt(6)
 v_mfma_f32_32x32x16_bf16 v[128:143], v[56:59], v[188:191], v[128:143]
 ds_read_b64_tr_b16 v[44:45], v18 offset:55296
 ds_read_b64_tr_b16 v[46:47], v18 offset:55808
 s_add_u32 m0, s35, 10240
 s_add_u32 s37, s89, 1658880
 buffer_load_dwordx4 v9, s[56:59], s37 offen lds
 s_waitcnt lgkmcnt(6)
 v_mfma_f32_32x32x16_bf16 v[144:159], v[60:63], v[188:191], v[144:159]
 ds_read_b64_tr_b16 v[48:49], v19 offset:55296
 ds_read_b64_tr_b16 v[50:51], v19 offset:55808
 s_add_u32 s37, s62, 0
 s_cmp_lt_u32 s98, 6
 s_cselect_b32 m0, s37, s74
 s_nop 0
 buffer_load_dwordx4 v10, s[80:83], s90 offen lds
 s_add_u32 s90, s90, s63
 s_waitcnt lgkmcnt(4)
 v_mfma_f32_32x32x16_bf16 v[64:79], v[40:43], v[176:179], v[64:79]
 ds_read_b64_tr_b16 v[52:53], v20 offset:55296
 ds_read_b64_tr_b16 v[54:55], v20 offset:55808
 v_lshlrev_b32 v221, 16, v214
 v_and_b32 v222, 0xffff0000, v214
 v_mul_f32 v219, v219, v221
 s_waitcnt lgkmcnt(4)
 v_mfma_f32_32x32x16_bf16 v[80:95], v[44:47], v[176:179], v[80:95]
 ds_read_b64_tr_b16 v[56:57], v252 offset:63488
 ds_read_b64_tr_b16 v[58:59], v252 offset:63744
 v_mul_f32 v220, v220, v222
 v_cvt_pk_bf16_f32 v219, v219, v220
 v_lshlrev_b32 v220, 16, v219
 s_waitcnt lgkmcnt(4)
 v_mfma_f32_32x32x16_bf16 v[96:111], v[48:51], v[176:179], v[96:111]
 ds_read_b64_tr_b16 v[60:61], v253 offset:63488
 ds_read_b64_tr_b16 v[62:63], v253 offset:63744
 v_and_b32 v219, 0xffff0000, v219
 v_add_f32 v217, v217, v220
 v_add_f32 v218, v218, v219
 s_waitcnt lgkmcnt(4)
 v_mfma_f32_32x32x16_bf16 v[112:127], v[52:55], v[176:179], v[112:127]
 ds_read_b64_tr_b16 v[40:41], v17 offset:57344
 ds_read_b64_tr_b16 v[42:43], v17 offset:57856
 v_lshlrev_b32 v219, 16, v211
 v_and_b32 v220, 0xffff0000, v211
 v_lshlrev_b32 v221, 16, v215
 s_waitcnt lgkmcnt(4)
 v_mfma_f32_32x32x16_bf16 v[128:143], v[56:59], v[176:179], v[128:143]
 ds_read_b64_tr_b16 v[44:45], v18 offset:57344
 ds_read_b64_tr_b16 v[46:47], v18 offset:57856
 v_and_b32 v222, 0xffff0000, v215
 v_mul_f32 v219, v219, v221
 v_mul_f32 v220, v220, v222
 s_waitcnt lgkmcnt(4)
 v_mfma_f32_32x32x16_bf16 v[144:159], v[60:63], v[176:179], v[144:159]
 ds_read_b64_tr_b16 v[48:49], v19 offset:57344
 ds_read_b64_tr_b16 v[50:51], v19 offset:57856
 v_cvt_pk_bf16_f32 v219, v219, v220
 v_lshlrev_b32 v220, 16, v219
 v_and_b32 v219, 0xffff0000, v219
 s_waitcnt lgkmcnt(4)
 v_mfma_f32_32x32x16_bf16 v[64:79], v[40:43], v[180:183], v[64:79]
 ds_read_b64_tr_b16 v[52:53], v20 offset:57344
 ds_read_b64_tr_b16 v[54:55], v20 offset:57856
 v_add_f32 v217, v217, v220
 v_add_f32 v218, v218, v219
 v_add_f32 v217, v217, v218
 s_waitcnt lgkmcnt(4)
 v_mfma_f32_32x32x16_bf16 v[80:95], v[44:47], v[180:183], v[80:95]
 ds_read_b64_tr_b16 v[56:57], v252 offset:64512
 ds_read_b64_tr_b16 v[58:59], v252 offset:64768
 s_waitcnt lgkmcnt(4)
 v_mfma_f32_32x32x16_bf16 v[96:111], v[48:51], v[180:183], v[96:111]
 ds_read_b64_tr_b16 v[60:61], v253 offset:64512
 ds_read_b64_tr_b16 v[62:63], v253 offset:64768
 ds_swizzle_b32 v218, v217 offset:1055
 s_waitcnt lgkmcnt(5)
 v_mfma_f32_32x32x16_bf16 v[112:127], v[52:55], v[180:183], v[112:127]
 s_waitcnt vmcnt(9)
 s_barrier
 ds_read_b128 v[184:187], v6 offset:0
 ds_read_b128 v[188:191], v7 offset:0
 ds_read_b64_tr_b16 v[40:41], v21 offset:12288
 ds_read_b64_tr_b16 v[42:43], v21 offset:12800
 s_add_u32 m0, s35, 22528
 s_add_u32 s37, s88, 1966080
 buffer_load_dwordx4 v8, s[40:43], s37 offen lds
 s_waitcnt lgkmcnt(7)
 v_mfma_f32_32x32x16_bf16 v[128:143], v[56:59], v[180:183], v[128:143]
 ds_read_b64_tr_b16 v[44:45], v22 offset:12288
 ds_read_b64_tr_b16 v[46:47], v22 offset:12800
 s_add_u32 m0, s35, 32768
 s_add_u32 s37, s89, 1769472
 buffer_load_dwordx4 v9, s[56:59], s37 offen lds
 s_waitcnt lgkmcnt(7)
 v_mfma_f32_32x32x16_bf16 v[144:159], v[60:63], v[180:183], v[144:159]
 ds_read_b64_tr_b16 v[48:49], v23 offset:12288
 ds_read_b64_tr_b16 v[50:51], v23 offset:12800
 s_add_u32 s37, s62, 22528
 s_cmp_lt_u32 s98, 6
 s_cselect_b32 m0, s37, s74
 s_nop 0
 buffer_load_dwordx4 v10, s[80:83], s90 offen lds
 s_add_u32 s90, s90, s63
 s_waitcnt lgkmcnt(4)
 v_mfma_f32_32x32x16_bf16 v[64:79], v[40:43], v[184:187], v[64:79]
 ds_read_b64_tr_b16 v[52:53], v24 offset:12288
 ds_read_b64_tr_b16 v[54:55], v24 offset:12800
 s_add_u32 m0, s36, 32768
 s_movk_i32 s37, 1024
 buffer_load_dwordx4 v2, s[4:7], s37 offen lds
 s_waitcnt lgkmcnt(4)
 v_mfma_f32_32x32x16_bf16 v[80:95], v[44:47], v[184:187], v[80:95]
 ds_read_b64_tr_b16 v[56:57], v254 offset:20480
 ds_read_b64_tr_b16 v[58:59], v254 offset:20736
 s_add_u32 m0, s36, 33792
 s_movk_i32 s37, 1024
 buffer_load_dwordx4 v3, s[4:7], s37 offen lds
 s_waitcnt lgkmcnt(4)
 v_mfma_f32_32x32x16_bf16 v[96:111], v[48:51], v[184:187], v[96:111]
 ds_read_b64_tr_b16 v[60:61], v255 offset:20480
 ds_read_b64_tr_b16 v[62:63], v255 offset:20736
 s_waitcnt lgkmcnt(4)
 v_mfma_f32_32x32x16_bf16 v[112:127], v[52:55], v[184:187], v[112:127]
 ds_read_b64_tr_b16 v[40:41], v21 offset:14336
 ds_read_b64_tr_b16 v[42:43], v21 offset:14848
 s_waitcnt lgkmcnt(4)
 v_mfma_f32_32x32x16_bf16 v[128:143], v[56:59], v[184:187], v[128:143]
 ds_read_b64_tr_b16 v[44:45], v22 offset:14336
 ds_read_b64_tr_b16 v[46:47], v22 offset:14848
 v_add_f32 v217, v217, v218
 s_waitcnt lgkmcnt(4)
 v_mfma_f32_32x32x16_bf16 v[144:159], v[60:63], v[184:187], v[144:159]
 ds_read_b64_tr_b16 v[48:49], v23 offset:14336
 ds_read_b64_tr_b16 v[50:51], v23 offset:14848
 ds_swizzle_b32 v218, v217 offset:2079
 s_waitcnt lgkmcnt(5)
 v_mfma_f32_32x32x16_bf16 v[64:79], v[40:43], v[188:191], v[64:79]
 ds_read_b64_tr_b16 v[52:53], v24 offset:14336
 ds_read_b64_tr_b16 v[54:55], v24 offset:14848
 s_waitcnt lgkmcnt(5)
 v_mfma_f32_32x32x16_bf16 v[80:95], v[44:47], v[188:191], v[80:95]
 ds_read_b64_tr_b16 v[56:57], v254 offset:21504
 ds_read_b64_tr_b16 v[58:59], v254 offset:21760
 s_waitcnt lgkmcnt(5)
 v_mfma_f32_32x32x16_bf16 v[96:111], v[48:51], v[188:191], v[96:111]
 ds_read_b64_tr_b16 v[60:61], v255 offset:21504
 ds_read_b64_tr_b16 v[62:63], v255 offset:21760
 s_waitcnt lgkmcnt(6)
 v_add_f32 v217, v217, v218
 s_waitcnt lgkmcnt(4)
 v_mfma_f32_32x32x16_bf16 v[112:127], v[52:55], v[188:191], v[112:127]
 s_waitcnt vmcnt(9)
 s_barrier
 ds_read_b128 v[176:179], v4 offset:16384
 ds_read_b128 v[180:183], v5 offset:16384
 ds_read_b64_tr_b16 v[40:41], v21 offset:34816
 ds_read_b64_tr_b16 v[42:43], v21 offset:35328
 s_add_u32 m0, s35, 45056
 s_add_u32 s37, s88, 2088960
 buffer_load_dwordx4 v8, s[40:43], s37 offen lds
 s_waitcnt lgkmcnt(6)
 v_mfma_f32_32x32x16_bf16 v[128:143], v[56:59], v[188:191], v[128:143]
 ds_read_b64_tr_b16 v[44:45], v22 offset:34816
 ds_read_b64_tr_b16 v[46:47], v22 offset:35328
 s_add_u32 m0, s35, 55296
 s_add_u32 s37, s89, 1880064
 buffer_load_dwordx4 v9, s[56:59], s37 offen lds
 s_waitcnt lgkmcnt(6)
 v_mfma_f32_32x32x16_bf16 v[144:159], v[60:63], v[188:191], v[144:159]
 ds_read_b64_tr_b16 v[48:49], v23 offset:34816
 ds_read_b64_tr_b16 v[50:51], v23 offset:35328
 s_add_u32 s37, s62, 45056
 s_cmp_lt_u32 s98, 6
 s_cselect_b32 m0, s37, s74
 s_nop 0
 buffer_load_dwordx4 v10, s[80:83], s90 offen lds
 s_add_u32 s90, s90, s63
 s_waitcnt lgkmcnt(4)
 v_mfma_f32_32x32x16_bf16 v[64:79], v[40:43], v[176:179], v[64:79]
 ds_read_b64_tr_b16 v[52:53], v24 offset:34816
 ds_read_b64_tr_b16 v[54:55], v24 offset:35328
 ds_swizzle_b32 v218, v217 offset:4127
 s_waitcnt lgkmcnt(5)
 v_mfma_f32_32x32x16_bf16 v[80:95], v[44:47], v[176:179], v[80:95]
 ds_read_b64_tr_b16 v[56:57], v254 offset:43008
 ds_read_b64_tr_b16 v[58:59], v254 offset:43264
 s_waitcnt lgkmcnt(5)
 v_mfma_f32_32x32x16_bf16 v[96:111], v[48:51], v[176:179], v[96:111]
 ds_read_b64_tr_b16 v[60:61], v255 offset:43008
 ds_read_b64_tr_b16 v[62:63], v255 offset:43264
 s_waitcnt lgkmcnt(5)
 v_mfma_f32_32x32x16_bf16 v[112:127], v[52:55], v[176:179], v[112:127]
 ds_read_b64_tr_b16 v[40:41], v21 offset:36864
 ds_read_b64_tr_b16 v[42:43], v21 offset:37376
 s_waitcnt lgkmcnt(6)
 v_add_f32 v217, v217, v218
 s_waitcnt lgkmcnt(4)
 v_mfma_f32_32x32x16_bf16 v[128:143], v[56:59], v[176:179], v[128:143]
 ds_read_b64_tr_b16 v[44:45], v22 offset:36864
 ds_read_b64_tr_b16 v[46:47], v22 offset:37376
 ds_swizzle_b32 v218, v217 offset:8223
 s_waitcnt lgkmcnt(5)
 v_mfma_f32_32x32x16_bf16 v[144:159], v[60:63], v[176:179], v[144:159]
 ds_read_b64_tr_b16 v[48:49], v23 offset:36864
 ds_read_b64_tr_b16 v[50:51], v23 offset:37376
 s_waitcnt lgkmcnt(5)
 v_mfma_f32_32x32x16_bf16 v[64:79], v[40:43], v[180:183], v[64:79]
 ds_read_b64_tr_b16 v[52:53], v24 offset:36864
 ds_read_b64_tr_b16 v[54:55], v24 offset:37376
 s_waitcnt lgkmcnt(5)
 v_mfma_f32_32x32x16_bf16 v[80:95], v[44:47], v[180:183], v[80:95]
 ds_read_b64_tr_b16 v[56:57], v254 offset:44032
 ds_read_b64_tr_b16 v[58:59], v254 offset:44288
 s_waitcnt lgkmcnt(6)
 v_add_f32 v217, v217, v218
 s_waitcnt lgkmcnt(4)
 v_mfma_f32_32x32x16_bf16 v[96:111], v[48:51], v[180:183], v[96:111]
 ds_read_b64_tr_b16 v[60:61], v255 offset:44032
 ds_read_b64_tr_b16 v[62:63], v255 offset:44288
 ds_swizzle_b32 v218, v217 offset:16415
 s_waitcnt lgkmcnt(5)
 v_mfma_f32_32x32x16_bf16 v[112:127], v[52:55], v[180:183], v[112:127]
 s_waitcnt vmcnt(8)
 s_barrier
 ds_read_b128 v[184:187], v6 offset:16384
 ds_read_b128 v[188:191], v7 offset:16384
 ds_read_b64_tr_b16 v[40:41], v17 offset:10240
 ds_read_b64_tr_b16 v[42:43], v17 offset:10752
 s_add_u32 m0, s35, 67584
 s_add_u32 s37, s88, 2211840
 buffer_load_dwordx4 v8, s[40:43], s37 offen lds
 s_waitcnt lgkmcnt(7)
 v_mfma_f32_32x32x16_bf16 v[128:143], v[56:59], v[180:183], v[128:143]
 ds_read_b64_tr_b16 v[44:45], v18 offset:10240
 ds_read_b64_tr_b16 v[46:47], v18 offset:10752
 s_add_u32 m0, s35, 77824
 s_add_u32 s37, s89, 1990656
 buffer_load_dwordx4 v9, s[56:59], s37 offen lds
 s_waitcnt lgkmcnt(7)
 v_mfma_f32_32x32x16_bf16 v[144:159], v[60:63], v[180:183], v[144:159]
 ds_read_b64_tr_b16 v[48:49], v19 offset:10240
 ds_read_b64_tr_b16 v[50:51], v19 offset:10752
 s_add_u32 s37, s62, 67584
 s_cmp_lt_u32 s98, 6
 s_cselect_b32 m0, s37, s74
 s_nop 0
 buffer_load_dwordx4 v10, s[80:83], s90 offen lds
 s_add_u32 s90, s90, s63
 s_waitcnt lgkmcnt(4)
 v_mfma_f32_32x32x16_bf16 v[64:79], v[40:43], v[184:187], v[64:79]
 ds_read_b64_tr_b16 v[52:53], v20 offset:10240
 ds_read_b64_tr_b16 v[54:55], v20 offset:10752
 s_add_u32 m0, s36, 0
 s_movk_i32 s37, 1152
 buffer_load_dwordx4 v2, s[4:7], s37 offen lds
 s_waitcnt lgkmcnt(4)
 v_mfma_f32_32x32x16_bf16 v[80:95], v[44:47], v[184:187], v[80:95]
 ds_read_b64_tr_b16 v[56:57], v252 offset:18432
 ds_read_b64_tr_b16 v[58:59], v252 offset:18688
 s_add_u32 m0, s36, 1024
 s_movk_i32 s37, 1152
 buffer_load_dwordx4 v3, s[4:7], s37 offen lds
 s_waitcnt lgkmcnt(4)
 v_mfma_f32_32x32x16_bf16 v[96:111], v[48:51], v[184:187], v[96:111]
 ds_read_b64_tr_b16 v[60:61], v253 offset:18432
 ds_read_b64_tr_b16 v[62:63], v253 offset:18688
 s_waitcnt lgkmcnt(4)
 v_mfma_f32_32x32x16_bf16 v[112:127], v[52:55], v[184:187], v[112:127]
 ds_read_b64_tr_b16 v[40:41], v17 offset:12288
 ds_read_b64_tr_b16 v[42:43], v17 offset:12800
 s_waitcnt lgkmcnt(4)
 v_mfma_f32_32x32x16_bf16 v[128:143], v[56:59], v[184:187], v[128:143]
 ds_read_b64_tr_b16 v[44:45], v18 offset:12288
 ds_read_b64_tr_b16 v[46:47], v18 offset:12800
 v_add_f32 v217, v217, v218
 v_cvt_pk_bf16_f32 v217, v217, v217
 v_lshlrev_b32 v217, 16, v217
 s_waitcnt lgkmcnt(4)
 v_mfma_f32_32x32x16_bf16 v[144:159], v[60:63], v[184:187], v[144:159]
 ds_read_b64_tr_b16 v[48:49], v19 offset:12288
 ds_read_b64_tr_b16 v[50:51], v19 offset:12800
 v_mul_f32 v217, 0xbfb8aa3b, v217
 v_exp_f32 v217, v217
 v_lshlrev_b32 v219, 2, v216
 s_waitcnt lgkmcnt(4)
 v_mfma_f32_32x32x16_bf16 v[64:79], v[40:43], v[188:191], v[64:79]
 ds_read_b64_tr_b16 v[52:53], v20 offset:12288
 ds_read_b64_tr_b16 v[54:55], v20 offset:12800
 v_add_f32 v217, 1.0, v217
 v_rcp_f32 v217, v217
 s_mov_b32 s38, 20971520
 s_waitcnt lgkmcnt(4)
 v_mfma_f32_32x32x16_bf16 v[80:95], v[44:47], v[188:191], v[80:95]
 ds_read_b64_tr_b16 v[56:57], v252 offset:19456
 ds_read_b64_tr_b16 v[58:59], v252 offset:19712
 v_cvt_pk_bf16_f32 v217, v217, v217
 v_lshlrev_b32 v217, 16, v217
 buffer_store_dword v217, v219, s[16:19], s38 offen
 s_waitcnt lgkmcnt(4)
 v_mfma_f32_32x32x16_bf16 v[96:111], v[48:51], v[188:191], v[96:111]
 ds_read_b64_tr_b16 v[60:61], v253 offset:19456
 ds_read_b64_tr_b16 v[62:63], v253 offset:19712
 s_waitcnt lgkmcnt(4)
 v_mfma_f32_32x32x16_bf16 v[112:127], v[52:55], v[188:191], v[112:127]
 s_waitcnt vmcnt(9)
 s_barrier
 ds_read_b128 v[176:179], v4 offset:32768
 ds_read_b128 v[180:183], v5 offset:32768
 ds_read_b64_tr_b16 v[40:41], v17 offset:32768
 ds_read_b64_tr_b16 v[42:43], v17 offset:33280
 s_add_u32 m0, s35, 90112
 s_add_u32 s37, s88, 2334720
 buffer_load_dwordx4 v8, s[40:43], s37 offen lds
 s_waitcnt lgkmcnt(6)
 v_mfma_f32_32x32x16_bf16 v[128:143], v[56:59], v[188:191], v[128:143]
 ds_read_b64_tr_b16 v[44:45], v18 offset:32768
 ds_read_b64_tr_b16 v[46:47], v18 offset:33280
 s_add_u32 m0, s35, 100352
 s_add_u32 s37, s89, 2101248
 buffer_load_dwordx4 v9, s[56:59], s37 offen lds
 s_waitcnt lgkmcnt(6)
 v_mfma_f32_32x32x16_bf16 v[144:159], v[60:63], v[188:191], v[144:159]
 ds_read_b64_tr_b16 v[48:49], v19 offset:32768
 ds_read_b64_tr_b16 v[50:51], v19 offset:33280
 s_add_u32 s37, s62, 90112
 s_cmp_lt_u32 s98, 6
 s_cselect_b32 m0, s37, s74
 s_nop 0
 buffer_load_dwordx4 v10, s[80:83], s90 offen lds
 s_add_u32 s90, s90, s63
 s_waitcnt lgkmcnt(4)
 v_mfma_f32_32x32x16_bf16 v[64:79], v[40:43], v[176:179], v[64:79]
 ds_read_b64_tr_b16 v[52:53], v20 offset:32768
 ds_read_b64_tr_b16 v[54:55], v20 offset:33280
 s_waitcnt lgkmcnt(4)
 v_mfma_f32_32x32x16_bf16 v[80:95], v[44:47], v[176:179], v[80:95]
 ds_read_b64_tr_b16 v[56:57], v252 offset:40960
 ds_read_b64_tr_b16 v[58:59], v252 offset:41216
 s_waitcnt lgkmcnt(4)
 v_mfma_f32_32x32x16_bf16 v[96:111], v[48:51], v[176:179], v[96:111]
 ds_read_b64_tr_b16 v[60:61], v253 offset:40960
 ds_read_b64_tr_b16 v[62:63], v253 offset:41216
 s_waitcnt lgkmcnt(4)
 v_mfma_f32_32x32x16_bf16 v[112:127], v[52:55], v[176:179], v[112:127]
 ds_read_b64_tr_b16 v[40:41], v17 offset:34816
 ds_read_b64_tr_b16 v[42:43], v17 offset:35328
 s_waitcnt lgkmcnt(4)
 v_mfma_f32_32x32x16_bf16 v[128:143], v[56:59], v[176:179], v[128:143]
 ds_read_b64_tr_b16 v[44:45], v18 offset:34816
 ds_read_b64_tr_b16 v[46:47], v18 offset:35328
 s_waitcnt lgkmcnt(4)
 v_mfma_f32_32x32x16_bf16 v[144:159], v[60:63], v[176:179], v[144:159]
 ds_read_b64_tr_b16 v[48:49], v19 offset:34816
 ds_read_b64_tr_b16 v[50:51], v19 offset:35328
 s_waitcnt lgkmcnt(4)
 v_mfma_f32_32x32x16_bf16 v[64:79], v[40:43], v[180:183], v[64:79]
 ds_read_b64_tr_b16 v[52:53], v20 offset:34816
 ds_read_b64_tr_b16 v[54:55], v20 offset:35328
 s_waitcnt lgkmcnt(4)
 v_mfma_f32_32x32x16_bf16 v[80:95], v[44:47], v[180:183], v[80:95]
 ds_read_b64_tr_b16 v[56:57], v252 offset:41984
 ds_read_b64_tr_b16 v[58:59], v252 offset:42240
 s_waitcnt lgkmcnt(4)
 v_mfma_f32_32x32x16_bf16 v[96:111], v[48:51], v[180:183], v[96:111]
 ds_read_b64_tr_b16 v[60:61], v253 offset:41984
 ds_read_b64_tr_b16 v[62:63], v253 offset:42240
 s_waitcnt lgkmcnt(4)
 v_mfma_f32_32x32x16_bf16 v[112:127], v[52:55], v[180:183], v[112:127]
 s_waitcnt vmcnt(9)
 s_barrier
 ds_read_b128 v[184:187], v6 offset:32768
 ds_read_b128 v[188:191], v7 offset:32768
 ds_read_b64_tr_b16 v[40:41], v17 offset:55296
 ds_read_b64_tr_b16 v[42:43], v17 offset:55808
 s_waitcnt lgkmcnt(6)
 v_mfma_f32_32x32x16_bf16 v[128:143], v[56:59], v[180:183], v[128:143]
 ds_read_b64_tr_b16 v[44:45], v18 offset:55296
 ds_read_b64_tr_b16 v[46:47], v18 offset:55808
 s_waitcnt lgkmcnt(6)
 v_mfma_f32_32x32x16_bf16 v[144:159], v[60:63], v[180:183], v[144:159]
 ds_read_b64_tr_b16 v[48:49], v19 offset:55296
 ds_read_b64_tr_b16 v[50:51], v19 offset:55808
 s_waitcnt lgkmcnt(4)
 v_mfma_f32_32x32x16_bf16 v[64:79], v[40:43], v[184:187], v[64:79]
 ds_read_b64_tr_b16 v[52:53], v20 offset:55296
 ds_read_b64_tr_b16 v[54:55], v20 offset:55808
 s_waitcnt lgkmcnt(4)
 v_mfma_f32_32x32x16_bf16 v[80:95], v[44:47], v[184:187], v[80:95]
 ds_read_b64_tr_b16 v[56:57], v252 offset:63488
 ds_read_b64_tr_b16 v[58:59], v252 offset:63744
 s_waitcnt lgkmcnt(4)
 v_mfma_f32_32x32x16_bf16 v[96:111], v[48:51], v[184:187], v[96:111]
 ds_read_b64_tr_b16 v[60:61], v253 offset:63488
 ds_read_b64_tr_b16 v[62:63], v253 offset:63744
 s_waitcnt lgkmcnt(4)
 v_mfma_f32_32x32x16_bf16 v[112:127], v[52:55], v[184:187], v[112:127]
 ds_read_b64_tr_b16 v[40:41], v17 offset:57344
 ds_read_b64_tr_b16 v[42:43], v17 offset:57856
 s_waitcnt lgkmcnt(4)
 v_mfma_f32_32x32x16_bf16 v[128:143], v[56:59], v[184:187], v[128:143]
 ds_read_b64_tr_b16 v[44:45], v18 offset:57344
 ds_read_b64_tr_b16 v[46:47], v18 offset:57856
 s_waitcnt lgkmcnt(4)
 v_mfma_f32_32x32x16_bf16 v[144:159], v[60:63], v[184:187], v[144:159]
 ds_read_b64_tr_b16 v[48:49], v19 offset:57344
 ds_read_b64_tr_b16 v[50:51], v19 offset:57856
 s_waitcnt lgkmcnt(4)
 v_mfma_f32_32x32x16_bf16 v[64:79], v[40:43], v[188:191], v[64:79]
 ds_read_b64_tr_b16 v[52:53], v20 offset:57344
 ds_read_b64_tr_b16 v[54:55], v20 offset:57856
 s_waitcnt lgkmcnt(4)
 v_mfma_f32_32x32x16_bf16 v[80:95], v[44:47], v[188:191], v[80:95]
 ds_read_b64_tr_b16 v[56:57], v252 offset:64512
 ds_read_b64_tr_b16 v[58:59], v252 offset:64768
 s_waitcnt lgkmcnt(4)
 v_mfma_f32_32x32x16_bf16 v[96:111], v[48:51], v[188:191], v[96:111]
 ds_read_b64_tr_b16 v[60:61], v253 offset:64512
 ds_read_b64_tr_b16 v[62:63], v253 offset:64768
 s_waitcnt lgkmcnt(4)
 v_mfma_f32_32x32x16_bf16 v[112:127], v[52:55], v[188:191], v[112:127]
 s_waitcnt vmcnt(4)
 s_barrier
 ds_read_b128 v[176:179], v4 offset:0
 ds_read_b128 v[180:183], v5 offset:0
 ds_read_b64_tr_b16 v[40:41], v21 offset:12288
 ds_read_b64_tr_b16 v[42:43], v21 offset:12800
 s_waitcnt lgkmcnt(6)
 v_mfma_f32_32x32x16_bf16 v[128:143], v[56:59], v[188:191], v[128:143]
 ds_read_b64_tr_b16 v[44:45], v22 offset:12288
 ds_read_b64_tr_b16 v[46:47], v22 offset:12800
 s_waitcnt lgkmcnt(6)
 v_mfma_f32_32x32x16_bf16 v[144:159], v[60:63], v[188:191], v[144:159]
 ds_read_b64_tr_b16 v[48:49], v23 offset:12288
 ds_read_b64_tr_b16 v[50:51], v23 offset:12800
 s_waitcnt lgkmcnt(4)
 v_mfma_f32_32x32x16_bf16 v[64:79], v[40:43], v[176:179], v[64:79]
 ds_read_b64_tr_b16 v[52:53], v24 offset:12288
 ds_read_b64_tr_b16 v[54:55], v24 offset:12800
 s_waitcnt lgkmcnt(4)
 v_mfma_f32_32x32x16_bf16 v[80:95], v[44:47], v[176:179], v[80:95]
 ds_read_b64_tr_b16 v[56:57], v254 offset:20480
 ds_read_b64_tr_b16 v[58:59], v254 offset:20736
 s_waitcnt lgkmcnt(4)
 v_mfma_f32_32x32x16_bf16 v[96:111], v[48:51], v[176:179], v[96:111]
 ds_read_b64_tr_b16 v[60:61], v255 offset:20480
 ds_read_b64_tr_b16 v[62:63], v255 offset:20736
 s_waitcnt lgkmcnt(4)
 v_mfma_f32_32x32x16_bf16 v[112:127], v[52:55], v[176:179], v[112:127]
 ds_read_b64_tr_b16 v[40:41], v21 offset:14336
 ds_read_b64_tr_b16 v[42:43], v21 offset:14848
 s_waitcnt lgkmcnt(4)
 v_mfma_f32_32x32x16_bf16 v[128:143], v[56:59], v[176:179], v[128:143]
 ds_read_b64_tr_b16 v[44:45], v22 offset:14336
 ds_read_b64_tr_b16 v[46:47], v22 offset:14848
 s_waitcnt lgkmcnt(4)
 v_mfma_f32_32x32x16_bf16 v[144:159], v[60:63], v[176:179], v[144:159]
 ds_read_b64_tr_b16 v[48:49], v23 offset:14336
 ds_read_b64_tr_b16 v[50:51], v23 offset:14848
 s_waitcnt lgkmcnt(4)
 v_mfma_f32_32x32x16_bf16 v[64:79], v[40:43], v[180:183], v[64:79]
 ds_read_b64_tr_b16 v[52:53], v24 offset:14336
 ds_read_b64_tr_b16 v[54:55], v24 offset:14848
 s_waitcnt lgkmcnt(4)
 v_mfma_f32_32x32x16_bf16 v[80:95], v[44:47], v[180:183], v[80:95]
 ds_read_b64_tr_b16 v[56:57], v254 offset:21504
 ds_read_b64_tr_b16 v[58:59], v254 offset:21760
 s_waitcnt lgkmcnt(4)
 v_mfma_f32_32x32x16_bf16 v[96:111], v[48:51], v[180:183], v[96:111]
 ds_read_b64_tr_b16 v[60:61], v255 offset:21504
 ds_read_b64_tr_b16 v[62:63], v255 offset:21760
 s_waitcnt lgkmcnt(4)
 v_mfma_f32_32x32x16_bf16 v[112:127], v[52:55], v[180:183], v[112:127]
 s_waitcnt vmcnt(0)
 s_barrier
 ds_read_b128 v[184:187], v6 offset:0
 ds_read_b128 v[188:191], v7 offset:0
 ds_read_b64_tr_b16 v[40:41], v21 offset:34816
 ds_read_b64_tr_b16 v[42:43], v21 offset:35328
 s_waitcnt lgkmcnt(6)
 v_mfma_f32_32x32x16_bf16 v[128:143], v[56:59], v[180:183], v[128:143]
 ds_read_b64_tr_b16 v[44:45], v22 offset:34816
 ds_read_b64_tr_b16 v[46:47], v22 offset:35328
 s_waitcnt lgkmcnt(6)
 v_mfma_f32_32x32x16_bf16 v[144:159], v[60:63], v[180:183], v[144:159]
 ds_read_b64_tr_b16 v[48:49], v23 offset:34816
 ds_read_b64_tr_b16 v[50:51], v23 offset:35328
 s_waitcnt lgkmcnt(4)
 v_mfma_f32_32x32x16_bf16 v[64:79], v[40:43], v[184:187], v[64:79]
 ds_read_b64_tr_b16 v[52:53], v24 offset:34816
 ds_read_b64_tr_b16 v[54:55], v24 offset:35328
 s_waitcnt lgkmcnt(4)
 v_mfma_f32_32x32x16_bf16 v[80:95], v[44:47], v[184:187], v[80:95]
 ds_read_b64_tr_b16 v[56:57], v254 offset:43008
 ds_read_b64_tr_b16 v[58:59], v254 offset:43264
 s_waitcnt lgkmcnt(4)
 v_mfma_f32_32x32x16_bf16 v[96:111], v[48:51], v[184:187], v[96:111]
 ds_read_b64_tr_b16 v[60:61], v255 offset:43008
 ds_read_b64_tr_b16 v[62:63], v255 offset:43264
 s_waitcnt lgkmcnt(4)
 v_mfma_f32_32x32x16_bf16 v[112:127], v[52:55], v[184:187], v[112:127]
 ds_read_b64_tr_b16 v[40:41], v21 offset:36864
 ds_read_b64_tr_b16 v[42:43], v21 offset:37376
 s_waitcnt lgkmcnt(4)
 v_mfma_f32_32x32x16_bf16 v[128:143], v[56:59], v[184:187], v[128:143]
 ds_read_b64_tr_b16 v[44:45], v22 offset:36864
 ds_read_b64_tr_b16 v[46:47], v22 offset:37376
 s_waitcnt lgkmcnt(4)
 v_mfma_f32_32x32x16_bf16 v[144:159], v[60:63], v[184:187], v[144:159]
 ds_read_b64_tr_b16 v[48:49], v23 offset:36864
 ds_read_b64_tr_b16 v[50:51], v23 offset:37376
 s_waitcnt lgkmcnt(4)
 v_mfma_f32_32x32x16_bf16 v[64:79], v[40:43], v[188:191], v[64:79]
 ds_read_b64_tr_b16 v[52:53], v24 offset:36864
 ds_read_b64_tr_b16 v[54:55], v24 offset:37376
 s_waitcnt lgkmcnt(4)
 v_mfma_f32_32x32x16_bf16 v[80:95], v[44:47], v[188:191], v[80:95]
 ds_read_b64_tr_b16 v[56:57], v254 offset:44032
 ds_read_b64_tr_b16 v[58:59], v254 offset:44288
 s_waitcnt lgkmcnt(4)
 v_mfma_f32_32x32x16_bf16 v[96:111], v[48:51], v[188:191], v[96:111]
 ds_read_b64_tr_b16 v[60:61], v255 offset:44032
 ds_read_b64_tr_b16 v[62:63], v255 offset:44288
 s_waitcnt lgkmcnt(4)
 v_mfma_f32_32x32x16_bf16 v[112:127], v[52:55], v[188:191], v[112:127]
 s_waitcnt lgkmcnt(2)
 v_mfma_f32_32x32x16_bf16 v[128:143], v[56:59], v[188:191], v[128:143]
 s_waitcnt lgkmcnt(0)
 v_mfma_f32_32x32x16_bf16 v[144:159], v[60:63], v[188:191], v[144:159]
 s_setprio 0
 s_waitcnt lgkmcnt(0)
 s_barrier
 s_getpc_b64 s[28:29]
L_k2pf_1:
 s_add_u32 s28, s28, k2_kernel - L_k2pf_1
 s_addc_u32 s29, s29, 0
 s_lshl_b32 s30, s20, 12
 v_lshlrev_b32 v35, 6, v1
 v_add_u32 v35, s30, v35
 v_min_u32 v35, L_text_end - k2_kernel - 4, v35
 global_load_dword v250, v35, s[28:29]
 v_lshrrev_b32 v35, 1, v1
 v_mul_u32_u24 v35, 1280, v35
 v_and_b32 v36, 1, v1
 v_lshl_add_u32 v37, v36, 4, v35
 s_mul_i32 s24, s2, 12
 s_mul_i32 s25, s20, 3
 s_add_u32 s24, s24, s25
 s_mul_i32 s31, s20, 3072
 s_add_u32 s31, s31, 102592
 s_add_u32 s25, s24, 0
 s_min_u32 s25, s25, 2959
 s_mul_hi_u32 s80, s25, 107374183
 s_mul_i32 s26, s80, 40
 s_sub_u32 s81, s25, s26
 s_cmp_lt_u32 s80, 54
 s_cselect_b32 s76, s52, s46
 s_cselect_b32 s77, s53, s47
 s_mov_b32 s78, 819200
 s_cselect_b32 s78, 2211840, s78
 s_mov_b32 s79, 0x00020000
 s_cselect_b32 s26, 0, 54
 s_sub_u32 s26, s80, s26
 s_mul_i32 s26, s26, 40960
 s_lshl_b32 s27, s81, 5
 s_add_u32 s26, s26, s27
 s_add_u32 m0, s31, 0
 s_nop 0
 buffer_load_dwordx4 v37, s[76:79], s26 offen lds
 s_add_u32 s25, s24, 1
 s_min_u32 s25, s25, 2959
 s_mul_hi_u32 s82, s25, 107374183
 s_mul_i32 s26, s82, 40
 s_sub_u32 s83, s25, s26
 s_cmp_lt_u32 s82, 54
 s_cselect_b32 s76, s52, s46
 s_cselect_b32 s77, s53, s47
 s_mov_b32 s78, 819200
 s_cselect_b32 s78, 2211840, s78
 s_mov_b32 s79, 0x00020000
 s_cselect_b32 s26, 0, 54
 s_sub_u32 s26, s82, s26
 s_mul_i32 s26, s26, 40960
 s_lshl_b32 s27, s83, 5
 s_add_u32 s26, s26, s27
 s_add_u32 m0, s31, 1024
 s_nop 0
 buffer_load_dwordx4 v37, s[76:79], s26 offen lds
 s_add_u32 s25, s24, 2
 s_min_u32 s25, s25, 2959
 s_mul_hi_u32 s84, s25, 107374183
 s_mul_i32 s26, s84, 40
 s_sub_u32 s85, s25, s26
 s_cmp_lt_u32 s84, 54
 s_cselect_b32 s76, s52, s46
 s_cselect_b32 s77, s53, s47
 s_mov_b32 s78, 819200
 s_cselect_b32 s78, 2211840, s78
 s_mov_b32 s79, 0x00020000
 s_cselect_b32 s26, 0, 54
 s_sub_u32 s26, s84, s26
 s_mul_i32 s26, s26, 40960
 s_lshl_b32 s27, s85, 5
 s_add_u32 s26, s26, s27
 s_add_u32 m0, s31, 2048
 s_nop 0
 buffer_load_dwordx4 v37, s[76:79], s26 offen lds
 s_barrier
 v_cvt_pk_bf16_f32 v161, v64, v65
 v_cvt_pk_bf16_f32 v163, v72, v73
 v_lshlrev_b32 v160, 16, v161
 v_and_b32 v161, 0xffff0000, v161
 v_mul_f32 v164, v160, v160
 v_mul_f32 v165, v161, v161
 v_fmamk_f32 v164, v164, 0xbdd2d3e8, v26
 v_fmamk_f32 v165, v165, 0xbdd2d3e8, v26
 v_mul_f32 v164, v164, v160
 v_mul_f32 v165, v165, v161
 v_exp_f32 v164, v164
 v_exp_f32 v165, v165
 v_lshlrev_b32 v162, 16, v163
 v_add_f32 v164, 1.0, v164
 v_add_f32 v165, 1.0, v165
 v_rcp_f32 v164, v164
 v_rcp_f32 v165, v165
 v_and_b32 v163, 0xffff0000, v163
 v_mul_f32 v164, v164, v160
 v_mul_f32 v165, v165, v161
 v_cvt_pk_bf16_f32 v165, v164, v165
 v_lshlrev_b32 v164, 16, v165
 v_and_b32 v165, 0xffff0000, v165
 v_mul_f32 v164, v164, v162
 v_mul_f32 v165, v165, v163
 v_cvt_pk_bf16_f32 v172, v164, v165
 v_cvt_pk_bf16_f32 v161, v66, v67
 v_cvt_pk_bf16_f32 v163, v74, v75
 v_lshlrev_b32 v160, 16, v161
 v_and_b32 v161, 0xffff0000, v161
 v_mul_f32 v164, v160, v160
 v_mul_f32 v165, v161, v161
 v_fmamk_f32 v164, v164, 0xbdd2d3e8, v26
 v_fmamk_f32 v165, v165, 0xbdd2d3e8, v26
 v_mul_f32 v164, v164, v160
 v_mul_f32 v165, v165, v161
 v_exp_f32 v164, v164
 v_exp_f32 v165, v165
 v_lshlrev_b32 v162, 16, v163
 v_add_f32 v164, 1.0, v164
 v_add_f32 v165, 1.0, v165
 v_rcp_f32 v164, v164
 v_rcp_f32 v165, v165
 v_and_b32 v163, 0xffff0000, v163
 v_mul_f32 v164, v164, v160
 v_mul_f32 v165, v165, v161
 v_cvt_pk_bf16_f32 v165, v164, v165
 v_lshlrev_b32 v164, 16, v165
 v_and_b32 v165, 0xffff0000, v165
 v_mul_f32 v164, v164, v162
 v_mul_f32 v165, v165, v163
 v_cvt_pk_bf16_f32 v173, v164, v165
 v_cvt_pk_bf16_f32 v161, v68, v69
 v_cvt_pk_bf16_f32 v163, v76, v77
 v_lshlrev_b32 v160, 16, v161
 v_and_b32 v161, 0xffff0000, v161
 v_mul_f32 v164, v160, v160
 v_mul_f32 v165, v161, v161
 v_fmamk_f32 v164, v164, 0xbdd2d3e8, v26
 v_fmamk_f32 v165, v165, 0xbdd2d3e8, v26
 v_mul_f32 v164, v164, v160
 v_mul_f32 v165, v165, v161
 v_exp_f32 v164, v164
 v_exp_f32 v165, v165
 v_lshlrev_b32 v162, 16, v163
 v_add_f32 v164, 1.0, v164
 v_add_f32 v165, 1.0, v165
 v_rcp_f32 v164, v164
 v_rcp_f32 v165, v165
 v_and_b32 v163, 0xffff0000, v163
 v_mul_f32 v164, v164, v160
 v_mul_f32 v165, v165, v161
 v_cvt_pk_bf16_f32 v165, v164, v165
 v_lshlrev_b32 v164, 16, v165
 v_and_b32 v165, 0xffff0000, v165
 v_mul_f32 v164, v164, v162
 v_mul_f32 v165, v165, v163
 v_cvt_pk_bf16_f32 v174, v164, v165
 v_cvt_pk_bf16_f32 v161, v70, v71
 v_cvt_pk_bf16_f32 v163, v78, v79
 v_lshlrev_b32 v160, 16, v161
 v_and_b32 v161, 0xffff0000, v161
 v_mul_f32 v164, v160, v160
 v_mul_f32 v165, v161, v161
 v_fmamk_f32 v164, v164, 0xbdd2d3e8, v26
 v_fmamk_f32 v165, v165, 0xbdd2d3e8, v26
 v_mul_f32 v164, v164, v160
 v_mul_f32 v165, v165, v161
 v_exp_f32 v164, v164
 v_exp_f32 v165, v165
 v_lshlrev_b32 v162, 16, v163
 v_add_f32 v164, 1.0, v164
 v_add_f32 v165, 1.0, v165
 v_rcp_f32 v164, v164
 v_rcp_f32 v165, v165
 v_and_b32 v163, 0xffff0000, v163
 v_mul_f32 v164, v164, v160
 v_mul_f32 v165, v165, v161
 v_cvt_pk_bf16_f32 v165, v164, v165
 v_lshlrev_b32 v164, 16, v165
 v_and_b32 v165, 0xffff0000, v165
 v_mul_f32 v164, v164, v162
 v_mul_f32 v165, v165, v163
 v_cvt_pk_bf16_f32 v175, v164, v165
 s_add_u32 s38, s34, 0
 buffer_store_dwordx4 v[172:175], v25, s[16:19], s38 offen sc0 sc1
 v_cvt_pk_bf16_f32 v177, v80, v81
 v_cvt_pk_bf16_f32 v179, v88, v89
 v_lshlrev_b32 v176, 16, v177
 v_and_b32 v177, 0xffff0000, v177
 v_mul_f32 v180, v176, v176
 v_mul_f32 v181, v177, v177
 v_fmamk_f32 v180, v180, 0xbdd2d3e8, v26
 v_fmamk_f32 v181, v181, 0xbdd2d3e8, v26
 v_mul_f32 v180, v180, v176
 v_mul_f32 v181, v181, v177
 v_exp_f32 v180, v180
 v_exp_f32 v181, v181
 v_lshlrev_b32 v178, 16, v179
 v_add_f32 v180, 1.0, v180
 v_add_f32 v181, 1.0, v181
 v_rcp_f32 v180, v180
 v_rcp_f32 v181, v181
 v_and_b32 v179, 0xffff0000, v179
 v_mul_f32 v180, v180, v176
 v_mul_f32 v181, v181, v177
 v_cvt_pk_bf16_f32 v181, v180, v181
 v_lshlrev_b32 v180, 16, v181
 v_and_b32 v181, 0xffff0000, v181
 v_mul_f32 v180, v180, v178
 v_mul_f32 v181, v181, v179
 v_cvt_pk_bf16_f32 v188, v180, v181
 v_cvt_pk_bf16_f32 v177, v82, v83
 v_cvt_pk_bf16_f32 v179, v90, v91
 v_lshlrev_b32 v176, 16, v177
 v_and_b32 v177, 0xffff0000, v177
 v_mul_f32 v180, v176, v176
 v_mul_f32 v181, v177, v177
 v_fmamk_f32 v180, v180, 0xbdd2d3e8, v26
 v_fmamk_f32 v181, v181, 0xbdd2d3e8, v26
 v_mul_f32 v180, v180, v176
 v_mul_f32 v181, v181, v177
 v_exp_f32 v180, v180
 v_exp_f32 v181, v181
 v_lshlrev_b32 v178, 16, v179
 v_add_f32 v180, 1.0, v180
 v_add_f32 v181, 1.0, v181
 v_rcp_f32 v180, v180
 v_rcp_f32 v181, v181
 v_and_b32 v179, 0xffff0000, v179
 v_mul_f32 v180, v180, v176
 v_mul_f32 v181, v181, v177
 v_cvt_pk_bf16_f32 v181, v180, v181
 v_lshlrev_b32 v180, 16, v181
 v_and_b32 v181, 0xffff0000, v181
 v_mul_f32 v180, v180, v178
 v_mul_f32 v181, v181, v179
 v_cvt_pk_bf16_f32 v189, v180, v181
 v_cvt_pk_bf16_f32 v177, v84, v85
 v_cvt_pk_bf16_f32 v179, v92, v93
 v_lshlrev_b32 v176, 16, v177
 v_and_b32 v177, 0xffff0000, v177
 v_mul_f32 v180, v176, v176
 v_mul_f32 v181, v177, v177
 v_fmamk_f32 v180, v180, 0xbdd2d3e8, v26
 v_fmamk_f32 v181, v181, 0xbdd2d3e8, v26
 v_mul_f32 v180, v180, v176
 v_mul_f32 v181, v181, v177
 v_exp_f32 v180, v180
 v_exp_f32 v181, v181
 v_lshlrev_b32 v178, 16, v179
 v_add_f32 v180, 1.0, v180
 v_add_f32 v181, 1.0, v181
 v_rcp_f32 v180, v180
 v_rcp_f32 v181, v181
 v_and_b32 v179, 0xffff0000, v179
 v_mul_f32 v180, v180, v176
 v_mul_f32 v181, v181, v177
 v_cvt_pk_bf16_f32 v181, v180, v181
 v_lshlrev_b32 v180, 16, v181
 v_and_b32 v181, 0xffff0000, v181
 v_mul_f32 v180, v180, v178
 v_mul_f32 v181, v181, v179
 v_cvt_pk_bf16_f32 v190, v180, v181
 v_cvt_pk_bf16_f32 v177, v86, v87
 v_cvt_pk_bf16_f32 v179, v94, v95
 v_lshlrev_b32 v176, 16, v177
 v_and_b32 v177, 0xffff0000, v177
 v_mul_f32 v180, v176, v176
 v_mul_f32 v181, v177, v177
 v_fmamk_f32 v180, v180, 0xbdd2d3e8, v26
 v_fmamk_f32 v181, v181, 0xbdd2d3e8, v26
 v_mul_f32 v180, v180, v176
 v_mul_f32 v181, v181, v177
 v_exp_f32 v180, v180
 v_exp_f32 v181, v181
 v_lshlrev_b32 v178, 16, v179
 v_add_f32 v180, 1.0, v180
 v_add_f32 v181, 1.0, v181
 v_rcp_f32 v180, v180
 v_rcp_f32 v181, v181
 v_and_b32 v179, 0xffff0000, v179
 v_mul_f32 v180, v180, v176
 v_mul_f32 v181, v181, v177
 v_cvt_pk_bf16_f32 v181, v180, v181
 v_lshlrev_b32 v180, 16, v181
 v_and_b32 v181, 0xffff0000, v181
 v_mul_f32 v180, v180, v178
 v_mul_f32 v181, v181, v179
 v_cvt_pk_bf16_f32 v191, v180, v181
 s_add_u32 s38, s34, 512
 buffer_store_dwordx4 v[188:191], v25, s[16:19], s38 offen sc0 sc1
 v_cvt_pk_bf16_f32 v161, v96, v97
 v_cvt_pk_bf16_f32 v163, v104, v105
 v_lshlrev_b32 v160, 16, v161
 v_and_b32 v161, 0xffff0000, v161
 v_mul_f32 v164, v160, v160
 v_mul_f32 v165, v161, v161
 v_fmamk_f32 v164, v164, 0xbdd2d3e8, v26
 v_fmamk_f32 v165, v165, 0xbdd2d3e8, v26
 v_mul_f32 v164, v164, v160
 v_mul_f32 v165, v165, v161
 v_exp_f32 v164, v164
 v_exp_f32 v165, v165
 v_lshlrev_b32 v162, 16, v163
 v_add_f32 v164, 1.0, v164
 v_add_f32 v165, 1.0, v165
 v_rcp_f32 v164, v164
 v_rcp_f32 v165, v165
 v_and_b32 v163, 0xffff0000, v163
 v_mul_f32 v164, v164, v160
 v_mul_f32 v165, v165, v161
 v_cvt_pk_bf16_f32 v165, v164, v165
 v_lshlrev_b32 v164, 16, v165
 v_and_b32 v165, 0xffff0000, v165
 v_mul_f32 v164, v164, v162
 v_mul_f32 v165, v165, v163
 v_cvt_pk_bf16_f32 v172, v164, v165
 v_cvt_pk_bf16_f32 v161, v98, v99
 v_cvt_pk_bf16_f32 v163, v106, v107
 v_lshlrev_b32 v160, 16, v161
 v_and_b32 v161, 0xffff0000, v161
 v_mul_f32 v164, v160, v160
 v_mul_f32 v165, v161, v161
 v_fmamk_f32 v164, v164, 0xbdd2d3e8, v26
 v_fmamk_f32 v165, v165, 0xbdd2d3e8, v26
 v_mul_f32 v164, v164, v160
 v_mul_f32 v165, v165, v161
 v_exp_f32 v164, v164
 v_exp_f32 v165, v165
 v_lshlrev_b32 v162, 16, v163
 v_add_f32 v164, 1.0, v164
 v_add_f32 v165, 1.0, v165
 v_rcp_f32 v164, v164
 v_rcp_f32 v165, v165
 v_and_b32 v163, 0xffff0000, v163
 v_mul_f32 v164, v164, v160
 v_mul_f32 v165, v165, v161
 v_cvt_pk_bf16_f32 v165, v164, v165
 v_lshlrev_b32 v164, 16, v165
 v_and_b32 v165, 0xffff0000, v165
 v_mul_f32 v164, v164, v162
 v_mul_f32 v165, v165, v163
 v_cvt_pk_bf16_f32 v173, v164, v165
 v_cvt_pk_bf16_f32 v161, v100, v101
 v_cvt_pk_bf16_f32 v163, v108, v109
 v_lshlrev_b32 v160, 16, v161
 v_and_b32 v161, 0xffff0000, v161
 v_mul_f32 v164, v160, v160
 v_mul_f32 v165, v161, v161
 v_fmamk_f32 v164, v164, 0xbdd2d3e8, v26
 v_fmamk_f32 v165, v165, 0xbdd2d3e8, v26
 v_mul_f32 v164, v164, v160
 v_mul_f32 v165, v165, v161
 v_exp_f32 v164, v164
 v_exp_f32 v165, v165
 v_lshlrev_b32 v162, 16, v163
 v_add_f32 v164, 1.0, v164
 v_add_f32 v165, 1.0, v165
 v_rcp_f32 v164, v164
 v_rcp_f32 v165, v165
 v_and_b32 v163, 0xffff0000, v163
 v_mul_f32 v164, v164, v160
 v_mul_f32 v165, v165, v161
 v_cvt_pk_bf16_f32 v165, v164, v165
 v_lshlrev_b32 v164, 16, v165
 v_and_b32 v165, 0xffff0000, v165
 v_mul_f32 v164, v164, v162
 v_mul_f32 v165, v165, v163
 v_cvt_pk_bf16_f32 v174, v164, v165
 v_cvt_pk_bf16_f32 v161, v102, v103
 v_cvt_pk_bf16_f32 v163, v110, v111
 v_lshlrev_b32 v160, 16, v161
 v_and_b32 v161, 0xffff0000, v161
 v_mul_f32 v164, v160, v160
 v_mul_f32 v165, v161, v161
 v_fmamk_f32 v164, v164, 0xbdd2d3e8, v26
 v_fmamk_f32 v165, v165, 0xbdd2d3e8, v26
 v_mul_f32 v164, v164, v160
 v_mul_f32 v165, v165, v161
 v_exp_f32 v164, v164
 v_exp_f32 v165, v165
 v_lshlrev_b32 v162, 16, v163
 v_add_f32 v164, 1.0, v164
 v_add_f32 v165, 1.0, v165
 v_rcp_f32 v164, v164
 v_rcp_f32 v165, v165
 v_and_b32 v163, 0xffff0000, v163
 v_mul_f32 v164, v164, v160
 v_mul_f32 v165, v165, v161
 v_cvt_pk_bf16_f32 v165, v164, v165
 v_lshlrev_b32 v164, 16, v165
 v_and_b32 v165, 0xffff0000, v165
 v_mul_f32 v164, v164, v162
 v_mul_f32 v165, v165, v163
 v_cvt_pk_bf16_f32 v175, v164, v165
 s_add_u32 s38, s34, 1024
 buffer_store_dwordx4 v[172:175], v25, s[16:19], s38 offen sc0 sc1
 v_cvt_pk_bf16_f32 v177, v112, v113
 v_cvt_pk_bf16_f32 v179, v120, v121
 v_lshlrev_b32 v176, 16, v177
 v_and_b32 v177, 0xffff0000, v177
 v_mul_f32 v180, v176, v176
 v_mul_f32 v181, v177, v177
 v_fmamk_f32 v180, v180, 0xbdd2d3e8, v26
 v_fmamk_f32 v181, v181, 0xbdd2d3e8, v26
 v_mul_f32 v180, v180, v176
 v_mul_f32 v181, v181, v177
 v_exp_f32 v180, v180
 v_exp_f32 v181, v181
 v_lshlrev_b32 v178, 16, v179
 v_add_f32 v180, 1.0, v180
 v_add_f32 v181, 1.0, v181
 v_rcp_f32 v180, v180
 v_rcp_f32 v181, v181
 v_and_b32 v179, 0xffff0000, v179
 v_mul_f32 v180, v180, v176
 v_mul_f32 v181, v181, v177
 v_cvt_pk_bf16_f32 v181, v180, v181
 v_lshlrev_b32 v180, 16, v181
 v_and_b32 v181, 0xffff0000, v181
 v_mul_f32 v180, v180, v178
 v_mul_f32 v181, v181, v179
 v_cvt_pk_bf16_f32 v188, v180, v181
 v_cvt_pk_bf16_f32 v177, v114, v115
 v_cvt_pk_bf16_f32 v179, v122, v123
 v_lshlrev_b32 v176, 16, v177
 v_and_b32 v177, 0xffff0000, v177
 v_mul_f32 v180, v176, v176
 v_mul_f32 v181, v177, v177
 v_fmamk_f32 v180, v180, 0xbdd2d3e8, v26
 v_fmamk_f32 v181, v181, 0xbdd2d3e8, v26
 v_mul_f32 v180, v180, v176
 v_mul_f32 v181, v181, v177
 v_exp_f32 v180, v180
 v_exp_f32 v181, v181
 v_lshlrev_b32 v178, 16, v179
 v_add_f32 v180, 1.0, v180
 v_add_f32 v181, 1.0, v181
 v_rcp_f32 v180, v180
 v_rcp_f32 v181, v181
 v_and_b32 v179, 0xffff0000, v179
 v_mul_f32 v180, v180, v176
 v_mul_f32 v181, v181, v177
 v_cvt_pk_bf16_f32 v181, v180, v181
 v_lshlrev_b32 v180, 16, v181
 v_and_b32 v181, 0xffff0000, v181
 v_mul_f32 v180, v180, v178
 v_mul_f32 v181, v181, v179
 v_cvt_pk_bf16_f32 v189, v180, v181
 v_cvt_pk_bf16_f32 v177, v116, v117
 v_cvt_pk_bf16_f32 v179, v124, v125
 v_lshlrev_b32 v176, 16, v177
 v_and_b32 v177, 0xffff0000, v177
 v_mul_f32 v180, v176, v176
 v_mul_f32 v181, v177, v177
 v_fmamk_f32 v180, v180, 0xbdd2d3e8, v26
 v_fmamk_f32 v181, v181, 0xbdd2d3e8, v26
 v_mul_f32 v180, v180, v176
 v_mul_f32 v181, v181, v177
 v_exp_f32 v180, v180
 v_exp_f32 v181, v181
 v_lshlrev_b32 v178, 16, v179
 v_add_f32 v180, 1.0, v180
 v_add_f32 v181, 1.0, v181
 v_rcp_f32 v180, v180
 v_rcp_f32 v181, v181
 v_and_b32 v179, 0xffff0000, v179
 v_mul_f32 v180, v180, v176
 v_mul_f32 v181, v181, v177
 v_cvt_pk_bf16_f32 v181, v180, v181
 v_lshlrev_b32 v180, 16, v181
 v_and_b32 v181, 0xffff0000, v181
 v_mul_f32 v180, v180, v178
 v_mul_f32 v181, v181, v179
 v_cvt_pk_bf16_f32 v190, v180, v181
 v_cvt_pk_bf16_f32 v177, v118, v119
 v_cvt_pk_bf16_f32 v179, v126, v127
 v_lshlrev_b32 v176, 16, v177
 v_and_b32 v177, 0xffff0000, v177
 v_mul_f32 v180, v176, v176
 v_mul_f32 v181, v177, v177
 v_fmamk_f32 v180, v180, 0xbdd2d3e8, v26
 v_fmamk_f32 v181, v181, 0xbdd2d3e8, v26
 v_mul_f32 v180, v180, v176
 v_mul_f32 v181, v181, v177
 v_exp_f32 v180, v180
 v_exp_f32 v181, v181
 v_lshlrev_b32 v178, 16, v179
 v_add_f32 v180, 1.0, v180
 v_add_f32 v181, 1.0, v181
 v_rcp_f32 v180, v180
 v_rcp_f32 v181, v181
 v_and_b32 v179, 0xffff0000, v179
 v_mul_f32 v180, v180, v176
 v_mul_f32 v181, v181, v177
 v_cvt_pk_bf16_f32 v181, v180, v181
 v_lshlrev_b32 v180, 16, v181
 v_and_b32 v181, 0xffff0000, v181
 v_mul_f32 v180, v180, v178
 v_mul_f32 v181, v181, v179
 v_cvt_pk_bf16_f32 v191, v180, v181
 s_add_u32 s38, s34, 1536
 buffer_store_dwordx4 v[188:191], v25, s[16:19], s38 offen sc0 sc1
 v_cvt_pk_bf16_f32 v161, v128, v129
 v_cvt_pk_bf16_f32 v163, v136, v137
 v_lshlrev_b32 v160, 16, v161
 v_and_b32 v161, 0xffff0000, v161
 v_mul_f32 v164, v160, v160
 v_mul_f32 v165, v161, v161
 v_fmamk_f32 v164, v164, 0xbdd2d3e8, v26
 v_fmamk_f32 v165, v165, 0xbdd2d3e8, v26
 v_mul_f32 v164, v164, v160
 v_mul_f32 v165, v165, v161
 v_exp_f32 v164, v164
 v_exp_f32 v165, v165
 v_lshlrev_b32 v162, 16, v163
 v_add_f32 v164, 1.0, v164
 v_add_f32 v165, 1.0, v165
 v_rcp_f32 v164, v164
 v_rcp_f32 v165, v165
 v_and_b32 v163, 0xffff0000, v163
 v_mul_f32 v164, v164, v160
 v_mul_f32 v165, v165, v161
 v_cvt_pk_bf16_f32 v165, v164, v165
 v_lshlrev_b32 v164, 16, v165
 v_and_b32 v165, 0xffff0000, v165
 v_mul_f32 v164, v164, v162
 v_mul_f32 v165, v165, v163
 v_cvt_pk_bf16_f32 v172, v164, v165
 v_cvt_pk_bf16_f32 v161, v130, v131
 v_cvt_pk_bf16_f32 v163, v138, v139
 v_lshlrev_b32 v160, 16, v161
 v_and_b32 v161, 0xffff0000, v161
 v_mul_f32 v164, v160, v160
 v_mul_f32 v165, v161, v161
 v_fmamk_f32 v164, v164, 0xbdd2d3e8, v26
 v_fmamk_f32 v165, v165, 0xbdd2d3e8, v26
 v_mul_f32 v164, v164, v160
 v_mul_f32 v165, v165, v161
 v_exp_f32 v164, v164
 v_exp_f32 v165, v165
 v_lshlrev_b32 v162, 16, v163
 v_add_f32 v164, 1.0, v164
 v_add_f32 v165, 1.0, v165
 v_rcp_f32 v164, v164
 v_rcp_f32 v165, v165
 v_and_b32 v163, 0xffff0000, v163
 v_mul_f32 v164, v164, v160
 v_mul_f32 v165, v165, v161
 v_cvt_pk_bf16_f32 v165, v164, v165
 v_lshlrev_b32 v164, 16, v165
 v_and_b32 v165, 0xffff0000, v165
 v_mul_f32 v164, v164, v162
 v_mul_f32 v165, v165, v163
 v_cvt_pk_bf16_f32 v173, v164, v165
 v_cvt_pk_bf16_f32 v161, v132, v133
 v_cvt_pk_bf16_f32 v163, v140, v141
 v_lshlrev_b32 v160, 16, v161
 v_and_b32 v161, 0xffff0000, v161
 v_mul_f32 v164, v160, v160
 v_mul_f32 v165, v161, v161
 v_fmamk_f32 v164, v164, 0xbdd2d3e8, v26
 v_fmamk_f32 v165, v165, 0xbdd2d3e8, v26
 v_mul_f32 v164, v164, v160
 v_mul_f32 v165, v165, v161
 v_exp_f32 v164, v164
 v_exp_f32 v165, v165
 v_lshlrev_b32 v162, 16, v163
 v_add_f32 v164, 1.0, v164
 v_add_f32 v165, 1.0, v165
 v_rcp_f32 v164, v164
 v_rcp_f32 v165, v165
 v_and_b32 v163, 0xffff0000, v163
 v_mul_f32 v164, v164, v160
 v_mul_f32 v165, v165, v161
 v_cvt_pk_bf16_f32 v165, v164, v165
 v_lshlrev_b32 v164, 16, v165
 v_and_b32 v165, 0xffff0000, v165
 v_mul_f32 v164, v164, v162
 v_mul_f32 v165, v165, v163
 v_cvt_pk_bf16_f32 v174, v164, v165
 v_cvt_pk_bf16_f32 v161, v134, v135
 v_cvt_pk_bf16_f32 v163, v142, v143
 v_lshlrev_b32 v160, 16, v161
 v_and_b32 v161, 0xffff0000, v161
 v_mul_f32 v164, v160, v160
 v_mul_f32 v165, v161, v161
 v_fmamk_f32 v164, v164, 0xbdd2d3e8, v26
 v_fmamk_f32 v165, v165, 0xbdd2d3e8, v26
 v_mul_f32 v164, v164, v160
 v_mul_f32 v165, v165, v161
 v_exp_f32 v164, v164
 v_exp_f32 v165, v165
 v_lshlrev_b32 v162, 16, v163
 v_add_f32 v164, 1.0, v164
 v_add_f32 v165, 1.0, v165
 v_rcp_f32 v164, v164
 v_rcp_f32 v165, v165
 v_and_b32 v163, 0xffff0000, v163
 v_mul_f32 v164, v164, v160
 v_mul_f32 v165, v165, v161
 v_cvt_pk_bf16_f32 v165, v164, v165
 v_lshlrev_b32 v164, 16, v165
 v_and_b32 v165, 0xffff0000, v165
 v_mul_f32 v164, v164, v162
 v_mul_f32 v165, v165, v163
 v_cvt_pk_bf16_f32 v175, v164, v165
 s_add_u32 s38, s33, 0
 buffer_store_dwordx4 v[172:175], v25, s[16:19], s38 offen sc0 sc1
 v_cvt_pk_bf16_f32 v177, v144, v145
 v_cvt_pk_bf16_f32 v179, v152, v153
 v_lshlrev_b32 v176, 16, v177
 v_and_b32 v177, 0xffff0000, v177
 v_mul_f32 v180, v176, v176
 v_mul_f32 v181, v177, v177
 v_fmamk_f32 v180, v180, 0xbdd2d3e8, v26
 v_fmamk_f32 v181, v181, 0xbdd2d3e8, v26
 v_mul_f32 v180, v180, v176
 v_mul_f32 v181, v181, v177
 v_exp_f32 v180, v180
 v_exp_f32 v181, v181
 v_lshlrev_b32 v178, 16, v179
 v_add_f32 v180, 1.0, v180
 v_add_f32 v181, 1.0, v181
 v_rcp_f32 v180, v180
 v_rcp_f32 v181, v181
 v_and_b32 v179, 0xffff0000, v179
 v_mul_f32 v180, v180, v176
 v_mul_f32 v181, v181, v177
 v_cvt_pk_bf16_f32 v181, v180, v181
 v_lshlrev_b32 v180, 16, v181
 v_and_b32 v181, 0xffff0000, v181
 v_mul_f32 v180, v180, v178
 v_mul_f32 v181, v181, v179
 v_cvt_pk_bf16_f32 v188, v180, v181
 v_cvt_pk_bf16_f32 v177, v146, v147
 v_cvt_pk_bf16_f32 v179, v154, v155
 v_lshlrev_b32 v176, 16, v177
 v_and_b32 v177, 0xffff0000, v177
 v_mul_f32 v180, v176, v176
 v_mul_f32 v181, v177, v177
 v_fmamk_f32 v180, v180, 0xbdd2d3e8, v26
 v_fmamk_f32 v181, v181, 0xbdd2d3e8, v26
 v_mul_f32 v180, v180, v176
 v_mul_f32 v181, v181, v177
 v_exp_f32 v180, v180
 v_exp_f32 v181, v181
 v_lshlrev_b32 v178, 16, v179
 v_add_f32 v180, 1.0, v180
 v_add_f32 v181, 1.0, v181
 v_rcp_f32 v180, v180
 v_rcp_f32 v181, v181
 v_and_b32 v179, 0xffff0000, v179
 v_mul_f32 v180, v180, v176
 v_mul_f32 v181, v181, v177
 v_cvt_pk_bf16_f32 v181, v180, v181
 v_lshlrev_b32 v180, 16, v181
 v_and_b32 v181, 0xffff0000, v181
 v_mul_f32 v180, v180, v178
 v_mul_f32 v181, v181, v179
 v_cvt_pk_bf16_f32 v189, v180, v181
 v_cvt_pk_bf16_f32 v177, v148, v149
 v_cvt_pk_bf16_f32 v179, v156, v157
 v_lshlrev_b32 v176, 16, v177
 v_and_b32 v177, 0xffff0000, v177
 v_mul_f32 v180, v176, v176
 v_mul_f32 v181, v177, v177
 v_fmamk_f32 v180, v180, 0xbdd2d3e8, v26
 v_fmamk_f32 v181, v181, 0xbdd2d3e8, v26
 v_mul_f32 v180, v180, v176
 v_mul_f32 v181, v181, v177
 v_exp_f32 v180, v180
 v_exp_f32 v181, v181
 v_lshlrev_b32 v178, 16, v179
 v_add_f32 v180, 1.0, v180
 v_add_f32 v181, 1.0, v181
 v_rcp_f32 v180, v180
 v_rcp_f32 v181, v181
 v_and_b32 v179, 0xffff0000, v179
 v_mul_f32 v180, v180, v176
 v_mul_f32 v181, v181, v177
 v_cvt_pk_bf16_f32 v181, v180, v181
 v_lshlrev_b32 v180, 16, v181
 v_and_b32 v181, 0xffff0000, v181
 v_mul_f32 v180, v180, v178
 v_mul_f32 v181, v181, v179
 v_cvt_pk_bf16_f32 v190, v180, v181
 v_cvt_pk_bf16_f32 v177, v150, v151
 v_cvt_pk_bf16_f32 v179, v158, v159
 v_lshlrev_b32 v176, 16, v177
 v_and_b32 v177, 0xffff0000, v177
 v_mul_f32 v180, v176, v176
 v_mul_f32 v181, v177, v177
 v_fmamk_f32 v180, v180, 0xbdd2d3e8, v26
 v_fmamk_f32 v181, v181, 0xbdd2d3e8, v26
 v_mul_f32 v180, v180, v176
 v_mul_f32 v181, v181, v177
 v_exp_f32 v180, v180
 v_exp_f32 v181, v181
 v_lshlrev_b32 v178, 16, v179
 v_add_f32 v180, 1.0, v180
 v_add_f32 v181, 1.0, v181
 v_rcp_f32 v180, v180
 v_rcp_f32 v181, v181
 v_and_b32 v179, 0xffff0000, v179
 v_mul_f32 v180, v180, v176
 v_mul_f32 v181, v181, v177
 v_cvt_pk_bf16_f32 v181, v180, v181
 v_lshlrev_b32 v180, 16, v181
 v_and_b32 v181, 0xffff0000, v181
 v_mul_f32 v180, v180, v178
 v_mul_f32 v181, v181, v179
 v_cvt_pk_bf16_f32 v191, v180, v181
 s_add_u32 s38, s33, 512
 buffer_store_dwordx4 v[188:191], v25, s[16:19], s38 offen sc0 sc1
 v_lshrrev_b32 v35, 4, v1
 v_bfe_u32 v36, v1, 2, 2
 v_and_b32 v37, 3, v1
 v_lshrrev_b32 v38, 1, v35
 v_lshlrev_b32 v38, 4, v38
 v_and_b32 v39, 1, v35
 v_lshl_add_u32 v38, v39, 2, v38
 v_add_u32 v38, v38, v36
 v_lshl_add_u32 v39, v35, 3, v36
 v_lshlrev_b32 v37, 3, v37
 s_mul_i32 s31, s20, 3072
 s_add_u32 s31, s31, 102592
 v_add_u32 v37, s31, v37
 v_lshl_add_u32 v38, v38, 5, v37
 v_lshl_add_u32 v39, v39, 5, v37
 v_add_u32 v35, 256, v38
 v_add_u32 v36, 128, v39
 v_lshlrev_b32 v160, 4, v1
 s_waitcnt vmcnt(6)
 s_cmp_lt_u32 s80, 54
 s_cselect_b64 vcc, -1, 0
 s_nop 1
 v_cndmask_b32 v161, v39, v38, vcc
 v_cndmask_b32 v162, v36, v35, vcc
 ds_read_b64_tr_b16 v[164:165], v161 offset:0
 ds_read_b64_tr_b16 v[166:167], v162 offset:0
 s_cmp_lt_u32 s82, 54
 s_cselect_b64 vcc, -1, 0
 s_nop 1
 v_cndmask_b32 v161, v39, v38, vcc
 v_cndmask_b32 v162, v36, v35, vcc
 ds_read_b64_tr_b16 v[168:169], v161 offset:1024
 ds_read_b64_tr_b16 v[170:171], v162 offset:1024
 s_cmp_lt_u32 s84, 54
 s_cselect_b64 vcc, -1, 0
 s_nop 1
 v_cndmask_b32 v161, v39, v38, vcc
 v_cndmask_b32 v162, v36, v35, vcc
 ds_read_b64_tr_b16 v[172:173], v161 offset:2048
 ds_read_b64_tr_b16 v[174:175], v162 offset:2048
 s_mul_hi_u32 s24, s81, 858993460
 s_mul_i32 s25, s24, 5
 s_sub_u32 s25, s81, s25
 s_mul_i32 s24, s24, 74
 s_add_u32 s24, s24, s80
 s_mul_i32 s24, s24, 5120
 s_lshl_b32 s25, s25, 10
 s_add_u32 s24, s24, s25
 s_add_u32 s24, s24, 12582912
 s_waitcnt lgkmcnt(4)
 buffer_store_dwordx4 v[164:167], v160, s[16:19], s24 offen sc0 sc1
 s_mul_hi_u32 s24, s83, 858993460
 s_mul_i32 s25, s24, 5
 s_sub_u32 s25, s83, s25
 s_mul_i32 s24, s24, 74
 s_add_u32 s24, s24, s82
 s_mul_i32 s24, s24, 5120
 s_lshl_b32 s25, s25, 10
 s_add_u32 s24, s24, s25
 s_add_u32 s24, s24, 12582912
 s_waitcnt lgkmcnt(2)
 buffer_store_dwordx4 v[168:171], v160, s[16:19], s24 offen sc0 sc1
 s_mul_hi_u32 s24, s85, 858993460
 s_mul_i32 s25, s24, 5
 s_sub_u32 s25, s85, s25
 s_mul_i32 s24, s24, 74
 s_add_u32 s24, s24, s84
 s_mul_i32 s24, s24, 5120
 s_lshl_b32 s25, s25, 10
 s_add_u32 s24, s24, s25
 s_add_u32 s24, s24, 12582912
 s_waitcnt lgkmcnt(0)
 buffer_store_dwordx4 v[172:175], v160, s[16:19], s24 offen sc0 sc1
 s_endpgm
L_k1_KV:
 v_and_b32 v1, 63, v0
 v_lshrrev_b32 v35, 3, v1
 v_and_b32 v36, 7, v1
 v_lshrrev_b32 v37, 4, v1
 v_xor_b32 v37, v36, v37
 v_lshlrev_b32 v37, 4, v37
 s_lshl_b32 s24, s21, 7
 s_lshl_b32 s25, s98, 4
 s_add_u32 s24, s24, s25
 v_add_u32 v38, s24, v35
 v_mul_u32_u24 v38, 1280, v38
 v_add_u32 v2, v38, v37
 v_xor_b32 v37, 64, v37
 v_add_u32 v3, v38, v37
 v_add_u32 v3, 10240, v3
 s_lshl_b32 s36, s98, 11
 s_add_u32 s36, s36, 112640
 s_lshl_b32 s35, s98, 10
 s_lshl_b32 s24, s98, 6
 s_add_u32 s24, s24, 0
 v_add_u32 v35, s24, v1
 v_mul_u32_u24 v36, 3277, v35
 v_lshrrev_b32 v36, 16, v36
 v_mul_u32_u24 v37, 20, v36
 v_sub_u32 v37, v35, v37
 v_mul_u32_u24 v36, 3840, v36
 v_lshl_add_u32 v8, v37, 4, v36
 v_cmp_le_u32 vcc, 10, v37
 v_add_u32 v36, 1120, v8
 s_nop 0
 v_cndmask_b32 v8, v8, v36, vcc
 s_mul_i32 s88, s22, 160
 s_add_u32 s88, s88, 1280
 s_mov_b32 s40, s64
 s_mov_b32 s41, s65
 s_mov_b32 s42, 2457600
 s_mov_b32 s43, 0x00020000
 v_lshrrev_b32 v35, 3, v1
 v_and_b32 v36, 7, v1
 v_bfe_u32 v37, v1, 4, 1
 v_lshlrev_b32 v37, 1, v37
 v_xor_b32 v37, v37, v36
 s_and_b32 s24, s98, 4
 v_xor_b32 v37, s24, v37
 v_lshlrev_b32 v37, 4, v37
 s_lshl_b32 s24, s20, 3
 v_add_u32 v35, s24, v35
 v_mul_u32_u24 v35, 3456, v35
 v_add_u32 v9, v35, v37
 s_lshl_b32 s89, s23, 7
 s_cmp_lt_u32 s98, 4
 s_cselect_b32 s56, s8, s12
 s_cselect_b32 s57, s9, s13
 s_mov_b32 s58, 2211840
 s_mov_b32 s59, 0x00020000
 v_lshrrev_b32 v35, 2, v1
 v_and_b32 v36, 3, v1
 s_and_b32 s24, s98, 2
 v_xor_b32 v36, s24, v36
 s_and_b32 s24, s98, 1
 s_lshl_b32 s24, s24, 4
 v_add_u32 v35, s24, v35
 v_mul_u32_u24 v35, 3456, v35
 v_lshl_add_u32 v10, v36, 4, v35
 s_lshl_b32 s90, s96, 7
 s_lshl_b32 s24, s97, 5
 s_add_u32 s90, s90, s24
 s_mov_b32 s63, 110592
 s_add_u32 s62, s35, 18432
 s_cmp_lt_u32 s98, 2
 s_cselect_b32 s80, s8, s12
 s_cselect_b32 s81, s9, s13
 s_mov_b32 s82, 2211840
 s_mov_b32 s83, 0x00020000
 s_lshl_b32 s24, s98, 6
 s_add_u32 s24, s24, 256
 v_add_u32 v35, s24, v1
 v_mul_u32_u24 v36, 3277, v35
 v_lshrrev_b32 v36, 16, v36
 v_mul_u32_u24 v37, 20, v36
 v_sub_u32 v37, v35, v37
 v_mul_u32_u24 v36, 3840, v36
 v_lshl_add_u32 v38, v37, 4, v36
 v_cmp_le_u32 vcc, 10, v37
 v_add_u32 v36, 1120, v38
 s_nop 0
 v_cndmask_b32 v38, v38, v36, vcc
 s_cmp_ge_u32 s98, 4
 s_cselect_b64 vcc, -1, 0
 s_cselect_b32 s80, s64, s80
 s_cselect_b32 s81, s65, s81
 s_cselect_b32 s82, 2457600, s82
 s_cselect_b32 s90, s88, s90
 s_cselect_b32 s63, 122880, s63
 s_add_u32 s24, s35, 4096
 s_cmp_ge_u32 s98, 4
 s_cselect_b32 s62, s24, s62
 v_cndmask_b32 v10, v10, v38, vcc
 s_cmp_ge_u32 s98, 6
 s_cselect_b64 vcc, -1, 0
 v_mov_b32 v36, 0x80000000
 s_nop 0
 v_cndmask_b32 v10, v10, v36, vcc
 s_cmp_ge_u32 s98, 4
 s_cbranch_scc1 L3_KV_h1
 s_and_b32 s74, s35, 1024
 s_add_u32 s74, s74, 161792
 s_add_u32 m0, s36, 0
 s_movk_i32 s37, 0
 buffer_load_dwordx4 v2, s[4:7], s37 offen lds
 s_add_u32 m0, s36, 1024
 s_movk_i32 s37, 0
 buffer_load_dwordx4 v3, s[4:7], s37 offen lds
 s_add_u32 m0, s35, 0
 s_add_u32 s37, s88, 0
 buffer_load_dwordx4 v8, s[40:43], s37 offen lds
 s_add_u32 m0, s35, 10240
 s_add_u32 s37, s89, 0
 buffer_load_dwordx4 v9, s[56:59], s37 offen lds
 s_add_u32 s37, s62, 0
 s_cmp_lt_u32 s98, 6
 s_cselect_b32 m0, s37, s74
 s_nop 0
 buffer_load_dwordx4 v10, s[80:83], s90 offen lds
 s_add_u32 s90, s90, s63
 s_add_u32 m0, s35, 22528
 s_add_u32 s37, s88, 122880
 buffer_load_dwordx4 v8, s[40:43], s37 offen lds
 s_add_u32 m0, s35, 32768
 s_add_u32 s37, s89, 110592
 buffer_load_dwordx4 v9, s[56:59], s37 offen lds
 s_add_u32 s37, s62, 22528
 s_cmp_lt_u32 s98, 6
 s_cselect_b32 m0, s37, s74
 s_nop 0
 buffer_load_dwordx4 v10, s[80:83], s90 offen lds
 s_add_u32 s90, s90, s63
 s_add_u32 m0, s36, 16384
 s_movk_i32 s37, 128
 buffer_load_dwordx4 v2, s[4:7], s37 offen lds
 s_add_u32 m0, s36, 17408
 s_movk_i32 s37, 128
 buffer_load_dwordx4 v3, s[4:7], s37 offen lds
 s_add_u32 m0, s35, 45056
 s_add_u32 s37, s88, 245760
 buffer_load_dwordx4 v8, s[40:43], s37 offen lds
 s_add_u32 m0, s35, 55296
 s_add_u32 s37, s89, 221184
 buffer_load_dwordx4 v9, s[56:59], s37 offen lds
 s_add_u32 s37, s62, 45056
 s_cmp_lt_u32 s98, 6
 s_cselect_b32 m0, s37, s74
 s_nop 0
 buffer_load_dwordx4 v10, s[80:83], s90 offen lds
 s_add_u32 s90, s90, s63
 v_and_b32 v35, 31, v1
 v_lshrrev_b32 v36, 5, v1
 v_bfe_u32 v37, v1, 1, 3
 v_xor_b32 v37, v37, v36
 v_lshlrev_b32 v38, 7, v35
 s_lshl_b32 s24, s20, 12
 s_add_u32 s24, s24, 112640
 v_add_u32 v38, s24, v38
 v_xor_b32 v39, 0, v37
 v_lshl_add_u32 v4, v39, 4, v38
 v_xor_b32 v39, 2, v37
 v_lshl_add_u32 v5, v39, 4, v38
 v_xor_b32 v39, 4, v37
 v_lshl_add_u32 v6, v39, 4, v38
 v_xor_b32 v39, 6, v37
 v_lshl_add_u32 v7, v39, 4, v38
 v_and_b32 v35, 31, v1
 v_lshrrev_b32 v36, 5, v1
 s_mul_i32 s24, s20, 10752
 s_add_u32 s24, s24, 20480
 v_mul_u32_u24 v38, 336, v35
 v_add_u32 v38, s24, v38
 v_lshl_add_u32 v28, v36, 3, v38
 s_mul_i32 s25, s20, 6400
 s_add_u32 s25, s25, 63488
 v_mul_u32_u24 v38, 200, v35
 v_add_u32 v38, s25, v38
 v_lshl_add_u32 v31, v36, 3, v38
 v_lshl_add_u32 v32, v36, 4, v38
 v_and_b32 v35, 15, v1
 v_lshrrev_b32 v36, 4, v1
 v_mul_u32_u24 v37, 336, v35
 v_add_u32 v37, s24, v37
 v_mul_u32_u24 v38, 40, v36
 v_add_u32 v29, v37, v38
 v_mul_u32_u24 v38, 80, v36
 v_add_u32 v30, v37, v38
 v_bfe_u32 v35, v1, 4, 1
 v_lshrrev_b32 v36, 5, v1
 v_bfe_u32 v37, v1, 2, 2
 v_and_b32 v38, 3, v1
 v_lshlrev_b32 v35, 5, v35
 v_lshl_add_u32 v35, v38, 3, v35
 v_lshl_add_u32 v39, v36, 3, v37
 v_mul_u32_u24 v39, 320, v39
 v_add_u32 v13, v39, v35
 v_add_u32 v14, 0x10000, v13
 v_lshl_add_u32 v39, v36, 2, v37
 v_lshl_add_u32 v39, v39, 6, v35
 v_add_u32 v27, 0, v39
 v_lshrrev_b32 v35, 4, v1
 v_lshl_add_u32 v35, v35, 3, v37
 v_mul_u32_u24 v36, 336, v35
 v_lshl_add_u32 v36, v38, 3, v36
 s_mul_i32 s24, s20, 80
 s_add_u32 s24, s24, 20480
 v_add_u32 v33, s24, v36
 v_mul_u32_u24 v36, 200, v35
 v_lshl_add_u32 v36, v38, 3, v36
 s_mul_i32 s25, s20, 48
 s_add_u32 s25, s25, 63488
 v_add_u32 v34, s25, v36
 s_mov_b32 s72, 0x3fb8aa3b
 s_waitcnt vmcnt(8)
 s_barrier
 ds_read_b128 v[176:179], v4 offset:0
 ds_read_b128 v[180:183], v5 offset:0
 ds_read_b64_tr_b16 v[40:41], v13 offset:0
 ds_read_b64_tr_b16 v[42:43], v13 offset:1280
 s_add_u32 m0, s35, 67584
 s_add_u32 s37, s88, 368640
 buffer_load_dwordx4 v8, s[40:43], s37 offen lds
 ds_read_b64_tr_b16 v[44:45], v13 offset:64
 ds_read_b64_tr_b16 v[46:47], v13 offset:1344
 s_add_u32 m0, s35, 77824
 s_add_u32 s37, s89, 331776
 buffer_load_dwordx4 v9, s[56:59], s37 offen lds
 ds_read_b64_tr_b16 v[48:49], v13 offset:128
 ds_read_b64_tr_b16 v[50:51], v13 offset:1408
 s_add_u32 s37, s62, 67584
 s_cmp_lt_u32 s98, 6
 s_cselect_b32 m0, s37, s74
 s_nop 0
 buffer_load_dwordx4 v10, s[80:83], s90 offen lds
 s_add_u32 s90, s90, s63
 s_waitcnt lgkmcnt(4)
 v_mfma_f32_32x32x16_bf16 v[64:79], v[40:43], v[176:179], 0
 ds_read_b64_tr_b16 v[52:53], v13 offset:192
 ds_read_b64_tr_b16 v[54:55], v13 offset:1472
 s_lshl_b32 s32, s22, 2
 s_mul_i32 s38, s32, 800
 v_add_u32 v200, 0, v0
 s_waitcnt lgkmcnt(4)
 v_mfma_f32_32x32x16_bf16 v[80:95], v[44:47], v[176:179], 0
 ds_read_b64_tr_b16 v[56:57], v13 offset:256
 ds_read_b64_tr_b16 v[58:59], v13 offset:1536
 v_lshrrev_b32 v201, 7, v200
 v_add_u32 v202, 1, v201
 v_lshrrev_b32 v202, 2, v202
 s_waitcnt lgkmcnt(4)
 v_mfma_f32_32x32x16_bf16 v[96:111], v[48:51], v[176:179], 0
 ds_read_b64_tr_b16 v[60:61], v13 offset:5120
 ds_read_b64_tr_b16 v[62:63], v13 offset:6400
 v_lshlrev_b32 v203, 1, v202
 v_sub_u32 v201, v201, v203
 v_bfe_u32 v203, v200, 3, 4
 s_waitcnt lgkmcnt(4)
 v_mfma_f32_32x32x16_bf16 v[112:127], v[52:55], v[176:179], 0
 ds_read_b64_tr_b16 v[40:41], v13 offset:5184
 ds_read_b64_tr_b16 v[42:43], v13 offset:6464
 v_lshl_add_u32 v201, v201, 4, v203
 v_and_b32 v203, 7, v200
 v_lshlrev_b32 v203, 2, v203
 s_waitcnt lgkmcnt(4)
 v_mfma_f32_32x32x16_bf16 v[128:143], v[56:59], v[176:179], 0
 ds_read_b64_tr_b16 v[44:45], v13 offset:5248
 ds_read_b64_tr_b16 v[46:47], v13 offset:6528
 v_lshl_add_u32 v202, v202, 5, v203
 v_mul_u32_u24 v203, 3277, v201
 v_lshrrev_b32 v203, 16, v203
 s_waitcnt lgkmcnt(4)
 v_mfma_f32_32x32x16_bf16 v[64:79], v[60:63], v[180:183], v[64:79]
 ds_read_b64_tr_b16 v[48:49], v13 offset:5312
 ds_read_b64_tr_b16 v[50:51], v13 offset:6592
 v_mul_u32_u24 v204, 3277, v202
 v_lshrrev_b32 v204, 16, v204
 v_cmp_eq_u32 vcc, v203, v204
 s_waitcnt lgkmcnt(4)
 v_mfma_f32_32x32x16_bf16 v[80:95], v[40:43], v[180:183], v[80:95]
 ds_read_b64_tr_b16 v[52:53], v13 offset:5376
 ds_read_b64_tr_b16 v[54:55], v13 offset:6656
 v_mul_u32_u24 v201, 40, v201
 v_lshl_add_u32 v201, v202, 1, v201
 v_mul_u32_u24 v204, 40, v204
 s_waitcnt lgkmcnt(4)
 v_mfma_f32_32x32x16_bf16 v[96:111], v[44:47], v[180:183], v[96:111]
 s_waitcnt vmcnt(8)
 s_barrier
 ds_read_b128 v[184:187], v6 offset:0
 ds_read_b128 v[188:191], v7 offset:0
 ds_read_b64_tr_b16 v[56:57], v13 offset:22528
 ds_read_b64_tr_b16 v[58:59], v13 offset:23808
 s_add_u32 m0, s35, 90112
 s_add_u32 s37, s88, 491520
 buffer_load_dwordx4 v8, s[40:43], s37 offen lds
 s_waitcnt lgkmcnt(6)
 v_mfma_f32_32x32x16_bf16 v[112:127], v[48:51], v[180:183], v[112:127]
 ds_read_b64_tr_b16 v[60:61], v13 offset:22592
 ds_read_b64_tr_b16 v[62:63], v13 offset:23872
 s_add_u32 m0, s35, 100352
 s_add_u32 s37, s89, 442368
 buffer_load_dwordx4 v9, s[56:59], s37 offen lds
 s_waitcnt lgkmcnt(6)
 v_mfma_f32_32x32x16_bf16 v[128:143], v[52:55], v[180:183], v[128:143]
 ds_read_b64_tr_b16 v[40:41], v13 offset:22656
 ds_read_b64_tr_b16 v[42:43], v13 offset:23936
 s_add_u32 s37, s62, 90112
 s_cmp_lt_u32 s98, 6
 s_cselect_b32 m0, s37, s74
 s_nop 0
 buffer_load_dwordx4 v10, s[80:83], s90 offen lds
 s_add_u32 s90, s90, s63
 s_waitcnt lgkmcnt(4)
 v_mfma_f32_32x32x16_bf16 v[64:79], v[56:59], v[184:187], v[64:79]
 ds_read_b64_tr_b16 v[44:45], v13 offset:22720
 ds_read_b64_tr_b16 v[46:47], v13 offset:24000
 s_add_u32 m0, s36, 32768
 s_movk_i32 s37, 256
 buffer_load_dwordx4 v2, s[4:7], s37 offen lds
 s_waitcnt lgkmcnt(4)
 v_mfma_f32_32x32x16_bf16 v[80:95], v[60:63], v[184:187], v[80:95]
 ds_read_b64_tr_b16 v[48:49], v13 offset:22784
 ds_read_b64_tr_b16 v[50:51], v13 offset:24064
 s_add_u32 m0, s36, 33792
 s_movk_i32 s37, 256
 buffer_load_dwordx4 v3, s[4:7], s37 offen lds
 s_waitcnt lgkmcnt(4)
 v_mfma_f32_32x32x16_bf16 v[96:111], v[40:43], v[184:187], v[96:111]
 ds_read_b64_tr_b16 v[52:53], v13 offset:27648
 ds_read_b64_tr_b16 v[54:55], v13 offset:28928
 v_sub_u32 v201, v201, v204
 v_mov_b32 v204, 0x80000000
 v_cndmask_b32 v201, v204, v201, vcc
 s_waitcnt lgkmcnt(4)
 v_mfma_f32_32x32x16_bf16 v[112:127], v[44:47], v[184:187], v[112:127]
 ds_read_b64_tr_b16 v[56:57], v13 offset:27712
 ds_read_b64_tr_b16 v[58:59], v13 offset:28992
 buffer_load_dwordx2 v[144:145], v201, s[68:71], s38 offen
 s_waitcnt lgkmcnt(4)
 v_mfma_f32_32x32x16_bf16 v[128:143], v[48:51], v[184:187], v[128:143]
 ds_read_b64_tr_b16 v[60:61], v13 offset:27776
 ds_read_b64_tr_b16 v[62:63], v13 offset:29056
 v_add_u32 v200, 256, v0
 v_lshrrev_b32 v201, 7, v200
 v_add_u32 v202, 1, v201
 s_waitcnt lgkmcnt(4)
 v_mfma_f32_32x32x16_bf16 v[64:79], v[52:55], v[188:191], v[64:79]
 ds_read_b64_tr_b16 v[40:41], v13 offset:27840
 ds_read_b64_tr_b16 v[42:43], v13 offset:29120
 v_lshrrev_b32 v202, 2, v202
 v_lshlrev_b32 v203, 1, v202
 v_sub_u32 v201, v201, v203
 s_waitcnt lgkmcnt(4)
 v_mfma_f32_32x32x16_bf16 v[80:95], v[56:59], v[188:191], v[80:95]
 ds_read_b64_tr_b16 v[44:45], v13 offset:27904
 ds_read_b64_tr_b16 v[46:47], v13 offset:29184
 v_bfe_u32 v203, v200, 3, 4
 v_lshl_add_u32 v201, v201, 4, v203
 v_and_b32 v203, 7, v200
 s_waitcnt lgkmcnt(4)
 v_mfma_f32_32x32x16_bf16 v[96:111], v[60:63], v[188:191], v[96:111]
 s_waitcnt vmcnt(9)
 s_barrier
 ds_read_b128 v[176:179], v4 offset:16384
 ds_read_b128 v[180:183], v5 offset:16384
 ds_read_b64_tr_b16 v[48:49], v13 offset:45056
 ds_read_b64_tr_b16 v[50:51], v13 offset:46336
 s_add_u32 m0, s35, 0
 s_add_u32 s37, s88, 614400
 buffer_load_dwordx4 v8, s[40:43], s37 offen lds
 s_waitcnt lgkmcnt(6)
 v_mfma_f32_32x32x16_bf16 v[112:127], v[40:43], v[188:191], v[112:127]
 ds_read_b64_tr_b16 v[52:53], v13 offset:45120
 ds_read_b64_tr_b16 v[54:55], v13 offset:46400
 s_add_u32 m0, s35, 10240
 s_add_u32 s37, s89, 552960
 buffer_load_dwordx4 v9, s[56:59], s37 offen lds
 s_waitcnt lgkmcnt(6)
 v_mfma_f32_32x32x16_bf16 v[128:143], v[44:47], v[188:191], v[128:143]
 ds_read_b64_tr_b16 v[56:57], v13 offset:45184
 ds_read_b64_tr_b16 v[58:59], v13 offset:46464
 s_add_u32 s37, s62, 0
 s_cmp_lt_u32 s98, 6
 s_cselect_b32 m0, s37, s74
 s_nop 0
 buffer_load_dwordx4 v10, s[80:83], s90 offen lds
 s_add_u32 s90, s90, s63
 s_waitcnt lgkmcnt(4)
 v_mfma_f32_32x32x16_bf16 v[64:79], v[48:51], v[176:179], v[64:79]
 ds_read_b64_tr_b16 v[60:61], v13 offset:45248
 ds_read_b64_tr_b16 v[62:63], v13 offset:46528
 v_lshlrev_b32 v203, 2, v203
 v_lshl_add_u32 v202, v202, 5, v203
 v_mul_u32_u24 v203, 3277, v201
 s_waitcnt lgkmcnt(4)
 v_mfma_f32_32x32x16_bf16 v[80:95], v[52:55], v[176:179], v[80:95]
 ds_read_b64_tr_b16 v[40:41], v13 offset:45312
 ds_read_b64_tr_b16 v[42:43], v13 offset:46592
 v_lshrrev_b32 v203, 16, v203
 v_mul_u32_u24 v204, 3277, v202
 v_lshrrev_b32 v204, 16, v204
 s_waitcnt lgkmcnt(4)
 v_mfma_f32_32x32x16_bf16 v[96:111], v[56:59], v[176:179], v[96:111]
 ds_read_b64_tr_b16 v[44:45], v13 offset:50176
 ds_read_b64_tr_b16 v[46:47], v13 offset:51456
 v_cmp_eq_u32 vcc, v203, v204
 v_mul_u32_u24 v201, 40, v201
 v_lshl_add_u32 v201, v202, 1, v201
 s_waitcnt lgkmcnt(4)
 v_mfma_f32_32x32x16_bf16 v[112:127], v[60:63], v[176:179], v[112:127]
 ds_read_b64_tr_b16 v[48:49], v13 offset:50240
 ds_read_b64_tr_b16 v[50:51], v13 offset:51520
 v_mul_u32_u24 v204, 40, v204
 v_sub_u32 v201, v201, v204
 v_mov_b32 v204, 0x80000000
 s_waitcnt lgkmcnt(4)
 v_mfma_f32_32x32x16_bf16 v[128:143], v[40:43], v[176:179], v[128:143]
 ds_read_b64_tr_b16 v[52:53], v13 offset:50304
 ds_read_b64_tr_b16 v[54:55], v13 offset:51584
 v_cndmask_b32 v201, v204, v201, vcc
 buffer_load_dwordx2 v[146:147], v201, s[68:71], s38 offen
 s_waitcnt lgkmcnt(4)
 v_mfma_f32_32x32x16_bf16 v[64:79], v[44:47], v[180:183], v[64:79]
 ds_read_b64_tr_b16 v[56:57], v13 offset:50368
 ds_read_b64_tr_b16 v[58:59], v13 offset:51648
 v_add_u32 v200, 512, v0
 v_lshrrev_b32 v201, 7, v200
 v_add_u32 v202, 1, v201
 s_waitcnt lgkmcnt(4)
 v_mfma_f32_32x32x16_bf16 v[80:95], v[48:51], v[180:183], v[80:95]
 ds_read_b64_tr_b16 v[60:61], v13 offset:50432
 ds_read_b64_tr_b16 v[62:63], v13 offset:51712
 v_lshrrev_b32 v202, 2, v202
 v_lshlrev_b32 v203, 1, v202
 v_sub_u32 v201, v201, v203
 s_waitcnt lgkmcnt(4)
 v_mfma_f32_32x32x16_bf16 v[96:111], v[52:55], v[180:183], v[96:111]
 s_waitcnt vmcnt(10)
 s_barrier
 ds_read_b128 v[184:187], v6 offset:16384
 ds_read_b128 v[188:191], v7 offset:16384
 ds_read_b64_tr_b16 v[40:41], v14 offset:2048
 ds_read_b64_tr_b16 v[42:43], v14 offset:3328
 s_add_u32 m0, s35, 22528
 s_add_u32 s37, s88, 737280
 buffer_load_dwordx4 v8, s[40:43], s37 offen lds
 s_waitcnt lgkmcnt(6)
 v_mfma_f32_32x32x16_bf16 v[112:127], v[56:59], v[180:183], v[112:127]
 ds_read_b64_tr_b16 v[44:45], v14 offset:2112
 ds_read_b64_tr_b16 v[46:47], v14 offset:3392
 s_add_u32 m0, s35, 32768
 s_add_u32 s37, s89, 663552
 buffer_load_dwordx4 v9, s[56:59], s37 offen lds
 s_waitcnt lgkmcnt(6)
 v_mfma_f32_32x32x16_bf16 v[128:143], v[60:63], v[180:183], v[128:143]
 ds_read_b64_tr_b16 v[48:49], v14 offset:2176
 ds_read_b64_tr_b16 v[50:51], v14 offset:3456
 s_add_u32 s37, s62, 22528
 s_cmp_lt_u32 s98, 6
 s_cselect_b32 m0, s37, s74
 s_nop 0
 buffer_load_dwordx4 v10, s[80:83], s90 offen lds
 s_add_u32 s90, s90, s63
 s_waitcnt lgkmcnt(4)
 v_mfma_f32_32x32x16_bf16 v[64:79], v[40:43], v[184:187], v[64:79]
 ds_read_b64_tr_b16 v[52:53], v14 offset:2240
 ds_read_b64_tr_b16 v[54:55], v14 offset:3520
 s_add_u32 m0, s36, 0
 s_movk_i32 s37, 384
 buffer_load_dwordx4 v2, s[4:7], s37 offen lds
 s_waitcnt lgkmcnt(4)
 v_mfma_f32_32x32x16_bf16 v[80:95], v[44:47], v[184:187], v[80:95]
 ds_read_b64_tr_b16 v[56:57], v14 offset:2304
 ds_read_b64_tr_b16 v[58:59], v14 offset:3584
 s_add_u32 m0, s36, 1024
 s_movk_i32 s37, 384
 buffer_load_dwordx4 v3, s[4:7], s37 offen lds
 s_waitcnt lgkmcnt(4)
 v_mfma_f32_32x32x16_bf16 v[96:111], v[48:51], v[184:187], v[96:111]
 ds_read_b64_tr_b16 v[60:61], v14 offset:7168
 ds_read_b64_tr_b16 v[62:63], v14 offset:8448
 v_bfe_u32 v203, v200, 3, 4
 v_lshl_add_u32 v201, v201, 4, v203
 v_and_b32 v203, 7, v200
 s_waitcnt lgkmcnt(4)
 v_mfma_f32_32x32x16_bf16 v[112:127], v[52:55], v[184:187], v[112:127]
 ds_read_b64_tr_b16 v[40:41], v14 offset:7232
 ds_read_b64_tr_b16 v[42:43], v14 offset:8512
 v_lshlrev_b32 v203, 2, v203
 v_lshl_add_u32 v202, v202, 5, v203
 v_mul_u32_u24 v203, 3277, v201
 s_waitcnt lgkmcnt(4)
 v_mfma_f32_32x32x16_bf16 v[128:143], v[56:59], v[184:187], v[128:143]
 ds_read_b64_tr_b16 v[44:45], v14 offset:7296
 ds_read_b64_tr_b16 v[46:47], v14 offset:8576
 v_lshrrev_b32 v203, 16, v203
 v_mul_u32_u24 v204, 3277, v202
 v_lshrrev_b32 v204, 16, v204
 s_waitcnt lgkmcnt(4)
 v_mfma_f32_32x32x16_bf16 v[64:79], v[60:63], v[188:191], v[64:79]
 ds_read_b64_tr_b16 v[48:49], v14 offset:7360
 ds_read_b64_tr_b16 v[50:51], v14 offset:8640
 v_cmp_eq_u32 vcc, v203, v204
 v_mul_u32_u24 v201, 40, v201
 v_lshl_add_u32 v201, v202, 1, v201
 s_waitcnt lgkmcnt(4)
 v_mfma_f32_32x32x16_bf16 v[80:95], v[40:43], v[188:191], v[80:95]
 ds_read_b64_tr_b16 v[52:53], v14 offset:7424
 ds_read_b64_tr_b16 v[54:55], v14 offset:8704
 v_mul_u32_u24 v204, 40, v204
 v_sub_u32 v201, v201, v204
 v_mov_b32 v204, 0x80000000
 s_waitcnt lgkmcnt(4)
 v_mfma_f32_32x32x16_bf16 v[96:111], v[44:47], v[188:191], v[96:111]
 s_waitcnt vmcnt(10)
 s_barrier
 ds_read_b128 v[176:179], v4 offset:32768
 ds_read_b128 v[180:183], v5 offset:32768
 ds_read_b64_tr_b16 v[56:57], v14 offset:24576
 ds_read_b64_tr_b16 v[58:59], v14 offset:25856
 s_add_u32 m0, s35, 45056
 s_add_u32 s37, s88, 860160
 buffer_load_dwordx4 v8, s[40:43], s37 offen lds
 s_waitcnt lgkmcnt(6)
 v_mfma_f32_32x32x16_bf16 v[112:127], v[48:51], v[188:191], v[112:127]
 ds_read_b64_tr_b16 v[60:61], v14 offset:24640
 ds_read_b64_tr_b16 v[62:63], v14 offset:25920
 s_add_u32 m0, s35, 55296
 s_add_u32 s37, s89, 774144
 buffer_load_dwordx4 v9, s[56:59], s37 offen lds
 s_waitcnt lgkmcnt(6)
 v_mfma_f32_32x32x16_bf16 v[128:143], v[52:55], v[188:191], v[128:143]
 ds_read_b64_tr_b16 v[40:41], v14 offset:24704
 ds_read_b64_tr_b16 v[42:43], v14 offset:25984
 s_add_u32 s37, s62, 45056
 s_cmp_lt_u32 s98, 6
 s_cselect_b32 m0, s37, s74
 s_nop 0
 buffer_load_dwordx4 v10, s[80:83], s90 offen lds
 s_add_u32 s90, s90, s63
 s_waitcnt lgkmcnt(4)
 v_mfma_f32_32x32x16_bf16 v[64:79], v[56:59], v[176:179], v[64:79]
 ds_read_b64_tr_b16 v[44:45], v14 offset:24768
 ds_read_b64_tr_b16 v[46:47], v14 offset:26048
 v_cndmask_b32 v201, v204, v201, vcc
 buffer_load_dwordx2 v[148:149], v201, s[68:71], s38 offen
 s_waitcnt lgkmcnt(4)
 v_mfma_f32_32x32x16_bf16 v[80:95], v[60:63], v[176:179], v[80:95]
 ds_read_b64_tr_b16 v[48:49], v14 offset:24832
 ds_read_b64_tr_b16 v[50:51], v14 offset:26112
 v_add_u32 v200, 768, v0
 v_lshrrev_b32 v201, 7, v200
 v_add_u32 v202, 1, v201
 s_waitcnt lgkmcnt(4)
 v_mfma_f32_32x32x16_bf16 v[96:111], v[40:43], v[176:179], v[96:111]
 ds_read_b64_tr_b16 v[52:53], v14 offset:29696
 ds_read_b64_tr_b16 v[54:55], v14 offset:30976
 v_lshrrev_b32 v202, 2, v202
 v_lshlrev_b32 v203, 1, v202
 v_sub_u32 v201, v201, v203
 s_waitcnt lgkmcnt(4)
 v_mfma_f32_32x32x16_bf16 v[112:127], v[44:47], v[176:179], v[112:127]
 ds_read_b64_tr_b16 v[56:57], v14 offset:29760
 ds_read_b64_tr_b16 v[58:59], v14 offset:31040
 v_bfe_u32 v203, v200, 3, 4
 v_lshl_add_u32 v201, v201, 4, v203
 v_and_b32 v203, 7, v200
 s_waitcnt lgkmcnt(4)
 v_mfma_f32_32x32x16_bf16 v[128:143], v[48:51], v[176:179], v[128:143]
 ds_read_b64_tr_b16 v[60:61], v14 offset:29824
 ds_read_b64_tr_b16 v[62:63], v14 offset:31104
 v_lshlrev_b32 v203, 2, v203
 v_lshl_add_u32 v202, v202, 5, v203
 v_mul_u32_u24 v203, 3277, v201
 s_waitcnt lgkmcnt(4)
 v_mfma_f32_32x32x16_bf16 v[64:79], v[52:55], v[180:183], v[64:79]
 ds_read_b64_tr_b16 v[40:41], v14 offset:29888
 ds_read_b64_tr_b16 v[42:43], v14 offset:31168
 v_lshrrev_b32 v203, 16, v203
 v_mul_u32_u24 v204, 3277, v202
 v_lshrrev_b32 v204, 16, v204
 s_waitcnt lgkmcnt(4)
 v_mfma_f32_32x32x16_bf16 v[80:95], v[56:59], v[180:183], v[80:95]
 ds_read_b64_tr_b16 v[44:45], v14 offset:29952
 ds_read_b64_tr_b16 v[46:47], v14 offset:31232
 v_cmp_eq_u32 vcc, v203, v204
 v_mul_u32_u24 v201, 40, v201
 v_lshl_add_u32 v201, v202, 1, v201
 s_waitcnt lgkmcnt(4)
 v_mfma_f32_32x32x16_bf16 v[96:111], v[60:63], v[180:183], v[96:111]
 s_waitcnt vmcnt(10)
 s_barrier
 ds_read_b128 v[184:187], v6 offset:32768
 ds_read_b128 v[188:191], v7 offset:32768
 ds_read_b64_tr_b16 v[48:49], v13 offset:0
 ds_read_b64_tr_b16 v[50:51], v13 offset:1280
 s_add_u32 m0, s35, 67584
 s_add_u32 s37, s88, 983040
 buffer_load_dwordx4 v8, s[40:43], s37 offen lds
 s_waitcnt lgkmcnt(6)
 v_mfma_f32_32x32x16_bf16 v[112:127], v[40:43], v[180:183], v[112:127]
 ds_read_b64_tr_b16 v[52:53], v13 offset:64
 ds_read_b64_tr_b16 v[54:55], v13 offset:1344
 s_add_u32 m0, s35, 77824
 s_add_u32 s37, s89, 884736
 buffer_load_dwordx4 v9, s[56:59], s37 offen lds
 s_waitcnt lgkmcnt(6)
 v_mfma_f32_32x32x16_bf16 v[128:143], v[44:47], v[180:183], v[128:143]
 ds_read_b64_tr_b16 v[56:57], v13 offset:128
 ds_read_b64_tr_b16 v[58:59], v13 offset:1408
 s_add_u32 s37, s62, 67584
 s_cmp_lt_u32 s98, 6
 s_cselect_b32 m0, s37, s74
 s_nop 0
 buffer_load_dwordx4 v10, s[80:83], s90 offen lds
 s_add_u32 s90, s90, s63
 s_waitcnt lgkmcnt(4)
 v_mfma_f32_32x32x16_bf16 v[64:79], v[48:51], v[184:187], v[64:79]
 ds_read_b64_tr_b16 v[60:61], v13 offset:192
 ds_read_b64_tr_b16 v[62:63], v13 offset:1472
 s_add_u32 m0, s36, 16384
 s_movk_i32 s37, 512
 buffer_load_dwordx4 v2, s[4:7], s37 offen lds
 s_waitcnt lgkmcnt(4)
 v_mfma_f32_32x32x16_bf16 v[80:95], v[52:55], v[184:187], v[80:95]
 ds_read_b64_tr_b16 v[40:41], v13 offset:256
 ds_read_b64_tr_b16 v[42:43], v13 offset:1536
 s_add_u32 m0, s36, 17408
 s_movk_i32 s37, 512
 buffer_load_dwordx4 v3, s[4:7], s37 offen lds
 s_waitcnt lgkmcnt(4)
 v_mfma_f32_32x32x16_bf16 v[96:111], v[56:59], v[184:187], v[96:111]
 ds_read_b64_tr_b16 v[44:45], v13 offset:5120
 ds_read_b64_tr_b16 v[46:47], v13 offset:6400
 v_mul_u32_u24 v204, 40, v204
 v_sub_u32 v201, v201, v204
 v_mov_b32 v204, 0x80000000
 s_waitcnt lgkmcnt(4)
 v_mfma_f32_32x32x16_bf16 v[112:127], v[60:63], v[184:187], v[112:127]
 ds_read_b64_tr_b16 v[48:49], v13 offset:5184
 ds_read_b64_tr_b16 v[50:51], v13 offset:6464
 v_cndmask_b32 v201, v204, v201, vcc
 buffer_load_dwordx2 v[150:151], v201, s[68:71], s38 offen
 s_waitcnt lgkmcnt(4)
 v_mfma_f32_32x32x16_bf16 v[128:143], v[40:43], v[184:187], v[128:143]
 ds_read_b64_tr_b16 v[52:53], v13 offset:5248
 ds_read_b64_tr_b16 v[54:55], v13 offset:6528
 v_add_u32 v200, 1024, v0
 v_lshrrev_b32 v201, 7, v200
 v_add_u32 v202, 1, v201
 s_waitcnt lgkmcnt(4)
 v_mfma_f32_32x32x16_bf16 v[64:79], v[44:47], v[188:191], v[64:79]
 ds_read_b64_tr_b16 v[56:57], v13 offset:5312
 ds_read_b64_tr_b16 v[58:59], v13 offset:6592
 v_lshrrev_b32 v202, 2, v202
 v_lshlrev_b32 v203, 1, v202
 v_sub_u32 v201, v201, v203
 s_waitcnt lgkmcnt(4)
 v_mfma_f32_32x32x16_bf16 v[80:95], v[48:51], v[188:191], v[80:95]
 ds_read_b64_tr_b16 v[60:61], v13 offset:5376
 ds_read_b64_tr_b16 v[62:63], v13 offset:6656
 v_bfe_u32 v203, v200, 3, 4
 v_lshl_add_u32 v201, v201, 4, v203
 v_and_b32 v203, 7, v200
 s_waitcnt lgkmcnt(4)
 v_mfma_f32_32x32x16_bf16 v[96:111], v[52:55], v[188:191], v[96:111]
 s_waitcnt vmcnt(10)
 s_barrier
 ds_read_b128 v[176:179], v4 offset:0
 ds_read_b128 v[180:183], v5 offset:0
 ds_read_b64_tr_b16 v[40:41], v13 offset:22528
 ds_read_b64_tr_b16 v[42:43], v13 offset:23808
 s_add_u32 m0, s35, 90112
 s_add_u32 s37, s88, 1105920
 buffer_load_dwordx4 v8, s[40:43], s37 offen lds
 s_waitcnt lgkmcnt(6)
 v_mfma_f32_32x32x16_bf16 v[112:127], v[56:59], v[188:191], v[112:127]
 ds_read_b64_tr_b16 v[44:45], v13 offset:22592
 ds_read_b64_tr_b16 v[46:47], v13 offset:23872
 s_add_u32 m0, s35, 100352
 s_add_u32 s37, s89, 995328
 buffer_load_dwordx4 v9, s[56:59], s37 offen lds
 s_waitcnt lgkmcnt(6)
 v_mfma_f32_32x32x16_bf16 v[128:143], v[60:63], v[188:191], v[128:143]
 ds_read_b64_tr_b16 v[48:49], v13 offset:22656
 ds_read_b64_tr_b16 v[50:51], v13 offset:23936
 s_add_u32 s37, s62, 90112
 s_cmp_lt_u32 s98, 6
 s_cselect_b32 m0, s37, s74
 s_nop 0
 buffer_load_dwordx4 v10, s[80:83], s90 offen lds
 s_add_u32 s90, s90, s63
 s_waitcnt lgkmcnt(4)
 v_mfma_f32_32x32x16_bf16 v[64:79], v[40:43], v[176:179], v[64:79]
 ds_read_b64_tr_b16 v[52:53], v13 offset:22720
 ds_read_b64_tr_b16 v[54:55], v13 offset:24000
 v_lshlrev_b32 v203, 2, v203
 v_lshl_add_u32 v202, v202, 5, v203
 v_mul_u32_u24 v203, 3277, v201
 s_waitcnt lgkmcnt(4)
 v_mfma_f32_32x32x16_bf16 v[80:95], v[44:47], v[176:179], v[80:95]
 ds_read_b64_tr_b16 v[56:57], v13 offset:22784
 ds_read_b64_tr_b16 v[58:59], v13 offset:24064
 v_lshrrev_b32 v203, 16, v203
 v_mul_u32_u24 v204, 3277, v202
 v_lshrrev_b32 v204, 16, v204
 s_waitcnt lgkmcnt(4)
 v_mfma_f32_32x32x16_bf16 v[96:111], v[48:51], v[176:179], v[96:111]
 ds_read_b64_tr_b16 v[60:61], v13 offset:27648
 ds_read_b64_tr_b16 v[62:63], v13 offset:28928
 v_cmp_eq_u32 vcc, v203, v204
 v_mul_u32_u24 v201, 40, v201
 v_lshl_add_u32 v201, v202, 1, v201
 s_waitcnt lgkmcnt(4)
 v_mfma_f32_32x32x16_bf16 v[112:127], v[52:55], v[176:179], v[112:127]
 ds_read_b64_tr_b16 v[40:41], v13 offset:27712
 ds_read_b64_tr_b16 v[42:43], v13 offset:28992
 v_mul_u32_u24 v204, 40, v204
 v_sub_u32 v201, v201, v204
 v_mov_b32 v204, 0x80000000
 s_waitcnt lgkmcnt(4)
 v_mfma_f32_32x32x16_bf16 v[128:143], v[56:59], v[176:179], v[128:143]
 ds_read_b64_tr_b16 v[44:45], v13 offset:27776
 ds_read_b64_tr_b16 v[46:47], v13 offset:29056
 v_cndmask_b32 v201, v204, v201, vcc
 buffer_load_dwordx2 v[152:153], v201, s[68:71], s38 offen
 s_waitcnt lgkmcnt(4)
 v_mfma_f32_32x32x16_bf16 v[64:79], v[60:63], v[180:183], v[64:79]
 ds_read_b64_tr_b16 v[48:49], v13 offset:27840
 ds_read_b64_tr_b16 v[50:51], v13 offset:29120
 s_waitcnt lgkmcnt(4)
 v_mfma_f32_32x32x16_bf16 v[80:95], v[40:43], v[180:183], v[80:95]
 ds_read_b64_tr_b16 v[52:53], v13 offset:27904
 ds_read_b64_tr_b16 v[54:55], v13 offset:29184
 s_waitcnt lgkmcnt(4)
 v_mfma_f32_32x32x16_bf16 v[96:111], v[44:47], v[180:183], v[96:111]
 s_waitcnt vmcnt(11)
 s_barrier
 ds_read_b128 v[184:187], v6 offset:0
 ds_read_b128 v[188:191], v7 offset:0
 ds_read_b64_tr_b16 v[56:57], v13 offset:45056
 ds_read_b64_tr_b16 v[58:59], v13 offset:46336
 s_add_u32 m0, s35, 0
 s_add_u32 s37, s88, 1228800
 buffer_load_dwordx4 v8, s[40:43], s37 offen lds
 s_waitcnt lgkmcnt(6)
 v_mfma_f32_32x32x16_bf16 v[112:127], v[48:51], v[180:183], v[112:127]
 ds_read_b64_tr_b16 v[60:61], v13 offset:45120
 ds_read_b64_tr_b16 v[62:63], v13 offset:46400
 s_add_u32 m0, s35, 10240
 s_add_u32 s37, s89, 1105920
 buffer_load_dwordx4 v9, s[56:59], s37 offen lds
 s_waitcnt lgkmcnt(6)
 v_mfma_f32_32x32x16_bf16 v[128:143], v[52:55], v[180:183], v[128:143]
 ds_read_b64_tr_b16 v[40:41], v13 offset:45184
 ds_read_b64_tr_b16 v[42:43], v13 offset:46464
 s_add_u32 s37, s62, 0
 s_cmp_lt_u32 s98, 6
 s_cselect_b32 m0, s37, s74
 s_nop 0
 buffer_load_dwordx4 v10, s[80:83], s90 offen lds
 s_add_u32 s90, s90, s63
 s_waitcnt lgkmcnt(4)
 v_mfma_f32_32x32x16_bf16 v[64:79], v[56:59], v[184:187], v[64:79]
 ds_read_b64_tr_b16 v[44:45], v13 offset:45248
 ds_read_b64_tr_b16 v[46:47], v13 offset:46528
 s_add_u32 m0, s36, 32768
 s_movk_i32 s37, 640
 buffer_load_dwordx4 v2, s[4:7], s37 offen lds
 s_waitcnt lgkmcnt(4)
 v_mfma_f32_32x32x16_bf16 v[80:95], v[60:63], v[184:187], v[80:95]
 ds_read_b64_tr_b16 v[48:49], v13 offset:45312
 ds_read_b64_tr_b16 v[50:51], v13 offset:46592
 s_add_u32 m0, s36, 33792
 s_movk_i32 s37, 640
 buffer_load_dwordx4 v3, s[4:7], s37 offen lds
 s_waitcnt lgkmcnt(4)
 v_mfma_f32_32x32x16_bf16 v[96:111], v[40:43], v[184:187], v[96:111]
 ds_read_b64_tr_b16 v[52:53], v13 offset:50176
 ds_read_b64_tr_b16 v[54:55], v13 offset:51456
 s_waitcnt lgkmcnt(4)
 v_mfma_f32_32x32x16_bf16 v[112:127], v[44:47], v[184:187], v[112:127]
 ds_read_b64_tr_b16 v[56:57], v13 offset:50240
 ds_read_b64_tr_b16 v[58:59], v13 offset:51520
 s_waitcnt lgkmcnt(4)
 v_mfma_f32_32x32x16_bf16 v[128:143], v[48:51], v[184:187], v[128:143]
 ds_read_b64_tr_b16 v[60:61], v13 offset:50304
 ds_read_b64_tr_b16 v[62:63], v13 offset:51584
 s_waitcnt lgkmcnt(4)
 v_mfma_f32_32x32x16_bf16 v[64:79], v[52:55], v[188:191], v[64:79]
 ds_read_b64_tr_b16 v[40:41], v13 offset:50368
 ds_read_b64_tr_b16 v[42:43], v13 offset:51648
 s_waitcnt lgkmcnt(4)
 v_mfma_f32_32x32x16_bf16 v[80:95], v[56:59], v[188:191], v[80:95]
 ds_read_b64_tr_b16 v[44:45], v13 offset:50432
 ds_read_b64_tr_b16 v[46:47], v13 offset:51712
 s_waitcnt lgkmcnt(4)
 v_mfma_f32_32x32x16_bf16 v[96:111], v[60:63], v[188:191], v[96:111]
 s_waitcnt vmcnt(10)
 s_barrier
 ds_read_b128 v[176:179], v4 offset:16384
 ds_read_b128 v[180:183], v5 offset:16384
 ds_read_b64_tr_b16 v[48:49], v14 offset:2048
 ds_read_b64_tr_b16 v[50:51], v14 offset:3328
 s_add_u32 m0, s35, 22528
 s_add_u32 s37, s88, 1351680
 buffer_load_dwordx4 v8, s[40:43], s37 offen lds
 s_waitcnt lgkmcnt(6)
 v_mfma_f32_32x32x16_bf16 v[112:127], v[40:43], v[188:191], v[112:127]
 ds_read_b64_tr_b16 v[52:53], v14 offset:2112
 ds_read_b64_tr_b16 v[54:55], v14 offset:3392
 s_add_u32 m0, s35, 32768
 s_add_u32 s37, s89, 1216512
 buffer_load_dwordx4 v9, s[56:59], s37 offen lds
 s_waitcnt lgkmcnt(6)
 v_mfma_f32_32x32x16_bf16 v[128:143], v[44:47], v[188:191], v[128:143]
 ds_read_b64_tr_b16 v[56:57], v14 offset:2176
 ds_read_b64_tr_b16 v[58:59], v14 offset:3456
 s_add_u32 s37, s62, 22528
 s_cmp_lt_u32 s98, 6
 s_cselect_b32 m0, s37, s74
 s_nop 0
 buffer_load_dwordx4 v10, s[80:83], s90 offen lds
 s_add_u32 s90, s90, s63
 s_waitcnt lgkmcnt(4)
 v_mfma_f32_32x32x16_bf16 v[64:79], v[48:51], v[176:179], v[64:79]
 ds_read_b64_tr_b16 v[60:61], v14 offset:2240
 ds_read_b64_tr_b16 v[62:63], v14 offset:3520
 s_waitcnt lgkmcnt(4)
 v_mfma_f32_32x32x16_bf16 v[80:95], v[52:55], v[176:179], v[80:95]
 ds_read_b64_tr_b16 v[40:41], v14 offset:2304
 ds_read_b64_tr_b16 v[42:43], v14 offset:3584
 s_waitcnt lgkmcnt(4)
 v_mfma_f32_32x32x16_bf16 v[96:111], v[56:59], v[176:179], v[96:111]
 ds_read_b64_tr_b16 v[44:45], v14 offset:7168
 ds_read_b64_tr_b16 v[46:47], v14 offset:8448
 s_waitcnt lgkmcnt(4)
 v_mfma_f32_32x32x16_bf16 v[112:127], v[60:63], v[176:179], v[112:127]
 ds_read_b64_tr_b16 v[48:49], v14 offset:7232
 ds_read_b64_tr_b16 v[50:51], v14 offset:8512
 s_waitcnt lgkmcnt(4)
 v_mfma_f32_32x32x16_bf16 v[128:143], v[40:43], v[176:179], v[128:143]
 ds_read_b64_tr_b16 v[52:53], v14 offset:7296
 ds_read_b64_tr_b16 v[54:55], v14 offset:8576
 s_waitcnt lgkmcnt(4)
 v_mfma_f32_32x32x16_bf16 v[64:79], v[44:47], v[180:183], v[64:79]
 ds_read_b64_tr_b16 v[56:57], v14 offset:7360
 ds_read_b64_tr_b16 v[58:59], v14 offset:8640
 s_waitcnt lgkmcnt(4)
 v_mfma_f32_32x32x16_bf16 v[80:95], v[48:51], v[180:183], v[80:95]
 ds_read_b64_tr_b16 v[60:61], v14 offset:7424
 ds_read_b64_tr_b16 v[62:63], v14 offset:8704
 s_waitcnt lgkmcnt(4)
 v_mfma_f32_32x32x16_bf16 v[96:111], v[52:55], v[180:183], v[96:111]
 s_waitcnt vmcnt(9)
 s_barrier
 ds_read_b128 v[184:187], v6 offset:16384
 ds_read_b128 v[188:191], v7 offset:16384
 ds_read_b64_tr_b16 v[40:41], v14 offset:24576
 ds_read_b64_tr_b16 v[42:43], v14 offset:25856
 s_add_u32 m0, s35, 45056
 s_add_u32 s37, s88, 1474560
 buffer_load_dwordx4 v8, s[40:43], s37 offen lds
 s_waitcnt lgkmcnt(6)
 v_mfma_f32_32x32x16_bf16 v[112:127], v[56:59], v[180:183], v[112:127]
 ds_read_b64_tr_b16 v[44:45], v14 offset:24640
 ds_read_b64_tr_b16 v[46:47], v14 offset:25920
 s_add_u32 m0, s35, 55296
 s_add_u32 s37, s89, 1327104
 buffer_load_dwordx4 v9, s[56:59], s37 offen lds
 s_waitcnt lgkmcnt(6)
 v_mfma_f32_32x32x16_bf16 v[128:143], v[60:63], v[180:183], v[128:143]
 ds_read_b64_tr_b16 v[48:49], v14 offset:24704
 ds_read_b64_tr_b16 v[50:51], v14 offset:25984
 s_add_u32 s37, s62, 45056
 s_cmp_lt_u32 s98, 6
 s_cselect_b32 m0, s37, s74
 s_nop 0
 buffer_load_dwordx4 v10, s[80:83], s90 offen lds
 s_add_u32 s90, s90, s63
 s_waitcnt lgkmcnt(4)
 v_mfma_f32_32x32x16_bf16 v[64:79], v[40:43], v[184:187], v[64:79]
 ds_read_b64_tr_b16 v[52:53], v14 offset:24768
 ds_read_b64_tr_b16 v[54:55], v14 offset:26048
 s_add_u32 m0, s36, 0
 s_movk_i32 s37, 768
 buffer_load_dwordx4 v2, s[4:7], s37 offen lds
 s_waitcnt lgkmcnt(4)
 v_mfma_f32_32x32x16_bf16 v[80:95], v[44:47], v[184:187], v[80:95]
 ds_read_b64_tr_b16 v[56:57], v14 offset:24832
 ds_read_b64_tr_b16 v[58:59], v14 offset:26112
 s_add_u32 m0, s36, 1024
 s_movk_i32 s37, 768
 buffer_load_dwordx4 v3, s[4:7], s37 offen lds
 s_waitcnt lgkmcnt(4)
 v_mfma_f32_32x32x16_bf16 v[96:111], v[48:51], v[184:187], v[96:111]
 ds_read_b64_tr_b16 v[60:61], v14 offset:29696
 ds_read_b64_tr_b16 v[62:63], v14 offset:30976
 s_waitcnt lgkmcnt(4)
 v_mfma_f32_32x32x16_bf16 v[112:127], v[52:55], v[184:187], v[112:127]
 ds_read_b64_tr_b16 v[40:41], v14 offset:29760
 ds_read_b64_tr_b16 v[42:43], v14 offset:31040
 s_waitcnt lgkmcnt(4)
 v_mfma_f32_32x32x16_bf16 v[128:143], v[56:59], v[184:187], v[128:143]
 ds_read_b64_tr_b16 v[44:45], v14 offset:29824
 ds_read_b64_tr_b16 v[46:47], v14 offset:31104
 s_waitcnt lgkmcnt(4)
 v_mfma_f32_32x32x16_bf16 v[64:79], v[60:63], v[188:191], v[64:79]
 ds_read_b64_tr_b16 v[48:49], v14 offset:29888
 ds_read_b64_tr_b16 v[50:51], v14 offset:31168
 s_waitcnt lgkmcnt(4)
 v_mfma_f32_32x32x16_bf16 v[80:95], v[40:43], v[188:191], v[80:95]
 ds_read_b64_tr_b16 v[52:53], v14 offset:29952
 ds_read_b64_tr_b16 v[54:55], v14 offset:31232
 s_waitcnt lgkmcnt(4)
 v_mfma_f32_32x32x16_bf16 v[96:111], v[44:47], v[188:191], v[96:111]
 s_waitcnt vmcnt(8)
 s_barrier
 ds_read_b128 v[176:179], v4 offset:32768
 ds_read_b128 v[180:183], v5 offset:32768
 ds_read_b64_tr_b16 v[56:57], v13 offset:0
 ds_read_b64_tr_b16 v[58:59], v13 offset:1280
 s_add_u32 m0, s35, 67584
 s_add_u32 s37, s88, 1597440
 buffer_load_dwordx4 v8, s[40:43], s37 offen lds
 s_waitcnt lgkmcnt(6)
 v_mfma_f32_32x32x16_bf16 v[112:127], v[48:51], v[188:191], v[112:127]
 ds_read_b64_tr_b16 v[60:61], v13 offset:64
 ds_read_b64_tr_b16 v[62:63], v13 offset:1344
 s_add_u32 m0, s35, 77824
 s_add_u32 s37, s89, 1437696
 buffer_load_dwordx4 v9, s[56:59], s37 offen lds
 s_waitcnt lgkmcnt(6)
 v_mfma_f32_32x32x16_bf16 v[128:143], v[52:55], v[188:191], v[128:143]
 ds_read_b64_tr_b16 v[40:41], v13 offset:128
 ds_read_b64_tr_b16 v[42:43], v13 offset:1408
 s_add_u32 s37, s62, 67584
 s_cmp_lt_u32 s98, 6
 s_cselect_b32 m0, s37, s74
 s_nop 0
 buffer_load_dwordx4 v10, s[80:83], s90 offen lds
 s_add_u32 s90, s90, s63
 s_waitcnt lgkmcnt(4)
 v_mfma_f32_32x32x16_bf16 v[64:79], v[56:59], v[176:179], v[64:79]
 ds_read_b64_tr_b16 v[44:45], v13 offset:192
 ds_read_b64_tr_b16 v[46:47], v13 offset:1472
 s_waitcnt lgkmcnt(4)
 v_mfma_f32_32x32x16_bf16 v[80:95], v[60:63], v[176:179], v[80:95]
 ds_read_b64_tr_b16 v[48:49], v13 offset:256
 ds_read_b64_tr_b16 v[50:51], v13 offset:1536
 s_waitcnt lgkmcnt(4)
 v_mfma_f32_32x32x16_bf16 v[96:111], v[40:43], v[176:179], v[96:111]
 ds_read_b64_tr_b16 v[52:53], v13 offset:5120
 ds_read_b64_tr_b16 v[54:55], v13 offset:6400
 s_waitcnt lgkmcnt(4)
 v_mfma_f32_32x32x16_bf16 v[112:127], v[44:47], v[176:179], v[112:127]
 ds_read_b64_tr_b16 v[56:57], v13 offset:5184
 ds_read_b64_tr_b16 v[58:59], v13 offset:6464
 s_waitcnt lgkmcnt(4)
 v_mfma_f32_32x32x16_bf16 v[128:143], v[48:51], v[176:179], v[128:143]
 ds_read_b64_tr_b16 v[60:61], v13 offset:5248
 ds_read_b64_tr_b16 v[62:63], v13 offset:6528
 s_waitcnt lgkmcnt(4)
 v_mfma_f32_32x32x16_bf16 v[64:79], v[52:55], v[180:183], v[64:79]
 ds_read_b64_tr_b16 v[40:41], v13 offset:5312
 ds_read_b64_tr_b16 v[42:43], v13 offset:6592
 s_waitcnt lgkmcnt(4)
 v_mfma_f32_32x32x16_bf16 v[80:95], v[56:59], v[180:183], v[80:95]
 ds_read_b64_tr_b16 v[44:45], v13 offset:5376
 ds_read_b64_tr_b16 v[46:47], v13 offset:6656
 s_waitcnt lgkmcnt(4)
 v_mfma_f32_32x32x16_bf16 v[96:111], v[60:63], v[180:183], v[96:111]
 s_waitcnt vmcnt(8)
 s_barrier
 ds_read_b128 v[184:187], v6 offset:32768
 ds_read_b128 v[188:191], v7 offset:32768
 ds_read_b64_tr_b16 v[48:49], v13 offset:22528
 ds_read_b64_tr_b16 v[50:51], v13 offset:23808
 s_add_u32 m0, s35, 90112
 s_add_u32 s37, s88, 1720320
 buffer_load_dwordx4 v8, s[40:43], s37 offen lds
 s_waitcnt lgkmcnt(6)
 v_mfma_f32_32x32x16_bf16 v[112:127], v[40:43], v[180:183], v[112:127]
 ds_read_b64_tr_b16 v[52:53], v13 offset:22592
 ds_read_b64_tr_b16 v[54:55], v13 offset:23872
 s_add_u32 m0, s35, 100352
 s_add_u32 s37, s89, 1548288
 buffer_load_dwordx4 v9, s[56:59], s37 offen lds
 s_waitcnt lgkmcnt(6)
 v_mfma_f32_32x32x16_bf16 v[128:143], v[44:47], v[180:183], v[128:143]
 ds_read_b64_tr_b16 v[56:57], v13 offset:22656
 ds_read_b64_tr_b16 v[58:59], v13 offset:23936
 s_add_u32 s37, s62, 90112
 s_cmp_lt_u32 s98, 6
 s_cselect_b32 m0, s37, s74
 s_nop 0
 buffer_load_dwordx4 v10, s[80:83], s90 offen lds
 s_add_u32 s90, s90, s63
 s_waitcnt lgkmcnt(4)
 v_mfma_f32_32x32x16_bf16 v[64:79], v[48:51], v[184:187], v[64:79]
 ds_read_b64_tr_b16 v[60:61], v13 offset:22720
 ds_read_b64_tr_b16 v[62:63], v13 offset:24000
 s_add_u32 m0, s36, 16384
 s_movk_i32 s37, 896
 buffer_load_dwordx4 v2, s[4:7], s37 offen lds
 s_waitcnt lgkmcnt(4)
 v_mfma_f32_32x32x16_bf16 v[80:95], v[52:55], v[184:187], v[80:95]
 ds_read_b64_tr_b16 v[40:41], v13 offset:22784
 ds_read_b64_tr_b16 v[42:43], v13 offset:24064
 s_add_u32 m0, s36, 17408
 s_movk_i32 s37, 896
 buffer_load_dwordx4 v3, s[4:7], s37 offen lds
 s_waitcnt lgkmcnt(4)
 v_mfma_f32_32x32x16_bf16 v[96:111], v[56:59], v[184:187], v[96:111]
 ds_read_b64_tr_b16 v[44:45], v13 offset:27648
 ds_read_b64_tr_b16 v[46:47], v13 offset:28928
 s_waitcnt lgkmcnt(4)
 v_mfma_f32_32x32x16_bf16 v[112:127], v[60:63], v[184:187], v[112:127]
 ds_read_b64_tr_b16 v[48:49], v13 offset:27712
 ds_read_b64_tr_b16 v[50:51], v13 offset:28992
 s_waitcnt lgkmcnt(4)
 v_mfma_f32_32x32x16_bf16 v[128:143], v[40:43], v[184:187], v[128:143]
 ds_read_b64_tr_b16 v[52:53], v13 offset:27776
 ds_read_b64_tr_b16 v[54:55], v13 offset:29056
 s_waitcnt lgkmcnt(4)
 v_mfma_f32_32x32x16_bf16 v[64:79], v[44:47], v[188:191], v[64:79]
 ds_read_b64_tr_b16 v[56:57], v13 offset:27840
 ds_read_b64_tr_b16 v[58:59], v13 offset:29120
 s_waitcnt lgkmcnt(4)
 v_mfma_f32_32x32x16_bf16 v[80:95], v[48:51], v[188:191], v[80:95]
 ds_read_b64_tr_b16 v[60:61], v13 offset:27904
 ds_read_b64_tr_b16 v[62:63], v13 offset:29184
 s_waitcnt lgkmcnt(4)
 v_mfma_f32_32x32x16_bf16 v[96:111], v[52:55], v[188:191], v[96:111]
 s_waitcnt vmcnt(8)
 s_barrier
 ds_read_b128 v[176:179], v4 offset:0
 ds_read_b128 v[180:183], v5 offset:0
 ds_read_b64_tr_b16 v[40:41], v13 offset:45056
 ds_read_b64_tr_b16 v[42:43], v13 offset:46336
 s_add_u32 m0, s35, 0
 s_add_u32 s37, s88, 1843200
 buffer_load_dwordx4 v8, s[40:43], s37 offen lds
 s_waitcnt lgkmcnt(6)
 v_mfma_f32_32x32x16_bf16 v[112:127], v[56:59], v[188:191], v[112:127]
 ds_read_b64_tr_b16 v[44:45], v13 offset:45120
 ds_read_b64_tr_b16 v[46:47], v13 offset:46400
 s_add_u32 m0, s35, 10240
 s_add_u32 s37, s89, 1658880
 buffer_load_dwordx4 v9, s[56:59], s37 offen lds
 s_waitcnt lgkmcnt(6)
 v_mfma_f32_32x32x16_bf16 v[128:143], v[60:63], v[188:191], v[128:143]
 ds_read_b64_tr_b16 v[48:49], v13 offset:45184
 ds_read_b64_tr_b16 v[50:51], v13 offset:46464
 s_add_u32 s37, s62, 0
 s_cmp_lt_u32 s98, 6
 s_cselect_b32 m0, s37, s74
 s_nop 0
 buffer_load_dwordx4 v10, s[80:83], s90 offen lds
 s_add_u32 s90, s90, s63
 s_waitcnt lgkmcnt(4)
 v_mfma_f32_32x32x16_bf16 v[64:79], v[40:43], v[176:179], v[64:79]
 ds_read_b64_tr_b16 v[52:53], v13 offset:45248
 ds_read_b64_tr_b16 v[54:55], v13 offset:46528
 s_waitcnt lgkmcnt(4)
 v_mfma_f32_32x32x16_bf16 v[80:95], v[44:47], v[176:179], v[80:95]
 ds_read_b64_tr_b16 v[56:57], v13 offset:45312
 ds_read_b64_tr_b16 v[58:59], v13 offset:46592
 s_waitcnt lgkmcnt(4)
 v_mfma_f32_32x32x16_bf16 v[96:111], v[48:51], v[176:179], v[96:111]
 ds_read_b64_tr_b16 v[60:61], v13 offset:50176
 ds_read_b64_tr_b16 v[62:63], v13 offset:51456
 s_waitcnt lgkmcnt(4)
 v_mfma_f32_32x32x16_bf16 v[112:127], v[52:55], v[176:179], v[112:127]
 ds_read_b64_tr_b16 v[40:41], v13 offset:50240
 ds_read_b64_tr_b16 v[42:43], v13 offset:51520
 s_waitcnt lgkmcnt(4)
 v_mfma_f32_32x32x16_bf16 v[128:143], v[56:59], v[176:179], v[128:143]
 ds_read_b64_tr_b16 v[44:45], v13 offset:50304
 ds_read_b64_tr_b16 v[46:47], v13 offset:51584
 s_waitcnt lgkmcnt(4)
 v_mfma_f32_32x32x16_bf16 v[64:79], v[60:63], v[180:183], v[64:79]
 ds_read_b64_tr_b16 v[48:49], v13 offset:50368
 ds_read_b64_tr_b16 v[50:51], v13 offset:51648
 s_waitcnt lgkmcnt(4)
 v_mfma_f32_32x32x16_bf16 v[80:95], v[40:43], v[180:183], v[80:95]
 ds_read_b64_tr_b16 v[52:53], v13 offset:50432
 ds_read_b64_tr_b16 v[54:55], v13 offset:51712
 s_waitcnt lgkmcnt(4)
 v_mfma_f32_32x32x16_bf16 v[96:111], v[44:47], v[180:183], v[96:111]
 s_waitcnt vmcnt(8)
 s_barrier
 ds_read_b128 v[184:187], v6 offset:0
 ds_read_b128 v[188:191], v7 offset:0
 ds_read_b64_tr_b16 v[56:57], v14 offset:2048
 ds_read_b64_tr_b16 v[58:59], v14 offset:3328
 s_add_u32 m0, s35, 22528
 s_add_u32 s37, s88, 1966080
 buffer_load_dwordx4 v8, s[40:43], s37 offen lds
 s_waitcnt lgkmcnt(6)
 v_mfma_f32_32x32x16_bf16 v[112:127], v[48:51], v[180:183], v[112:127]
 ds_read_b64_tr_b16 v[60:61], v14 offset:2112
 ds_read_b64_tr_b16 v[62:63], v14 offset:3392
 s_add_u32 m0, s35, 32768
 s_add_u32 s37, s89, 1769472
 buffer_load_dwordx4 v9, s[56:59], s37 offen lds
 s_waitcnt lgkmcnt(6)
 v_mfma_f32_32x32x16_bf16 v[128:143], v[52:55], v[180:183], v[128:143]
 ds_read_b64_tr_b16 v[40:41], v14 offset:2176
 ds_read_b64_tr_b16 v[42:43], v14 offset:3456
 s_add_u32 s37, s62, 22528
 s_cmp_lt_u32 s98, 6
 s_cselect_b32 m0, s37, s74
 s_nop 0
 buffer_load_dwordx4 v10, s[80:83], s90 offen lds
 s_add_u32 s90, s90, s63
 s_waitcnt lgkmcnt(4)
 v_mfma_f32_32x32x16_bf16 v[64:79], v[56:59], v[184:187], v[64:79]
 ds_read_b64_tr_b16 v[44:45], v14 offset:2240
 ds_read_b64_tr_b16 v[46:47], v14 offset:3520
 s_add_u32 m0, s36, 32768
 s_movk_i32 s37, 1024
 buffer_load_dwordx4 v2, s[4:7], s37 offen lds
 s_waitcnt lgkmcnt(4)
 v_mfma_f32_32x32x16_bf16 v[80:95], v[60:63], v[184:187], v[80:95]
 ds_read_b64_tr_b16 v[48:49], v14 offset:2304
 ds_read_b64_tr_b16 v[50:51], v14 offset:3584
 s_add_u32 m0, s36, 33792
 s_movk_i32 s37, 1024
 buffer_load_dwordx4 v3, s[4:7], s37 offen lds
 s_waitcnt lgkmcnt(4)
 v_mfma_f32_32x32x16_bf16 v[96:111], v[40:43], v[184:187], v[96:111]
 ds_read_b64_tr_b16 v[52:53], v14 offset:7168
 ds_read_b64_tr_b16 v[54:55], v14 offset:8448
 s_waitcnt lgkmcnt(4)
 v_mfma_f32_32x32x16_bf16 v[112:127], v[44:47], v[184:187], v[112:127]
 ds_read_b64_tr_b16 v[56:57], v14 offset:7232
 ds_read_b64_tr_b16 v[58:59], v14 offset:8512
 s_waitcnt lgkmcnt(4)
 v_mfma_f32_32x32x16_bf16 v[128:143], v[48:51], v[184:187], v[128:143]
 ds_read_b64_tr_b16 v[60:61], v14 offset:7296
 ds_read_b64_tr_b16 v[62:63], v14 offset:8576
 s_waitcnt lgkmcnt(4)
 v_mfma_f32_32x32x16_bf16 v[64:79], v[52:55], v[188:191], v[64:79]
 ds_read_b64_tr_b16 v[40:41], v14 offset:7360
 ds_read_b64_tr_b16 v[42:43], v14 offset:8640
 s_waitcnt lgkmcnt(4)
 v_mfma_f32_32x32x16_bf16 v[80:95], v[56:59], v[188:191], v[80:95]
 ds_read_b64_tr_b16 v[44:45], v14 offset:7424
 ds_read_b64_tr_b16 v[46:47], v14 offset:8704
 s_waitcnt lgkmcnt(4)
 v_mfma_f32_32x32x16_bf16 v[96:111], v[60:63], v[188:191], v[96:111]
 s_waitcnt vmcnt(8)
 s_barrier
 ds_read_b128 v[176:179], v4 offset:16384
 ds_read_b128 v[180:183], v5 offset:16384
 ds_read_b64_tr_b16 v[48:49], v14 offset:24576
 ds_read_b64_tr_b16 v[50:51], v14 offset:25856
 s_add_u32 m0, s35, 45056
 s_add_u32 s37, s88, 2088960
 buffer_load_dwordx4 v8, s[40:43], s37 offen lds
 s_waitcnt lgkmcnt(6)
 v_mfma_f32_32x32x16_bf16 v[112:127], v[40:43], v[188:191], v[112:127]
 ds_read_b64_tr_b16 v[52:53], v14 offset:24640
 ds_read_b64_tr_b16 v[54:55], v14 offset:25920
 s_add_u32 m0, s35, 55296
 s_add_u32 s37, s89, 1880064
 buffer_load_dwordx4 v9, s[56:59], s37 offen lds
 s_waitcnt lgkmcnt(6)
 v_mfma_f32_32x32x16_bf16 v[128:143], v[44:47], v[188:191], v[128:143]
 ds_read_b64_tr_b16 v[56:57], v14 offset:24704
 ds_read_b64_tr_b16 v[58:59], v14 offset:25984
 s_add_u32 s37, s62, 45056
 s_cmp_lt_u32 s98, 6
 s_cselect_b32 m0, s37, s74
 s_nop 0
 buffer_load_dwordx4 v10, s[80:83], s90 offen lds
 s_add_u32 s90, s90, s63
 s_waitcnt lgkmcnt(4)
 v_mfma_f32_32x32x16_bf16 v[64:79], v[48:51], v[176:179], v[64:79]
 ds_read_b64_tr_b16 v[60:61], v14 offset:24768
 ds_read_b64_tr_b16 v[62:63], v14 offset:26048
 s_waitcnt lgkmcnt(4)
 v_mfma_f32_32x32x16_bf16 v[80:95], v[52:55], v[176:179], v[80:95]
 ds_read_b64_tr_b16 v[40:41], v14 offset:24832
 ds_read_b64_tr_b16 v[42:43], v14 offset:26112
 s_waitcnt lgkmcnt(4)
 v_mfma_f32_32x32x16_bf16 v[96:111], v[56:59], v[176:179], v[96:111]
 ds_read_b64_tr_b16 v[44:45], v14 offset:29696
 ds_read_b64_tr_b16 v[46:47], v14 offset:30976
 s_waitcnt lgkmcnt(4)
 v_mfma_f32_32x32x16_bf16 v[112:127], v[60:63], v[176:179], v[112:127]
 ds_read_b64_tr_b16 v[48:49], v14 offset:29760
 ds_read_b64_tr_b16 v[50:51], v14 offset:31040
 s_waitcnt lgkmcnt(4)
 v_mfma_f32_32x32x16_bf16 v[128:143], v[40:43], v[176:179], v[128:143]
 ds_read_b64_tr_b16 v[52:53], v14 offset:29824
 ds_read_b64_tr_b16 v[54:55], v14 offset:31104
 s_waitcnt lgkmcnt(4)
 v_mfma_f32_32x32x16_bf16 v[64:79], v[44:47], v[180:183], v[64:79]
 ds_read_b64_tr_b16 v[56:57], v14 offset:29888
 ds_read_b64_tr_b16 v[58:59], v14 offset:31168
 s_waitcnt lgkmcnt(4)
 v_mfma_f32_32x32x16_bf16 v[80:95], v[48:51], v[180:183], v[80:95]
 ds_read_b64_tr_b16 v[60:61], v14 offset:29952
 ds_read_b64_tr_b16 v[62:63], v14 offset:31232
 s_waitcnt lgkmcnt(4)
 v_mfma_f32_32x32x16_bf16 v[96:111], v[52:55], v[180:183], v[96:111]
 s_waitcnt vmcnt(8)
 s_barrier
 ds_read_b128 v[184:187], v6 offset:16384
 ds_read_b128 v[188:191], v7 offset:16384
 ds_read_b64_tr_b16 v[40:41], v13 offset:0
 ds_read_b64_tr_b16 v[42:43], v13 offset:1280
 s_add_u32 m0, s35, 67584
 s_add_u32 s37, s88, 2211840
 buffer_load_dwordx4 v8, s[40:43], s37 offen lds
 s_waitcnt lgkmcnt(6)
 v_mfma_f32_32x32x16_bf16 v[112:127], v[56:59], v[180:183], v[112:127]
 ds_read_b64_tr_b16 v[44:45], v13 offset:64
 ds_read_b64_tr_b16 v[46:47], v13 offset:1344
 s_add_u32 m0, s35, 77824
 s_add_u32 s37, s89, 1990656
 buffer_load_dwordx4 v9, s[56:59], s37 offen lds
 s_waitcnt lgkmcnt(6)
 v_mfma_f32_32x32x16_bf16 v[128:143], v[60:63], v[180:183], v[128:143]
 ds_read_b64_tr_b16 v[48:49], v13 offset:128
 ds_read_b64_tr_b16 v[50:51], v13 offset:1408
 s_add_u32 s37, s62, 67584
 s_cmp_lt_u32 s98, 6
 s_cselect_b32 m0, s37, s74
 s_nop 0
 buffer_load_dwordx4 v10, s[80:83], s90 offen lds
 s_add_u32 s90, s90, s63
 s_waitcnt lgkmcnt(4)
 v_mfma_f32_32x32x16_bf16 v[64:79], v[40:43], v[184:187], v[64:79]
 ds_read_b64_tr_b16 v[52:53], v13 offset:192
 ds_read_b64_tr_b16 v[54:55], v13 offset:1472
 s_add_u32 m0, s36, 0
 s_movk_i32 s37, 1152
 buffer_load_dwordx4 v2, s[4:7], s37 offen lds
 s_waitcnt lgkmcnt(4)
 v_mfma_f32_32x32x16_bf16 v[80:95], v[44:47], v[184:187], v[80:95]
 ds_read_b64_tr_b16 v[56:57], v13 offset:256
 ds_read_b64_tr_b16 v[58:59], v13 offset:1536
 s_add_u32 m0, s36, 1024
 s_movk_i32 s37, 1152
 buffer_load_dwordx4 v3, s[4:7], s37 offen lds
 s_waitcnt lgkmcnt(4)
 v_mfma_f32_32x32x16_bf16 v[96:111], v[48:51], v[184:187], v[96:111]
 ds_read_b64_tr_b16 v[60:61], v13 offset:5120
 ds_read_b64_tr_b16 v[62:63], v13 offset:6400
 s_waitcnt lgkmcnt(4)
 v_mfma_f32_32x32x16_bf16 v[112:127], v[52:55], v[184:187], v[112:127]
 ds_read_b64_tr_b16 v[40:41], v13 offset:5184
 ds_read_b64_tr_b16 v[42:43], v13 offset:6464
 s_waitcnt lgkmcnt(4)
 v_mfma_f32_32x32x16_bf16 v[128:143], v[56:59], v[184:187], v[128:143]
 ds_read_b64_tr_b16 v[44:45], v13 offset:5248
 ds_read_b64_tr_b16 v[46:47], v13 offset:6528
 s_waitcnt lgkmcnt(4)
 v_mfma_f32_32x32x16_bf16 v[64:79], v[60:63], v[188:191], v[64:79]
 ds_read_b64_tr_b16 v[48:49], v13 offset:5312
 ds_read_b64_tr_b16 v[50:51], v13 offset:6592
 s_waitcnt lgkmcnt(4)
 v_mfma_f32_32x32x16_bf16 v[80:95], v[40:43], v[188:191], v[80:95]
 ds_read_b64_tr_b16 v[52:53], v13 offset:5376
 ds_read_b64_tr_b16 v[54:55], v13 offset:6656
 s_waitcnt lgkmcnt(4)
 v_mfma_f32_32x32x16_bf16 v[96:111], v[44:47], v[188:191], v[96:111]
 s_waitcnt vmcnt(8)
 s_barrier
 ds_read_b128 v[176:179], v4 offset:32768
 ds_read_b128 v[180:183], v5 offset:32768
 ds_read_b64_tr_b16 v[56:57], v13 offset:22528
 ds_read_b64_tr_b16 v[58:59], v13 offset:23808
 s_add_u32 m0, s35, 90112
 s_add_u32 s37, s88, 2334720
 buffer_load_dwordx4 v8, s[40:43], s37 offen lds
 s_waitcnt lgkmcnt(6)
 v_mfma_f32_32x32x16_bf16 v[112:127], v[48:51], v[188:191], v[112:127]
 ds_read_b64_tr_b16 v[60:61], v13 offset:22592
 ds_read_b64_tr_b16 v[62:63], v13 offset:23872
 s_add_u32 m0, s35, 100352
 s_add_u32 s37, s89, 2101248
 buffer_load_dwordx4 v9, s[56:59], s37 offen lds
 s_waitcnt lgkmcnt(6)
 v_mfma_f32_32x32x16_bf16 v[128:143], v[52:55], v[188:191], v[128:143]
 ds_read_b64_tr_b16 v[40:41], v13 offset:22656
 ds_read_b64_tr_b16 v[42:43], v13 offset:23936
 s_add_u32 s37, s62, 90112
 s_cmp_lt_u32 s98, 6
 s_cselect_b32 m0, s37, s74
 s_nop 0
 buffer_load_dwordx4 v10, s[80:83], s90 offen lds
 s_add_u32 s90, s90, s63
 s_waitcnt lgkmcnt(4)
 v_mfma_f32_32x32x16_bf16 v[64:79], v[56:59], v[176:179], v[64:79]
 ds_read_b64_tr_b16 v[44:45], v13 offset:22720
 ds_read_b64_tr_b16 v[46:47], v13 offset:24000
 s_waitcnt lgkmcnt(4)
 v_mfma_f32_32x32x16_bf16 v[80:95], v[60:63], v[176:179], v[80:95]
 ds_read_b64_tr_b16 v[48:49], v13 offset:22784
 ds_read_b64_tr_b16 v[50:51], v13 offset:24064
 s_waitcnt lgkmcnt(4)
 v_mfma_f32_32x32x16_bf16 v[96:111], v[40:43], v[176:179], v[96:111]
 ds_read_b64_tr_b16 v[52:53], v13 offset:27648
 ds_read_b64_tr_b16 v[54:55], v13 offset:28928
 s_waitcnt lgkmcnt(4)
 v_mfma_f32_32x32x16_bf16 v[112:127], v[44:47], v[176:179], v[112:127]
 ds_read_b64_tr_b16 v[56:57], v13 offset:27712
 ds_read_b64_tr_b16 v[58:59], v13 offset:28992
 s_waitcnt lgkmcnt(4)
 v_mfma_f32_32x32x16_bf16 v[128:143], v[48:51], v[176:179], v[128:143]
 ds_read_b64_tr_b16 v[60:61], v13 offset:27776
 ds_read_b64_tr_b16 v[62:63], v13 offset:29056
 s_waitcnt lgkmcnt(4)
 v_mfma_f32_32x32x16_bf16 v[64:79], v[52:55], v[180:183], v[64:79]
 ds_read_b64_tr_b16 v[40:41], v13 offset:27840
 ds_read_b64_tr_b16 v[42:43], v13 offset:29120
 s_waitcnt lgkmcnt(4)
 v_mfma_f32_32x32x16_bf16 v[80:95], v[56:59], v[180:183], v[80:95]
 ds_read_b64_tr_b16 v[44:45], v13 offset:27904
 ds_read_b64_tr_b16 v[46:47], v13 offset:29184
 s_waitcnt lgkmcnt(4)
 v_mfma_f32_32x32x16_bf16 v[96:111], v[60:63], v[180:183], v[96:111]
 s_waitcnt vmcnt(8)
 s_barrier
 ds_read_b128 v[184:187], v6 offset:32768
 ds_read_b128 v[188:191], v7 offset:32768
 ds_read_b64_tr_b16 v[48:49], v13 offset:45056
 ds_read_b64_tr_b16 v[50:51], v13 offset:46336
 s_waitcnt lgkmcnt(6)
 v_mfma_f32_32x32x16_bf16 v[112:127], v[40:43], v[180:183], v[112:127]
 ds_read_b64_tr_b16 v[52:53], v13 offset:45120
 ds_read_b64_tr_b16 v[54:55], v13 offset:46400
 s_waitcnt lgkmcnt(6)
 v_mfma_f32_32x32x16_bf16 v[128:143], v[44:47], v[180:183], v[128:143]
 ds_read_b64_tr_b16 v[56:57], v13 offset:45184
 ds_read_b64_tr_b16 v[58:59], v13 offset:46464
 s_waitcnt lgkmcnt(4)
 v_mfma_f32_32x32x16_bf16 v[64:79], v[48:51], v[184:187], v[64:79]
 ds_read_b64_tr_b16 v[60:61], v13 offset:45248
 ds_read_b64_tr_b16 v[62:63], v13 offset:46528
 s_waitcnt lgkmcnt(4)
 v_mfma_f32_32x32x16_bf16 v[80:95], v[52:55], v[184:187], v[80:95]
 ds_read_b64_tr_b16 v[40:41], v13 offset:45312
 ds_read_b64_tr_b16 v[42:43], v13 offset:46592
 s_waitcnt lgkmcnt(4)
 v_mfma_f32_32x32x16_bf16 v[96:111], v[56:59], v[184:187], v[96:111]
 ds_read_b64_tr_b16 v[44:45], v13 offset:50176
 ds_read_b64_tr_b16 v[46:47], v13 offset:51456
 s_waitcnt lgkmcnt(4)
 v_mfma_f32_32x32x16_bf16 v[112:127], v[60:63], v[184:187], v[112:127]
 ds_read_b64_tr_b16 v[48:49], v13 offset:50240
 ds_read_b64_tr_b16 v[50:51], v13 offset:51520
 s_waitcnt lgkmcnt(4)
 v_mfma_f32_32x32x16_bf16 v[128:143], v[40:43], v[184:187], v[128:143]
 ds_read_b64_tr_b16 v[52:53], v13 offset:50304
 ds_read_b64_tr_b16 v[54:55], v13 offset:51584
 s_waitcnt lgkmcnt(4)
 v_mfma_f32_32x32x16_bf16 v[64:79], v[44:47], v[188:191], v[64:79]
 ds_read_b64_tr_b16 v[56:57], v13 offset:50368
 ds_read_b64_tr_b16 v[58:59], v13 offset:51648
 s_waitcnt lgkmcnt(4)
 v_mfma_f32_32x32x16_bf16 v[80:95], v[48:51], v[188:191], v[80:95]
 ds_read_b64_tr_b16 v[60:61], v13 offset:50432
 ds_read_b64_tr_b16 v[62:63], v13 offset:51712
 s_waitcnt lgkmcnt(4)
 v_mfma_f32_32x32x16_bf16 v[96:111], v[52:55], v[188:191], v[96:111]
 s_waitcnt vmcnt(3)
 s_barrier
 ds_read_b128 v[176:179], v4 offset:0
 ds_read_b128 v[180:183], v5 offset:0
 ds_read_b64_tr_b16 v[40:41], v14 offset:2048
 ds_read_b64_tr_b16 v[42:43], v14 offset:3328
 s_waitcnt lgkmcnt(6)
 v_mfma_f32_32x32x16_bf16 v[112:127], v[56:59], v[188:191], v[112:127]
 ds_read_b64_tr_b16 v[44:45], v14 offset:2112
 ds_read_b64_tr_b16 v[46:47], v14 offset:3392
 s_waitcnt lgkmcnt(6)
 v_mfma_f32_32x32x16_bf16 v[128:143], v[60:63], v[188:191], v[128:143]
 ds_read_b64_tr_b16 v[48:49], v14 offset:2176
 ds_read_b64_tr_b16 v[50:51], v14 offset:3456
 s_waitcnt lgkmcnt(4)
 v_mfma_f32_32x32x16_bf16 v[64:79], v[40:43], v[176:179], v[64:79]
 ds_read_b64_tr_b16 v[52:53], v14 offset:2240
 ds_read_b64_tr_b16 v[54:55], v14 offset:3520
 s_waitcnt lgkmcnt(4)
 v_mfma_f32_32x32x16_bf16 v[80:95], v[44:47], v[176:179], v[80:95]
 ds_read_b64_tr_b16 v[56:57], v14 offset:2304
 ds_read_b64_tr_b16 v[58:59], v14 offset:3584
 s_waitcnt lgkmcnt(4)
 v_mfma_f32_32x32x16_bf16 v[96:111], v[48:51], v[176:179], v[96:111]
 ds_read_b64_tr_b16 v[60:61], v14 offset:7168
 ds_read_b64_tr_b16 v[62:63], v14 offset:8448
 s_waitcnt lgkmcnt(4)
 v_mfma_f32_32x32x16_bf16 v[112:127], v[52:55], v[176:179], v[112:127]
 ds_read_b64_tr_b16 v[40:41], v14 offset:7232
 ds_read_b64_tr_b16 v[42:43], v14 offset:8512
 s_waitcnt lgkmcnt(4)
 v_mfma_f32_32x32x16_bf16 v[128:143], v[56:59], v[176:179], v[128:143]
 ds_read_b64_tr_b16 v[44:45], v14 offset:7296
 ds_read_b64_tr_b16 v[46:47], v14 offset:8576
 s_waitcnt lgkmcnt(4)
 v_mfma_f32_32x32x16_bf16 v[64:79], v[60:63], v[180:183], v[64:79]
 ds_read_b64_tr_b16 v[48:49], v14 offset:7360
 ds_read_b64_tr_b16 v[50:51], v14 offset:8640
 s_waitcnt lgkmcnt(4)
 v_mfma_f32_32x32x16_bf16 v[80:95], v[40:43], v[180:183], v[80:95]
 ds_read_b64_tr_b16 v[52:53], v14 offset:7424
 ds_read_b64_tr_b16 v[54:55], v14 offset:8704
 s_waitcnt lgkmcnt(4)
 v_mfma_f32_32x32x16_bf16 v[96:111], v[44:47], v[180:183], v[96:111]
 s_waitcnt vmcnt(0)
 s_barrier
 ds_read_b128 v[184:187], v6 offset:0
 ds_read_b128 v[188:191], v7 offset:0
 ds_read_b64_tr_b16 v[56:57], v14 offset:24576
 ds_read_b64_tr_b16 v[58:59], v14 offset:25856
 s_waitcnt lgkmcnt(6)
 v_mfma_f32_32x32x16_bf16 v[112:127], v[48:51], v[180:183], v[112:127]
 ds_read_b64_tr_b16 v[60:61], v14 offset:24640
 ds_read_b64_tr_b16 v[62:63], v14 offset:25920
 s_waitcnt lgkmcnt(6)
 v_mfma_f32_32x32x16_bf16 v[128:143], v[52:55], v[180:183], v[128:143]
 ds_read_b64_tr_b16 v[40:41], v14 offset:24704
 ds_read_b64_tr_b16 v[42:43], v14 offset:25984
 s_waitcnt lgkmcnt(4)
 v_mfma_f32_32x32x16_bf16 v[64:79], v[56:59], v[184:187], v[64:79]
 ds_read_b64_tr_b16 v[44:45], v14 offset:24768
 ds_read_b64_tr_b16 v[46:47], v14 offset:26048
 s_waitcnt lgkmcnt(4)
 v_mfma_f32_32x32x16_bf16 v[80:95], v[60:63], v[184:187], v[80:95]
 ds_read_b64_tr_b16 v[48:49], v14 offset:24832
 ds_read_b64_tr_b16 v[50:51], v14 offset:26112
 s_waitcnt lgkmcnt(4)
 v_mfma_f32_32x32x16_bf16 v[96:111], v[40:43], v[184:187], v[96:111]
 ds_read_b64_tr_b16 v[52:53], v14 offset:29696
 ds_read_b64_tr_b16 v[54:55], v14 offset:30976
 s_waitcnt lgkmcnt(4)
 v_mfma_f32_32x32x16_bf16 v[112:127], v[44:47], v[184:187], v[112:127]
 ds_read_b64_tr_b16 v[56:57], v14 offset:29760
 ds_read_b64_tr_b16 v[58:59], v14 offset:31040
 s_waitcnt lgkmcnt(4)
 v_mfma_f32_32x32x16_bf16 v[128:143], v[48:51], v[184:187], v[128:143]
 ds_read_b64_tr_b16 v[60:61], v14 offset:29824
 ds_read_b64_tr_b16 v[62:63], v14 offset:31104
 s_waitcnt lgkmcnt(4)
 v_mfma_f32_32x32x16_bf16 v[64:79], v[52:55], v[188:191], v[64:79]
 ds_read_b64_tr_b16 v[40:41], v14 offset:29888
 ds_read_b64_tr_b16 v[42:43], v14 offset:31168
 s_waitcnt lgkmcnt(4)
 v_mfma_f32_32x32x16_bf16 v[80:95], v[56:59], v[188:191], v[80:95]
 ds_read_b64_tr_b16 v[44:45], v14 offset:29952
 ds_read_b64_tr_b16 v[46:47], v14 offset:31232
 s_waitcnt lgkmcnt(4)
 v_mfma_f32_32x32x16_bf16 v[96:111], v[60:63], v[188:191], v[96:111]
 s_waitcnt lgkmcnt(2)
 v_mfma_f32_32x32x16_bf16 v[112:127], v[40:43], v[188:191], v[112:127]
 s_waitcnt lgkmcnt(0)
 v_mfma_f32_32x32x16_bf16 v[128:143], v[44:47], v[188:191], v[128:143]
 s_waitcnt lgkmcnt(0)
 s_barrier
 v_lshlrev_b32 v176, 3, v0
 v_add_u32 v176, 0, v176
 ds_write_b64 v176, v[144:145] offset:0
 ds_write_b64 v176, v[146:147] offset:2048
 ds_write_b64 v176, v[148:149] offset:4096
 ds_write_b64 v176, v[150:151] offset:6144
 ds_write_b64 v176, v[152:153] offset:8192
 s_waitcnt lgkmcnt(0)
 v_lshrrev_b32 v176, 5, v1
 v_mul_u32_u24 v176, 88, v176
 v_add_u32 v176, v176, v31
 v_mov_b32 v178, 0x3f803f80
 v_mov_b32 v179, 0x3f803f80
 ds_write_b64 v176, v[178:179] offset:40
 ds_write_b64 v176, v[178:179] offset:88
 v_cvt_pk_bf16_f32 v104, v104, v105
 v_cvt_pk_bf16_f32 v105, v106, v107
 ds_write_b64 v31, v[104:105] offset:0
 v_cvt_pk_bf16_f32 v108, v108, v109
 v_cvt_pk_bf16_f32 v109, v110, v111
 ds_write_b64 v31, v[108:109] offset:16
 v_cvt_pk_bf16_f32 v112, v112, v113
 v_cvt_pk_bf16_f32 v113, v114, v115
 ds_write_b64 v32, v[112:113] offset:32
 v_cvt_pk_bf16_f32 v116, v116, v117
 v_cvt_pk_bf16_f32 v117, v118, v119
 ds_write_b64 v31, v[116:117] offset:56
 v_cvt_pk_bf16_f32 v120, v120, v121
 v_cvt_pk_bf16_f32 v121, v122, v123
 ds_write_b64 v31, v[120:121] offset:72
 v_cvt_pk_bf16_f32 v124, v124, v125
 v_cvt_pk_bf16_f32 v125, v126, v127
 ds_write_b64 v31, v[124:125] offset:96
 v_cvt_pk_bf16_f32 v128, v128, v129
 v_cvt_pk_bf16_f32 v129, v130, v131
 ds_write_b64 v31, v[128:129] offset:112
 v_cvt_pk_bf16_f32 v132, v132, v133
 v_cvt_pk_bf16_f32 v133, v134, v135
 ds_write_b64 v32, v[132:133] offset:128
 v_cvt_pk_bf16_f32 v136, v136, v137
 v_cvt_pk_bf16_f32 v137, v138, v139
 ds_write_b64 v31, v[136:137] offset:152
 v_cvt_pk_bf16_f32 v140, v140, v141
 v_cvt_pk_bf16_f32 v141, v142, v143
 ds_write_b64 v31, v[140:141] offset:168
 v_cvt_pk_bf16_f32 v64, v64, v65
 v_cvt_pk_bf16_f32 v65, v66, v67
 v_cvt_pk_bf16_f32 v66, v68, v69
 v_cvt_pk_bf16_f32 v67, v70, v71
 v_cvt_pk_bf16_f32 v72, v72, v73
 v_cvt_pk_bf16_f32 v73, v74, v75
 v_cvt_pk_bf16_f32 v74, v76, v77
 v_cvt_pk_bf16_f32 v75, v78, v79
 v_cvt_pk_bf16_f32 v80, v80, v81
 v_cvt_pk_bf16_f32 v81, v82, v83
 v_cvt_pk_bf16_f32 v82, v84, v85
 v_cvt_pk_bf16_f32 v83, v86, v87
 v_cvt_pk_bf16_f32 v88, v88, v89
 v_cvt_pk_bf16_f32 v89, v90, v91
 v_cvt_pk_bf16_f32 v90, v92, v93
 v_cvt_pk_bf16_f32 v91, v94, v95
 v_cvt_pk_bf16_f32 v96, v96, v97
 v_cvt_pk_bf16_f32 v97, v98, v99
 v_cvt_pk_bf16_f32 v98, v100, v101
 v_cvt_pk_bf16_f32 v99, v102, v103
 s_barrier
 ds_read_b64_tr_b16 v[232:233], v27 offset:0
 ds_read_b64_tr_b16 v[234:235], v27 offset:512
 ds_read_b64_tr_b16 v[236:237], v27 offset:1024
 ds_read_b64_tr_b16 v[238:239], v27 offset:1536
 ds_read_b64_tr_b16 v[240:241], v27 offset:2048
 ds_read_b64_tr_b16 v[242:243], v27 offset:2560
 s_waitcnt lgkmcnt(4)
 v_mfma_f32_32x32x16_bf16 v[144:159], v[232:235], v[64:67], 0
 ds_read_b64_tr_b16 v[232:233], v27 offset:3072
 ds_read_b64_tr_b16 v[234:235], v27 offset:3584
 s_waitcnt lgkmcnt(4)
 v_mfma_f32_32x32x16_bf16 v[144:159], v[236:239], v[72:75], v[144:159]
 ds_read_b64_tr_b16 v[236:237], v27 offset:4096
 ds_read_b64_tr_b16 v[238:239], v27 offset:4608
 s_waitcnt lgkmcnt(4)
 v_mfma_f32_32x32x16_bf16 v[144:159], v[240:243], v[80:83], v[144:159]
 ds_read_b64_tr_b16 v[240:241], v27 offset:5120
 ds_read_b64_tr_b16 v[242:243], v27 offset:5632
 s_waitcnt lgkmcnt(4)
 v_mfma_f32_32x32x16_bf16 v[160:175], v[232:235], v[72:75], 0
 ds_read_b64_tr_b16 v[232:233], v27 offset:6144
 ds_read_b64_tr_b16 v[234:235], v27 offset:6656
 s_waitcnt lgkmcnt(4)
 v_mfma_f32_32x32x16_bf16 v[160:175], v[236:239], v[80:83], v[160:175]
 s_nop 3
 v_cvt_pk_bf16_f32 v144, v144, v145
 v_cvt_pk_bf16_f32 v145, v146, v147
 v_cvt_pk_bf16_f32 v148, v148, v149
 v_cvt_pk_bf16_f32 v149, v150, v151
 v_cvt_pk_bf16_f32 v152, v152, v153
 v_cvt_pk_bf16_f32 v153, v154, v155
 v_cvt_pk_bf16_f32 v156, v156, v157
 v_cvt_pk_bf16_f32 v157, v158, v159
 ds_write_b64 v28, v[144:145] offset:0
 ds_write_b64 v28, v[148:149] offset:16
 ds_write_b64 v28, v[152:153] offset:32
 ds_write_b64 v28, v[156:157] offset:48
 ds_read_b64_tr_b16 v[236:237], v27 offset:7168
 ds_read_b64_tr_b16 v[238:239], v27 offset:7680
 s_waitcnt lgkmcnt(8)
 v_mfma_f32_32x32x16_bf16 v[160:175], v[240:243], v[88:91], v[160:175]
 ds_read_b64_tr_b16 v[240:241], v27 offset:8192
 ds_read_b64_tr_b16 v[242:243], v27 offset:8704
 s_waitcnt lgkmcnt(8)
 v_mfma_f32_32x32x16_bf16 v[160:175], v[232:235], v[96:99], v[160:175]
 s_waitcnt lgkmcnt(2)
 v_mfma_f32_32x32x16_bf16 v[144:159], v[236:239], v[88:91], 0
 s_waitcnt lgkmcnt(0)
 v_mfma_f32_32x32x16_bf16 v[144:159], v[240:243], v[96:99], v[144:159]
 s_nop 7
 v_cvt_pk_bf16_f32 v160, v160, v161
 v_cvt_pk_bf16_f32 v161, v162, v163
 v_cvt_pk_bf16_f32 v164, v164, v165
 v_cvt_pk_bf16_f32 v165, v166, v167
 v_cvt_pk_bf16_f32 v168, v168, v169
 v_cvt_pk_bf16_f32 v169, v170, v171
 v_cvt_pk_bf16_f32 v172, v172, v173
 v_cvt_pk_bf16_f32 v173, v174, v175
 ds_write_b64 v28, v[160:161] offset:64
 ds_write_b64 v28, v[164:165] offset:80
 ds_write_b64 v28, v[168:169] offset:96
 ds_write_b64 v28, v[172:173] offset:112
 v_cvt_pk_bf16_f32 v144, v144, v145
 v_cvt_pk_bf16_f32 v145, v146, v147
 v_cvt_pk_bf16_f32 v148, v148, v149
 v_cvt_pk_bf16_f32 v149, v150, v151
 ds_write_b64 v28, v[144:145] offset:128
 ds_write_b64 v28, v[148:149] offset:144
 s_waitcnt lgkmcnt(0)
 ds_read_b64 v[176:177], v29 offset:0
 ds_read_b64 v[178:179], v29 offset:8
 ds_read_b64 v[180:181], v29 offset:16
 ds_read_b64 v[182:183], v29 offset:24
 ds_read_b64 v[184:185], v29 offset:32
 s_waitcnt lgkmcnt(0)
 v_lshlrev_b32 v186, 16, v176
 v_and_b32 v187, 0xffff0000, v176
 v_lshlrev_b32 v188, 16, v177
 v_and_b32 v189, 0xffff0000, v177
 v_lshlrev_b32 v190, 16, v178
 v_and_b32 v191, 0xffff0000, v178
 v_lshlrev_b32 v192, 16, v179
 v_and_b32 v193, 0xffff0000, v179
 v_lshlrev_b32 v194, 16, v180
 v_and_b32 v195, 0xffff0000, v180
 v_lshlrev_b32 v196, 16, v181
 v_and_b32 v197, 0xffff0000, v181
 v_lshlrev_b32 v198, 16, v182
 v_and_b32 v199, 0xffff0000, v182
 v_lshlrev_b32 v200, 16, v183
 v_and_b32 v201, 0xffff0000, v183
 v_lshlrev_b32 v202, 16, v184
 v_and_b32 v203, 0xffff0000, v184
 v_lshlrev_b32 v204, 16, v185
 v_and_b32 v205, 0xffff0000, v185
 ds_read_b64 v[176:177], v29 offset:5376
 ds_read_b64 v[178:179], v29 offset:5384
 ds_read_b64 v[180:181], v29 offset:5392
 ds_read_b64 v[182:183], v29 offset:5400
 ds_read_b64 v[184:185], v29 offset:5408
 v_max3_f32 v226, v186, v187, v188
 v_min3_f32 v227, v186, v187, v188
 v_max3_f32 v228, v189, v190, v191
 v_min3_f32 v229, v189, v190, v191
 v_max3_f32 v226, v226, v192, v193
 v_min3_f32 v227, v227, v192, v193
 v_max3_f32 v228, v228, v194, v195
 v_min3_f32 v229, v229, v194, v195
 v_max3_f32 v226, v226, v196, v197
 v_min3_f32 v227, v227, v196, v197
 v_max3_f32 v228, v228, v198, v199
 v_min3_f32 v229, v229, v198, v199
 v_max3_f32 v226, v226, v200, v201
 v_min3_f32 v227, v227, v200, v201
 v_max3_f32 v228, v228, v202, v203
 v_min3_f32 v229, v229, v202, v203
 v_max3_f32 v226, v226, v204, v205
 v_min3_f32 v227, v227, v204, v205
 v_max_f32 v226, v226, v228
 v_min_f32 v227, v227, v229
 v_mul_f32 v226, s72, v226
 v_mul_f32 v227, s72, v227
 v_fma_f32 v206, -v186, s72, v227
 v_fma_f32 v186, v186, s72, -v226
 v_fma_f32 v207, -v187, s72, v227
 v_fma_f32 v187, v187, s72, -v226
 v_exp_f32 v206, v206
 v_exp_f32 v186, v186
 v_exp_f32 v207, v207
 v_exp_f32 v187, v187
 v_fma_f32 v208, -v188, s72, v227
 v_fma_f32 v188, v188, s72, -v226
 v_fma_f32 v209, -v189, s72, v227
 v_fma_f32 v189, v189, s72, -v226
 v_exp_f32 v208, v208
 v_exp_f32 v188, v188
 v_exp_f32 v209, v209
 v_exp_f32 v189, v189
 v_fma_f32 v210, -v190, s72, v227
 v_fma_f32 v190, v190, s72, -v226
 v_fma_f32 v211, -v191, s72, v227
 v_fma_f32 v191, v191, s72, -v226
 v_exp_f32 v210, v210
 v_exp_f32 v190, v190
 v_exp_f32 v211, v211
 v_exp_f32 v191, v191
 v_fma_f32 v212, -v192, s72, v227
 v_fma_f32 v192, v192, s72, -v226
 v_fma_f32 v213, -v193, s72, v227
 v_fma_f32 v193, v193, s72, -v226
 v_exp_f32 v212, v212
 v_exp_f32 v192, v192
 v_exp_f32 v213, v213
 v_exp_f32 v193, v193
 v_fma_f32 v214, -v194, s72, v227
 v_fma_f32 v194, v194, s72, -v226
 v_fma_f32 v215, -v195, s72, v227
 v_fma_f32 v195, v195, s72, -v226
 v_exp_f32 v214, v214
 v_exp_f32 v194, v194
 v_exp_f32 v215, v215
 v_exp_f32 v195, v195
 v_fma_f32 v216, -v196, s72, v227
 v_fma_f32 v196, v196, s72, -v226
 v_fma_f32 v217, -v197, s72, v227
 v_fma_f32 v197, v197, s72, -v226
 v_exp_f32 v216, v216
 v_exp_f32 v196, v196
 v_exp_f32 v217, v217
 v_exp_f32 v197, v197
 v_fma_f32 v218, -v198, s72, v227
 v_fma_f32 v198, v198, s72, -v226
 v_fma_f32 v219, -v199, s72, v227
 v_fma_f32 v199, v199, s72, -v226
 v_exp_f32 v218, v218
 v_exp_f32 v198, v198
 v_exp_f32 v219, v219
 v_exp_f32 v199, v199
 v_fma_f32 v220, -v200, s72, v227
 v_fma_f32 v200, v200, s72, -v226
 v_fma_f32 v221, -v201, s72, v227
 v_fma_f32 v201, v201, s72, -v226
 v_exp_f32 v220, v220
 v_exp_f32 v200, v200
 v_exp_f32 v221, v221
 v_exp_f32 v201, v201
 v_fma_f32 v222, -v202, s72, v227
 v_fma_f32 v202, v202, s72, -v226
 v_fma_f32 v223, -v203, s72, v227
 v_fma_f32 v203, v203, s72, -v226
 v_exp_f32 v222, v222
 v_exp_f32 v202, v202
 v_exp_f32 v223, v223
 v_exp_f32 v203, v203
 v_fma_f32 v224, -v204, s72, v227
 v_fma_f32 v204, v204, s72, -v226
 v_fma_f32 v225, -v205, s72, v227
 v_fma_f32 v205, v205, s72, -v226
 v_exp_f32 v224, v224
 v_exp_f32 v204, v204
 v_exp_f32 v225, v225
 v_exp_f32 v205, v205
 v_add_f32 v226, v186, v187
 v_add_f32 v227, v206, v207
 v_add_f32 v228, v188, v189
 v_add_f32 v229, v208, v209
 v_add_f32 v226, v226, v190
 v_add_f32 v227, v227, v210
 v_add_f32 v228, v228, v191
 v_add_f32 v229, v229, v211
 v_add_f32 v226, v226, v192
 v_add_f32 v227, v227, v212
 v_add_f32 v228, v228, v193
 v_add_f32 v229, v229, v213
 v_add_f32 v226, v226, v194
 v_add_f32 v227, v227, v214
 v_add_f32 v228, v228, v195
 v_add_f32 v229, v229, v215
 v_add_f32 v226, v226, v196
 v_add_f32 v227, v227, v216
 v_add_f32 v228, v228, v197
 v_add_f32 v229, v229, v217
 v_add_f32 v226, v226, v198
 v_add_f32 v227, v227, v218
 v_add_f32 v228, v228, v199
 v_add_f32 v229, v229, v219
 v_add_f32 v226, v226, v200
 v_add_f32 v227, v227, v220
 v_add_f32 v228, v228, v201
 v_add_f32 v229, v229, v221
 v_add_f32 v226, v226, v202
 v_add_f32 v227, v227, v222
 v_add_f32 v228, v228, v203
 v_add_f32 v229, v229, v223
 v_add_f32 v226, v226, v204
 v_add_f32 v227, v227, v224
 v_add_f32 v228, v228, v205
 v_add_f32 v229, v229, v225
 v_add_f32 v226, v226, v228
 v_add_f32 v227, v227, v229
 v_rcp_f32 v226, v226
 v_rcp_f32 v227, v227
 v_mul_f32 v186, v186, v226
 v_mul_f32 v187, v187, v226
 v_mul_f32 v206, v206, v227
 v_mul_f32 v207, v207, v227
 v_cvt_pk_bf16_f32 v232, v186, v187
 v_cvt_pk_bf16_f32 v242, v206, v207
 v_mul_f32 v188, v188, v226
 v_mul_f32 v189, v189, v226
 v_mul_f32 v208, v208, v227
 v_mul_f32 v209, v209, v227
 v_cvt_pk_bf16_f32 v233, v188, v189
 v_cvt_pk_bf16_f32 v243, v208, v209
 v_mul_f32 v190, v190, v226
 v_mul_f32 v191, v191, v226
 v_mul_f32 v210, v210, v227
 v_mul_f32 v211, v211, v227
 v_cvt_pk_bf16_f32 v234, v190, v191
 v_cvt_pk_bf16_f32 v244, v210, v211
 v_mul_f32 v192, v192, v226
 v_mul_f32 v193, v193, v226
 v_mul_f32 v212, v212, v227
 v_mul_f32 v213, v213, v227
 v_cvt_pk_bf16_f32 v235, v192, v193
 v_cvt_pk_bf16_f32 v245, v212, v213
 v_mul_f32 v194, v194, v226
 v_mul_f32 v195, v195, v226
 v_mul_f32 v214, v214, v227
 v_mul_f32 v215, v215, v227
 v_cvt_pk_bf16_f32 v236, v194, v195
 v_cvt_pk_bf16_f32 v246, v214, v215
 v_mul_f32 v196, v196, v226
 v_mul_f32 v197, v197, v226
 v_mul_f32 v216, v216, v227
 v_mul_f32 v217, v217, v227
 v_cvt_pk_bf16_f32 v237, v196, v197
 v_cvt_pk_bf16_f32 v247, v216, v217
 v_mul_f32 v198, v198, v226
 v_mul_f32 v199, v199, v226
 v_mul_f32 v218, v218, v227
 v_mul_f32 v219, v219, v227
 v_cvt_pk_bf16_f32 v238, v198, v199
 v_cvt_pk_bf16_f32 v248, v218, v219
 v_mul_f32 v200, v200, v226
 v_mul_f32 v201, v201, v226
 v_mul_f32 v220, v220, v227
 v_mul_f32 v221, v221, v227
 v_cvt_pk_bf16_f32 v239, v200, v201
 v_cvt_pk_bf16_f32 v249, v220, v221
 v_mul_f32 v202, v202, v226
 v_mul_f32 v203, v203, v226
 v_mul_f32 v222, v222, v227
 v_mul_f32 v223, v223, v227
 v_cvt_pk_bf16_f32 v240, v202, v203
 v_cvt_pk_bf16_f32 v250, v222, v223
 v_mul_f32 v204, v204, v226
 v_mul_f32 v205, v205, v226
 v_mul_f32 v224, v224, v227
 v_mul_f32 v225, v225, v227
 v_cvt_pk_bf16_f32 v241, v204, v205
 v_cvt_pk_bf16_f32 v251, v224, v225
 ds_write_b128 v30, v[232:235] offset:0
 ds_write_b128 v30, v[236:239] offset:16
 ds_write_b128 v30, v[240:243] offset:32
 ds_write_b128 v30, v[244:247] offset:48
 ds_write_b128 v30, v[248:251] offset:64
 s_waitcnt lgkmcnt(5)
 v_lshlrev_b32 v186, 16, v176
 v_and_b32 v187, 0xffff0000, v176
 v_lshlrev_b32 v188, 16, v177
 v_and_b32 v189, 0xffff0000, v177
 v_lshlrev_b32 v190, 16, v178
 v_and_b32 v191, 0xffff0000, v178
 v_lshlrev_b32 v192, 16, v179
 v_and_b32 v193, 0xffff0000, v179
 v_lshlrev_b32 v194, 16, v180
 v_and_b32 v195, 0xffff0000, v180
 v_lshlrev_b32 v196, 16, v181
 v_and_b32 v197, 0xffff0000, v181
 v_lshlrev_b32 v198, 16, v182
 v_and_b32 v199, 0xffff0000, v182
 v_lshlrev_b32 v200, 16, v183
 v_and_b32 v201, 0xffff0000, v183
 v_lshlrev_b32 v202, 16, v184
 v_and_b32 v203, 0xffff0000, v184
 v_lshlrev_b32 v204, 16, v185
 v_and_b32 v205, 0xffff0000, v185
 v_max3_f32 v226, v186, v187, v188
 v_min3_f32 v227, v186, v187, v188
 v_max3_f32 v228, v189, v190, v191
 v_min3_f32 v229, v189, v190, v191
 v_max3_f32 v226, v226, v192, v193
 v_min3_f32 v227, v227, v192, v193
 v_max3_f32 v228, v228, v194, v195
 v_min3_f32 v229, v229, v194, v195
 v_max3_f32 v226, v226, v196, v197
 v_min3_f32 v227, v227, v196, v197
 v_max3_f32 v228, v228, v198, v199
 v_min3_f32 v229, v229, v198, v199
 v_max3_f32 v226, v226, v200, v201
 v_min3_f32 v227, v227, v200, v201
 v_max3_f32 v228, v228, v202, v203
 v_min3_f32 v229, v229, v202, v203
 v_max3_f32 v226, v226, v204, v205
 v_min3_f32 v227, v227, v204, v205
 v_max_f32 v226, v226, v228
 v_min_f32 v227, v227, v229
 v_mul_f32 v226, s72, v226
 v_mul_f32 v227, s72, v227
 v_fma_f32 v206, -v186, s72, v227
 v_fma_f32 v186, v186, s72, -v226
 v_fma_f32 v207, -v187, s72, v227
 v_fma_f32 v187, v187, s72, -v226
 v_exp_f32 v206, v206
 v_exp_f32 v186, v186
 v_exp_f32 v207, v207
 v_exp_f32 v187, v187
 v_fma_f32 v208, -v188, s72, v227
 v_fma_f32 v188, v188, s72, -v226
 v_fma_f32 v209, -v189, s72, v227
 v_fma_f32 v189, v189, s72, -v226
 v_exp_f32 v208, v208
 v_exp_f32 v188, v188
 v_exp_f32 v209, v209
 v_exp_f32 v189, v189
 v_fma_f32 v210, -v190, s72, v227
 v_fma_f32 v190, v190, s72, -v226
 v_fma_f32 v211, -v191, s72, v227
 v_fma_f32 v191, v191, s72, -v226
 v_exp_f32 v210, v210
 v_exp_f32 v190, v190
 v_exp_f32 v211, v211
 v_exp_f32 v191, v191
 v_fma_f32 v212, -v192, s72, v227
 v_fma_f32 v192, v192, s72, -v226
 v_fma_f32 v213, -v193, s72, v227
 v_fma_f32 v193, v193, s72, -v226
 v_exp_f32 v212, v212
 v_exp_f32 v192, v192
 v_exp_f32 v213, v213
 v_exp_f32 v193, v193
 v_fma_f32 v214, -v194, s72, v227
 v_fma_f32 v194, v194, s72, -v226
 v_fma_f32 v215, -v195, s72, v227
 v_fma_f32 v195, v195, s72, -v226
 v_exp_f32 v214, v214
 v_exp_f32 v194, v194
 v_exp_f32 v215, v215
 v_exp_f32 v195, v195
 v_fma_f32 v216, -v196, s72, v227
 v_fma_f32 v196, v196, s72, -v226
 v_fma_f32 v217, -v197, s72, v227
 v_fma_f32 v197, v197, s72, -v226
 v_exp_f32 v216, v216
 v_exp_f32 v196, v196
 v_exp_f32 v217, v217
 v_exp_f32 v197, v197
 v_fma_f32 v218, -v198, s72, v227
 v_fma_f32 v198, v198, s72, -v226
 v_fma_f32 v219, -v199, s72, v227
 v_fma_f32 v199, v199, s72, -v226
 v_exp_f32 v218, v218
 v_exp_f32 v198, v198
 v_exp_f32 v219, v219
 v_exp_f32 v199, v199
 v_fma_f32 v220, -v200, s72, v227
 v_fma_f32 v200, v200, s72, -v226
 v_fma_f32 v221, -v201, s72, v227
 v_fma_f32 v201, v201, s72, -v226
 v_exp_f32 v220, v220
 v_exp_f32 v200, v200
 v_exp_f32 v221, v221
 v_exp_f32 v201, v201
 v_fma_f32 v222, -v202, s72, v227
 v_fma_f32 v202, v202, s72, -v226
 v_fma_f32 v223, -v203, s72, v227
 v_fma_f32 v203, v203, s72, -v226
 v_exp_f32 v222, v222
 v_exp_f32 v202, v202
 v_exp_f32 v223, v223
 v_exp_f32 v203, v203
 v_fma_f32 v224, -v204, s72, v227
 v_fma_f32 v204, v204, s72, -v226
 v_fma_f32 v225, -v205, s72, v227
 v_fma_f32 v205, v205, s72, -v226
 v_exp_f32 v224, v224
 v_exp_f32 v204, v204
 v_exp_f32 v225, v225
 v_exp_f32 v205, v205
 v_add_f32 v226, v186, v187
 v_add_f32 v227, v206, v207
 v_add_f32 v228, v188, v189
 v_add_f32 v229, v208, v209
 v_add_f32 v226, v226, v190
 v_add_f32 v227, v227, v210
 v_add_f32 v228, v228, v191
 v_add_f32 v229, v229, v211
 v_add_f32 v226, v226, v192
 v_add_f32 v227, v227, v212
 v_add_f32 v228, v228, v193
 v_add_f32 v229, v229, v213
 v_add_f32 v226, v226, v194
 v_add_f32 v227, v227, v214
 v_add_f32 v228, v228, v195
 v_add_f32 v229, v229, v215
 v_add_f32 v226, v226, v196
 v_add_f32 v227, v227, v216
 v_add_f32 v228, v228, v197
 v_add_f32 v229, v229, v217
 v_add_f32 v226, v226, v198
 v_add_f32 v227, v227, v218
 v_add_f32 v228, v228, v199
 v_add_f32 v229, v229, v219
 v_add_f32 v226, v226, v200
 v_add_f32 v227, v227, v220
 v_add_f32 v228, v228, v201
 v_add_f32 v229, v229, v221
 v_add_f32 v226, v226, v202
 v_add_f32 v227, v227, v222
 v_add_f32 v228, v228, v203
 v_add_f32 v229, v229, v223
 v_add_f32 v226, v226, v204
 v_add_f32 v227, v227, v224
 v_add_f32 v228, v228, v205
 v_add_f32 v229, v229, v225
 v_add_f32 v226, v226, v228
 v_add_f32 v227, v227, v229
 v_rcp_f32 v226, v226
 v_rcp_f32 v227, v227
 v_mul_f32 v186, v186, v226
 v_mul_f32 v187, v187, v226
 v_mul_f32 v206, v206, v227
 v_mul_f32 v207, v207, v227
 v_cvt_pk_bf16_f32 v232, v186, v187
 v_cvt_pk_bf16_f32 v242, v206, v207
 v_mul_f32 v188, v188, v226
 v_mul_f32 v189, v189, v226
 v_mul_f32 v208, v208, v227
 v_mul_f32 v209, v209, v227
 v_cvt_pk_bf16_f32 v233, v188, v189
 v_cvt_pk_bf16_f32 v243, v208, v209
 v_mul_f32 v190, v190, v226
 v_mul_f32 v191, v191, v226
 v_mul_f32 v210, v210, v227
 v_mul_f32 v211, v211, v227
 v_cvt_pk_bf16_f32 v234, v190, v191
 v_cvt_pk_bf16_f32 v244, v210, v211
 v_mul_f32 v192, v192, v226
 v_mul_f32 v193, v193, v226
 v_mul_f32 v212, v212, v227
 v_mul_f32 v213, v213, v227
 v_cvt_pk_bf16_f32 v235, v192, v193
 v_cvt_pk_bf16_f32 v245, v212, v213
 v_mul_f32 v194, v194, v226
 v_mul_f32 v195, v195, v226
 v_mul_f32 v214, v214, v227
 v_mul_f32 v215, v215, v227
 v_cvt_pk_bf16_f32 v236, v194, v195
 v_cvt_pk_bf16_f32 v246, v214, v215
 v_mul_f32 v196, v196, v226
 v_mul_f32 v197, v197, v226
 v_mul_f32 v216, v216, v227
 v_mul_f32 v217, v217, v227
 v_cvt_pk_bf16_f32 v237, v196, v197
 v_cvt_pk_bf16_f32 v247, v216, v217
 v_mul_f32 v198, v198, v226
 v_mul_f32 v199, v199, v226
 v_mul_f32 v218, v218, v227
 v_mul_f32 v219, v219, v227
 v_cvt_pk_bf16_f32 v238, v198, v199
 v_cvt_pk_bf16_f32 v248, v218, v219
 v_mul_f32 v200, v200, v226
 v_mul_f32 v201, v201, v226
 v_mul_f32 v220, v220, v227
 v_mul_f32 v221, v221, v227
 v_cvt_pk_bf16_f32 v239, v200, v201
 v_cvt_pk_bf16_f32 v249, v220, v221
 v_mul_f32 v202, v202, v226
 v_mul_f32 v203, v203, v226
 v_mul_f32 v222, v222, v227
 v_mul_f32 v223, v223, v227
 v_cvt_pk_bf16_f32 v240, v202, v203
 v_cvt_pk_bf16_f32 v250, v222, v223
 v_mul_f32 v204, v204, v226
 v_mul_f32 v205, v205, v226
 v_mul_f32 v224, v224, v227
 v_mul_f32 v225, v225, v227
 v_cvt_pk_bf16_f32 v241, v204, v205
 v_cvt_pk_bf16_f32 v251, v224, v225
 ds_write_b128 v30, v[232:235] offset:5376
 ds_write_b128 v30, v[236:239] offset:5392
 ds_write_b128 v30, v[240:243] offset:5408
 ds_write_b128 v30, v[244:247] offset:5424
 ds_write_b128 v30, v[248:251] offset:5440
 s_waitcnt lgkmcnt(0)
 s_add_u32 s38, s32, s20
 s_mul_i32 s73, s38, 3840
 s_add_u32 s73, s73, 18874368
 s_mul_i32 s38, s20, 3360
 s_add_u32 s38, s38, 89088
 v_and_b32 v144, 15, v1
 v_lshrrev_b32 v145, 4, v1
 v_mul_u32_u24 v146, 160, v144
 v_lshl_add_u32 v146, v145, 4, v146
 v_add_u32 v8, s38, v146
 v_lshlrev_b32 v10, 2, v1
 v_add_u32 v9, s38, v10
 v_mov_b32 v146, 0x80000000
 v_cmp_gt_u32 s[60:61], 8, v1
 v_cmp_gt_u32 s[62:63], 2, v145
 v_cmp_gt_u32 s[90:91], 5, v144
 v_cndmask_b32 v11, v146, v10, s[60:61]
 s_and_b64 s[88:89], s[62:63], s[90:91]
 s_lshl_b32 s38, s22, 2
 v_mov_b32 v144, 0
 buffer_load_dword v145, v144, s[92:95], s38 offen sc1
 s_barrier
 ds_read_b64_tr_b16 v[176:177], v33 offset:0
 ds_read_b64_tr_b16 v[178:179], v33 offset:1344
 ds_read_b64_tr_b16 v[180:181], v33 offset:32
 ds_read_b64_tr_b16 v[182:183], v33 offset:1376
 ds_read_b64_tr_b16 v[184:185], v33 offset:64
 ds_read_b64_tr_b16 v[186:187], v33 offset:1408
 ds_read_b64_tr_b16 v[188:189], v34 offset:0
 ds_read_b64_tr_b16 v[190:191], v34 offset:800
 ds_read_b64_tr_b16 v[192:193], v34 offset:32
 ds_read_b64_tr_b16 v[194:195], v34 offset:832
 ds_read_b64_tr_b16 v[196:197], v33 offset:10752
 ds_read_b64_tr_b16 v[198:199], v33 offset:12096
 ds_read_b64_tr_b16 v[200:201], v33 offset:10784
 ds_read_b64_tr_b16 v[202:203], v33 offset:12128
 ds_read_b64_tr_b16 v[204:205], v33 offset:10816
 ds_read_b64_tr_b16 v[206:207], v33 offset:12160
 ds_read_b64_tr_b16 v[208:209], v34 offset:6400
 ds_read_b64_tr_b16 v[210:211], v34 offset:7200
 ds_read_b64_tr_b16 v[212:213], v34 offset:6432
 ds_read_b64_tr_b16 v[214:215], v34 offset:7232
 s_waitcnt lgkmcnt(10)
 v_mfma_f32_16x16x32_bf16 v[64:67], v[176:179], v[188:191], 0
 v_mfma_f32_16x16x32_bf16 v[68:71], v[176:179], v[192:195], 0
 v_mfma_f32_16x16x32_bf16 v[72:75], v[180:183], v[188:191], 0
 v_mfma_f32_16x16x32_bf16 v[76:79], v[180:183], v[192:195], 0
 v_mfma_f32_16x16x32_bf16 v[80:83], v[184:187], v[188:191], 0
 v_mfma_f32_16x16x32_bf16 v[84:87], v[184:187], v[192:195], 0
 ds_read_b64_tr_b16 v[176:177], v33 offset:21504
 ds_read_b64_tr_b16 v[178:179], v33 offset:22848
 ds_read_b64_tr_b16 v[180:181], v33 offset:21536
 ds_read_b64_tr_b16 v[182:183], v33 offset:22880
 ds_read_b64_tr_b16 v[184:185], v33 offset:21568
 ds_read_b64_tr_b16 v[186:187], v33 offset:22912
 ds_read_b64_tr_b16 v[188:189], v34 offset:12800
 ds_read_b64_tr_b16 v[190:191], v34 offset:13600
 ds_read_b64_tr_b16 v[192:193], v34 offset:12832
 ds_read_b64_tr_b16 v[194:195], v34 offset:13632
 s_waitcnt lgkmcnt(10)
 v_mfma_f32_16x16x32_bf16 v[64:67], v[196:199], v[208:211], v[64:67]
 v_mfma_f32_16x16x32_bf16 v[68:71], v[196:199], v[212:215], v[68:71]
 v_mfma_f32_16x16x32_bf16 v[72:75], v[200:203], v[208:211], v[72:75]
 v_mfma_f32_16x16x32_bf16 v[76:79], v[200:203], v[212:215], v[76:79]
 v_mfma_f32_16x16x32_bf16 v[80:83], v[204:207], v[208:211], v[80:83]
 v_mfma_f32_16x16x32_bf16 v[84:87], v[204:207], v[212:215], v[84:87]
 ds_read_b64_tr_b16 v[196:197], v33 offset:32256
 ds_read_b64_tr_b16 v[198:199], v33 offset:33600
 ds_read_b64_tr_b16 v[200:201], v33 offset:32288
 ds_read_b64_tr_b16 v[202:203], v33 offset:33632
 ds_read_b64_tr_b16 v[204:205], v33 offset:32320
 ds_read_b64_tr_b16 v[206:207], v33 offset:33664
 ds_read_b64_tr_b16 v[208:209], v34 offset:19200
 ds_read_b64_tr_b16 v[210:211], v34 offset:20000
 ds_read_b64_tr_b16 v[212:213], v34 offset:19232
 ds_read_b64_tr_b16 v[214:215], v34 offset:20032
 s_waitcnt lgkmcnt(10)
 v_mfma_f32_16x16x32_bf16 v[64:67], v[176:179], v[188:191], v[64:67]
 v_mfma_f32_16x16x32_bf16 v[68:71], v[176:179], v[192:195], v[68:71]
 v_mfma_f32_16x16x32_bf16 v[72:75], v[180:183], v[188:191], v[72:75]
 v_mfma_f32_16x16x32_bf16 v[76:79], v[180:183], v[192:195], v[76:79]
 v_mfma_f32_16x16x32_bf16 v[80:83], v[184:187], v[188:191], v[80:83]
 v_mfma_f32_16x16x32_bf16 v[84:87], v[184:187], v[192:195], v[84:87]
 s_waitcnt lgkmcnt(0)
 v_mfma_f32_16x16x32_bf16 v[64:67], v[196:199], v[208:211], v[64:67]
 v_mfma_f32_16x16x32_bf16 v[68:71], v[196:199], v[212:215], v[68:71]
 v_mfma_f32_16x16x32_bf16 v[72:75], v[200:203], v[208:211], v[72:75]
 v_mfma_f32_16x16x32_bf16 v[76:79], v[200:203], v[212:215], v[76:79]
 v_mfma_f32_16x16x32_bf16 v[80:83], v[204:207], v[208:211], v[80:83]
 v_mfma_f32_16x16x32_bf16 v[84:87], v[204:207], v[212:215], v[84:87]
 s_nop 2
 ds_write_b128 v8, v[64:67] offset:0
 s_mov_b64 exec, s[90:91]
 ds_write_b128 v8, v[68:71] offset:2560
 s_mov_b64 exec, -1
 ds_write_b128 v8, v[72:75] offset:64
 s_mov_b64 exec, s[90:91]
 ds_write_b128 v8, v[76:79] offset:2624
 s_mov_b64 exec, -1
 s_mov_b64 exec, s[62:63]
 ds_write_b128 v8, v[80:83] offset:128
 s_mov_b64 exec, -1
 s_mov_b64 exec, s[88:89]
 ds_write_b128 v8, v[84:87] offset:2688
 s_mov_b64 exec, -1
 s_waitcnt lgkmcnt(0)
 ds_read_b32 v176, v9 offset:0
 ds_read_b32 v177, v9 offset:256
 ds_read_b32 v178, v9 offset:512
 ds_read_b32 v179, v9 offset:768
 ds_read_b32 v180, v9 offset:1024
 ds_read_b32 v181, v9 offset:1280
 ds_read_b32 v182, v9 offset:1536
 ds_read_b32 v183, v9 offset:1792
 ds_read_b32 v184, v9 offset:2048
 ds_read_b32 v185, v9 offset:2304
 ds_read_b32 v186, v9 offset:2560
 ds_read_b32 v187, v9 offset:2816
 ds_read_b32 v188, v9 offset:3072
 ds_read_b32 v189, v9 offset:3328
 s_waitcnt vmcnt(0)
 v_readfirstlane_b32 s74, v145
 s_nop 0
 s_cmp_ge_u32 s74, 16
 s_cbranch_scc1 L3_kv_go
L3_kv_poll:
 s_sleep 8
 buffer_load_dword v145, v144, s[92:95], s38 offen sc1
 s_waitcnt vmcnt(0)
 v_readfirstlane_b32 s74, v145
 s_nop 0
 s_cmp_lt_u32 s74, 16
 s_cbranch_scc1 L3_kv_poll
L3_kv_go:
 s_waitcnt lgkmcnt(13)
 buffer_atomic_add_f32 v176, v10, s[16:19], s73 offen offset:0
 s_waitcnt lgkmcnt(12)
 buffer_atomic_add_f32 v177, v10, s[16:19], s73 offen offset:256
 s_waitcnt lgkmcnt(11)
 buffer_atomic_add_f32 v178, v10, s[16:19], s73 offen offset:512
 s_waitcnt lgkmcnt(10)
 buffer_atomic_add_f32 v179, v10, s[16:19], s73 offen offset:768
 s_waitcnt lgkmcnt(9)
 buffer_atomic_add_f32 v180, v10, s[16:19], s73 offen offset:1024
 s_waitcnt lgkmcnt(8)
 buffer_atomic_add_f32 v181, v10, s[16:19], s73 offen offset:1280
 s_waitcnt lgkmcnt(7)
 buffer_atomic_add_f32 v182, v10, s[16:19], s73 offen offset:1536
 s_waitcnt lgkmcnt(6)
 buffer_atomic_add_f32 v183, v10, s[16:19], s73 offen offset:1792
 s_waitcnt lgkmcnt(5)
 buffer_atomic_add_f32 v184, v10, s[16:19], s73 offen offset:2048
 s_waitcnt lgkmcnt(4)
 buffer_atomic_add_f32 v185, v10, s[16:19], s73 offen offset:2304
 s_waitcnt lgkmcnt(3)
 buffer_atomic_add_f32 v186, v10, s[16:19], s73 offen offset:2560
 s_waitcnt lgkmcnt(2)
 buffer_atomic_add_f32 v187, v10, s[16:19], s73 offen offset:2816
 s_waitcnt lgkmcnt(1)
 buffer_atomic_add_f32 v188, v10, s[16:19], s73 offen offset:3072
 s_waitcnt lgkmcnt(0)
 buffer_atomic_add_f32 v189, v11, s[16:19], s73 offen offset:3328
 s_endpgm
L3_KV_h1:
 s_and_b32 s74, s35, 1024
 s_add_u32 s74, s74, 161792
 s_add_u32 m0, s36, 0
 s_movk_i32 s37, 0
 buffer_load_dwordx4 v2, s[4:7], s37 offen lds
 s_add_u32 m0, s36, 1024
 s_movk_i32 s37, 0
 buffer_load_dwordx4 v3, s[4:7], s37 offen lds
 s_add_u32 m0, s35, 0
 s_add_u32 s37, s88, 0
 buffer_load_dwordx4 v8, s[40:43], s37 offen lds
 s_add_u32 m0, s35, 10240
 s_add_u32 s37, s89, 0
 buffer_load_dwordx4 v9, s[56:59], s37 offen lds
 s_add_u32 s37, s62, 0
 s_cmp_lt_u32 s98, 6
 s_cselect_b32 m0, s37, s74
 s_nop 0
 buffer_load_dwordx4 v10, s[80:83], s90 offen lds
 s_add_u32 s90, s90, s63
 s_add_u32 m0, s35, 22528
 s_add_u32 s37, s88, 122880
 buffer_load_dwordx4 v8, s[40:43], s37 offen lds
 s_add_u32 m0, s35, 32768
 s_add_u32 s37, s89, 110592
 buffer_load_dwordx4 v9, s[56:59], s37 offen lds
 s_add_u32 s37, s62, 22528
 s_cmp_lt_u32 s98, 6
 s_cselect_b32 m0, s37, s74
 s_nop 0
 buffer_load_dwordx4 v10, s[80:83], s90 offen lds
 s_add_u32 s90, s90, s63
 s_add_u32 m0, s36, 16384
 s_movk_i32 s37, 128
 buffer_load_dwordx4 v2, s[4:7], s37 offen lds
 s_add_u32 m0, s36, 17408
 s_movk_i32 s37, 128
 buffer_load_dwordx4 v3, s[4:7], s37 offen lds
 s_add_u32 m0, s35, 45056
 s_add_u32 s37, s88, 245760
 buffer_load_dwordx4 v8, s[40:43], s37 offen lds
 s_add_u32 m0, s35, 55296
 s_add_u32 s37, s89, 221184
 buffer_load_dwordx4 v9, s[56:59], s37 offen lds
 s_add_u32 s37, s62, 45056
 s_cmp_lt_u32 s98, 6
 s_cselect_b32 m0, s37, s74
 s_nop 0
 buffer_load_dwordx4 v10, s[80:83], s90 offen lds
 s_add_u32 s90, s90, s63
 v_and_b32 v35, 31, v1
 v_lshrrev_b32 v36, 5, v1
 v_bfe_u32 v37, v1, 1, 3
 v_xor_b32 v37, v37, v36
 v_lshlrev_b32 v38, 7, v35
 s_lshl_b32 s24, s20, 12
 s_add_u32 s24, s24, 112640
 v_add_u32 v38, s24, v38
 v_xor_b32 v39, 0, v37
 v_lshl_add_u32 v4, v39, 4, v38
 v_xor_b32 v39, 2, v37
 v_lshl_add_u32 v5, v39, 4, v38
 v_xor_b32 v39, 4, v37
 v_lshl_add_u32 v6, v39, 4, v38
 v_xor_b32 v39, 6, v37
 v_lshl_add_u32 v7, v39, 4, v38
 v_bfe_u32 v35, v1, 4, 1
 v_lshrrev_b32 v36, 5, v1
 v_bfe_u32 v37, v1, 2, 2
 v_and_b32 v38, 3, v1
 v_lshlrev_b32 v39, 12, v35
 v_lshl_add_u32 v39, v36, 10, v39
 v_lshl_add_u32 v39, v37, 7, v39
 v_lshl_add_u32 v39, v38, 3, v39
 v_lshrrev_b32 v37, 1, v37
 v_lshl_or_b32 v37, v35, 1, v37
 v_xor_b32 v38, 0, v37
 v_lshl_add_u32 v17, v38, 5, v39
 v_add_u32 v21, 0x10000, v17
 v_xor_b32 v38, 1, v37
 v_lshl_add_u32 v18, v38, 5, v39
 v_add_u32 v22, 0x10000, v18
 v_xor_b32 v38, 2, v37
 v_lshl_add_u32 v19, v38, 5, v39
 v_add_u32 v23, 0x10000, v19
 v_xor_b32 v38, 3, v37
 v_lshl_add_u32 v20, v38, 5, v39
 v_add_u32 v24, 0x10000, v20
 s_lshl_b32 s24, s20, 1
 v_add_u32 v35, s24, v35
 s_mov_b32 s25, 55296
 v_mul_lo_u32 v35, v35, s25
 v_and_b32 v37, 15, v1
 v_lshl_add_u32 v37, v36, 4, v37
 v_lshl_add_u32 v25, v37, 4, v35
 s_mul_i32 s34, s21, 442368
 s_add_u32 s34, s34, 0
 s_lshl_b32 s24, s96, 11
 s_add_u32 s33, s34, s24
 s_lshl_b32 s24, s97, 9
 s_add_u32 s33, s33, s24
 s_lshl_b32 s24, s23, 11
 s_add_u32 s34, s34, s24
 v_mov_b32 v26, 0xc0135761
 v_mov_b32 v244, 0xbdd2d3e8
 v_mov_b32 v245, 0xbdd2d3e8
 v_mov_b32 v246, 0xc0135761
 v_mov_b32 v247, 0xc0135761
 v_bfe_u32 v35, v1, 4, 1
 v_bfe_u32 v37, v1, 2, 2
 v_and_b32 v38, 3, v1
 v_lshlrev_b32 v39, 11, v35
 v_lshl_add_u32 v39, v36, 9, v39
 v_lshl_add_u32 v39, v37, 6, v39
 v_lshl_add_u32 v39, v38, 3, v39
 v_lshl_add_u32 v252, v35, 5, v39
 v_xor_b32 v253, 32, v252
 v_add_u32 v254, 0x10000, v252
 v_add_u32 v255, 0x10000, v253
 s_cmp_eq_u32 s20, 0
 s_cselect_b32 s76, s8, s12
 s_cselect_b32 s77, s9, s13
 s_mov_b32 s78, 2211840
 s_mov_b32 s61, 221184
 s_mul_i32 s60, s2, 864
 s_cmp_eq_u32 s20, 2
 s_cselect_b32 s76, s64, s76
 s_cselect_b32 s77, s65, s77
 s_cselect_b32 s78, 2457600, s78
 s_cselect_b32 s61, 245760, s61
 s_mul_i32 s24, s2, 960
 s_cselect_b32 s60, s24, s60
 s_cmp_eq_u32 s20, 3
 s_cselect_b32 s76, s4, s76
 s_cselect_b32 s77, s5, s77
 s_cselect_b32 s78, 2621440, s78
 s_cselect_b32 s61, 128, s61
 s_mul_i32 s24, s2, 10240
 s_cselect_b32 s60, s24, s60
 s_mov_b32 s79, 0x00020000
 s_movk_i32 s24, 128
 s_cselect_b32 s24, 1280, s24
 v_mul_lo_u32 v35, v1, s24
 v_mov_b32 v36, 0x80000000
 v_cmp_gt_u32 vcc, 8, v1
 s_nop 1
 v_cndmask_b32 v251, v36, v35, vcc
 s_add_u32 s60, s60, s61
 buffer_load_dword v250, v251, s[76:79], s60 offen
 s_add_u32 s60, s60, s61
 buffer_load_dword v250, v251, s[76:79], s60 offen
 s_add_u32 s60, s60, s61
 s_setprio 1
 s_waitcnt vmcnt(10)
 s_barrier
 buffer_load_dword v250, v251, s[76:79], s60 offen
 s_add_u32 s60, s60, s61
 ds_read_b128 v[176:179], v4 offset:0
 ds_read_b128 v[180:183], v5 offset:0
 ds_read_b64_tr_b16 v[40:41], v17 offset:10240
 ds_read_b64_tr_b16 v[42:43], v17 offset:10752
 s_add_u32 m0, s35, 67584
 s_add_u32 s37, s88, 368640
 buffer_load_dwordx4 v8, s[40:43], s37 offen lds
 ds_read_b64_tr_b16 v[44:45], v18 offset:10240
 ds_read_b64_tr_b16 v[46:47], v18 offset:10752
 s_add_u32 m0, s35, 77824
 s_add_u32 s37, s89, 331776
 buffer_load_dwordx4 v9, s[56:59], s37 offen lds
 ds_read_b64_tr_b16 v[48:49], v19 offset:10240
 ds_read_b64_tr_b16 v[50:51], v19 offset:10752
 s_add_u32 s37, s62, 67584
 s_cmp_lt_u32 s98, 6
 s_cselect_b32 m0, s37, s74
 s_nop 0
 buffer_load_dwordx4 v10, s[80:83], s90 offen lds
 s_add_u32 s90, s90, s63
 s_waitcnt lgkmcnt(4)
 v_mfma_f32_32x32x16_bf16 v[64:79], v[40:43], v[176:179], 0
 ds_read_b64_tr_b16 v[52:53], v20 offset:10240
 ds_read_b64_tr_b16 v[54:55], v20 offset:10752
 s_mul_i32 s24, s22, 15360
 s_mul_i32 s25, s21, 960
 s_add_u32 s24, s24, s25
 s_waitcnt lgkmcnt(4)
 v_mfma_f32_32x32x16_bf16 v[80:95], v[44:47], v[176:179], 0
 ds_read_b64_tr_b16 v[56:57], v252 offset:18432
 ds_read_b64_tr_b16 v[58:59], v252 offset:18688
 s_add_u32 s24, s24, 18874368
 v_lshlrev_b32 v35, 4, v0
 v_mov_b32 v36, 0x80000000
 s_waitcnt lgkmcnt(4)
 v_mfma_f32_32x32x16_bf16 v[96:111], v[48:51], v[176:179], 0
 ds_read_b64_tr_b16 v[60:61], v253 offset:18432
 ds_read_b64_tr_b16 v[62:63], v253 offset:18688
 v_cmp_gt_u32 vcc, 60, v0
 v_mov_b32 v228, 0
 v_mov_b32 v229, 0
 s_waitcnt lgkmcnt(4)
 v_mfma_f32_32x32x16_bf16 v[112:127], v[52:55], v[176:179], 0
 ds_read_b64_tr_b16 v[40:41], v17 offset:12288
 ds_read_b64_tr_b16 v[42:43], v17 offset:12800
 v_mov_b32 v230, 0
 v_mov_b32 v231, 0
 v_cndmask_b32 v35, v36, v35, vcc
 s_waitcnt lgkmcnt(4)
 v_mfma_f32_32x32x16_bf16 v[128:143], v[56:59], v[176:179], 0
 ds_read_b64_tr_b16 v[44:45], v18 offset:12288
 ds_read_b64_tr_b16 v[46:47], v18 offset:12800
 buffer_store_dwordx4 v[228:231], v35, s[16:19], s24 offen sc1
 s_waitcnt lgkmcnt(4)
 v_mfma_f32_32x32x16_bf16 v[144:159], v[60:63], v[176:179], 0
 ds_read_b64_tr_b16 v[48:49], v19 offset:12288
 ds_read_b64_tr_b16 v[50:51], v19 offset:12800
 s_nop 1
 s_mov_b32 s84, s54
 s_mov_b32 s85, s55
 s_waitcnt lgkmcnt(4)
 v_mfma_f32_32x32x16_bf16 v[64:79], v[40:43], v[180:183], v[64:79]
 ds_read_b64_tr_b16 v[52:53], v20 offset:12288
 ds_read_b64_tr_b16 v[54:55], v20 offset:12800
 s_mov_b32 s86, 1280
 s_mov_b32 s87, 0x00020000
 s_lshl_b32 s24, s2, 3
 s_waitcnt lgkmcnt(4)
 v_mfma_f32_32x32x16_bf16 v[80:95], v[44:47], v[180:183], v[80:95]
 ds_read_b64_tr_b16 v[56:57], v252 offset:19456
 ds_read_b64_tr_b16 v[58:59], v252 offset:19712
 s_lshl_b32 s25, s20, 1
 s_add_u32 s24, s24, s25
 v_lshrrev_b32 v35, 5, v1
 s_waitcnt lgkmcnt(4)
 v_mfma_f32_32x32x16_bf16 v[96:111], v[48:51], v[180:183], v[96:111]
 ds_read_b64_tr_b16 v[60:61], v253 offset:19456
 ds_read_b64_tr_b16 v[62:63], v253 offset:19712
 v_add_u32 v216, s24, v35
 v_mul_u32_u24 v35, 1280, v216
 v_and_b32 v36, 31, v1
 s_waitcnt lgkmcnt(4)
 v_mfma_f32_32x32x16_bf16 v[112:127], v[52:55], v[180:183], v[112:127]
 s_waitcnt vmcnt(12)
 s_barrier
 ds_read_b128 v[184:187], v6 offset:0
 ds_read_b128 v[188:191], v7 offset:0
 ds_read_b64_tr_b16 v[40:41], v17 offset:32768
 ds_read_b64_tr_b16 v[42:43], v17 offset:33280
 s_add_u32 m0, s35, 90112
 s_add_u32 s37, s88, 491520
 buffer_load_dwordx4 v8, s[40:43], s37 offen lds
 s_waitcnt lgkmcnt(6)
 v_mfma_f32_32x32x16_bf16 v[128:143], v[56:59], v[180:183], v[128:143]
 ds_read_b64_tr_b16 v[44:45], v18 offset:32768
 ds_read_b64_tr_b16 v[46:47], v18 offset:33280
 s_add_u32 m0, s35, 100352
 s_add_u32 s37, s89, 442368
 buffer_load_dwordx4 v9, s[56:59], s37 offen lds
 s_waitcnt lgkmcnt(6)
 v_mfma_f32_32x32x16_bf16 v[144:159], v[60:63], v[180:183], v[144:159]
 ds_read_b64_tr_b16 v[48:49], v19 offset:32768
 ds_read_b64_tr_b16 v[50:51], v19 offset:33280
 s_add_u32 s37, s62, 90112
 s_cmp_lt_u32 s98, 6
 s_cselect_b32 m0, s37, s74
 s_nop 0
 buffer_load_dwordx4 v10, s[80:83], s90 offen lds
 s_add_u32 s90, s90, s63
 s_waitcnt lgkmcnt(4)
 v_mfma_f32_32x32x16_bf16 v[64:79], v[40:43], v[184:187], v[64:79]
 ds_read_b64_tr_b16 v[52:53], v20 offset:32768
 ds_read_b64_tr_b16 v[54:55], v20 offset:33280
 s_add_u32 m0, s36, 32768
 s_movk_i32 s37, 256
 buffer_load_dwordx4 v2, s[4:7], s37 offen lds
 s_waitcnt lgkmcnt(4)
 v_mfma_f32_32x32x16_bf16 v[80:95], v[44:47], v[184:187], v[80:95]
 ds_read_b64_tr_b16 v[56:57], v252 offset:40960
 ds_read_b64_tr_b16 v[58:59], v252 offset:41216
 s_add_u32 m0, s36, 33792
 s_movk_i32 s37, 256
 buffer_load_dwordx4 v3, s[4:7], s37 offen lds
 s_waitcnt lgkmcnt(4)
 v_mfma_f32_32x32x16_bf16 v[96:111], v[48:51], v[184:187], v[96:111]
 ds_read_b64_tr_b16 v[60:61], v253 offset:40960
 ds_read_b64_tr_b16 v[62:63], v253 offset:41216
 v_lshlrev_b32 v36, 4, v36
 v_add_u32 v35, v35, v36
 v_mov_b32 v37, 0x80000000
 s_waitcnt lgkmcnt(4)
 v_mfma_f32_32x32x16_bf16 v[112:127], v[52:55], v[184:187], v[112:127]
 ds_read_b64_tr_b16 v[40:41], v17 offset:34816
 ds_read_b64_tr_b16 v[42:43], v17 offset:35328
 v_cmp_gt_u32 vcc, 256, v36
 s_nop 1
 v_cndmask_b32 v38, v37, v35, vcc
 s_waitcnt lgkmcnt(4)
 v_mfma_f32_32x32x16_bf16 v[128:143], v[56:59], v[184:187], v[128:143]
 ds_read_b64_tr_b16 v[44:45], v18 offset:34816
 ds_read_b64_tr_b16 v[46:47], v18 offset:35328
 v_cndmask_b32 v39, v37, v36, vcc
 buffer_load_dwordx4 v[192:195], v35, s[4:7], 0 offen offset:0
 s_waitcnt lgkmcnt(4)
 v_mfma_f32_32x32x16_bf16 v[144:159], v[60:63], v[184:187], v[144:159]
 ds_read_b64_tr_b16 v[48:49], v19 offset:34816
 ds_read_b64_tr_b16 v[50:51], v19 offset:35328
 buffer_load_dwordx4 v[196:199], v36, s[84:87], 0 offen offset:0
 s_waitcnt lgkmcnt(4)
 v_mfma_f32_32x32x16_bf16 v[64:79], v[40:43], v[188:191], v[64:79]
 ds_read_b64_tr_b16 v[52:53], v20 offset:34816
 ds_read_b64_tr_b16 v[54:55], v20 offset:35328
 buffer_load_dwordx4 v[200:203], v35, s[4:7], 0 offen offset:512
 s_waitcnt lgkmcnt(4)
 v_mfma_f32_32x32x16_bf16 v[80:95], v[44:47], v[188:191], v[80:95]
 ds_read_b64_tr_b16 v[56:57], v252 offset:41984
 ds_read_b64_tr_b16 v[58:59], v252 offset:42240
 buffer_load_dwordx4 v[204:207], v36, s[84:87], 0 offen offset:512
 s_waitcnt lgkmcnt(4)
 v_mfma_f32_32x32x16_bf16 v[96:111], v[48:51], v[188:191], v[96:111]
 ds_read_b64_tr_b16 v[60:61], v253 offset:41984
 ds_read_b64_tr_b16 v[62:63], v253 offset:42240
 buffer_load_dwordx4 v[208:211], v38, s[4:7], 0 offen offset:1024
 s_waitcnt lgkmcnt(4)
 v_mfma_f32_32x32x16_bf16 v[112:127], v[52:55], v[188:191], v[112:127]
 s_waitcnt vmcnt(17)
 s_barrier
 buffer_load_dword v250, v251, s[76:79], s60 offen
 s_add_u32 s60, s60, s61
 ds_read_b128 v[176:179], v4 offset:16384
 ds_read_b128 v[180:183], v5 offset:16384
 ds_read_b64_tr_b16 v[40:41], v17 offset:55296
 ds_read_b64_tr_b16 v[42:43], v17 offset:55808
 s_add_u32 m0, s35, 0
 s_add_u32 s37, s88, 614400
 buffer_load_dwordx4 v8, s[40:43], s37 offen lds
 s_waitcnt lgkmcnt(6)
 v_mfma_f32_32x32x16_bf16 v[128:143], v[56:59], v[188:191], v[128:143]
 ds_read_b64_tr_b16 v[44:45], v18 offset:55296
 ds_read_b64_tr_b16 v[46:47], v18 offset:55808
 s_add_u32 m0, s35, 10240
 s_add_u32 s37, s89, 552960
 buffer_load_dwordx4 v9, s[56:59], s37 offen lds
 s_waitcnt lgkmcnt(6)
 v_mfma_f32_32x32x16_bf16 v[144:159], v[60:63], v[188:191], v[144:159]
 ds_read_b64_tr_b16 v[48:49], v19 offset:55296
 ds_read_b64_tr_b16 v[50:51], v19 offset:55808
 s_add_u32 s37, s62, 0
 s_cmp_lt_u32 s98, 6
 s_cselect_b32 m0, s37, s74
 s_nop 0
 buffer_load_dwordx4 v10, s[80:83], s90 offen lds
 s_add_u32 s90, s90, s63
 s_waitcnt lgkmcnt(4)
 v_mfma_f32_32x32x16_bf16 v[64:79], v[40:43], v[176:179], v[64:79]
 ds_read_b64_tr_b16 v[52:53], v20 offset:55296
 ds_read_b64_tr_b16 v[54:55], v20 offset:55808
 buffer_load_dwordx4 v[212:215], v39, s[84:87], 0 offen offset:1024
 s_waitcnt lgkmcnt(4)
 v_mfma_f32_32x32x16_bf16 v[80:95], v[44:47], v[176:179], v[80:95]
 ds_read_b64_tr_b16 v[56:57], v252 offset:63488
 ds_read_b64_tr_b16 v[58:59], v252 offset:63744
 s_mul_i32 s24, s2, 10240
 s_add_u32 s24, s24, 15728640
 s_add_u32 s25, s24, 4096
 s_waitcnt lgkmcnt(4)
 v_mfma_f32_32x32x16_bf16 v[96:111], v[48:51], v[176:179], v[96:111]
 ds_read_b64_tr_b16 v[60:61], v253 offset:63488
 ds_read_b64_tr_b16 v[62:63], v253 offset:63744
 s_add_u32 s26, s24, 8192
 v_lshlrev_b32 v35, 4, v0
 v_cmp_gt_u32 vcc, 128, v0
 s_waitcnt lgkmcnt(4)
 v_mfma_f32_32x32x16_bf16 v[112:127], v[52:55], v[176:179], v[112:127]
 ds_read_b64_tr_b16 v[40:41], v17 offset:57344
 ds_read_b64_tr_b16 v[42:43], v17 offset:57856
 v_mov_b32 v218, -1
 v_mov_b32 v219, -1
 v_mov_b32 v220, -1
 s_waitcnt lgkmcnt(4)
 v_mfma_f32_32x32x16_bf16 v[128:143], v[56:59], v[176:179], v[128:143]
 ds_read_b64_tr_b16 v[44:45], v18 offset:57344
 ds_read_b64_tr_b16 v[46:47], v18 offset:57856
 v_mov_b32 v221, -1
 v_cndmask_b32 v36, v37, v35, vcc
 buffer_store_dwordx4 v[218:221], v35, s[16:19], s24 offen
 s_waitcnt lgkmcnt(4)
 v_mfma_f32_32x32x16_bf16 v[144:159], v[60:63], v[176:179], v[144:159]
 ds_read_b64_tr_b16 v[48:49], v19 offset:57344
 ds_read_b64_tr_b16 v[50:51], v19 offset:57856
 buffer_store_dwordx4 v[218:221], v35, s[16:19], s25 offen
 s_waitcnt lgkmcnt(4)
 v_mfma_f32_32x32x16_bf16 v[64:79], v[40:43], v[180:183], v[64:79]
 ds_read_b64_tr_b16 v[52:53], v20 offset:57344
 ds_read_b64_tr_b16 v[54:55], v20 offset:57856
 buffer_store_dwordx4 v[218:221], v36, s[16:19], s26 offen
 s_waitcnt lgkmcnt(4)
 v_mfma_f32_32x32x16_bf16 v[80:95], v[44:47], v[180:183], v[80:95]
 ds_read_b64_tr_b16 v[56:57], v252 offset:64512
 ds_read_b64_tr_b16 v[58:59], v252 offset:64768
 s_waitcnt lgkmcnt(4)
 v_mfma_f32_32x32x16_bf16 v[96:111], v[48:51], v[180:183], v[96:111]
 ds_read_b64_tr_b16 v[60:61], v253 offset:64512
 ds_read_b64_tr_b16 v[62:63], v253 offset:64768
 s_waitcnt lgkmcnt(4)
 v_mfma_f32_32x32x16_bf16 v[112:127], v[52:55], v[180:183], v[112:127]
 s_waitcnt vmcnt(19)
 s_barrier
 ds_read_b128 v[184:187], v6 offset:16384
 ds_read_b128 v[188:191], v7 offset:16384
 ds_read_b64_tr_b16 v[40:41], v21 offset:12288
 ds_read_b64_tr_b16 v[42:43], v21 offset:12800
 s_add_u32 m0, s35, 22528
 s_add_u32 s37, s88, 737280
 buffer_load_dwordx4 v8, s[40:43], s37 offen lds
 s_waitcnt lgkmcnt(6)
 v_mfma_f32_32x32x16_bf16 v[128:143], v[56:59], v[180:183], v[128:143]
 ds_read_b64_tr_b16 v[44:45], v22 offset:12288
 ds_read_b64_tr_b16 v[46:47], v22 offset:12800
 s_add_u32 m0, s35, 32768
 s_add_u32 s37, s89, 663552
 buffer_load_dwordx4 v9, s[56:59], s37 offen lds
 s_waitcnt lgkmcnt(6)
 v_mfma_f32_32x32x16_bf16 v[144:159], v[60:63], v[180:183], v[144:159]
 ds_read_b64_tr_b16 v[48:49], v23 offset:12288
 ds_read_b64_tr_b16 v[50:51], v23 offset:12800
 s_add_u32 s37, s62, 22528
 s_cmp_lt_u32 s98, 6
 s_cselect_b32 m0, s37, s74
 s_nop 0
 buffer_load_dwordx4 v10, s[80:83], s90 offen lds
 s_add_u32 s90, s90, s63
 s_waitcnt lgkmcnt(4)
 v_mfma_f32_32x32x16_bf16 v[64:79], v[40:43], v[184:187], v[64:79]
 ds_read_b64_tr_b16 v[52:53], v24 offset:12288
 ds_read_b64_tr_b16 v[54:55], v24 offset:12800
 s_add_u32 m0, s36, 0
 s_movk_i32 s37, 384
 buffer_load_dwordx4 v2, s[4:7], s37 offen lds
 s_waitcnt lgkmcnt(4)
 v_mfma_f32_32x32x16_bf16 v[80:95], v[44:47], v[184:187], v[80:95]
 ds_read_b64_tr_b16 v[56:57], v254 offset:20480
 ds_read_b64_tr_b16 v[58:59], v254 offset:20736
 s_add_u32 m0, s36, 1024
 s_movk_i32 s37, 384
 buffer_load_dwordx4 v3, s[4:7], s37 offen lds
 s_waitcnt lgkmcnt(4)
 v_mfma_f32_32x32x16_bf16 v[96:111], v[48:51], v[184:187], v[96:111]
 ds_read_b64_tr_b16 v[60:61], v255 offset:20480
 ds_read_b64_tr_b16 v[62:63], v255 offset:20736
 s_waitcnt lgkmcnt(4)
 v_mfma_f32_32x32x16_bf16 v[112:127], v[52:55], v[184:187], v[112:127]
 ds_read_b64_tr_b16 v[40:41], v21 offset:14336
 ds_read_b64_tr_b16 v[42:43], v21 offset:14848
 s_waitcnt lgkmcnt(4)
 v_mfma_f32_32x32x16_bf16 v[128:143], v[56:59], v[184:187], v[128:143]
 ds_read_b64_tr_b16 v[44:45], v22 offset:14336
 ds_read_b64_tr_b16 v[46:47], v22 offset:14848
 s_waitcnt lgkmcnt(4)
 v_mfma_f32_32x32x16_bf16 v[144:159], v[60:63], v[184:187], v[144:159]
 ds_read_b64_tr_b16 v[48:49], v23 offset:14336
 ds_read_b64_tr_b16 v[50:51], v23 offset:14848
 s_waitcnt lgkmcnt(4)
 v_mfma_f32_32x32x16_bf16 v[64:79], v[40:43], v[188:191], v[64:79]
 ds_read_b64_tr_b16 v[52:53], v24 offset:14336
 ds_read_b64_tr_b16 v[54:55], v24 offset:14848
 s_waitcnt lgkmcnt(4)
 v_mfma_f32_32x32x16_bf16 v[80:95], v[44:47], v[188:191], v[80:95]
 ds_read_b64_tr_b16 v[56:57], v254 offset:21504
 ds_read_b64_tr_b16 v[58:59], v254 offset:21760
 s_waitcnt lgkmcnt(4)
 v_mfma_f32_32x32x16_bf16 v[96:111], v[48:51], v[188:191], v[96:111]
 ds_read_b64_tr_b16 v[60:61], v255 offset:21504
 ds_read_b64_tr_b16 v[62:63], v255 offset:21760
 s_waitcnt lgkmcnt(4)
 v_mfma_f32_32x32x16_bf16 v[112:127], v[52:55], v[188:191], v[112:127]
 s_waitcnt vmcnt(18)
 s_barrier
 buffer_load_dword v250, v251, s[76:79], s60 offen
 s_add_u32 s60, s60, s61
 ds_read_b128 v[176:179], v4 offset:32768
 ds_read_b128 v[180:183], v5 offset:32768
 ds_read_b64_tr_b16 v[40:41], v21 offset:34816
 ds_read_b64_tr_b16 v[42:43], v21 offset:35328
 s_add_u32 m0, s35, 45056
 s_add_u32 s37, s88, 860160
 buffer_load_dwordx4 v8, s[40:43], s37 offen lds
 s_waitcnt lgkmcnt(6)
 v_mfma_f32_32x32x16_bf16 v[128:143], v[56:59], v[188:191], v[128:143]
 ds_read_b64_tr_b16 v[44:45], v22 offset:34816
 ds_read_b64_tr_b16 v[46:47], v22 offset:35328
 s_add_u32 m0, s35, 55296
 s_add_u32 s37, s89, 774144
 buffer_load_dwordx4 v9, s[56:59], s37 offen lds
 s_waitcnt lgkmcnt(6)
 v_mfma_f32_32x32x16_bf16 v[144:159], v[60:63], v[188:191], v[144:159]
 ds_read_b64_tr_b16 v[48:49], v23 offset:34816
 ds_read_b64_tr_b16 v[50:51], v23 offset:35328
 s_add_u32 s37, s62, 45056
 s_cmp_lt_u32 s98, 6
 s_cselect_b32 m0, s37, s74
 s_nop 0
 buffer_load_dwordx4 v10, s[80:83], s90 offen lds
 s_add_u32 s90, s90, s63
 s_waitcnt lgkmcnt(4)
 v_mfma_f32_32x32x16_bf16 v[64:79], v[40:43], v[176:179], v[64:79]
 ds_read_b64_tr_b16 v[52:53], v24 offset:34816
 ds_read_b64_tr_b16 v[54:55], v24 offset:35328
 s_waitcnt lgkmcnt(4)
 v_mfma_f32_32x32x16_bf16 v[80:95], v[44:47], v[176:179], v[80:95]
 ds_read_b64_tr_b16 v[56:57], v254 offset:43008
 ds_read_b64_tr_b16 v[58:59], v254 offset:43264
 s_waitcnt lgkmcnt(4)
 v_mfma_f32_32x32x16_bf16 v[96:111], v[48:51], v[176:179], v[96:111]
 ds_read_b64_tr_b16 v[60:61], v255 offset:43008
 ds_read_b64_tr_b16 v[62:63], v255 offset:43264
 s_waitcnt lgkmcnt(4)
 v_mfma_f32_32x32x16_bf16 v[112:127], v[52:55], v[176:179], v[112:127]
 ds_read_b64_tr_b16 v[40:41], v21 offset:36864
 ds_read_b64_tr_b16 v[42:43], v21 offset:37376
 s_waitcnt lgkmcnt(4)
 v_mfma_f32_32x32x16_bf16 v[128:143], v[56:59], v[176:179], v[128:143]
 ds_read_b64_tr_b16 v[44:45], v22 offset:36864
 ds_read_b64_tr_b16 v[46:47], v22 offset:37376
 s_waitcnt lgkmcnt(4)
 v_mfma_f32_32x32x16_bf16 v[144:159], v[60:63], v[176:179], v[144:159]
 ds_read_b64_tr_b16 v[48:49], v23 offset:36864
 ds_read_b64_tr_b16 v[50:51], v23 offset:37376
 s_waitcnt lgkmcnt(4)
 v_mfma_f32_32x32x16_bf16 v[64:79], v[40:43], v[180:183], v[64:79]
 ds_read_b64_tr_b16 v[52:53], v24 offset:36864
 ds_read_b64_tr_b16 v[54:55], v24 offset:37376
 s_waitcnt lgkmcnt(4)
 v_mfma_f32_32x32x16_bf16 v[80:95], v[44:47], v[180:183], v[80:95]
 ds_read_b64_tr_b16 v[56:57], v254 offset:44032
 ds_read_b64_tr_b16 v[58:59], v254 offset:44288
 s_waitcnt lgkmcnt(4)
 v_mfma_f32_32x32x16_bf16 v[96:111], v[48:51], v[180:183], v[96:111]
 ds_read_b64_tr_b16 v[60:61], v255 offset:44032
 ds_read_b64_tr_b16 v[62:63], v255 offset:44288
 s_waitcnt lgkmcnt(4)
 v_mfma_f32_32x32x16_bf16 v[112:127], v[52:55], v[180:183], v[112:127]
 s_waitcnt vmcnt(13)
 s_barrier
 ds_read_b128 v[184:187], v6 offset:32768
 ds_read_b128 v[188:191], v7 offset:32768
 ds_read_b64_tr_b16 v[40:41], v17 offset:10240
 ds_read_b64_tr_b16 v[42:43], v17 offset:10752
 s_add_u32 m0, s35, 67584
 s_add_u32 s37, s88, 983040
 buffer_load_dwordx4 v8, s[40:43], s37 offen lds
 s_waitcnt lgkmcnt(6)
 v_mfma_f32_32x32x16_bf16 v[128:143], v[56:59], v[180:183], v[128:143]
 ds_read_b64_tr_b16 v[44:45], v18 offset:10240
 ds_read_b64_tr_b16 v[46:47], v18 offset:10752
 s_add_u32 m0, s35, 77824
 s_add_u32 s37, s89, 884736
 buffer_load_dwordx4 v9, s[56:59], s37 offen lds
 s_waitcnt lgkmcnt(6)
 v_mfma_f32_32x32x16_bf16 v[144:159], v[60:63], v[180:183], v[144:159]
 ds_read_b64_tr_b16 v[48:49], v19 offset:10240
 ds_read_b64_tr_b16 v[50:51], v19 offset:10752
 s_add_u32 s37, s62, 67584
 s_cmp_lt_u32 s98, 6
 s_cselect_b32 m0, s37, s74
 s_nop 0
 buffer_load_dwordx4 v10, s[80:83], s90 offen lds
 s_add_u32 s90, s90, s63
 s_waitcnt lgkmcnt(4)
 v_mfma_f32_32x32x16_bf16 v[64:79], v[40:43], v[184:187], v[64:79]
 ds_read_b64_tr_b16 v[52:53], v20 offset:10240
 ds_read_b64_tr_b16 v[54:55], v20 offset:10752
 s_add_u32 m0, s36, 16384
 s_movk_i32 s37, 512
 buffer_load_dwordx4 v2, s[4:7], s37 offen lds
 s_waitcnt lgkmcnt(4)
 v_mfma_f32_32x32x16_bf16 v[80:95], v[44:47], v[184:187], v[80:95]
 ds_read_b64_tr_b16 v[56:57], v252 offset:18432
 ds_read_b64_tr_b16 v[58:59], v252 offset:18688
 s_add_u32 m0, s36, 17408
 s_movk_i32 s37, 512
 buffer_load_dwordx4 v3, s[4:7], s37 offen lds
 s_waitcnt lgkmcnt(4)
 v_mfma_f32_32x32x16_bf16 v[96:111], v[48:51], v[184:187], v[96:111]
 ds_read_b64_tr_b16 v[60:61], v253 offset:18432
 ds_read_b64_tr_b16 v[62:63], v253 offset:18688
 s_waitcnt lgkmcnt(4)
 v_mfma_f32_32x32x16_bf16 v[112:127], v[52:55], v[184:187], v[112:127]
 ds_read_b64_tr_b16 v[40:41], v17 offset:12288
 ds_read_b64_tr_b16 v[42:43], v17 offset:12800
 s_waitcnt lgkmcnt(4)
 v_mfma_f32_32x32x16_bf16 v[128:143], v[56:59], v[184:187], v[128:143]
 ds_read_b64_tr_b16 v[44:45], v18 offset:12288
 ds_read_b64_tr_b16 v[46:47], v18 offset:12800
 s_waitcnt lgkmcnt(4)
 v_mfma_f32_32x32x16_bf16 v[144:159], v[60:63], v[184:187], v[144:159]
 ds_read_b64_tr_b16 v[48:49], v19 offset:12288
 ds_read_b64_tr_b16 v[50:51], v19 offset:12800
 s_waitcnt lgkmcnt(4)
 v_mfma_f32_32x32x16_bf16 v[64:79], v[40:43], v[188:191], v[64:79]
 ds_read_b64_tr_b16 v[52:53], v20 offset:12288
 ds_read_b64_tr_b16 v[54:55], v20 offset:12800
 s_waitcnt lgkmcnt(4)
 v_mfma_f32_32x32x16_bf16 v[80:95], v[44:47], v[188:191], v[80:95]
 ds_read_b64_tr_b16 v[56:57], v252 offset:19456
 ds_read_b64_tr_b16 v[58:59], v252 offset:19712
 s_waitcnt lgkmcnt(4)
 v_mfma_f32_32x32x16_bf16 v[96:111], v[48:51], v[188:191], v[96:111]
 ds_read_b64_tr_b16 v[60:61], v253 offset:19456
 ds_read_b64_tr_b16 v[62:63], v253 offset:19712
 s_waitcnt lgkmcnt(4)
 v_mfma_f32_32x32x16_bf16 v[112:127], v[52:55], v[188:191], v[112:127]
 s_waitcnt vmcnt(9)
 s_barrier
 buffer_load_dword v250, v251, s[76:79], s60 offen
 s_add_u32 s60, s60, s61
 ds_read_b128 v[176:179], v4 offset:0
 ds_read_b128 v[180:183], v5 offset:0
 ds_read_b64_tr_b16 v[40:41], v17 offset:32768
 ds_read_b64_tr_b16 v[42:43], v17 offset:33280
 s_add_u32 m0, s35, 90112
 s_add_u32 s37, s88, 1105920
 buffer_load_dwordx4 v8, s[40:43], s37 offen lds
 s_waitcnt lgkmcnt(6)
 v_mfma_f32_32x32x16_bf16 v[128:143], v[56:59], v[188:191], v[128:143]
 ds_read_b64_tr_b16 v[44:45], v18 offset:32768
 ds_read_b64_tr_b16 v[46:47], v18 offset:33280
 s_add_u32 m0, s35, 100352
 s_add_u32 s37, s89, 995328
 buffer_load_dwordx4 v9, s[56:59], s37 offen lds
 s_waitcnt lgkmcnt(6)
 v_mfma_f32_32x32x16_bf16 v[144:159], v[60:63], v[188:191], v[144:159]
 ds_read_b64_tr_b16 v[48:49], v19 offset:32768
 ds_read_b64_tr_b16 v[50:51], v19 offset:33280
 s_add_u32 s37, s62, 90112
 s_cmp_lt_u32 s98, 6
 s_cselect_b32 m0, s37, s74
 s_nop 0
 buffer_load_dwordx4 v10, s[80:83], s90 offen lds
 s_add_u32 s90, s90, s63
 s_waitcnt lgkmcnt(4)
 v_mfma_f32_32x32x16_bf16 v[64:79], v[40:43], v[176:179], v[64:79]
 ds_read_b64_tr_b16 v[52:53], v20 offset:32768
 ds_read_b64_tr_b16 v[54:55], v20 offset:33280
 s_waitcnt lgkmcnt(4)
 v_mfma_f32_32x32x16_bf16 v[80:95], v[44:47], v[176:179], v[80:95]
 ds_read_b64_tr_b16 v[56:57], v252 offset:40960
 ds_read_b64_tr_b16 v[58:59], v252 offset:41216
 s_waitcnt lgkmcnt(4)
 v_mfma_f32_32x32x16_bf16 v[96:111], v[48:51], v[176:179], v[96:111]
 ds_read_b64_tr_b16 v[60:61], v253 offset:40960
 ds_read_b64_tr_b16 v[62:63], v253 offset:41216
 s_waitcnt lgkmcnt(4)
 v_mfma_f32_32x32x16_bf16 v[112:127], v[52:55], v[176:179], v[112:127]
 ds_read_b64_tr_b16 v[40:41], v17 offset:34816
 ds_read_b64_tr_b16 v[42:43], v17 offset:35328
 s_waitcnt lgkmcnt(4)
 v_mfma_f32_32x32x16_bf16 v[128:143], v[56:59], v[176:179], v[128:143]
 ds_read_b64_tr_b16 v[44:45], v18 offset:34816
 ds_read_b64_tr_b16 v[46:47], v18 offset:35328
 s_waitcnt lgkmcnt(4)
 v_mfma_f32_32x32x16_bf16 v[144:159], v[60:63], v[176:179], v[144:159]
 ds_read_b64_tr_b16 v[48:49], v19 offset:34816
 ds_read_b64_tr_b16 v[50:51], v19 offset:35328
 s_waitcnt lgkmcnt(4)
 v_mfma_f32_32x32x16_bf16 v[64:79], v[40:43], v[180:183], v[64:79]
 ds_read_b64_tr_b16 v[52:53], v20 offset:34816
 ds_read_b64_tr_b16 v[54:55], v20 offset:35328
 s_waitcnt lgkmcnt(4)
 v_mfma_f32_32x32x16_bf16 v[80:95], v[44:47], v[180:183], v[80:95]
 ds_read_b64_tr_b16 v[56:57], v252 offset:41984
 ds_read_b64_tr_b16 v[58:59], v252 offset:42240
 s_waitcnt lgkmcnt(4)
 v_mfma_f32_32x32x16_bf16 v[96:111], v[48:51], v[180:183], v[96:111]
 ds_read_b64_tr_b16 v[60:61], v253 offset:41984
 ds_read_b64_tr_b16 v[62:63], v253 offset:42240
 s_waitcnt lgkmcnt(4)
 v_mfma_f32_32x32x16_bf16 v[112:127], v[52:55], v[180:183], v[112:127]
 s_waitcnt vmcnt(9)
 s_barrier
 ds_read_b128 v[184:187], v6 offset:0
 ds_read_b128 v[188:191], v7 offset:0
 ds_read_b64_tr_b16 v[40:41], v17 offset:55296
 ds_read_b64_tr_b16 v[42:43], v17 offset:55808
 s_add_u32 m0, s35, 0
 s_add_u32 s37, s88, 1228800
 buffer_load_dwordx4 v8, s[40:43], s37 offen lds
 s_waitcnt lgkmcnt(6)
 v_mfma_f32_32x32x16_bf16 v[128:143], v[56:59], v[180:183], v[128:143]
 ds_read_b64_tr_b16 v[44:45], v18 offset:55296
 ds_read_b64_tr_b16 v[46:47], v18 offset:55808
 s_add_u32 m0, s35, 10240
 s_add_u32 s37, s89, 1105920
 buffer_load_dwordx4 v9, s[56:59], s37 offen lds
 s_waitcnt lgkmcnt(6)
 v_mfma_f32_32x32x16_bf16 v[144:159], v[60:63], v[180:183], v[144:159]
 ds_read_b64_tr_b16 v[48:49], v19 offset:55296
 ds_read_b64_tr_b16 v[50:51], v19 offset:55808
 s_add_u32 s37, s62, 0
 s_cmp_lt_u32 s98, 6
 s_cselect_b32 m0, s37, s74
 s_nop 0
 buffer_load_dwordx4 v10, s[80:83], s90 offen lds
 s_add_u32 s90, s90, s63
 s_waitcnt lgkmcnt(4)
 v_mfma_f32_32x32x16_bf16 v[64:79], v[40:43], v[184:187], v[64:79]
 ds_read_b64_tr_b16 v[52:53], v20 offset:55296
 ds_read_b64_tr_b16 v[54:55], v20 offset:55808
 s_add_u32 m0, s36, 32768
 s_movk_i32 s37, 640
 buffer_load_dwordx4 v2, s[4:7], s37 offen lds
 s_waitcnt lgkmcnt(4)
 v_mfma_f32_32x32x16_bf16 v[80:95], v[44:47], v[184:187], v[80:95]
 ds_read_b64_tr_b16 v[56:57], v252 offset:63488
 ds_read_b64_tr_b16 v[58:59], v252 offset:63744
 s_add_u32 m0, s36, 33792
 s_movk_i32 s37, 640
 buffer_load_dwordx4 v3, s[4:7], s37 offen lds
 s_waitcnt lgkmcnt(4)
 v_mfma_f32_32x32x16_bf16 v[96:111], v[48:51], v[184:187], v[96:111]
 ds_read_b64_tr_b16 v[60:61], v253 offset:63488
 ds_read_b64_tr_b16 v[62:63], v253 offset:63744
 s_waitcnt lgkmcnt(4)
 v_mfma_f32_32x32x16_bf16 v[112:127], v[52:55], v[184:187], v[112:127]
 ds_read_b64_tr_b16 v[40:41], v17 offset:57344
 ds_read_b64_tr_b16 v[42:43], v17 offset:57856
 s_waitcnt lgkmcnt(4)
 v_mfma_f32_32x32x16_bf16 v[128:143], v[56:59], v[184:187], v[128:143]
 ds_read_b64_tr_b16 v[44:45], v18 offset:57344
 ds_read_b64_tr_b16 v[46:47], v18 offset:57856
 s_waitcnt lgkmcnt(4)
 v_mfma_f32_32x32x16_bf16 v[144:159], v[60:63], v[184:187], v[144:159]
 ds_read_b64_tr_b16 v[48:49], v19 offset:57344
 ds_read_b64_tr_b16 v[50:51], v19 offset:57856
 s_waitcnt lgkmcnt(4)
 v_mfma_f32_32x32x16_bf16 v[64:79], v[40:43], v[188:191], v[64:79]
 ds_read_b64_tr_b16 v[52:53], v20 offset:57344
 ds_read_b64_tr_b16 v[54:55], v20 offset:57856
 s_waitcnt lgkmcnt(4)
 v_mfma_f32_32x32x16_bf16 v[80:95], v[44:47], v[188:191], v[80:95]
 ds_read_b64_tr_b16 v[56:57], v252 offset:64512
 ds_read_b64_tr_b16 v[58:59], v252 offset:64768
 s_waitcnt lgkmcnt(4)
 v_mfma_f32_32x32x16_bf16 v[96:111], v[48:51], v[188:191], v[96:111]
 ds_read_b64_tr_b16 v[60:61], v253 offset:64512
 ds_read_b64_tr_b16 v[62:63], v253 offset:64768
 v_mov_b32 v217, 0
 v_mov_b32 v218, 0
 v_lshlrev_b32 v219, 16, v192
 s_waitcnt lgkmcnt(4)
 v_mfma_f32_32x32x16_bf16 v[112:127], v[52:55], v[188:191], v[112:127]
 s_waitcnt vmcnt(9)
 s_barrier
 buffer_load_dword v250, v251, s[76:79], s60 offen
 s_add_u32 s60, s60, s61
 ds_read_b128 v[176:179], v4 offset:16384
 ds_read_b128 v[180:183], v5 offset:16384
 ds_read_b64_tr_b16 v[40:41], v21 offset:12288
 ds_read_b64_tr_b16 v[42:43], v21 offset:12800
 s_add_u32 m0, s35, 22528
 s_add_u32 s37, s88, 1351680
 buffer_load_dwordx4 v8, s[40:43], s37 offen lds
 s_waitcnt lgkmcnt(6)
 v_mfma_f32_32x32x16_bf16 v[128:143], v[56:59], v[188:191], v[128:143]
 ds_read_b64_tr_b16 v[44:45], v22 offset:12288
 ds_read_b64_tr_b16 v[46:47], v22 offset:12800
 s_add_u32 m0, s35, 32768
 s_add_u32 s37, s89, 1216512
 buffer_load_dwordx4 v9, s[56:59], s37 offen lds
 s_waitcnt lgkmcnt(6)
 v_mfma_f32_32x32x16_bf16 v[144:159], v[60:63], v[188:191], v[144:159]
 ds_read_b64_tr_b16 v[48:49], v23 offset:12288
 ds_read_b64_tr_b16 v[50:51], v23 offset:12800
 s_add_u32 s37, s62, 22528
 s_cmp_lt_u32 s98, 6
 s_cselect_b32 m0, s37, s74
 s_nop 0
 buffer_load_dwordx4 v10, s[80:83], s90 offen lds
 s_add_u32 s90, s90, s63
 s_waitcnt lgkmcnt(4)
 v_mfma_f32_32x32x16_bf16 v[64:79], v[40:43], v[176:179], v[64:79]
 ds_read_b64_tr_b16 v[52:53], v24 offset:12288
 ds_read_b64_tr_b16 v[54:55], v24 offset:12800
 v_and_b32 v220, 0xffff0000, v192
 v_lshlrev_b32 v221, 16, v196
 v_and_b32 v222, 0xffff0000, v196
 s_waitcnt lgkmcnt(4)
 v_mfma_f32_32x32x16_bf16 v[80:95], v[44:47], v[176:179], v[80:95]
 ds_read_b64_tr_b16 v[56:57], v254 offset:20480
 ds_read_b64_tr_b16 v[58:59], v254 offset:20736
 v_mul_f32 v219, v219, v221
 v_mul_f32 v220, v220, v222
 v_cvt_pk_bf16_f32 v219, v219, v220
 s_waitcnt lgkmcnt(4)
 v_mfma_f32_32x32x16_bf16 v[96:111], v[48:51], v[176:179], v[96:111]
 ds_read_b64_tr_b16 v[60:61], v255 offset:20480
 ds_read_b64_tr_b16 v[62:63], v255 offset:20736
 v_lshlrev_b32 v220, 16, v219
 v_and_b32 v219, 0xffff0000, v219
 v_add_f32 v217, v217, v220
 s_waitcnt lgkmcnt(4)
 v_mfma_f32_32x32x16_bf16 v[112:127], v[52:55], v[176:179], v[112:127]
 ds_read_b64_tr_b16 v[40:41], v21 offset:14336
 ds_read_b64_tr_b16 v[42:43], v21 offset:14848
 v_add_f32 v218, v218, v219
 v_lshlrev_b32 v219, 16, v193
 v_and_b32 v220, 0xffff0000, v193
 s_waitcnt lgkmcnt(4)
 v_mfma_f32_32x32x16_bf16 v[128:143], v[56:59], v[176:179], v[128:143]
 ds_read_b64_tr_b16 v[44:45], v22 offset:14336
 ds_read_b64_tr_b16 v[46:47], v22 offset:14848
 v_lshlrev_b32 v221, 16, v197
 v_and_b32 v222, 0xffff0000, v197
 v_mul_f32 v219, v219, v221
 s_waitcnt lgkmcnt(4)
 v_mfma_f32_32x32x16_bf16 v[144:159], v[60:63], v[176:179], v[144:159]
 ds_read_b64_tr_b16 v[48:49], v23 offset:14336
 ds_read_b64_tr_b16 v[50:51], v23 offset:14848
 v_mul_f32 v220, v220, v222
 v_cvt_pk_bf16_f32 v219, v219, v220
 v_lshlrev_b32 v220, 16, v219
 s_waitcnt lgkmcnt(4)
 v_mfma_f32_32x32x16_bf16 v[64:79], v[40:43], v[180:183], v[64:79]
 ds_read_b64_tr_b16 v[52:53], v24 offset:14336
 ds_read_b64_tr_b16 v[54:55], v24 offset:14848
 v_and_b32 v219, 0xffff0000, v219
 v_add_f32 v217, v217, v220
 v_add_f32 v218, v218, v219
 s_waitcnt lgkmcnt(4)
 v_mfma_f32_32x32x16_bf16 v[80:95], v[44:47], v[180:183], v[80:95]
 ds_read_b64_tr_b16 v[56:57], v254 offset:21504
 ds_read_b64_tr_b16 v[58:59], v254 offset:21760
 v_lshlrev_b32 v219, 16, v194
 v_and_b32 v220, 0xffff0000, v194
 v_lshlrev_b32 v221, 16, v198
 s_waitcnt lgkmcnt(4)
 v_mfma_f32_32x32x16_bf16 v[96:111], v[48:51], v[180:183], v[96:111]
 ds_read_b64_tr_b16 v[60:61], v255 offset:21504
 ds_read_b64_tr_b16 v[62:63], v255 offset:21760
 v_and_b32 v222, 0xffff0000, v198
 v_mul_f32 v219, v219, v221
 v_mul_f32 v220, v220, v222
 s_waitcnt lgkmcnt(4)
 v_mfma_f32_32x32x16_bf16 v[112:127], v[52:55], v[180:183], v[112:127]
 s_waitcnt vmcnt(9)
 s_barrier
 ds_read_b128 v[184:187], v6 offset:16384
 ds_read_b128 v[188:191], v7 offset:16384
 ds_read_b64_tr_b16 v[40:41], v21 offset:34816
 ds_read_b64_tr_b16 v[42:43], v21 offset:35328
 s_add_u32 m0, s35, 45056
 s_add_u32 s37, s88, 1474560
 buffer_load_dwordx4 v8, s[40:43], s37 offen lds
 s_waitcnt lgkmcnt(6)
 v_mfma_f32_32x32x16_bf16 v[128:143], v[56:59], v[180:183], v[128:143]
 ds_read_b64_tr_b16 v[44:45], v22 offset:34816
 ds_read_b64_tr_b16 v[46:47], v22 offset:35328
 s_add_u32 m0, s35, 55296
 s_add_u32 s37, s89, 1327104
 buffer_load_dwordx4 v9, s[56:59], s37 offen lds
 s_waitcnt lgkmcnt(6)
 v_mfma_f32_32x32x16_bf16 v[144:159], v[60:63], v[180:183], v[144:159]
 ds_read_b64_tr_b16 v[48:49], v23 offset:34816
 ds_read_b64_tr_b16 v[50:51], v23 offset:35328
 s_add_u32 s37, s62, 45056
 s_cmp_lt_u32 s98, 6
 s_cselect_b32 m0, s37, s74
 s_nop 0
 buffer_load_dwordx4 v10, s[80:83], s90 offen lds
 s_add_u32 s90, s90, s63
 s_waitcnt lgkmcnt(4)
 v_mfma_f32_32x32x16_bf16 v[64:79], v[40:43], v[184:187], v[64:79]
 ds_read_b64_tr_b16 v[52:53], v24 offset:34816
 ds_read_b64_tr_b16 v[54:55], v24 offset:35328
 s_add_u32 m0, s36, 0
 s_movk_i32 s37, 768
 buffer_load_dwordx4 v2, s[4:7], s37 offen lds
 s_waitcnt lgkmcnt(4)
 v_mfma_f32_32x32x16_bf16 v[80:95], v[44:47], v[184:187], v[80:95]
 ds_read_b64_tr_b16 v[56:57], v254 offset:43008
 ds_read_b64_tr_b16 v[58:59], v254 offset:43264
 s_add_u32 m0, s36, 1024
 s_movk_i32 s37, 768
 buffer_load_dwordx4 v3, s[4:7], s37 offen lds
 s_waitcnt lgkmcnt(4)
 v_mfma_f32_32x32x16_bf16 v[96:111], v[48:51], v[184:187], v[96:111]
 ds_read_b64_tr_b16 v[60:61], v255 offset:43008
 ds_read_b64_tr_b16 v[62:63], v255 offset:43264
 v_cvt_pk_bf16_f32 v219, v219, v220
 v_lshlrev_b32 v220, 16, v219
 v_and_b32 v219, 0xffff0000, v219
 s_waitcnt lgkmcnt(4)
 v_mfma_f32_32x32x16_bf16 v[112:127], v[52:55], v[184:187], v[112:127]
 ds_read_b64_tr_b16 v[40:41], v21 offset:36864
 ds_read_b64_tr_b16 v[42:43], v21 offset:37376
 v_add_f32 v217, v217, v220
 v_add_f32 v218, v218, v219
 v_lshlrev_b32 v219, 16, v195
 s_waitcnt lgkmcnt(4)
 v_mfma_f32_32x32x16_bf16 v[128:143], v[56:59], v[184:187], v[128:143]
 ds_read_b64_tr_b16 v[44:45], v22 offset:36864
 ds_read_b64_tr_b16 v[46:47], v22 offset:37376
 v_and_b32 v220, 0xffff0000, v195
 v_lshlrev_b32 v221, 16, v199
 v_and_b32 v222, 0xffff0000, v199
 s_waitcnt lgkmcnt(4)
 v_mfma_f32_32x32x16_bf16 v[144:159], v[60:63], v[184:187], v[144:159]
 ds_read_b64_tr_b16 v[48:49], v23 offset:36864
 ds_read_b64_tr_b16 v[50:51], v23 offset:37376
 v_mul_f32 v219, v219, v221
 v_mul_f32 v220, v220, v222
 v_cvt_pk_bf16_f32 v219, v219, v220
 s_waitcnt lgkmcnt(4)
 v_mfma_f32_32x32x16_bf16 v[64:79], v[40:43], v[188:191], v[64:79]
 ds_read_b64_tr_b16 v[52:53], v24 offset:36864
 ds_read_b64_tr_b16 v[54:55], v24 offset:37376
 v_lshlrev_b32 v220, 16, v219
 v_and_b32 v219, 0xffff0000, v219
 v_add_f32 v217, v217, v220
 s_waitcnt lgkmcnt(4)
 v_mfma_f32_32x32x16_bf16 v[80:95], v[44:47], v[188:191], v[80:95]
 ds_read_b64_tr_b16 v[56:57], v254 offset:44032
 ds_read_b64_tr_b16 v[58:59], v254 offset:44288
 v_add_f32 v218, v218, v219
 v_lshlrev_b32 v219, 16, v200
 v_and_b32 v220, 0xffff0000, v200
 s_waitcnt lgkmcnt(4)
 v_mfma_f32_32x32x16_bf16 v[96:111], v[48:51], v[188:191], v[96:111]
 ds_read_b64_tr_b16 v[60:61], v255 offset:44032
 ds_read_b64_tr_b16 v[62:63], v255 offset:44288
 v_lshlrev_b32 v221, 16, v204
 v_and_b32 v222, 0xffff0000, v204
 v_mul_f32 v219, v219, v221
 s_waitcnt lgkmcnt(4)
 v_mfma_f32_32x32x16_bf16 v[112:127], v[52:55], v[188:191], v[112:127]
 s_waitcnt vmcnt(9)
 s_barrier
 buffer_load_dword v250, v251, s[76:79], s60 offen
 s_add_u32 s60, s60, s61
 ds_read_b128 v[176:179], v4 offset:32768
 ds_read_b128 v[180:183], v5 offset:32768
 ds_read_b64_tr_b16 v[40:41], v17 offset:10240
 ds_read_b64_tr_b16 v[42:43], v17 offset:10752
 s_add_u32 m0, s35, 67584
 s_add_u32 s37, s88, 1597440
 buffer_load_dwordx4 v8, s[40:43], s37 offen lds
 s_waitcnt lgkmcnt(6)
 v_mfma_f32_32x32x16_bf16 v[128:143], v[56:59], v[188:191], v[128:143]
 ds_read_b64_tr_b16 v[44:45], v18 offset:10240
 ds_read_b64_tr_b16 v[46:47], v18 offset:10752
 s_add_u32 m0, s35, 77824
 s_add_u32 s37, s89, 1437696
 buffer_load_dwordx4 v9, s[56:59], s37 offen lds
 s_waitcnt lgkmcnt(6)
 v_mfma_f32_32x32x16_bf16 v[144:159], v[60:63], v[188:191], v[144:159]
 ds_read_b64_tr_b16 v[48:49], v19 offset:10240
 ds_read_b64_tr_b16 v[50:51], v19 offset:10752
 s_add_u32 s37, s62, 67584
 s_cmp_lt_u32 s98, 6
 s_cselect_b32 m0, s37, s74
 s_nop 0
 buffer_load_dwordx4 v10, s[80:83], s90 offen lds
 s_add_u32 s90, s90, s63
 s_waitcnt lgkmcnt(4)
 v_mfma_f32_32x32x16_bf16 v[64:79], v[40:43], v[176:179], v[64:79]
 ds_read_b64_tr_b16 v[52:53], v20 offset:10240
 ds_read_b64_tr_b16 v[54:55], v20 offset:10752
 v_mul_f32 v220, v220, v222
 v_cvt_pk_bf16_f32 v219, v219, v220
 v_lshlrev_b32 v220, 16, v219
 s_waitcnt lgkmcnt(4)
 v_mfma_f32_32x32x16_bf16 v[80:95], v[44:47], v[176:179], v[80:95]
 ds_read_b64_tr_b16 v[56:57], v252 offset:18432
 ds_read_b64_tr_b16 v[58:59], v252 offset:18688
 v_and_b32 v219, 0xffff0000, v219
 v_add_f32 v217, v217, v220
 v_add_f32 v218, v218, v219
 s_waitcnt lgkmcnt(4)
 v_mfma_f32_32x32x16_bf16 v[96:111], v[48:51], v[176:179], v[96:111]
 ds_read_b64_tr_b16 v[60:61], v253 offset:18432
 ds_read_b64_tr_b16 v[62:63], v253 offset:18688
 v_lshlrev_b32 v219, 16, v201
 v_and_b32 v220, 0xffff0000, v201
 v_lshlrev_b32 v221, 16, v205
 s_waitcnt lgkmcnt(4)
 v_mfma_f32_32x32x16_bf16 v[112:127], v[52:55], v[176:179], v[112:127]
 ds_read_b64_tr_b16 v[40:41], v17 offset:12288
 ds_read_b64_tr_b16 v[42:43], v17 offset:12800
 v_and_b32 v222, 0xffff0000, v205
 v_mul_f32 v219, v219, v221
 v_mul_f32 v220, v220, v222
 s_waitcnt lgkmcnt(4)
 v_mfma_f32_32x32x16_bf16 v[128:143], v[56:59], v[176:179], v[128:143]
 ds_read_b64_tr_b16 v[44:45], v18 offset:12288
 ds_read_b64_tr_b16 v[46:47], v18 offset:12800
 v_cvt_pk_bf16_f32 v219, v219, v220
 v_lshlrev_b32 v220, 16, v219
 v_and_b32 v219, 0xffff0000, v219
 s_waitcnt lgkmcnt(4)
 v_mfma_f32_32x32x16_bf16 v[144:159], v[60:63], v[176:179], v[144:159]
 ds_read_b64_tr_b16 v[48:49], v19 offset:12288
 ds_read_b64_tr_b16 v[50:51], v19 offset:12800
 v_add_f32 v217, v217, v220
 v_add_f32 v218, v218, v219
 v_lshlrev_b32 v219, 16, v202
 s_waitcnt lgkmcnt(4)
 v_mfma_f32_32x32x16_bf16 v[64:79], v[40:43], v[180:183], v[64:79]
 ds_read_b64_tr_b16 v[52:53], v20 offset:12288
 ds_read_b64_tr_b16 v[54:55], v20 offset:12800
 v_and_b32 v220, 0xffff0000, v202
 v_lshlrev_b32 v221, 16, v206
 v_and_b32 v222, 0xffff0000, v206
 s_waitcnt lgkmcnt(4)
 v_mfma_f32_32x32x16_bf16 v[80:95], v[44:47], v[180:183], v[80:95]
 ds_read_b64_tr_b16 v[56:57], v252 offset:19456
 ds_read_b64_tr_b16 v[58:59], v252 offset:19712
 v_mul_f32 v219, v219, v221
 v_mul_f32 v220, v220, v222
 v_cvt_pk_bf16_f32 v219, v219, v220
 s_waitcnt lgkmcnt(4)
 v_mfma_f32_32x32x16_bf16 v[96:111], v[48:51], v[180:183], v[96:111]
 ds_read_b64_tr_b16 v[60:61], v253 offset:19456
 ds_read_b64_tr_b16 v[62:63], v253 offset:19712
 v_lshlrev_b32 v220, 16, v219
 v_and_b32 v219, 0xffff0000, v219
 v_add_f32 v217, v217, v220
 s_waitcnt lgkmcnt(4)
 v_mfma_f32_32x32x16_bf16 v[112:127], v[52:55], v[180:183], v[112:127]
 s_waitcnt vmcnt(9)
 s_barrier
 ds_read_b128 v[184:187], v6 offset:32768
 ds_read_b128 v[188:191], v7 offset:32768
 ds_read_b64_tr_b16 v[40:41], v17 offset:32768
 ds_read_b64_tr_b16 v[42:43], v17 offset:33280
 s_add_u32 m0, s35, 90112
 s_add_u32 s37, s88, 1720320
 buffer_load_dwordx4 v8, s[40:43], s37 offen lds
 s_waitcnt lgkmcnt(6)
 v_mfma_f32_32x32x16_bf16 v[128:143], v[56:59], v[180:183], v[128:143]
 ds_read_b64_tr_b16 v[44:45], v18 offset:32768
 ds_read_b64_tr_b16 v[46:47], v18 offset:33280
 s_add_u32 m0, s35, 100352
 s_add_u32 s37, s89, 1548288
 buffer_load_dwordx4 v9, s[56:59], s37 offen lds
 s_waitcnt lgkmcnt(6)
 v_mfma_f32_32x32x16_bf16 v[144:159], v[60:63], v[180:183], v[144:159]
 ds_read_b64_tr_b16 v[48:49], v19 offset:32768
 ds_read_b64_tr_b16 v[50:51], v19 offset:33280
 s_add_u32 s37, s62, 90112
 s_cmp_lt_u32 s98, 6
 s_cselect_b32 m0, s37, s74
 s_nop 0
 buffer_load_dwordx4 v10, s[80:83], s90 offen lds
 s_add_u32 s90, s90, s63
 s_waitcnt lgkmcnt(4)
 v_mfma_f32_32x32x16_bf16 v[64:79], v[40:43], v[184:187], v[64:79]
 ds_read_b64_tr_b16 v[52:53], v20 offset:32768
 ds_read_b64_tr_b16 v[54:55], v20 offset:33280
 s_add_u32 m0, s36, 16384
 s_movk_i32 s37, 896
 buffer_load_dwordx4 v2, s[4:7], s37 offen lds
 s_waitcnt lgkmcnt(4)
 v_mfma_f32_32x32x16_bf16 v[80:95], v[44:47], v[184:187], v[80:95]
 ds_read_b64_tr_b16 v[56:57], v252 offset:40960
 ds_read_b64_tr_b16 v[58:59], v252 offset:41216
 s_add_u32 m0, s36, 17408
 s_movk_i32 s37, 896
 buffer_load_dwordx4 v3, s[4:7], s37 offen lds
 s_waitcnt lgkmcnt(4)
 v_mfma_f32_32x32x16_bf16 v[96:111], v[48:51], v[184:187], v[96:111]
 ds_read_b64_tr_b16 v[60:61], v253 offset:40960
 ds_read_b64_tr_b16 v[62:63], v253 offset:41216
 v_add_f32 v218, v218, v219
 v_lshlrev_b32 v219, 16, v203
 v_and_b32 v220, 0xffff0000, v203
 s_waitcnt lgkmcnt(4)
 v_mfma_f32_32x32x16_bf16 v[112:127], v[52:55], v[184:187], v[112:127]
 ds_read_b64_tr_b16 v[40:41], v17 offset:34816
 ds_read_b64_tr_b16 v[42:43], v17 offset:35328
 v_lshlrev_b32 v221, 16, v207
 v_and_b32 v222, 0xffff0000, v207
 v_mul_f32 v219, v219, v221
 s_waitcnt lgkmcnt(4)
 v_mfma_f32_32x32x16_bf16 v[128:143], v[56:59], v[184:187], v[128:143]
 ds_read_b64_tr_b16 v[44:45], v18 offset:34816
 ds_read_b64_tr_b16 v[46:47], v18 offset:35328
 v_mul_f32 v220, v220, v222
 v_cvt_pk_bf16_f32 v219, v219, v220
 v_lshlrev_b32 v220, 16, v219
 s_waitcnt lgkmcnt(4)
 v_mfma_f32_32x32x16_bf16 v[144:159], v[60:63], v[184:187], v[144:159]
 ds_read_b64_tr_b16 v[48:49], v19 offset:34816
 ds_read_b64_tr_b16 v[50:51], v19 offset:35328
 v_and_b32 v219, 0xffff0000, v219
 v_add_f32 v217, v217, v220
 v_add_f32 v218, v218, v219
 s_waitcnt lgkmcnt(4)
 v_mfma_f32_32x32x16_bf16 v[64:79], v[40:43], v[188:191], v[64:79]
 ds_read_b64_tr_b16 v[52:53], v20 offset:34816
 ds_read_b64_tr_b16 v[54:55], v20 offset:35328
 v_lshlrev_b32 v219, 16, v208
 v_and_b32 v220, 0xffff0000, v208
 v_lshlrev_b32 v221, 16, v212
 s_waitcnt lgkmcnt(4)
 v_mfma_f32_32x32x16_bf16 v[80:95], v[44:47], v[188:191], v[80:95]
 ds_read_b64_tr_b16 v[56:57], v252 offset:41984
 ds_read_b64_tr_b16 v[58:59], v252 offset:42240
 v_and_b32 v222, 0xffff0000, v212
 v_mul_f32 v219, v219, v221
 v_mul_f32 v220, v220, v222
 s_waitcnt lgkmcnt(4)
 v_mfma_f32_32x32x16_bf16 v[96:111], v[48:51], v[188:191], v[96:111]
 ds_read_b64_tr_b16 v[60:61], v253 offset:41984
 ds_read_b64_tr_b16 v[62:63], v253 offset:42240
 v_cvt_pk_bf16_f32 v219, v219, v220
 v_lshlrev_b32 v220, 16, v219
 v_and_b32 v219, 0xffff0000, v219
 s_waitcnt lgkmcnt(4)
 v_mfma_f32_32x32x16_bf16 v[112:127], v[52:55], v[188:191], v[112:127]
 s_waitcnt vmcnt(9)
 s_barrier
 buffer_load_dword v250, v251, s[76:79], s60 offen
 s_add_u32 s60, s60, s61
 ds_read_b128 v[176:179], v4 offset:0
 ds_read_b128 v[180:183], v5 offset:0
 ds_read_b64_tr_b16 v[40:41], v17 offset:55296
 ds_read_b64_tr_b16 v[42:43], v17 offset:55808
 s_add_u32 m0, s35, 0
 s_add_u32 s37, s88, 1843200
 buffer_load_dwordx4 v8, s[40:43], s37 offen lds
 s_waitcnt lgkmcnt(6)
 v_mfma_f32_32x32x16_bf16 v[128:143], v[56:59], v[188:191], v[128:143]
 ds_read_b64_tr_b16 v[44:45], v18 offset:55296
 ds_read_b64_tr_b16 v[46:47], v18 offset:55808
 s_add_u32 m0, s35, 10240
 s_add_u32 s37, s89, 1658880
 buffer_load_dwordx4 v9, s[56:59], s37 offen lds
 s_waitcnt lgkmcnt(6)
 v_mfma_f32_32x32x16_bf16 v[144:159], v[60:63], v[188:191], v[144:159]
 ds_read_b64_tr_b16 v[48:49], v19 offset:55296
 ds_read_b64_tr_b16 v[50:51], v19 offset:55808
 s_add_u32 s37, s62, 0
 s_cmp_lt_u32 s98, 6
 s_cselect_b32 m0, s37, s74
 s_nop 0
 buffer_load_dwordx4 v10, s[80:83], s90 offen lds
 s_add_u32 s90, s90, s63
 s_waitcnt lgkmcnt(4)
 v_mfma_f32_32x32x16_bf16 v[64:79], v[40:43], v[176:179], v[64:79]
 ds_read_b64_tr_b16 v[52:53], v20 offset:55296
 ds_read_b64_tr_b16 v[54:55], v20 offset:55808
 v_add_f32 v217, v217, v220
 v_add_f32 v218, v218, v219
 v_lshlrev_b32 v219, 16, v209
 s_waitcnt lgkmcnt(4)
 v_mfma_f32_32x32x16_bf16 v[80:95], v[44:47], v[176:179], v[80:95]
 ds_read_b64_tr_b16 v[56:57], v252 offset:63488
 ds_read_b64_tr_b16 v[58:59], v252 offset:63744
 v_and_b32 v220, 0xffff0000, v209
 v_lshlrev_b32 v221, 16, v213
 v_and_b32 v222, 0xffff0000, v213
 s_waitcnt lgkmcnt(4)
 v_mfma_f32_32x32x16_bf16 v[96:111], v[48:51], v[176:179], v[96:111]
 ds_read_b64_tr_b16 v[60:61], v253 offset:63488
 ds_read_b64_tr_b16 v[62:63], v253 offset:63744
 v_mul_f32 v219, v219, v221
 v_mul_f32 v220, v220, v222
 v_cvt_pk_bf16_f32 v219, v219, v220
 s_waitcnt lgkmcnt(4)
 v_mfma_f32_32x32x16_bf16 v[112:127], v[52:55], v[176:179], v[112:127]
 ds_read_b64_tr_b16 v[40:41], v17 offset:57344
 ds_read_b64_tr_b16 v[42:43], v17 offset:57856
 v_lshlrev_b32 v220, 16, v219
 v_and_b32 v219, 0xffff0000, v219
 v_add_f32 v217, v217, v220
 s_waitcnt lgkmcnt(4)
 v_mfma_f32_32x32x16_bf16 v[128:143], v[56:59], v[176:179], v[128:143]
 ds_read_b64_tr_b16 v[44:45], v18 offset:57344
 ds_read_b64_tr_b16 v[46:47], v18 offset:57856
 v_add_f32 v218, v218, v219
 v_lshlrev_b32 v219, 16, v210
 v_and_b32 v220, 0xffff0000, v210
 s_waitcnt lgkmcnt(4)
 v_mfma_f32_32x32x16_bf16 v[144:159], v[60:63], v[176:179], v[144:159]
 ds_read_b64_tr_b16 v[48:49], v19 offset:57344
 ds_read_b64_tr_b16 v[50:51], v19 offset:57856
 v_lshlrev_b32 v221, 16, v214
 v_and_b32 v222, 0xffff0000, v214
 v_mul_f32 v219, v219, v221
 s_waitcnt lgkmcnt(4)
 v_mfma_f32_32x32x16_bf16 v[64:79], v[40:43], v[180:183], v[64:79]
 ds_read_b64_tr_b16 v[52:53], v20 offset:57344
 ds_read_b64_tr_b16 v[54:55], v20 offset:57856
 v_mul_f32 v220, v220, v222
 v_cvt_pk_bf16_f32 v219, v219, v220
 v_lshlrev_b32 v220, 16, v219
 s_waitcnt lgkmcnt(4)
 v_mfma_f32_32x32x16_bf16 v[80:95], v[44:47], v[180:183], v[80:95]
 ds_read_b64_tr_b16 v[56:57], v252 offset:64512
 ds_read_b64_tr_b16 v[58:59], v252 offset:64768
 v_and_b32 v219, 0xffff0000, v219
 v_add_f32 v217, v217, v220
 v_add_f32 v218, v218, v219
 s_waitcnt lgkmcnt(4)
 v_mfma_f32_32x32x16_bf16 v[96:111], v[48:51], v[180:183], v[96:111]
 ds_read_b64_tr_b16 v[60:61], v253 offset:64512
 ds_read_b64_tr_b16 v[62:63], v253 offset:64768
 v_lshlrev_b32 v219, 16, v211
 v_and_b32 v220, 0xffff0000, v211
 v_lshlrev_b32 v221, 16, v215
 s_waitcnt lgkmcnt(4)
 v_mfma_f32_32x32x16_bf16 v[112:127], v[52:55], v[180:183], v[112:127]
 s_waitcnt vmcnt(9)
 s_barrier
 ds_read_b128 v[184:187], v6 offset:0
 ds_read_b128 v[188:191], v7 offset:0
 ds_read_b64_tr_b16 v[40:41], v21 offset:12288
 ds_read_b64_tr_b16 v[42:43], v21 offset:12800
 s_add_u32 m0, s35, 22528
 s_add_u32 s37, s88, 1966080
 buffer_load_dwordx4 v8, s[40:43], s37 offen lds
 s_waitcnt lgkmcnt(6)
 v_mfma_f32_32x32x16_bf16 v[128:143], v[56:59], v[180:183], v[128:143]
 ds_read_b64_tr_b16 v[44:45], v22 offset:12288
 ds_read_b64_tr_b16 v[46:47], v22 offset:12800
 s_add_u32 m0, s35, 32768
 s_add_u32 s37, s89, 1769472
 buffer_load_dwordx4 v9, s[56:59], s37 offen lds
 s_waitcnt lgkmcnt(6)
 v_mfma_f32_32x32x16_bf16 v[144:159], v[60:63], v[180:183], v[144:159]
 ds_read_b64_tr_b16 v[48:49], v23 offset:12288
 ds_read_b64_tr_b16 v[50:51], v23 offset:12800
 s_add_u32 s37, s62, 22528
 s_cmp_lt_u32 s98, 6
 s_cselect_b32 m0, s37, s74
 s_nop 0
 buffer_load_dwordx4 v10, s[80:83], s90 offen lds
 s_add_u32 s90, s90, s63
 s_waitcnt lgkmcnt(4)
 v_mfma_f32_32x32x16_bf16 v[64:79], v[40:43], v[184:187], v[64:79]
 ds_read_b64_tr_b16 v[52:53], v24 offset:12288
 ds_read_b64_tr_b16 v[54:55], v24 offset:12800
 s_add_u32 m0, s36, 32768
 s_movk_i32 s37, 1024
 buffer_load_dwordx4 v2, s[4:7], s37 offen lds
 s_waitcnt lgkmcnt(4)
 v_mfma_f32_32x32x16_bf16 v[80:95], v[44:47], v[184:187], v[80:95]
 ds_read_b64_tr_b16 v[56:57], v254 offset:20480
 ds_read_b64_tr_b16 v[58:59], v254 offset:20736
 s_add_u32 m0, s36, 33792
 s_movk_i32 s37, 1024
 buffer_load_dwordx4 v3, s[4:7], s37 offen lds
 s_waitcnt lgkmcnt(4)
 v_mfma_f32_32x32x16_bf16 v[96:111], v[48:51], v[184:187], v[96:111]
 ds_read_b64_tr_b16 v[60:61], v255 offset:20480
 ds_read_b64_tr_b16 v[62:63], v255 offset:20736
 v_and_b32 v222, 0xffff0000, v215
 v_mul_f32 v219, v219, v221
 v_mul_f32 v220, v220, v222
 s_waitcnt lgkmcnt(4)
 v_mfma_f32_32x32x16_bf16 v[112:127], v[52:55], v[184:187], v[112:127]
 ds_read_b64_tr_b16 v[40:41], v21 offset:14336
 ds_read_b64_tr_b16 v[42:43], v21 offset:14848
 v_cvt_pk_bf16_f32 v219, v219, v220
 v_lshlrev_b32 v220, 16, v219
 v_and_b32 v219, 0xffff0000, v219
 s_waitcnt lgkmcnt(4)
 v_mfma_f32_32x32x16_bf16 v[128:143], v[56:59], v[184:187], v[128:143]
 ds_read_b64_tr_b16 v[44:45], v22 offset:14336
 ds_read_b64_tr_b16 v[46:47], v22 offset:14848
 v_add_f32 v217, v217, v220
 v_add_f32 v218, v218, v219
 v_add_f32 v217, v217, v218
 s_waitcnt lgkmcnt(4)
 v_mfma_f32_32x32x16_bf16 v[144:159], v[60:63], v[184:187], v[144:159]
 ds_read_b64_tr_b16 v[48:49], v23 offset:14336
 ds_read_b64_tr_b16 v[50:51], v23 offset:14848
 s_waitcnt lgkmcnt(4)
 v_mfma_f32_32x32x16_bf16 v[64:79], v[40:43], v[188:191], v[64:79]
 ds_read_b64_tr_b16 v[52:53], v24 offset:14336
 ds_read_b64_tr_b16 v[54:55], v24 offset:14848
 ds_swizzle_b32 v218, v217 offset:1055
 s_waitcnt lgkmcnt(5)
 v_mfma_f32_32x32x16_bf16 v[80:95], v[44:47], v[188:191], v[80:95]
 ds_read_b64_tr_b16 v[56:57], v254 offset:21504
 ds_read_b64_tr_b16 v[58:59], v254 offset:21760
 s_waitcnt lgkmcnt(5)
 v_mfma_f32_32x32x16_bf16 v[96:111], v[48:51], v[188:191], v[96:111]
 ds_read_b64_tr_b16 v[60:61], v255 offset:21504
 ds_read_b64_tr_b16 v[62:63], v255 offset:21760
 s_waitcnt lgkmcnt(5)
 v_mfma_f32_32x32x16_bf16 v[112:127], v[52:55], v[188:191], v[112:127]
 s_waitcnt vmcnt(9)
 s_barrier
 ds_read_b128 v[176:179], v4 offset:16384
 ds_read_b128 v[180:183], v5 offset:16384
 ds_read_b64_tr_b16 v[40:41], v21 offset:34816
 ds_read_b64_tr_b16 v[42:43], v21 offset:35328
 s_add_u32 m0, s35, 45056
 s_add_u32 s37, s88, 2088960
 buffer_load_dwordx4 v8, s[40:43], s37 offen lds
 s_waitcnt lgkmcnt(6)
 v_mfma_f32_32x32x16_bf16 v[128:143], v[56:59], v[188:191], v[128:143]
 ds_read_b64_tr_b16 v[44:45], v22 offset:34816
 ds_read_b64_tr_b16 v[46:47], v22 offset:35328
 s_add_u32 m0, s35, 55296
 s_add_u32 s37, s89, 1880064
 buffer_load_dwordx4 v9, s[56:59], s37 offen lds
 s_waitcnt lgkmcnt(6)
 v_mfma_f32_32x32x16_bf16 v[144:159], v[60:63], v[188:191], v[144:159]
 ds_read_b64_tr_b16 v[48:49], v23 offset:34816
 ds_read_b64_tr_b16 v[50:51], v23 offset:35328
 s_add_u32 s37, s62, 45056
 s_cmp_lt_u32 s98, 6
 s_cselect_b32 m0, s37, s74
 s_nop 0
 buffer_load_dwordx4 v10, s[80:83], s90 offen lds
 s_add_u32 s90, s90, s63
 s_waitcnt lgkmcnt(4)
 v_mfma_f32_32x32x16_bf16 v[64:79], v[40:43], v[176:179], v[64:79]
 ds_read_b64_tr_b16 v[52:53], v24 offset:34816
 ds_read_b64_tr_b16 v[54:55], v24 offset:35328
 v_add_f32 v217, v217, v218
 s_waitcnt lgkmcnt(4)
 v_mfma_f32_32x32x16_bf16 v[80:95], v[44:47], v[176:179], v[80:95]
 ds_read_b64_tr_b16 v[56:57], v254 offset:43008
 ds_read_b64_tr_b16 v[58:59], v254 offset:43264
 ds_swizzle_b32 v218, v217 offset:2079
 s_waitcnt lgkmcnt(5)
 v_mfma_f32_32x32x16_bf16 v[96:111], v[48:51], v[176:179], v[96:111]
 ds_read_b64_tr_b16 v[60:61], v255 offset:43008
 ds_read_b64_tr_b16 v[62:63], v255 offset:43264
 s_waitcnt lgkmcnt(5)
 v_mfma_f32_32x32x16_bf16 v[112:127], v[52:55], v[176:179], v[112:127]
 ds_read_b64_tr_b16 v[40:41], v21 offset:36864
 ds_read_b64_tr_b16 v[42:43], v21 offset:37376
 s_waitcnt lgkmcnt(5)
 v_mfma_f32_32x32x16_bf16 v[128:143], v[56:59], v[176:179], v[128:143]
 ds_read_b64_tr_b16 v[44:45], v22 offset:36864
 ds_read_b64_tr_b16 v[46:47], v22 offset:37376
 s_waitcnt lgkmcnt(6)
 v_add_f32 v217, v217, v218
 s_waitcnt lgkmcnt(4)
 v_mfma_f32_32x32x16_bf16 v[144:159], v[60:63], v[176:179], v[144:159]
 ds_read_b64_tr_b16 v[48:49], v23 offset:36864
 ds_read_b64_tr_b16 v[50:51], v23 offset:37376
 ds_swizzle_b32 v218, v217 offset:4127
 s_waitcnt lgkmcnt(5)
 v_mfma_f32_32x32x16_bf16 v[64:79], v[40:43], v[180:183], v[64:79]
 ds_read_b64_tr_b16 v[52:53], v24 offset:36864
 ds_read_b64_tr_b16 v[54:55], v24 offset:37376
 s_waitcnt lgkmcnt(5)
 v_mfma_f32_32x32x16_bf16 v[80:95], v[44:47], v[180:183], v[80:95]
 ds_read_b64_tr_b16 v[56:57], v254 offset:44032
 ds_read_b64_tr_b16 v[58:59], v254 offset:44288
 s_waitcnt lgkmcnt(5)
 v_mfma_f32_32x32x16_bf16 v[96:111], v[48:51], v[180:183], v[96:111]
 ds_read_b64_tr_b16 v[60:61], v255 offset:44032
 ds_read_b64_tr_b16 v[62:63], v255 offset:44288
 s_waitcnt lgkmcnt(6)
 v_add_f32 v217, v217, v218
 s_waitcnt lgkmcnt(4)
 v_mfma_f32_32x32x16_bf16 v[112:127], v[52:55], v[180:183], v[112:127]
 s_waitcnt vmcnt(8)
 s_barrier
 ds_read_b128 v[184:187], v6 offset:16384
 ds_read_b128 v[188:191], v7 offset:16384
 ds_read_b64_tr_b16 v[40:41], v17 offset:10240
 ds_read_b64_tr_b16 v[42:43], v17 offset:10752
 s_add_u32 m0, s35, 67584
 s_add_u32 s37, s88, 2211840
 buffer_load_dwordx4 v8, s[40:43], s37 offen lds
 s_waitcnt lgkmcnt(6)
 v_mfma_f32_32x32x16_bf16 v[128:143], v[56:59], v[180:183], v[128:143]
 ds_read_b64_tr_b16 v[44:45], v18 offset:10240
 ds_read_b64_tr_b16 v[46:47], v18 offset:10752
 s_add_u32 m0, s35, 77824
 s_add_u32 s37, s89, 1990656
 buffer_load_dwordx4 v9, s[56:59], s37 offen lds
 s_waitcnt lgkmcnt(6)
 v_mfma_f32_32x32x16_bf16 v[144:159], v[60:63], v[180:183], v[144:159]
 ds_read_b64_tr_b16 v[48:49], v19 offset:10240
 ds_read_b64_tr_b16 v[50:51], v19 offset:10752
 s_add_u32 s37, s62, 67584
 s_cmp_lt_u32 s98, 6
 s_cselect_b32 m0, s37, s74
 s_nop 0
 buffer_load_dwordx4 v10, s[80:83], s90 offen lds
 s_add_u32 s90, s90, s63
 s_waitcnt lgkmcnt(4)
 v_mfma_f32_32x32x16_bf16 v[64:79], v[40:43], v[184:187], v[64:79]
 ds_read_b64_tr_b16 v[52:53], v20 offset:10240
 ds_read_b64_tr_b16 v[54:55], v20 offset:10752
 s_add_u32 m0, s36, 0
 s_movk_i32 s37, 1152
 buffer_load_dwordx4 v2, s[4:7], s37 offen lds
 s_waitcnt lgkmcnt(4)
 v_mfma_f32_32x32x16_bf16 v[80:95], v[44:47], v[184:187], v[80:95]
 ds_read_b64_tr_b16 v[56:57], v252 offset:18432
 ds_read_b64_tr_b16 v[58:59], v252 offset:18688
 s_add_u32 m0, s36, 1024
 s_movk_i32 s37, 1152
 buffer_load_dwordx4 v3, s[4:7], s37 offen lds
 s_waitcnt lgkmcnt(4)
 v_mfma_f32_32x32x16_bf16 v[96:111], v[48:51], v[184:187], v[96:111]
 ds_read_b64_tr_b16 v[60:61], v253 offset:18432
 ds_read_b64_tr_b16 v[62:63], v253 offset:18688
 ds_swizzle_b32 v218, v217 offset:8223
 s_waitcnt lgkmcnt(5)
 v_mfma_f32_32x32x16_bf16 v[112:127], v[52:55], v[184:187], v[112:127]
 ds_read_b64_tr_b16 v[40:41], v17 offset:12288
 ds_read_b64_tr_b16 v[42:43], v17 offset:12800
 s_waitcnt lgkmcnt(5)
 v_mfma_f32_32x32x16_bf16 v[128:143], v[56:59], v[184:187], v[128:143]
 ds_read_b64_tr_b16 v[44:45], v18 offset:12288
 ds_read_b64_tr_b16 v[46:47], v18 offset:12800
 s_waitcnt lgkmcnt(5)
 v_mfma_f32_32x32x16_bf16 v[144:159], v[60:63], v[184:187], v[144:159]
 ds_read_b64_tr_b16 v[48:49], v19 offset:12288
 ds_read_b64_tr_b16 v[50:51], v19 offset:12800
 s_waitcnt lgkmcnt(6)
 v_add_f32 v217, v217, v218
 s_waitcnt lgkmcnt(4)
 v_mfma_f32_32x32x16_bf16 v[64:79], v[40:43], v[188:191], v[64:79]
 ds_read_b64_tr_b16 v[52:53], v20 offset:12288
 ds_read_b64_tr_b16 v[54:55], v20 offset:12800
 ds_swizzle_b32 v218, v217 offset:16415
 s_waitcnt lgkmcnt(5)
 v_mfma_f32_32x32x16_bf16 v[80:95], v[44:47], v[188:191], v[80:95]
 ds_read_b64_tr_b16 v[56:57], v252 offset:19456
 ds_read_b64_tr_b16 v[58:59], v252 offset:19712
 s_waitcnt lgkmcnt(5)
 v_mfma_f32_32x32x16_bf16 v[96:111], v[48:51], v[188:191], v[96:111]
 ds_read_b64_tr_b16 v[60:61], v253 offset:19456
 ds_read_b64_tr_b16 v[62:63], v253 offset:19712
 s_waitcnt lgkmcnt(5)
 v_mfma_f32_32x32x16_bf16 v[112:127], v[52:55], v[188:191], v[112:127]
 s_waitcnt vmcnt(8)
 s_barrier
 ds_read_b128 v[176:179], v4 offset:32768
 ds_read_b128 v[180:183], v5 offset:32768
 ds_read_b64_tr_b16 v[40:41], v17 offset:32768
 ds_read_b64_tr_b16 v[42:43], v17 offset:33280
 s_add_u32 m0, s35, 90112
 s_add_u32 s37, s88, 2334720
 buffer_load_dwordx4 v8, s[40:43], s37 offen lds
 s_waitcnt lgkmcnt(6)
 v_mfma_f32_32x32x16_bf16 v[128:143], v[56:59], v[188:191], v[128:143]
 ds_read_b64_tr_b16 v[44:45], v18 offset:32768
 ds_read_b64_tr_b16 v[46:47], v18 offset:33280
 s_add_u32 m0, s35, 100352
 s_add_u32 s37, s89, 2101248
 buffer_load_dwordx4 v9, s[56:59], s37 offen lds
 s_waitcnt lgkmcnt(6)
 v_mfma_f32_32x32x16_bf16 v[144:159], v[60:63], v[188:191], v[144:159]
 ds_read_b64_tr_b16 v[48:49], v19 offset:32768
 ds_read_b64_tr_b16 v[50:51], v19 offset:33280
 s_add_u32 s37, s62, 90112
 s_cmp_lt_u32 s98, 6
 s_cselect_b32 m0, s37, s74
 s_nop 0
 buffer_load_dwordx4 v10, s[80:83], s90 offen lds
 s_add_u32 s90, s90, s63
 s_waitcnt lgkmcnt(4)
 v_mfma_f32_32x32x16_bf16 v[64:79], v[40:43], v[176:179], v[64:79]
 ds_read_b64_tr_b16 v[52:53], v20 offset:32768
 ds_read_b64_tr_b16 v[54:55], v20 offset:33280
 v_add_f32 v217, v217, v218
 v_cvt_pk_bf16_f32 v217, v217, v217
 v_lshlrev_b32 v217, 16, v217
 s_waitcnt lgkmcnt(4)
 v_mfma_f32_32x32x16_bf16 v[80:95], v[44:47], v[176:179], v[80:95]
 ds_read_b64_tr_b16 v[56:57], v252 offset:40960
 ds_read_b64_tr_b16 v[58:59], v252 offset:41216
 v_mul_f32 v217, 0xbfb8aa3b, v217
 v_exp_f32 v217, v217
 v_lshlrev_b32 v219, 2, v216
 s_waitcnt lgkmcnt(4)
 v_mfma_f32_32x32x16_bf16 v[96:111], v[48:51], v[176:179], v[96:111]
 ds_read_b64_tr_b16 v[60:61], v253 offset:40960
 ds_read_b64_tr_b16 v[62:63], v253 offset:41216
 v_add_f32 v217, 1.0, v217
 v_rcp_f32 v217, v217
 s_mov_b32 s38, 20971520
 s_waitcnt lgkmcnt(4)
 v_mfma_f32_32x32x16_bf16 v[112:127], v[52:55], v[176:179], v[112:127]
 ds_read_b64_tr_b16 v[40:41], v17 offset:34816
 ds_read_b64_tr_b16 v[42:43], v17 offset:35328
 v_cvt_pk_bf16_f32 v217, v217, v217
 v_lshlrev_b32 v217, 16, v217
 buffer_store_dword v217, v219, s[16:19], s38 offen
 s_waitcnt lgkmcnt(4)
 v_mfma_f32_32x32x16_bf16 v[128:143], v[56:59], v[176:179], v[128:143]
 ds_read_b64_tr_b16 v[44:45], v18 offset:34816
 ds_read_b64_tr_b16 v[46:47], v18 offset:35328
 s_lshl_b32 s38, s22, 2
 v_mov_b32 v228, 0x80000000
 v_mov_b32 v229, 1
 v_mov_b32 v230, 0
 v_cmp_eq_u32 vcc, 0, v0
 s_nop 1
 v_cndmask_b32 v228, v228, v230, vcc
 buffer_atomic_add v229, v228, s[92:95], s38 offen sc1
 s_waitcnt lgkmcnt(4)
 v_mfma_f32_32x32x16_bf16 v[144:159], v[60:63], v[176:179], v[144:159]
 ds_read_b64_tr_b16 v[48:49], v19 offset:34816
 ds_read_b64_tr_b16 v[50:51], v19 offset:35328
 s_waitcnt lgkmcnt(4)
 v_mfma_f32_32x32x16_bf16 v[64:79], v[40:43], v[180:183], v[64:79]
 ds_read_b64_tr_b16 v[52:53], v20 offset:34816
 ds_read_b64_tr_b16 v[54:55], v20 offset:35328
 s_waitcnt lgkmcnt(4)
 v_mfma_f32_32x32x16_bf16 v[80:95], v[44:47], v[180:183], v[80:95]
 ds_read_b64_tr_b16 v[56:57], v252 offset:41984
 ds_read_b64_tr_b16 v[58:59], v252 offset:42240
 s_waitcnt lgkmcnt(4)
 v_mfma_f32_32x32x16_bf16 v[96:111], v[48:51], v[180:183], v[96:111]
 ds_read_b64_tr_b16 v[60:61], v253 offset:41984
 ds_read_b64_tr_b16 v[62:63], v253 offset:42240
 s_waitcnt lgkmcnt(4)
 v_mfma_f32_32x32x16_bf16 v[112:127], v[52:55], v[180:183], v[112:127]
 s_waitcnt vmcnt(10)
 s_barrier
 ds_read_b128 v[184:187], v6 offset:32768
 ds_read_b128 v[188:191], v7 offset:32768
 ds_read_b64_tr_b16 v[40:41], v17 offset:55296
 ds_read_b64_tr_b16 v[42:43], v17 offset:55808
 s_waitcnt lgkmcnt(6)
 v_mfma_f32_32x32x16_bf16 v[128:143], v[56:59], v[180:183], v[128:143]
 ds_read_b64_tr_b16 v[44:45], v18 offset:55296
 ds_read_b64_tr_b16 v[46:47], v18 offset:55808
 s_waitcnt lgkmcnt(6)
 v_mfma_f32_32x32x16_bf16 v[144:159], v[60:63], v[180:183], v[144:159]
 ds_read_b64_tr_b16 v[48:49], v19 offset:55296
 ds_read_b64_tr_b16 v[50:51], v19 offset:55808
 s_waitcnt lgkmcnt(4)
 v_mfma_f32_32x32x16_bf16 v[64:79], v[40:43], v[184:187], v[64:79]
 ds_read_b64_tr_b16 v[52:53], v20 offset:55296
 ds_read_b64_tr_b16 v[54:55], v20 offset:55808
 s_waitcnt lgkmcnt(4)
 v_mfma_f32_32x32x16_bf16 v[80:95], v[44:47], v[184:187], v[80:95]
 ds_read_b64_tr_b16 v[56:57], v252 offset:63488
 ds_read_b64_tr_b16 v[58:59], v252 offset:63744
 s_waitcnt lgkmcnt(4)
 v_mfma_f32_32x32x16_bf16 v[96:111], v[48:51], v[184:187], v[96:111]
 ds_read_b64_tr_b16 v[60:61], v253 offset:63488
 ds_read_b64_tr_b16 v[62:63], v253 offset:63744
 s_waitcnt lgkmcnt(4)
 v_mfma_f32_32x32x16_bf16 v[112:127], v[52:55], v[184:187], v[112:127]
 ds_read_b64_tr_b16 v[40:41], v17 offset:57344
 ds_read_b64_tr_b16 v[42:43], v17 offset:57856
 s_waitcnt lgkmcnt(4)
 v_mfma_f32_32x32x16_bf16 v[128:143], v[56:59], v[184:187], v[128:143]
 ds_read_b64_tr_b16 v[44:45], v18 offset:57344
 ds_read_b64_tr_b16 v[46:47], v18 offset:57856
 s_waitcnt lgkmcnt(4)
 v_mfma_f32_32x32x16_bf16 v[144:159], v[60:63], v[184:187], v[144:159]
 ds_read_b64_tr_b16 v[48:49], v19 offset:57344
 ds_read_b64_tr_b16 v[50:51], v19 offset:57856
 s_waitcnt lgkmcnt(4)
 v_mfma_f32_32x32x16_bf16 v[64:79], v[40:43], v[188:191], v[64:79]
 ds_read_b64_tr_b16 v[52:53], v20 offset:57344
 ds_read_b64_tr_b16 v[54:55], v20 offset:57856
 s_waitcnt lgkmcnt(4)
 v_mfma_f32_32x32x16_bf16 v[80:95], v[44:47], v[188:191], v[80:95]
 ds_read_b64_tr_b16 v[56:57], v252 offset:64512
 ds_read_b64_tr_b16 v[58:59], v252 offset:64768
 s_waitcnt lgkmcnt(4)
 v_mfma_f32_32x32x16_bf16 v[96:111], v[48:51], v[188:191], v[96:111]
 ds_read_b64_tr_b16 v[60:61], v253 offset:64512
 ds_read_b64_tr_b16 v[62:63], v253 offset:64768
 s_waitcnt lgkmcnt(4)
 v_mfma_f32_32x32x16_bf16 v[112:127], v[52:55], v[188:191], v[112:127]
 s_waitcnt vmcnt(5)
 s_barrier
 ds_read_b128 v[176:179], v4 offset:0
 ds_read_b128 v[180:183], v5 offset:0
 ds_read_b64_tr_b16 v[40:41], v21 offset:12288
 ds_read_b64_tr_b16 v[42:43], v21 offset:12800
 s_waitcnt lgkmcnt(6)
 v_mfma_f32_32x32x16_bf16 v[128:143], v[56:59], v[188:191], v[128:143]
 ds_read_b64_tr_b16 v[44:45], v22 offset:12288
 ds_read_b64_tr_b16 v[46:47], v22 offset:12800
 s_waitcnt lgkmcnt(6)
 v_mfma_f32_32x32x16_bf16 v[144:159], v[60:63], v[188:191], v[144:159]
 ds_read_b64_tr_b16 v[48:49], v23 offset:12288
 ds_read_b64_tr_b16 v[50:51], v23 offset:12800
 s_waitcnt lgkmcnt(4)
 v_mfma_f32_32x32x16_bf16 v[64:79], v[40:43], v[176:179], v[64:79]
 ds_read_b64_tr_b16 v[52:53], v24 offset:12288
 ds_read_b64_tr_b16 v[54:55], v24 offset:12800
 s_waitcnt lgkmcnt(4)
 v_mfma_f32_32x32x16_bf16 v[80:95], v[44:47], v[176:179], v[80:95]
 ds_read_b64_tr_b16 v[56:57], v254 offset:20480
 ds_read_b64_tr_b16 v[58:59], v254 offset:20736
 s_waitcnt lgkmcnt(4)
 v_mfma_f32_32x32x16_bf16 v[96:111], v[48:51], v[176:179], v[96:111]
 ds_read_b64_tr_b16 v[60:61], v255 offset:20480
 ds_read_b64_tr_b16 v[62:63], v255 offset:20736
 s_waitcnt lgkmcnt(4)
 v_mfma_f32_32x32x16_bf16 v[112:127], v[52:55], v[176:179], v[112:127]
 ds_read_b64_tr_b16 v[40:41], v21 offset:14336
 ds_read_b64_tr_b16 v[42:43], v21 offset:14848
 s_waitcnt lgkmcnt(4)
 v_mfma_f32_32x32x16_bf16 v[128:143], v[56:59], v[176:179], v[128:143]
 ds_read_b64_tr_b16 v[44:45], v22 offset:14336
 ds_read_b64_tr_b16 v[46:47], v22 offset:14848
 s_waitcnt lgkmcnt(4)
 v_mfma_f32_32x32x16_bf16 v[144:159], v[60:63], v[176:179], v[144:159]
 ds_read_b64_tr_b16 v[48:49], v23 offset:14336
 ds_read_b64_tr_b16 v[50:51], v23 offset:14848
 s_waitcnt lgkmcnt(4)
 v_mfma_f32_32x32x16_bf16 v[64:79], v[40:43], v[180:183], v[64:79]
 ds_read_b64_tr_b16 v[52:53], v24 offset:14336
 ds_read_b64_tr_b16 v[54:55], v24 offset:14848
 s_waitcnt lgkmcnt(4)
 v_mfma_f32_32x32x16_bf16 v[80:95], v[44:47], v[180:183], v[80:95]
 ds_read_b64_tr_b16 v[56:57], v254 offset:21504
 ds_read_b64_tr_b16 v[58:59], v254 offset:21760
 s_waitcnt lgkmcnt(4)
 v_mfma_f32_32x32x16_bf16 v[96:111], v[48:51], v[180:183], v[96:111]
 ds_read_b64_tr_b16 v[60:61], v255 offset:21504
 ds_read_b64_tr_b16 v[62:63], v255 offset:21760
 s_waitcnt lgkmcnt(4)
 v_mfma_f32_32x32x16_bf16 v[112:127], v[52:55], v[180:183], v[112:127]
 s_waitcnt vmcnt(2)
 s_barrier
 ds_read_b128 v[184:187], v6 offset:0
 ds_read_b128 v[188:191], v7 offset:0
 ds_read_b64_tr_b16 v[40:41], v21 offset:34816
 ds_read_b64_tr_b16 v[42:43], v21 offset:35328
 s_waitcnt lgkmcnt(6)
 v_mfma_f32_32x32x16_bf16 v[128:143], v[56:59], v[180:183], v[128:143]
 ds_read_b64_tr_b16 v[44:45], v22 offset:34816
 ds_read_b64_tr_b16 v[46:47], v22 offset:35328
 s_waitcnt lgkmcnt(6)
 v_mfma_f32_32x32x16_bf16 v[144:159], v[60:63], v[180:183], v[144:159]
 ds_read_b64_tr_b16 v[48:49], v23 offset:34816
 ds_read_b64_tr_b16 v[50:51], v23 offset:35328
 s_waitcnt lgkmcnt(4)
 v_mfma_f32_32x32x16_bf16 v[64:79], v[40:43], v[184:187], v[64:79]
 ds_read_b64_tr_b16 v[52:53], v24 offset:34816
 ds_read_b64_tr_b16 v[54:55], v24 offset:35328
 s_waitcnt lgkmcnt(4)
 v_mfma_f32_32x32x16_bf16 v[80:95], v[44:47], v[184:187], v[80:95]
 ds_read_b64_tr_b16 v[56:57], v254 offset:43008
 ds_read_b64_tr_b16 v[58:59], v254 offset:43264
 s_waitcnt lgkmcnt(4)
 v_mfma_f32_32x32x16_bf16 v[96:111], v[48:51], v[184:187], v[96:111]
 ds_read_b64_tr_b16 v[60:61], v255 offset:43008
 ds_read_b64_tr_b16 v[62:63], v255 offset:43264
 s_waitcnt lgkmcnt(4)
 v_mfma_f32_32x32x16_bf16 v[112:127], v[52:55], v[184:187], v[112:127]
 ds_read_b64_tr_b16 v[40:41], v21 offset:36864
 ds_read_b64_tr_b16 v[42:43], v21 offset:37376
 s_waitcnt lgkmcnt(4)
 v_mfma_f32_32x32x16_bf16 v[128:143], v[56:59], v[184:187], v[128:143]
 ds_read_b64_tr_b16 v[44:45], v22 offset:36864
 ds_read_b64_tr_b16 v[46:47], v22 offset:37376
 s_waitcnt lgkmcnt(4)
 v_mfma_f32_32x32x16_bf16 v[144:159], v[60:63], v[184:187], v[144:159]
 ds_read_b64_tr_b16 v[48:49], v23 offset:36864
 ds_read_b64_tr_b16 v[50:51], v23 offset:37376
 s_waitcnt lgkmcnt(4)
 v_mfma_f32_32x32x16_bf16 v[64:79], v[40:43], v[188:191], v[64:79]
 ds_read_b64_tr_b16 v[52:53], v24 offset:36864
 ds_read_b64_tr_b16 v[54:55], v24 offset:37376
 s_waitcnt lgkmcnt(4)
 v_mfma_f32_32x32x16_bf16 v[80:95], v[44:47], v[188:191], v[80:95]
 ds_read_b64_tr_b16 v[56:57], v254 offset:44032
 ds_read_b64_tr_b16 v[58:59], v254 offset:44288
 s_waitcnt lgkmcnt(4)
 v_mfma_f32_32x32x16_bf16 v[96:111], v[48:51], v[188:191], v[96:111]
 ds_read_b64_tr_b16 v[60:61], v255 offset:44032
 ds_read_b64_tr_b16 v[62:63], v255 offset:44288
 s_waitcnt lgkmcnt(4)
 v_mfma_f32_32x32x16_bf16 v[112:127], v[52:55], v[188:191], v[112:127]
 s_waitcnt lgkmcnt(2)
 v_mfma_f32_32x32x16_bf16 v[128:143], v[56:59], v[188:191], v[128:143]
 s_waitcnt lgkmcnt(0)
 v_mfma_f32_32x32x16_bf16 v[144:159], v[60:63], v[188:191], v[144:159]
 s_setprio 0
 s_waitcnt lgkmcnt(0)
 s_barrier
 s_getpc_b64 s[28:29]
L_k2pf_2:
 s_add_u32 s28, s28, k2_kernel - L_k2pf_2
 s_addc_u32 s29, s29, 0
 s_lshl_b32 s30, s20, 12
 v_lshlrev_b32 v35, 6, v1
 v_add_u32 v35, s30, v35
 v_min_u32 v35, L_text_end - k2_kernel - 4, v35
 global_load_dword v250, v35, s[28:29]
 v_lshrrev_b32 v35, 1, v1
 v_mul_u32_u24 v35, 1280, v35
 v_and_b32 v36, 1, v1
 v_lshl_add_u32 v37, v36, 4, v35
 s_mul_i32 s24, s2, 12
 s_mul_i32 s25, s20, 3
 s_add_u32 s24, s24, s25
 s_mul_i32 s31, s20, 3072
 s_add_u32 s31, s31, 102592
 s_add_u32 s25, s24, 0
 s_min_u32 s25, s25, 2959
 s_mul_hi_u32 s80, s25, 107374183
 s_mul_i32 s26, s80, 40
 s_sub_u32 s81, s25, s26
 s_cmp_lt_u32 s80, 54
 s_cselect_b32 s76, s52, s46
 s_cselect_b32 s77, s53, s47
 s_mov_b32 s78, 819200
 s_cselect_b32 s78, 2211840, s78
 s_mov_b32 s79, 0x00020000
 s_cselect_b32 s26, 0, 54
 s_sub_u32 s26, s80, s26
 s_mul_i32 s26, s26, 40960
 s_lshl_b32 s27, s81, 5
 s_add_u32 s26, s26, s27
 s_add_u32 m0, s31, 0
 s_nop 0
 buffer_load_dwordx4 v37, s[76:79], s26 offen lds
 s_add_u32 s25, s24, 1
 s_min_u32 s25, s25, 2959
 s_mul_hi_u32 s82, s25, 107374183
 s_mul_i32 s26, s82, 40
 s_sub_u32 s83, s25, s26
 s_cmp_lt_u32 s82, 54
 s_cselect_b32 s76, s52, s46
 s_cselect_b32 s77, s53, s47
 s_mov_b32 s78, 819200
 s_cselect_b32 s78, 2211840, s78
 s_mov_b32 s79, 0x00020000
 s_cselect_b32 s26, 0, 54
 s_sub_u32 s26, s82, s26
 s_mul_i32 s26, s26, 40960
 s_lshl_b32 s27, s83, 5
 s_add_u32 s26, s26, s27
 s_add_u32 m0, s31, 1024
 s_nop 0
 buffer_load_dwordx4 v37, s[76:79], s26 offen lds
 s_add_u32 s25, s24, 2
 s_min_u32 s25, s25, 2959
 s_mul_hi_u32 s84, s25, 107374183
 s_mul_i32 s26, s84, 40
 s_sub_u32 s85, s25, s26
 s_cmp_lt_u32 s84, 54
 s_cselect_b32 s76, s52, s46
 s_cselect_b32 s77, s53, s47
 s_mov_b32 s78, 819200
 s_cselect_b32 s78, 2211840, s78
 s_mov_b32 s79, 0x00020000
 s_cselect_b32 s26, 0, 54
 s_sub_u32 s26, s84, s26
 s_mul_i32 s26, s26, 40960
 s_lshl_b32 s27, s85, 5
 s_add_u32 s26, s26, s27
 s_add_u32 m0, s31, 2048
 s_nop 0
 buffer_load_dwordx4 v37, s[76:79], s26 offen lds
 s_barrier
 v_cvt_pk_bf16_f32 v161, v64, v65
 v_cvt_pk_bf16_f32 v163, v72, v73
 v_lshlrev_b32 v160, 16, v161
 v_and_b32 v161, 0xffff0000, v161
 v_mul_f32 v164, v160, v160
 v_mul_f32 v165, v161, v161
 v_fmamk_f32 v164, v164, 0xbdd2d3e8, v26
 v_fmamk_f32 v165, v165, 0xbdd2d3e8, v26
 v_mul_f32 v164, v164, v160
 v_mul_f32 v165, v165, v161
 v_exp_f32 v164, v164
 v_exp_f32 v165, v165
 v_lshlrev_b32 v162, 16, v163
 v_add_f32 v164, 1.0, v164
 v_add_f32 v165, 1.0, v165
 v_rcp_f32 v164, v164
 v_rcp_f32 v165, v165
 v_and_b32 v163, 0xffff0000, v163
 v_mul_f32 v164, v164, v160
 v_mul_f32 v165, v165, v161
 v_cvt_pk_bf16_f32 v165, v164, v165
 v_lshlrev_b32 v164, 16, v165
 v_and_b32 v165, 0xffff0000, v165
 v_mul_f32 v164, v164, v162
 v_mul_f32 v165, v165, v163
 v_cvt_pk_bf16_f32 v172, v164, v165
 v_cvt_pk_bf16_f32 v161, v66, v67
 v_cvt_pk_bf16_f32 v163, v74, v75
 v_lshlrev_b32 v160, 16, v161
 v_and_b32 v161, 0xffff0000, v161
 v_mul_f32 v164, v160, v160
 v_mul_f32 v165, v161, v161
 v_fmamk_f32 v164, v164, 0xbdd2d3e8, v26
 v_fmamk_f32 v165, v165, 0xbdd2d3e8, v26
 v_mul_f32 v164, v164, v160
 v_mul_f32 v165, v165, v161
 v_exp_f32 v164, v164
 v_exp_f32 v165, v165
 v_lshlrev_b32 v162, 16, v163
 v_add_f32 v164, 1.0, v164
 v_add_f32 v165, 1.0, v165
 v_rcp_f32 v164, v164
 v_rcp_f32 v165, v165
 v_and_b32 v163, 0xffff0000, v163
 v_mul_f32 v164, v164, v160
 v_mul_f32 v165, v165, v161
 v_cvt_pk_bf16_f32 v165, v164, v165
 v_lshlrev_b32 v164, 16, v165
 v_and_b32 v165, 0xffff0000, v165
 v_mul_f32 v164, v164, v162
 v_mul_f32 v165, v165, v163
 v_cvt_pk_bf16_f32 v173, v164, v165
 v_cvt_pk_bf16_f32 v161, v68, v69
 v_cvt_pk_bf16_f32 v163, v76, v77
 v_lshlrev_b32 v160, 16, v161
 v_and_b32 v161, 0xffff0000, v161
 v_mul_f32 v164, v160, v160
 v_mul_f32 v165, v161, v161
 v_fmamk_f32 v164, v164, 0xbdd2d3e8, v26
 v_fmamk_f32 v165, v165, 0xbdd2d3e8, v26
 v_mul_f32 v164, v164, v160
 v_mul_f32 v165, v165, v161
 v_exp_f32 v164, v164
 v_exp_f32 v165, v165
 v_lshlrev_b32 v162, 16, v163
 v_add_f32 v164, 1.0, v164
 v_add_f32 v165, 1.0, v165
 v_rcp_f32 v164, v164
 v_rcp_f32 v165, v165
 v_and_b32 v163, 0xffff0000, v163
 v_mul_f32 v164, v164, v160
 v_mul_f32 v165, v165, v161
 v_cvt_pk_bf16_f32 v165, v164, v165
 v_lshlrev_b32 v164, 16, v165
 v_and_b32 v165, 0xffff0000, v165
 v_mul_f32 v164, v164, v162
 v_mul_f32 v165, v165, v163
 v_cvt_pk_bf16_f32 v174, v164, v165
 v_cvt_pk_bf16_f32 v161, v70, v71
 v_cvt_pk_bf16_f32 v163, v78, v79
 v_lshlrev_b32 v160, 16, v161
 v_and_b32 v161, 0xffff0000, v161
 v_mul_f32 v164, v160, v160
 v_mul_f32 v165, v161, v161
 v_fmamk_f32 v164, v164, 0xbdd2d3e8, v26
 v_fmamk_f32 v165, v165, 0xbdd2d3e8, v26
 v_mul_f32 v164, v164, v160
 v_mul_f32 v165, v165, v161
 v_exp_f32 v164, v164
 v_exp_f32 v165, v165
 v_lshlrev_b32 v162, 16, v163
 v_add_f32 v164, 1.0, v164
 v_add_f32 v165, 1.0, v165
 v_rcp_f32 v164, v164
 v_rcp_f32 v165, v165
 v_and_b32 v163, 0xffff0000, v163
 v_mul_f32 v164, v164, v160
 v_mul_f32 v165, v165, v161
 v_cvt_pk_bf16_f32 v165, v164, v165
 v_lshlrev_b32 v164, 16, v165
 v_and_b32 v165, 0xffff0000, v165
 v_mul_f32 v164, v164, v162
 v_mul_f32 v165, v165, v163
 v_cvt_pk_bf16_f32 v175, v164, v165
 s_add_u32 s38, s34, 0
 buffer_store_dwordx4 v[172:175], v25, s[16:19], s38 offen sc0 sc1
 v_cvt_pk_bf16_f32 v177, v80, v81
 v_cvt_pk_bf16_f32 v179, v88, v89
 v_lshlrev_b32 v176, 16, v177
 v_and_b32 v177, 0xffff0000, v177
 v_mul_f32 v180, v176, v176
 v_mul_f32 v181, v177, v177
 v_fmamk_f32 v180, v180, 0xbdd2d3e8, v26
 v_fmamk_f32 v181, v181, 0xbdd2d3e8, v26
 v_mul_f32 v180, v180, v176
 v_mul_f32 v181, v181, v177
 v_exp_f32 v180, v180
 v_exp_f32 v181, v181
 v_lshlrev_b32 v178, 16, v179
 v_add_f32 v180, 1.0, v180
 v_add_f32 v181, 1.0, v181
 v_rcp_f32 v180, v180
 v_rcp_f32 v181, v181
 v_and_b32 v179, 0xffff0000, v179
 v_mul_f32 v180, v180, v176
 v_mul_f32 v181, v181, v177
 v_cvt_pk_bf16_f32 v181, v180, v181
 v_lshlrev_b32 v180, 16, v181
 v_and_b32 v181, 0xffff0000, v181
 v_mul_f32 v180, v180, v178
 v_mul_f32 v181, v181, v179
 v_cvt_pk_bf16_f32 v188, v180, v181
 v_cvt_pk_bf16_f32 v177, v82, v83
 v_cvt_pk_bf16_f32 v179, v90, v91
 v_lshlrev_b32 v176, 16, v177
 v_and_b32 v177, 0xffff0000, v177
 v_mul_f32 v180, v176, v176
 v_mul_f32 v181, v177, v177
 v_fmamk_f32 v180, v180, 0xbdd2d3e8, v26
 v_fmamk_f32 v181, v181, 0xbdd2d3e8, v26
 v_mul_f32 v180, v180, v176
 v_mul_f32 v181, v181, v177
 v_exp_f32 v180, v180
 v_exp_f32 v181, v181
 v_lshlrev_b32 v178, 16, v179
 v_add_f32 v180, 1.0, v180
 v_add_f32 v181, 1.0, v181
 v_rcp_f32 v180, v180
 v_rcp_f32 v181, v181
 v_and_b32 v179, 0xffff0000, v179
 v_mul_f32 v180, v180, v176
 v_mul_f32 v181, v181, v177
 v_cvt_pk_bf16_f32 v181, v180, v181
 v_lshlrev_b32 v180, 16, v181
 v_and_b32 v181, 0xffff0000, v181
 v_mul_f32 v180, v180, v178
 v_mul_f32 v181, v181, v179
 v_cvt_pk_bf16_f32 v189, v180, v181
 v_cvt_pk_bf16_f32 v177, v84, v85
 v_cvt_pk_bf16_f32 v179, v92, v93
 v_lshlrev_b32 v176, 16, v177
 v_and_b32 v177, 0xffff0000, v177
 v_mul_f32 v180, v176, v176
 v_mul_f32 v181, v177, v177
 v_fmamk_f32 v180, v180, 0xbdd2d3e8, v26
 v_fmamk_f32 v181, v181, 0xbdd2d3e8, v26
 v_mul_f32 v180, v180, v176
 v_mul_f32 v181, v181, v177
 v_exp_f32 v180, v180
 v_exp_f32 v181, v181
 v_lshlrev_b32 v178, 16, v179
 v_add_f32 v180, 1.0, v180
 v_add_f32 v181, 1.0, v181
 v_rcp_f32 v180, v180
 v_rcp_f32 v181, v181
 v_and_b32 v179, 0xffff0000, v179
 v_mul_f32 v180, v180, v176
 v_mul_f32 v181, v181, v177
 v_cvt_pk_bf16_f32 v181, v180, v181
 v_lshlrev_b32 v180, 16, v181
 v_and_b32 v181, 0xffff0000, v181
 v_mul_f32 v180, v180, v178
 v_mul_f32 v181, v181, v179
 v_cvt_pk_bf16_f32 v190, v180, v181
 v_cvt_pk_bf16_f32 v177, v86, v87
 v_cvt_pk_bf16_f32 v179, v94, v95
 v_lshlrev_b32 v176, 16, v177
 v_and_b32 v177, 0xffff0000, v177
 v_mul_f32 v180, v176, v176
 v_mul_f32 v181, v177, v177
 v_fmamk_f32 v180, v180, 0xbdd2d3e8, v26
 v_fmamk_f32 v181, v181, 0xbdd2d3e8, v26
 v_mul_f32 v180, v180, v176
 v_mul_f32 v181, v181, v177
 v_exp_f32 v180, v180
 v_exp_f32 v181, v181
 v_lshlrev_b32 v178, 16, v179
 v_add_f32 v180, 1.0, v180
 v_add_f32 v181, 1.0, v181
 v_rcp_f32 v180, v180
 v_rcp_f32 v181, v181
 v_and_b32 v179, 0xffff0000, v179
 v_mul_f32 v180, v180, v176
 v_mul_f32 v181, v181, v177
 v_cvt_pk_bf16_f32 v181, v180, v181
 v_lshlrev_b32 v180, 16, v181
 v_and_b32 v181, 0xffff0000, v181
 v_mul_f32 v180, v180, v178
 v_mul_f32 v181, v181, v179
 v_cvt_pk_bf16_f32 v191, v180, v181
 s_add_u32 s38, s34, 512
 buffer_store_dwordx4 v[188:191], v25, s[16:19], s38 offen sc0 sc1
 v_cvt_pk_bf16_f32 v161, v96, v97
 v_cvt_pk_bf16_f32 v163, v104, v105
 v_lshlrev_b32 v160, 16, v161
 v_and_b32 v161, 0xffff0000, v161
 v_mul_f32 v164, v160, v160
 v_mul_f32 v165, v161, v161
 v_fmamk_f32 v164, v164, 0xbdd2d3e8, v26
 v_fmamk_f32 v165, v165, 0xbdd2d3e8, v26
 v_mul_f32 v164, v164, v160
 v_mul_f32 v165, v165, v161
 v_exp_f32 v164, v164
 v_exp_f32 v165, v165
 v_lshlrev_b32 v162, 16, v163
 v_add_f32 v164, 1.0, v164
 v_add_f32 v165, 1.0, v165
 v_rcp_f32 v164, v164
 v_rcp_f32 v165, v165
 v_and_b32 v163, 0xffff0000, v163
 v_mul_f32 v164, v164, v160
 v_mul_f32 v165, v165, v161
 v_cvt_pk_bf16_f32 v165, v164, v165
 v_lshlrev_b32 v164, 16, v165
 v_and_b32 v165, 0xffff0000, v165
 v_mul_f32 v164, v164, v162
 v_mul_f32 v165, v165, v163
 v_cvt_pk_bf16_f32 v172, v164, v165
 v_cvt_pk_bf16_f32 v161, v98, v99
 v_cvt_pk_bf16_f32 v163, v106, v107
 v_lshlrev_b32 v160, 16, v161
 v_and_b32 v161, 0xffff0000, v161
 v_mul_f32 v164, v160, v160
 v_mul_f32 v165, v161, v161
 v_fmamk_f32 v164, v164, 0xbdd2d3e8, v26
 v_fmamk_f32 v165, v165, 0xbdd2d3e8, v26
 v_mul_f32 v164, v164, v160
 v_mul_f32 v165, v165, v161
 v_exp_f32 v164, v164
 v_exp_f32 v165, v165
 v_lshlrev_b32 v162, 16, v163
 v_add_f32 v164, 1.0, v164
 v_add_f32 v165, 1.0, v165
 v_rcp_f32 v164, v164
 v_rcp_f32 v165, v165
 v_and_b32 v163, 0xffff0000, v163
 v_mul_f32 v164, v164, v160
 v_mul_f32 v165, v165, v161
 v_cvt_pk_bf16_f32 v165, v164, v165
 v_lshlrev_b32 v164, 16, v165
 v_and_b32 v165, 0xffff0000, v165
 v_mul_f32 v164, v164, v162
 v_mul_f32 v165, v165, v163
 v_cvt_pk_bf16_f32 v173, v164, v165
 v_cvt_pk_bf16_f32 v161, v100, v101
 v_cvt_pk_bf16_f32 v163, v108, v109
 v_lshlrev_b32 v160, 16, v161
 v_and_b32 v161, 0xffff0000, v161
 v_mul_f32 v164, v160, v160
 v_mul_f32 v165, v161, v161
 v_fmamk_f32 v164, v164, 0xbdd2d3e8, v26
 v_fmamk_f32 v165, v165, 0xbdd2d3e8, v26
 v_mul_f32 v164, v164, v160
 v_mul_f32 v165, v165, v161
 v_exp_f32 v164, v164
 v_exp_f32 v165, v165
 v_lshlrev_b32 v162, 16, v163
 v_add_f32 v164, 1.0, v164
 v_add_f32 v165, 1.0, v165
 v_rcp_f32 v164, v164
 v_rcp_f32 v165, v165
 v_and_b32 v163, 0xffff0000, v163
 v_mul_f32 v164, v164, v160
 v_mul_f32 v165, v165, v161
 v_cvt_pk_bf16_f32 v165, v164, v165
 v_lshlrev_b32 v164, 16, v165
 v_and_b32 v165, 0xffff0000, v165
 v_mul_f32 v164, v164, v162
 v_mul_f32 v165, v165, v163
 v_cvt_pk_bf16_f32 v174, v164, v165
 v_cvt_pk_bf16_f32 v161, v102, v103
 v_cvt_pk_bf16_f32 v163, v110, v111
 v_lshlrev_b32 v160, 16, v161
 v_and_b32 v161, 0xffff0000, v161
 v_mul_f32 v164, v160, v160
 v_mul_f32 v165, v161, v161
 v_fmamk_f32 v164, v164, 0xbdd2d3e8, v26
 v_fmamk_f32 v165, v165, 0xbdd2d3e8, v26
 v_mul_f32 v164, v164, v160
 v_mul_f32 v165, v165, v161
 v_exp_f32 v164, v164
 v_exp_f32 v165, v165
 v_lshlrev_b32 v162, 16, v163
 v_add_f32 v164, 1.0, v164
 v_add_f32 v165, 1.0, v165
 v_rcp_f32 v164, v164
 v_rcp_f32 v165, v165
 v_and_b32 v163, 0xffff0000, v163
 v_mul_f32 v164, v164, v160
 v_mul_f32 v165, v165, v161
 v_cvt_pk_bf16_f32 v165, v164, v165
 v_lshlrev_b32 v164, 16, v165
 v_and_b32 v165, 0xffff0000, v165
 v_mul_f32 v164, v164, v162
 v_mul_f32 v165, v165, v163
 v_cvt_pk_bf16_f32 v175, v164, v165
 s_add_u32 s38, s34, 1024
 buffer_store_dwordx4 v[172:175], v25, s[16:19], s38 offen sc0 sc1
 v_cvt_pk_bf16_f32 v177, v112, v113
 v_cvt_pk_bf16_f32 v179, v120, v121
 v_lshlrev_b32 v176, 16, v177
 v_and_b32 v177, 0xffff0000, v177
 v_mul_f32 v180, v176, v176
 v_mul_f32 v181, v177, v177
 v_fmamk_f32 v180, v180, 0xbdd2d3e8, v26
 v_fmamk_f32 v181, v181, 0xbdd2d3e8, v26
 v_mul_f32 v180, v180, v176
 v_mul_f32 v181, v181, v177
 v_exp_f32 v180, v180
 v_exp_f32 v181, v181
 v_lshlrev_b32 v178, 16, v179
 v_add_f32 v180, 1.0, v180
 v_add_f32 v181, 1.0, v181
 v_rcp_f32 v180, v180
 v_rcp_f32 v181, v181
 v_and_b32 v179, 0xffff0000, v179
 v_mul_f32 v180, v180, v176
 v_mul_f32 v181, v181, v177
 v_cvt_pk_bf16_f32 v181, v180, v181
 v_lshlrev_b32 v180, 16, v181
 v_and_b32 v181, 0xffff0000, v181
 v_mul_f32 v180, v180, v178
 v_mul_f32 v181, v181, v179
 v_cvt_pk_bf16_f32 v188, v180, v181
 v_cvt_pk_bf16_f32 v177, v114, v115
 v_cvt_pk_bf16_f32 v179, v122, v123
 v_lshlrev_b32 v176, 16, v177
 v_and_b32 v177, 0xffff0000, v177
 v_mul_f32 v180, v176, v176
 v_mul_f32 v181, v177, v177
 v_fmamk_f32 v180, v180, 0xbdd2d3e8, v26
 v_fmamk_f32 v181, v181, 0xbdd2d3e8, v26
 v_mul_f32 v180, v180, v176
 v_mul_f32 v181, v181, v177
 v_exp_f32 v180, v180
 v_exp_f32 v181, v181
 v_lshlrev_b32 v178, 16, v179
 v_add_f32 v180, 1.0, v180
 v_add_f32 v181, 1.0, v181
 v_rcp_f32 v180, v180
 v_rcp_f32 v181, v181
 v_and_b32 v179, 0xffff0000, v179
 v_mul_f32 v180, v180, v176
 v_mul_f32 v181, v181, v177
 v_cvt_pk_bf16_f32 v181, v180, v181
 v_lshlrev_b32 v180, 16, v181
 v_and_b32 v181, 0xffff0000, v181
 v_mul_f32 v180, v180, v178
 v_mul_f32 v181, v181, v179
 v_cvt_pk_bf16_f32 v189, v180, v181
 v_cvt_pk_bf16_f32 v177, v116, v117
 v_cvt_pk_bf16_f32 v179, v124, v125
 v_lshlrev_b32 v176, 16, v177
 v_and_b32 v177, 0xffff0000, v177
 v_mul_f32 v180, v176, v176
 v_mul_f32 v181, v177, v177
 v_fmamk_f32 v180, v180, 0xbdd2d3e8, v26
 v_fmamk_f32 v181, v181, 0xbdd2d3e8, v26
 v_mul_f32 v180, v180, v176
 v_mul_f32 v181, v181, v177
 v_exp_f32 v180, v180
 v_exp_f32 v181, v181
 v_lshlrev_b32 v178, 16, v179
 v_add_f32 v180, 1.0, v180
 v_add_f32 v181, 1.0, v181
 v_rcp_f32 v180, v180
 v_rcp_f32 v181, v181
 v_and_b32 v179, 0xffff0000, v179
 v_mul_f32 v180, v180, v176
 v_mul_f32 v181, v181, v177
 v_cvt_pk_bf16_f32 v181, v180, v181
 v_lshlrev_b32 v180, 16, v181
 v_and_b32 v181, 0xffff0000, v181
 v_mul_f32 v180, v180, v178
 v_mul_f32 v181, v181, v179
 v_cvt_pk_bf16_f32 v190, v180, v181
 v_cvt_pk_bf16_f32 v177, v118, v119
 v_cvt_pk_bf16_f32 v179, v126, v127
 v_lshlrev_b32 v176, 16, v177
 v_and_b32 v177, 0xffff0000, v177
 v_mul_f32 v180, v176, v176
 v_mul_f32 v181, v177, v177
 v_fmamk_f32 v180, v180, 0xbdd2d3e8, v26
 v_fmamk_f32 v181, v181, 0xbdd2d3e8, v26
 v_mul_f32 v180, v180, v176
 v_mul_f32 v181, v181, v177
 v_exp_f32 v180, v180
 v_exp_f32 v181, v181
 v_lshlrev_b32 v178, 16, v179
 v_add_f32 v180, 1.0, v180
 v_add_f32 v181, 1.0, v181
 v_rcp_f32 v180, v180
 v_rcp_f32 v181, v181
 v_and_b32 v179, 0xffff0000, v179
 v_mul_f32 v180, v180, v176
 v_mul_f32 v181, v181, v177
 v_cvt_pk_bf16_f32 v181, v180, v181
 v_lshlrev_b32 v180, 16, v181
 v_and_b32 v181, 0xffff0000, v181
 v_mul_f32 v180, v180, v178
 v_mul_f32 v181, v181, v179
 v_cvt_pk_bf16_f32 v191, v180, v181
 s_add_u32 s38, s34, 1536
 buffer_store_dwordx4 v[188:191], v25, s[16:19], s38 offen sc0 sc1
 s_barrier
 v_cvt_pk_bf16_f32 v161, v128, v129
 v_cvt_pk_bf16_f32 v163, v136, v137
 v_lshlrev_b32 v160, 16, v161
 v_and_b32 v161, 0xffff0000, v161
 v_mul_f32 v164, v160, v160
 v_mul_f32 v165, v161, v161
 v_fmamk_f32 v164, v164, 0xbdd2d3e8, v26
 v_fmamk_f32 v165, v165, 0xbdd2d3e8, v26
 v_mul_f32 v164, v164, v160
 v_mul_f32 v165, v165, v161
 v_exp_f32 v164, v164
 v_exp_f32 v165, v165
 v_lshlrev_b32 v162, 16, v163
 v_add_f32 v164, 1.0, v164
 v_add_f32 v165, 1.0, v165
 v_rcp_f32 v164, v164
 v_rcp_f32 v165, v165
 v_and_b32 v163, 0xffff0000, v163
 v_mul_f32 v164, v164, v160
 v_mul_f32 v165, v165, v161
 v_cvt_pk_bf16_f32 v165, v164, v165
 v_lshlrev_b32 v164, 16, v165
 v_and_b32 v165, 0xffff0000, v165
 v_mul_f32 v164, v164, v162
 v_mul_f32 v165, v165, v163
 v_cvt_pk_bf16_f32 v172, v164, v165
 v_cvt_pk_bf16_f32 v161, v130, v131
 v_cvt_pk_bf16_f32 v163, v138, v139
 v_lshlrev_b32 v160, 16, v161
 v_and_b32 v161, 0xffff0000, v161
 v_mul_f32 v164, v160, v160
 v_mul_f32 v165, v161, v161
 v_fmamk_f32 v164, v164, 0xbdd2d3e8, v26
 v_fmamk_f32 v165, v165, 0xbdd2d3e8, v26
 v_mul_f32 v164, v164, v160
 v_mul_f32 v165, v165, v161
 v_exp_f32 v164, v164
 v_exp_f32 v165, v165
 v_lshlrev_b32 v162, 16, v163
 v_add_f32 v164, 1.0, v164
 v_add_f32 v165, 1.0, v165
 v_rcp_f32 v164, v164
 v_rcp_f32 v165, v165
 v_and_b32 v163, 0xffff0000, v163
 v_mul_f32 v164, v164, v160
 v_mul_f32 v165, v165, v161
 v_cvt_pk_bf16_f32 v165, v164, v165
 v_lshlrev_b32 v164, 16, v165
 v_and_b32 v165, 0xffff0000, v165
 v_mul_f32 v164, v164, v162
 v_mul_f32 v165, v165, v163
 v_cvt_pk_bf16_f32 v173, v164, v165
 v_cvt_pk_bf16_f32 v161, v132, v133
 v_cvt_pk_bf16_f32 v163, v140, v141
 v_lshlrev_b32 v160, 16, v161
 v_and_b32 v161, 0xffff0000, v161
 v_mul_f32 v164, v160, v160
 v_mul_f32 v165, v161, v161
 v_fmamk_f32 v164, v164, 0xbdd2d3e8, v26
 v_fmamk_f32 v165, v165, 0xbdd2d3e8, v26
 v_mul_f32 v164, v164, v160
 v_mul_f32 v165, v165, v161
 v_exp_f32 v164, v164
 v_exp_f32 v165, v165
 v_lshlrev_b32 v162, 16, v163
 v_add_f32 v164, 1.0, v164
 v_add_f32 v165, 1.0, v165
 v_rcp_f32 v164, v164
 v_rcp_f32 v165, v165
 v_and_b32 v163, 0xffff0000, v163
 v_mul_f32 v164, v164, v160
 v_mul_f32 v165, v165, v161
 v_cvt_pk_bf16_f32 v165, v164, v165
 v_lshlrev_b32 v164, 16, v165
 v_and_b32 v165, 0xffff0000, v165
 v_mul_f32 v164, v164, v162
 v_mul_f32 v165, v165, v163
 v_cvt_pk_bf16_f32 v174, v164, v165
 v_cvt_pk_bf16_f32 v161, v134, v135
 v_cvt_pk_bf16_f32 v163, v142, v143
 v_lshlrev_b32 v160, 16, v161
 v_and_b32 v161, 0xffff0000, v161
 v_mul_f32 v164, v160, v160
 v_mul_f32 v165, v161, v161
 v_fmamk_f32 v164, v164, 0xbdd2d3e8, v26
 v_fmamk_f32 v165, v165, 0xbdd2d3e8, v26
 v_mul_f32 v164, v164, v160
 v_mul_f32 v165, v165, v161
 v_exp_f32 v164, v164
 v_exp_f32 v165, v165
 v_lshlrev_b32 v162, 16, v163
 v_add_f32 v164, 1.0, v164
 v_add_f32 v165, 1.0, v165
 v_rcp_f32 v164, v164
 v_rcp_f32 v165, v165
 v_and_b32 v163, 0xffff0000, v163
 v_mul_f32 v164, v164, v160
 v_mul_f32 v165, v165, v161
 v_cvt_pk_bf16_f32 v165, v164, v165
 v_lshlrev_b32 v164, 16, v165
 v_and_b32 v165, 0xffff0000, v165
 v_mul_f32 v164, v164, v162
 v_mul_f32 v165, v165, v163
 v_cvt_pk_bf16_f32 v175, v164, v165
 s_add_u32 s38, s33, 0
 buffer_store_dwordx4 v[172:175], v25, s[16:19], s38 offen sc0 sc1
 v_cvt_pk_bf16_f32 v177, v144, v145
 v_cvt_pk_bf16_f32 v179, v152, v153
 v_lshlrev_b32 v176, 16, v177
 v_and_b32 v177, 0xffff0000, v177
 v_mul_f32 v180, v176, v176
 v_mul_f32 v181, v177, v177
 v_fmamk_f32 v180, v180, 0xbdd2d3e8, v26
 v_fmamk_f32 v181, v181, 0xbdd2d3e8, v26
 v_mul_f32 v180, v180, v176
 v_mul_f32 v181, v181, v177
 v_exp_f32 v180, v180
 v_exp_f32 v181, v181
 v_lshlrev_b32 v178, 16, v179
 v_add_f32 v180, 1.0, v180
 v_add_f32 v181, 1.0, v181
 v_rcp_f32 v180, v180
 v_rcp_f32 v181, v181
 v_and_b32 v179, 0xffff0000, v179
 v_mul_f32 v180, v180, v176
 v_mul_f32 v181, v181, v177
 v_cvt_pk_bf16_f32 v181, v180, v181
 v_lshlrev_b32 v180, 16, v181
 v_and_b32 v181, 0xffff0000, v181
 v_mul_f32 v180, v180, v178
 v_mul_f32 v181, v181, v179
 v_cvt_pk_bf16_f32 v188, v180, v181
 v_cvt_pk_bf16_f32 v177, v146, v147
 v_cvt_pk_bf16_f32 v179, v154, v155
 v_lshlrev_b32 v176, 16, v177
 v_and_b32 v177, 0xffff0000, v177
 v_mul_f32 v180, v176, v176
 v_mul_f32 v181, v177, v177
 v_fmamk_f32 v180, v180, 0xbdd2d3e8, v26
 v_fmamk_f32 v181, v181, 0xbdd2d3e8, v26
 v_mul_f32 v180, v180, v176
 v_mul_f32 v181, v181, v177
 v_exp_f32 v180, v180
 v_exp_f32 v181, v181
 v_lshlrev_b32 v178, 16, v179
 v_add_f32 v180, 1.0, v180
 v_add_f32 v181, 1.0, v181
 v_rcp_f32 v180, v180
 v_rcp_f32 v181, v181
 v_and_b32 v179, 0xffff0000, v179
 v_mul_f32 v180, v180, v176
 v_mul_f32 v181, v181, v177
 v_cvt_pk_bf16_f32 v181, v180, v181
 v_lshlrev_b32 v180, 16, v181
 v_and_b32 v181, 0xffff0000, v181
 v_mul_f32 v180, v180, v178
 v_mul_f32 v181, v181, v179
 v_cvt_pk_bf16_f32 v189, v180, v181
 v_cvt_pk_bf16_f32 v177, v148, v149
 v_cvt_pk_bf16_f32 v179, v156, v157
 v_lshlrev_b32 v176, 16, v177
 v_and_b32 v177, 0xffff0000, v177
 v_mul_f32 v180, v176, v176
 v_mul_f32 v181, v177, v177
 v_fmamk_f32 v180, v180, 0xbdd2d3e8, v26
 v_fmamk_f32 v181, v181, 0xbdd2d3e8, v26
 v_mul_f32 v180, v180, v176
 v_mul_f32 v181, v181, v177
 v_exp_f32 v180, v180
 v_exp_f32 v181, v181
 v_lshlrev_b32 v178, 16, v179
 v_add_f32 v180, 1.0, v180
 v_add_f32 v181, 1.0, v181
 v_rcp_f32 v180, v180
 v_rcp_f32 v181, v181
 v_and_b32 v179, 0xffff0000, v179
 v_mul_f32 v180, v180, v176
 v_mul_f32 v181, v181, v177
 v_cvt_pk_bf16_f32 v181, v180, v181
 v_lshlrev_b32 v180, 16, v181
 v_and_b32 v181, 0xffff0000, v181
 v_mul_f32 v180, v180, v178
 v_mul_f32 v181, v181, v179
 v_cvt_pk_bf16_f32 v190, v180, v181
 v_cvt_pk_bf16_f32 v177, v150, v151
 v_cvt_pk_bf16_f32 v179, v158, v159
 v_lshlrev_b32 v176, 16, v177
 v_and_b32 v177, 0xffff0000, v177
 v_mul_f32 v180, v176, v176
 v_mul_f32 v181, v177, v177
 v_fmamk_f32 v180, v180, 0xbdd2d3e8, v26
 v_fmamk_f32 v181, v181, 0xbdd2d3e8, v26
 v_mul_f32 v180, v180, v176
 v_mul_f32 v181, v181, v177
 v_exp_f32 v180, v180
 v_exp_f32 v181, v181
 v_lshlrev_b32 v178, 16, v179
 v_add_f32 v180, 1.0, v180
 v_add_f32 v181, 1.0, v181
 v_rcp_f32 v180, v180
 v_rcp_f32 v181, v181
 v_and_b32 v179, 0xffff0000, v179
 v_mul_f32 v180, v180, v176
 v_mul_f32 v181, v181, v177
 v_cvt_pk_bf16_f32 v181, v180, v181
 v_lshlrev_b32 v180, 16, v181
 v_and_b32 v181, 0xffff0000, v181
 v_mul_f32 v180, v180, v178
 v_mul_f32 v181, v181, v179
 v_cvt_pk_bf16_f32 v191, v180, v181
 s_add_u32 s38, s33, 512
 buffer_store_dwordx4 v[188:191], v25, s[16:19], s38 offen sc0 sc1
 v_lshrrev_b32 v35, 4, v1
 v_bfe_u32 v36, v1, 2, 2
 v_and_b32 v37, 3, v1
 v_lshrrev_b32 v38, 1, v35
 v_lshlrev_b32 v38, 4, v38
 v_and_b32 v39, 1, v35
 v_lshl_add_u32 v38, v39, 2, v38
 v_add_u32 v38, v38, v36
 v_lshl_add_u32 v39, v35, 3, v36
 v_lshlrev_b32 v37, 3, v37
 s_mul_i32 s31, s20, 3072
 s_add_u32 s31, s31, 102592
 v_add_u32 v37, s31, v37
 v_lshl_add_u32 v38, v38, 5, v37
 v_lshl_add_u32 v39, v39, 5, v37
 v_add_u32 v35, 256, v38
 v_add_u32 v36, 128, v39
 v_lshlrev_b32 v160, 4, v1
 s_waitcnt vmcnt(6)
 s_cmp_lt_u32 s80, 54
 s_cselect_b64 vcc, -1, 0
 s_nop 1
 v_cndmask_b32 v161, v39, v38, vcc
 v_cndmask_b32 v162, v36, v35, vcc
 ds_read_b64_tr_b16 v[164:165], v161 offset:0
 ds_read_b64_tr_b16 v[166:167], v162 offset:0
 s_cmp_lt_u32 s82, 54
 s_cselect_b64 vcc, -1, 0
 s_nop 1
 v_cndmask_b32 v161, v39, v38, vcc
 v_cndmask_b32 v162, v36, v35, vcc
 ds_read_b64_tr_b16 v[168:169], v161 offset:1024
 ds_read_b64_tr_b16 v[170:171], v162 offset:1024
 s_cmp_lt_u32 s84, 54
 s_cselect_b64 vcc, -1, 0
 s_nop 1
 v_cndmask_b32 v161, v39, v38, vcc
 v_cndmask_b32 v162, v36, v35, vcc
 ds_read_b64_tr_b16 v[172:173], v161 offset:2048
 ds_read_b64_tr_b16 v[174:175], v162 offset:2048
 s_mul_hi_u32 s24, s81, 858993460
 s_mul_i32 s25, s24, 5
 s_sub_u32 s25, s81, s25
 s_mul_i32 s24, s24, 74
 s_add_u32 s24, s24, s80
 s_mul_i32 s24, s24, 5120
 s_lshl_b32 s25, s25, 10
 s_add_u32 s24, s24, s25
 s_add_u32 s24, s24, 12582912
 s_waitcnt lgkmcnt(4)
 buffer_store_dwordx4 v[164:167], v160, s[16:19], s24 offen sc0 sc1
 s_mul_hi_u32 s24, s83, 858993460
 s_mul_i32 s25, s24, 5
 s_sub_u32 s25, s83, s25
 s_mul_i32 s24, s24, 74
 s_add_u32 s24, s24, s82
 s_mul_i32 s24, s24, 5120
 s_lshl_b32 s25, s25, 10
 s_add_u32 s24, s24, s25
 s_add_u32 s24, s24, 12582912
 s_waitcnt lgkmcnt(2)
 buffer_store_dwordx4 v[168:171], v160, s[16:19], s24 offen sc0 sc1
 s_mul_hi_u32 s24, s85, 858993460
 s_mul_i32 s25, s24, 5
 s_sub_u32 s25, s85, s25
 s_mul_i32 s24, s24, 74
 s_add_u32 s24, s24, s84
 s_mul_i32 s24, s24, 5120
 s_lshl_b32 s25, s25, 10
 s_add_u32 s24, s24, s25
 s_add_u32 s24, s24, 12582912
 s_waitcnt lgkmcnt(0)
 buffer_store_dwordx4 v[172:175], v160, s[16:19], s24 offen sc0 sc1
 s_endpgm
L_k1_F:
 s_lshl_b32 s23, s25, 1
 s_add_u32 s23, s23, 12
 s_add_u32 s99, s23, 1
 s_mov_b32 s96, 26
 s_and_b32 s97, s25, 1
 s_lshl_b32 s97, s97, 1
 s_cmp_ge_u32 s25, 2
 s_cbranch_scc1 L_k1_F2
 v_and_b32 v1, 63, v0
 v_lshrrev_b32 v35, 3, v1
 v_and_b32 v36, 7, v1
 v_lshrrev_b32 v37, 4, v1
 v_xor_b32 v37, v36, v37
 v_lshlrev_b32 v37, 4, v37
 s_lshl_b32 s24, s21, 7
 s_lshl_b32 s25, s98, 4
 s_add_u32 s24, s24, s25
 v_add_u32 v38, s24, v35
 v_mul_u32_u24 v38, 1280, v38
 v_add_u32 v2, v38, v37
 v_xor_b32 v37, 64, v37
 v_add_u32 v3, v38, v37
 v_add_u32 v3, 10240, v3
 s_lshl_b32 s36, s98, 11
 s_add_u32 s36, s36, 112640
 s_lshl_b32 s35, s98, 10
 v_lshrrev_b32 v35, 3, v1
 v_and_b32 v36, 7, v1
 v_bfe_u32 v37, v1, 4, 1
 v_lshlrev_b32 v37, 1, v37
 v_xor_b32 v37, v37, v36
 s_and_b32 s24, s98, 4
 v_xor_b32 v37, s24, v37
 v_lshlrev_b32 v37, 4, v37
 s_lshl_b32 s24, s20, 3
 v_add_u32 v35, s24, v35
 v_mul_u32_u24 v35, 3456, v35
 v_add_u32 v8, v35, v37
 s_lshl_b32 s88, s23, 7
 s_cmp_lt_u32 s98, 4
 s_cselect_b32 s40, s8, s12
 s_cselect_b32 s41, s9, s13
 s_mov_b32 s42, 2211840
 s_mov_b32 s43, 0x00020000
 v_lshrrev_b32 v35, 3, v1
 v_and_b32 v36, 7, v1
 v_bfe_u32 v37, v1, 4, 1
 v_lshlrev_b32 v37, 1, v37
 v_xor_b32 v37, v37, v36
 s_and_b32 s24, s98, 4
 v_xor_b32 v37, s24, v37
 v_lshlrev_b32 v37, 4, v37
 s_lshl_b32 s24, s20, 3
 v_add_u32 v35, s24, v35
 v_mul_u32_u24 v35, 3456, v35
 v_add_u32 v9, v35, v37
 s_lshl_b32 s89, s99, 7
 s_cmp_lt_u32 s98, 4
 s_cselect_b32 s56, s8, s12
 s_cselect_b32 s57, s9, s13
 s_mov_b32 s58, 2211840
 s_mov_b32 s59, 0x00020000
 v_lshrrev_b32 v35, 2, v1
 v_and_b32 v36, 3, v1
 s_and_b32 s24, s98, 2
 v_xor_b32 v36, s24, v36
 s_and_b32 s24, s98, 1
 s_lshl_b32 s24, s24, 4
 v_add_u32 v35, s24, v35
 v_mul_u32_u24 v35, 3456, v35
 v_lshl_add_u32 v10, v36, 4, v35
 s_lshl_b32 s90, s96, 7
 s_lshl_b32 s24, s97, 5
 s_add_u32 s90, s90, s24
 s_mov_b32 s63, 110592
 s_add_u32 s62, s35, 16384
 s_cmp_lt_u32 s98, 2
 s_cselect_b32 s80, s8, s12
 s_cselect_b32 s81, s9, s13
 s_mov_b32 s82, 2211840
 s_mov_b32 s83, 0x00020000
 s_cmp_ge_u32 s98, 4
 s_cselect_b64 vcc, -1, 0
 v_mov_b32 v36, 0x80000000
 s_nop 0
 v_cndmask_b32 v10, v10, v36, vcc
 s_cmp_ge_u32 s98, 4
 s_cbranch_scc1 L3_C_h1
 s_and_b32 s74, s35, 1024
 s_add_u32 s74, s74, 161792
 s_add_u32 m0, s36, 0
 s_movk_i32 s37, 0
 buffer_load_dwordx4 v2, s[4:7], s37 offen lds
 s_add_u32 m0, s36, 1024
 s_movk_i32 s37, 0
 buffer_load_dwordx4 v3, s[4:7], s37 offen lds
 s_add_u32 m0, s35, 0
 s_add_u32 s37, s88, 0
 buffer_load_dwordx4 v8, s[40:43], s37 offen lds
 s_add_u32 m0, s35, 8192
 s_add_u32 s37, s89, 0
 buffer_load_dwordx4 v9, s[56:59], s37 offen lds
 s_add_u32 s37, s62, 0
 s_cmp_lt_u32 s98, 4
 s_cselect_b32 m0, s37, s74
 s_nop 0
 buffer_load_dwordx4 v10, s[80:83], s90 offen lds
 s_add_u32 s90, s90, s63
 s_add_u32 m0, s35, 22528
 s_add_u32 s37, s88, 110592
 buffer_load_dwordx4 v8, s[40:43], s37 offen lds
 s_add_u32 m0, s35, 30720
 s_add_u32 s37, s89, 110592
 buffer_load_dwordx4 v9, s[56:59], s37 offen lds
 s_add_u32 s37, s62, 22528
 s_cmp_lt_u32 s98, 4
 s_cselect_b32 m0, s37, s74
 s_nop 0
 buffer_load_dwordx4 v10, s[80:83], s90 offen lds
 s_add_u32 s90, s90, s63
 s_add_u32 m0, s36, 16384
 s_movk_i32 s37, 128
 buffer_load_dwordx4 v2, s[4:7], s37 offen lds
 s_add_u32 m0, s36, 17408
 s_movk_i32 s37, 128
 buffer_load_dwordx4 v3, s[4:7], s37 offen lds
 s_add_u32 m0, s35, 45056
 s_add_u32 s37, s88, 221184
 buffer_load_dwordx4 v8, s[40:43], s37 offen lds
 s_add_u32 m0, s35, 53248
 s_add_u32 s37, s89, 221184
 buffer_load_dwordx4 v9, s[56:59], s37 offen lds
 s_add_u32 s37, s62, 45056
 s_cmp_lt_u32 s98, 4
 s_cselect_b32 m0, s37, s74
 s_nop 0
 buffer_load_dwordx4 v10, s[80:83], s90 offen lds
 s_add_u32 s90, s90, s63
 v_and_b32 v35, 31, v1
 v_lshrrev_b32 v36, 5, v1
 v_bfe_u32 v37, v1, 1, 3
 v_xor_b32 v37, v37, v36
 v_lshlrev_b32 v38, 7, v35
 s_lshl_b32 s24, s20, 12
 s_add_u32 s24, s24, 112640
 v_add_u32 v38, s24, v38
 v_xor_b32 v39, 0, v37
 v_lshl_add_u32 v4, v39, 4, v38
 v_xor_b32 v39, 2, v37
 v_lshl_add_u32 v5, v39, 4, v38
 v_xor_b32 v39, 4, v37
 v_lshl_add_u32 v6, v39, 4, v38
 v_xor_b32 v39, 6, v37
 v_lshl_add_u32 v7, v39, 4, v38
 v_bfe_u32 v35, v1, 4, 1
 v_lshrrev_b32 v36, 5, v1
 v_bfe_u32 v37, v1, 2, 2
 v_and_b32 v38, 3, v1
 v_lshlrev_b32 v39, 12, v35
 v_lshl_add_u32 v39, v36, 10, v39
 v_lshl_add_u32 v39, v37, 7, v39
 v_lshl_add_u32 v39, v38, 3, v39
 v_lshrrev_b32 v37, 1, v37
 v_lshl_or_b32 v37, v35, 1, v37
 v_xor_b32 v38, 0, v37
 v_lshl_add_u32 v17, v38, 5, v39
 v_add_u32 v21, 0x10000, v17
 v_xor_b32 v38, 1, v37
 v_lshl_add_u32 v18, v38, 5, v39
 v_add_u32 v22, 0x10000, v18
 v_xor_b32 v38, 2, v37
 v_lshl_add_u32 v19, v38, 5, v39
 v_add_u32 v23, 0x10000, v19
 v_xor_b32 v38, 3, v37
 v_lshl_add_u32 v20, v38, 5, v39
 v_add_u32 v24, 0x10000, v20
 s_lshl_b32 s24, s20, 1
 v_add_u32 v35, s24, v35
 s_mov_b32 s25, 55296
 v_mul_lo_u32 v35, v35, s25
 v_and_b32 v37, 15, v1
 v_lshl_add_u32 v37, v36, 4, v37
 v_lshl_add_u32 v25, v37, 4, v35
 s_mul_i32 s34, s21, 442368
 s_add_u32 s34, s34, 0
 s_lshl_b32 s24, s96, 11
 s_add_u32 s33, s34, s24
 s_lshl_b32 s24, s97, 9
 s_add_u32 s33, s33, s24
 s_lshl_b32 s24, s23, 11
 s_add_u32 s34, s34, s24
 v_mov_b32 v26, 0xc0135761
 v_mov_b32 v244, 0xbdd2d3e8
 v_mov_b32 v245, 0xbdd2d3e8
 v_mov_b32 v246, 0xc0135761
 v_mov_b32 v247, 0xc0135761
 v_bfe_u32 v35, v1, 4, 1
 v_bfe_u32 v37, v1, 2, 2
 v_and_b32 v38, 3, v1
 v_lshlrev_b32 v39, 11, v35
 v_lshl_add_u32 v39, v36, 9, v39
 v_lshl_add_u32 v39, v37, 6, v39
 v_lshl_add_u32 v39, v38, 3, v39
 v_lshl_add_u32 v252, v35, 5, v39
 v_xor_b32 v253, 32, v252
 v_add_u32 v254, 0x10000, v252
 v_add_u32 v255, 0x10000, v253
 s_waitcnt vmcnt(8)
 s_barrier
 ds_read_b128 v[176:179], v4 offset:0
 ds_read_b128 v[180:183], v5 offset:0
 ds_read_b64_tr_b16 v[40:41], v17 offset:0
 ds_read_b64_tr_b16 v[42:43], v17 offset:512
 s_add_u32 m0, s35, 67584
 s_add_u32 s37, s88, 331776
 buffer_load_dwordx4 v8, s[40:43], s37 offen lds
 ds_read_b64_tr_b16 v[44:45], v18 offset:0
 ds_read_b64_tr_b16 v[46:47], v18 offset:512
 s_add_u32 m0, s35, 75776
 s_add_u32 s37, s89, 331776
 buffer_load_dwordx4 v9, s[56:59], s37 offen lds
 ds_read_b64_tr_b16 v[48:49], v19 offset:0
 ds_read_b64_tr_b16 v[50:51], v19 offset:512
 s_add_u32 s37, s62, 67584
 s_cmp_lt_u32 s98, 4
 s_cselect_b32 m0, s37, s74
 s_nop 0
 buffer_load_dwordx4 v10, s[80:83], s90 offen lds
 s_add_u32 s90, s90, s63
 s_waitcnt lgkmcnt(4)
 v_mfma_f32_32x32x16_bf16 v[64:79], v[40:43], v[176:179], 0
 ds_read_b64_tr_b16 v[52:53], v20 offset:0
 ds_read_b64_tr_b16 v[54:55], v20 offset:512
 s_mov_b32 s84, s54
 s_mov_b32 s85, s55
 s_mov_b32 s86, 1280
 s_waitcnt lgkmcnt(4)
 v_mfma_f32_32x32x16_bf16 v[80:95], v[44:47], v[176:179], 0
 ds_read_b64_tr_b16 v[56:57], v17 offset:2048
 ds_read_b64_tr_b16 v[58:59], v17 offset:2560
 s_mov_b32 s87, 0x00020000
 s_lshl_b32 s24, s2, 3
 s_lshl_b32 s25, s20, 1
 s_waitcnt lgkmcnt(4)
 v_mfma_f32_32x32x16_bf16 v[96:111], v[48:51], v[176:179], 0
 ds_read_b64_tr_b16 v[60:61], v18 offset:2048
 ds_read_b64_tr_b16 v[62:63], v18 offset:2560
 s_add_u32 s24, s24, s25
 v_lshrrev_b32 v35, 5, v1
 v_add_u32 v216, s24, v35
 s_waitcnt lgkmcnt(4)
 v_mfma_f32_32x32x16_bf16 v[112:127], v[52:55], v[176:179], 0
 ds_read_b64_tr_b16 v[40:41], v19 offset:2048
 ds_read_b64_tr_b16 v[42:43], v19 offset:2560
 v_mul_u32_u24 v35, 1280, v216
 v_and_b32 v36, 31, v1
 v_lshlrev_b32 v36, 4, v36
 s_waitcnt lgkmcnt(4)
 v_mfma_f32_32x32x16_bf16 v[64:79], v[56:59], v[180:183], v[64:79]
 ds_read_b64_tr_b16 v[44:45], v20 offset:2048
 ds_read_b64_tr_b16 v[46:47], v20 offset:2560
 v_add_u32 v35, v35, v36
 v_mov_b32 v37, 0x80000000
 v_cmp_gt_u32 vcc, 256, v36
 s_waitcnt lgkmcnt(4)
 v_mfma_f32_32x32x16_bf16 v[80:95], v[60:63], v[180:183], v[80:95]
 s_waitcnt vmcnt(8)
 s_barrier
 ds_read_b128 v[184:187], v6 offset:0
 ds_read_b128 v[188:191], v7 offset:0
 ds_read_b64_tr_b16 v[48:49], v17 offset:22528
 ds_read_b64_tr_b16 v[50:51], v17 offset:23040
 s_add_u32 m0, s35, 90112
 s_add_u32 s37, s88, 442368
 buffer_load_dwordx4 v8, s[40:43], s37 offen lds
 s_waitcnt lgkmcnt(6)
 v_mfma_f32_32x32x16_bf16 v[96:111], v[40:43], v[180:183], v[96:111]
 ds_read_b64_tr_b16 v[52:53], v18 offset:22528
 ds_read_b64_tr_b16 v[54:55], v18 offset:23040
 s_add_u32 m0, s35, 98304
 s_add_u32 s37, s89, 442368
 buffer_load_dwordx4 v9, s[56:59], s37 offen lds
 s_waitcnt lgkmcnt(6)
 v_mfma_f32_32x32x16_bf16 v[112:127], v[44:47], v[180:183], v[112:127]
 ds_read_b64_tr_b16 v[56:57], v19 offset:22528
 ds_read_b64_tr_b16 v[58:59], v19 offset:23040
 s_add_u32 s37, s62, 90112
 s_cmp_lt_u32 s98, 4
 s_cselect_b32 m0, s37, s74
 s_nop 0
 buffer_load_dwordx4 v10, s[80:83], s90 offen lds
 s_add_u32 s90, s90, s63
 s_waitcnt lgkmcnt(4)
 v_mfma_f32_32x32x16_bf16 v[64:79], v[48:51], v[184:187], v[64:79]
 ds_read_b64_tr_b16 v[60:61], v20 offset:22528
 ds_read_b64_tr_b16 v[62:63], v20 offset:23040
 s_add_u32 m0, s36, 32768
 s_movk_i32 s37, 256
 buffer_load_dwordx4 v2, s[4:7], s37 offen lds
 s_waitcnt lgkmcnt(4)
 v_mfma_f32_32x32x16_bf16 v[80:95], v[52:55], v[184:187], v[80:95]
 ds_read_b64_tr_b16 v[40:41], v17 offset:24576
 ds_read_b64_tr_b16 v[42:43], v17 offset:25088
 s_add_u32 m0, s36, 33792
 s_movk_i32 s37, 256
 buffer_load_dwordx4 v3, s[4:7], s37 offen lds
 s_waitcnt lgkmcnt(4)
 v_mfma_f32_32x32x16_bf16 v[96:111], v[56:59], v[184:187], v[96:111]
 ds_read_b64_tr_b16 v[44:45], v18 offset:24576
 ds_read_b64_tr_b16 v[46:47], v18 offset:25088
 s_nop 1
 v_cndmask_b32 v38, v37, v35, vcc
 v_cndmask_b32 v39, v37, v36, vcc
 s_waitcnt lgkmcnt(4)
 v_mfma_f32_32x32x16_bf16 v[112:127], v[60:63], v[184:187], v[112:127]
 ds_read_b64_tr_b16 v[48:49], v19 offset:24576
 ds_read_b64_tr_b16 v[50:51], v19 offset:25088
 buffer_load_dwordx4 v[192:195], v35, s[4:7], 0 offen offset:0
 s_waitcnt lgkmcnt(4)
 v_mfma_f32_32x32x16_bf16 v[64:79], v[40:43], v[188:191], v[64:79]
 ds_read_b64_tr_b16 v[52:53], v20 offset:24576
 ds_read_b64_tr_b16 v[54:55], v20 offset:25088
 buffer_load_dwordx4 v[196:199], v36, s[84:87], 0 offen offset:0
 s_waitcnt lgkmcnt(4)
 v_mfma_f32_32x32x16_bf16 v[80:95], v[44:47], v[188:191], v[80:95]
 s_waitcnt vmcnt(10)
 s_barrier
 ds_read_b128 v[176:179], v4 offset:16384
 ds_read_b128 v[180:183], v5 offset:16384
 ds_read_b64_tr_b16 v[56:57], v17 offset:45056
 ds_read_b64_tr_b16 v[58:59], v17 offset:45568
 s_add_u32 m0, s35, 0
 s_add_u32 s37, s88, 552960
 buffer_load_dwordx4 v8, s[40:43], s37 offen lds
 s_waitcnt lgkmcnt(6)
 v_mfma_f32_32x32x16_bf16 v[96:111], v[48:51], v[188:191], v[96:111]
 ds_read_b64_tr_b16 v[60:61], v18 offset:45056
 ds_read_b64_tr_b16 v[62:63], v18 offset:45568
 s_add_u32 m0, s35, 8192
 s_add_u32 s37, s89, 552960
 buffer_load_dwordx4 v9, s[56:59], s37 offen lds
 s_waitcnt lgkmcnt(6)
 v_mfma_f32_32x32x16_bf16 v[112:127], v[52:55], v[188:191], v[112:127]
 ds_read_b64_tr_b16 v[40:41], v19 offset:45056
 ds_read_b64_tr_b16 v[42:43], v19 offset:45568
 s_add_u32 s37, s62, 0
 s_cmp_lt_u32 s98, 4
 s_cselect_b32 m0, s37, s74
 s_nop 0
 buffer_load_dwordx4 v10, s[80:83], s90 offen lds
 s_add_u32 s90, s90, s63
 s_waitcnt lgkmcnt(4)
 v_mfma_f32_32x32x16_bf16 v[64:79], v[56:59], v[176:179], v[64:79]
 ds_read_b64_tr_b16 v[44:45], v20 offset:45056
 ds_read_b64_tr_b16 v[46:47], v20 offset:45568
 buffer_load_dwordx4 v[200:203], v35, s[4:7], 0 offen offset:512
 s_waitcnt lgkmcnt(4)
 v_mfma_f32_32x32x16_bf16 v[80:95], v[60:63], v[176:179], v[80:95]
 ds_read_b64_tr_b16 v[48:49], v17 offset:47104
 ds_read_b64_tr_b16 v[50:51], v17 offset:47616
 buffer_load_dwordx4 v[204:207], v36, s[84:87], 0 offen offset:512
 s_waitcnt lgkmcnt(4)
 v_mfma_f32_32x32x16_bf16 v[96:111], v[40:43], v[176:179], v[96:111]
 ds_read_b64_tr_b16 v[52:53], v18 offset:47104
 ds_read_b64_tr_b16 v[54:55], v18 offset:47616
 buffer_load_dwordx4 v[208:211], v38, s[4:7], 0 offen offset:1024
 s_waitcnt lgkmcnt(4)
 v_mfma_f32_32x32x16_bf16 v[112:127], v[44:47], v[176:179], v[112:127]
 ds_read_b64_tr_b16 v[56:57], v19 offset:47104
 ds_read_b64_tr_b16 v[58:59], v19 offset:47616
 buffer_load_dwordx4 v[212:215], v39, s[84:87], 0 offen offset:1024
 s_waitcnt lgkmcnt(4)
 v_mfma_f32_32x32x16_bf16 v[64:79], v[48:51], v[180:183], v[64:79]
 ds_read_b64_tr_b16 v[60:61], v20 offset:47104
 ds_read_b64_tr_b16 v[62:63], v20 offset:47616
 s_mul_i32 s24, s2, 10240
 s_add_u32 s24, s24, 15728640
 s_add_u32 s25, s24, 4096
 s_waitcnt lgkmcnt(4)
 v_mfma_f32_32x32x16_bf16 v[80:95], v[52:55], v[180:183], v[80:95]
 s_waitcnt vmcnt(14)
 s_barrier
 ds_read_b128 v[184:187], v6 offset:16384
 ds_read_b128 v[188:191], v7 offset:16384
 ds_read_b64_tr_b16 v[40:41], v21 offset:2048
 ds_read_b64_tr_b16 v[42:43], v21 offset:2560
 s_add_u32 m0, s35, 22528
 s_add_u32 s37, s88, 663552
 buffer_load_dwordx4 v8, s[40:43], s37 offen lds
 s_waitcnt lgkmcnt(6)
 v_mfma_f32_32x32x16_bf16 v[96:111], v[56:59], v[180:183], v[96:111]
 ds_read_b64_tr_b16 v[44:45], v22 offset:2048
 ds_read_b64_tr_b16 v[46:47], v22 offset:2560
 s_add_u32 m0, s35, 30720
 s_add_u32 s37, s89, 663552
 buffer_load_dwordx4 v9, s[56:59], s37 offen lds
 s_waitcnt lgkmcnt(6)
 v_mfma_f32_32x32x16_bf16 v[112:127], v[60:63], v[180:183], v[112:127]
 ds_read_b64_tr_b16 v[48:49], v23 offset:2048
 ds_read_b64_tr_b16 v[50:51], v23 offset:2560
 s_add_u32 s37, s62, 22528
 s_cmp_lt_u32 s98, 4
 s_cselect_b32 m0, s37, s74
 s_nop 0
 buffer_load_dwordx4 v10, s[80:83], s90 offen lds
 s_add_u32 s90, s90, s63
 s_waitcnt lgkmcnt(4)
 v_mfma_f32_32x32x16_bf16 v[64:79], v[40:43], v[184:187], v[64:79]
 ds_read_b64_tr_b16 v[52:53], v24 offset:2048
 ds_read_b64_tr_b16 v[54:55], v24 offset:2560
 s_add_u32 m0, s36, 0
 s_movk_i32 s37, 384
 buffer_load_dwordx4 v2, s[4:7], s37 offen lds
 s_waitcnt lgkmcnt(4)
 v_mfma_f32_32x32x16_bf16 v[80:95], v[44:47], v[184:187], v[80:95]
 ds_read_b64_tr_b16 v[56:57], v21 offset:4096
 ds_read_b64_tr_b16 v[58:59], v21 offset:4608
 s_add_u32 m0, s36, 1024
 s_movk_i32 s37, 384
 buffer_load_dwordx4 v3, s[4:7], s37 offen lds
 s_waitcnt lgkmcnt(4)
 v_mfma_f32_32x32x16_bf16 v[96:111], v[48:51], v[184:187], v[96:111]
 ds_read_b64_tr_b16 v[60:61], v22 offset:4096
 ds_read_b64_tr_b16 v[62:63], v22 offset:4608
 s_add_u32 s26, s24, 8192
 v_lshlrev_b32 v35, 4, v0
 v_cmp_gt_u32 vcc, 128, v0
 s_waitcnt lgkmcnt(4)
 v_mfma_f32_32x32x16_bf16 v[112:127], v[52:55], v[184:187], v[112:127]
 ds_read_b64_tr_b16 v[40:41], v23 offset:4096
 ds_read_b64_tr_b16 v[42:43], v23 offset:4608
 v_mov_b32 v218, -1
 v_mov_b32 v219, -1
 v_mov_b32 v220, -1
 s_waitcnt lgkmcnt(4)
 v_mfma_f32_32x32x16_bf16 v[64:79], v[56:59], v[188:191], v[64:79]
 ds_read_b64_tr_b16 v[44:45], v24 offset:4096
 ds_read_b64_tr_b16 v[46:47], v24 offset:4608
 v_mov_b32 v221, -1
 v_cndmask_b32 v36, v37, v35, vcc
 buffer_store_dwordx4 v[218:221], v35, s[16:19], s24 offen
 s_waitcnt lgkmcnt(4)
 v_mfma_f32_32x32x16_bf16 v[80:95], v[60:63], v[188:191], v[80:95]
 s_waitcnt vmcnt(15)
 s_barrier
 ds_read_b128 v[176:179], v4 offset:32768
 ds_read_b128 v[180:183], v5 offset:32768
 ds_read_b64_tr_b16 v[48:49], v21 offset:24576
 ds_read_b64_tr_b16 v[50:51], v21 offset:25088
 s_add_u32 m0, s35, 45056
 s_add_u32 s37, s88, 774144
 buffer_load_dwordx4 v8, s[40:43], s37 offen lds
 s_waitcnt lgkmcnt(6)
 v_mfma_f32_32x32x16_bf16 v[96:111], v[40:43], v[188:191], v[96:111]
 ds_read_b64_tr_b16 v[52:53], v22 offset:24576
 ds_read_b64_tr_b16 v[54:55], v22 offset:25088
 s_add_u32 m0, s35, 53248
 s_add_u32 s37, s89, 774144
 buffer_load_dwordx4 v9, s[56:59], s37 offen lds
 s_waitcnt lgkmcnt(6)
 v_mfma_f32_32x32x16_bf16 v[112:127], v[44:47], v[188:191], v[112:127]
 ds_read_b64_tr_b16 v[56:57], v23 offset:24576
 ds_read_b64_tr_b16 v[58:59], v23 offset:25088
 s_add_u32 s37, s62, 45056
 s_cmp_lt_u32 s98, 4
 s_cselect_b32 m0, s37, s74
 s_nop 0
 buffer_load_dwordx4 v10, s[80:83], s90 offen lds
 s_add_u32 s90, s90, s63
 s_waitcnt lgkmcnt(4)
 v_mfma_f32_32x32x16_bf16 v[64:79], v[48:51], v[176:179], v[64:79]
 ds_read_b64_tr_b16 v[60:61], v24 offset:24576
 ds_read_b64_tr_b16 v[62:63], v24 offset:25088
 buffer_store_dwordx4 v[218:221], v35, s[16:19], s25 offen
 s_waitcnt lgkmcnt(4)
 v_mfma_f32_32x32x16_bf16 v[80:95], v[52:55], v[176:179], v[80:95]
 ds_read_b64_tr_b16 v[40:41], v21 offset:26624
 ds_read_b64_tr_b16 v[42:43], v21 offset:27136
 buffer_store_dwordx4 v[218:221], v36, s[16:19], s26 offen
 s_waitcnt lgkmcnt(4)
 v_mfma_f32_32x32x16_bf16 v[96:111], v[56:59], v[176:179], v[96:111]
 ds_read_b64_tr_b16 v[44:45], v22 offset:26624
 ds_read_b64_tr_b16 v[46:47], v22 offset:27136
 s_waitcnt lgkmcnt(4)
 v_mfma_f32_32x32x16_bf16 v[112:127], v[60:63], v[176:179], v[112:127]
 ds_read_b64_tr_b16 v[48:49], v23 offset:26624
 ds_read_b64_tr_b16 v[50:51], v23 offset:27136
 s_waitcnt lgkmcnt(4)
 v_mfma_f32_32x32x16_bf16 v[64:79], v[40:43], v[180:183], v[64:79]
 ds_read_b64_tr_b16 v[52:53], v24 offset:26624
 ds_read_b64_tr_b16 v[54:55], v24 offset:27136
 s_waitcnt lgkmcnt(4)
 v_mfma_f32_32x32x16_bf16 v[80:95], v[44:47], v[180:183], v[80:95]
 s_waitcnt vmcnt(15)
 s_barrier
 ds_read_b128 v[184:187], v6 offset:32768
 ds_read_b128 v[188:191], v7 offset:32768
 ds_read_b64_tr_b16 v[56:57], v17 offset:0
 ds_read_b64_tr_b16 v[58:59], v17 offset:512
 s_add_u32 m0, s35, 67584
 s_add_u32 s37, s88, 884736
 buffer_load_dwordx4 v8, s[40:43], s37 offen lds
 s_waitcnt lgkmcnt(6)
 v_mfma_f32_32x32x16_bf16 v[96:111], v[48:51], v[180:183], v[96:111]
 ds_read_b64_tr_b16 v[60:61], v18 offset:0
 ds_read_b64_tr_b16 v[62:63], v18 offset:512
 s_add_u32 m0, s35, 75776
 s_add_u32 s37, s89, 884736
 buffer_load_dwordx4 v9, s[56:59], s37 offen lds
 s_waitcnt lgkmcnt(6)
 v_mfma_f32_32x32x16_bf16 v[112:127], v[52:55], v[180:183], v[112:127]
 ds_read_b64_tr_b16 v[40:41], v19 offset:0
 ds_read_b64_tr_b16 v[42:43], v19 offset:512
 s_add_u32 s37, s62, 67584
 s_cmp_lt_u32 s98, 4
 s_cselect_b32 m0, s37, s74
 s_nop 0
 buffer_load_dwordx4 v10, s[80:83], s90 offen lds
 s_add_u32 s90, s90, s63
 s_waitcnt lgkmcnt(4)
 v_mfma_f32_32x32x16_bf16 v[64:79], v[56:59], v[184:187], v[64:79]
 ds_read_b64_tr_b16 v[44:45], v20 offset:0
 ds_read_b64_tr_b16 v[46:47], v20 offset:512
 s_add_u32 m0, s36, 16384
 s_movk_i32 s37, 512
 buffer_load_dwordx4 v2, s[4:7], s37 offen lds
 s_waitcnt lgkmcnt(4)
 v_mfma_f32_32x32x16_bf16 v[80:95], v[60:63], v[184:187], v[80:95]
 ds_read_b64_tr_b16 v[48:49], v17 offset:2048
 ds_read_b64_tr_b16 v[50:51], v17 offset:2560
 s_add_u32 m0, s36, 17408
 s_movk_i32 s37, 512
 buffer_load_dwordx4 v3, s[4:7], s37 offen lds
 s_waitcnt lgkmcnt(4)
 v_mfma_f32_32x32x16_bf16 v[96:111], v[40:43], v[184:187], v[96:111]
 ds_read_b64_tr_b16 v[52:53], v18 offset:2048
 ds_read_b64_tr_b16 v[54:55], v18 offset:2560
 s_waitcnt lgkmcnt(4)
 v_mfma_f32_32x32x16_bf16 v[112:127], v[44:47], v[184:187], v[112:127]
 ds_read_b64_tr_b16 v[56:57], v19 offset:2048
 ds_read_b64_tr_b16 v[58:59], v19 offset:2560
 s_waitcnt lgkmcnt(4)
 v_mfma_f32_32x32x16_bf16 v[64:79], v[48:51], v[188:191], v[64:79]
 ds_read_b64_tr_b16 v[60:61], v20 offset:2048
 ds_read_b64_tr_b16 v[62:63], v20 offset:2560
 s_waitcnt lgkmcnt(4)
 v_mfma_f32_32x32x16_bf16 v[80:95], v[52:55], v[188:191], v[80:95]
 s_waitcnt vmcnt(11)
 s_barrier
 ds_read_b128 v[176:179], v4 offset:0
 ds_read_b128 v[180:183], v5 offset:0
 ds_read_b64_tr_b16 v[40:41], v17 offset:22528
 ds_read_b64_tr_b16 v[42:43], v17 offset:23040
 s_add_u32 m0, s35, 90112
 s_add_u32 s37, s88, 995328
 buffer_load_dwordx4 v8, s[40:43], s37 offen lds
 s_waitcnt lgkmcnt(6)
 v_mfma_f32_32x32x16_bf16 v[96:111], v[56:59], v[188:191], v[96:111]
 ds_read_b64_tr_b16 v[44:45], v18 offset:22528
 ds_read_b64_tr_b16 v[46:47], v18 offset:23040
 s_add_u32 m0, s35, 98304
 s_add_u32 s37, s89, 995328
 buffer_load_dwordx4 v9, s[56:59], s37 offen lds
 s_waitcnt lgkmcnt(6)
 v_mfma_f32_32x32x16_bf16 v[112:127], v[60:63], v[188:191], v[112:127]
 ds_read_b64_tr_b16 v[48:49], v19 offset:22528
 ds_read_b64_tr_b16 v[50:51], v19 offset:23040
 s_add_u32 s37, s62, 90112
 s_cmp_lt_u32 s98, 4
 s_cselect_b32 m0, s37, s74
 s_nop 0
 buffer_load_dwordx4 v10, s[80:83], s90 offen lds
 s_add_u32 s90, s90, s63
 s_waitcnt lgkmcnt(4)
 v_mfma_f32_32x32x16_bf16 v[64:79], v[40:43], v[176:179], v[64:79]
 ds_read_b64_tr_b16 v[52:53], v20 offset:22528
 ds_read_b64_tr_b16 v[54:55], v20 offset:23040
 s_waitcnt lgkmcnt(4)
 v_mfma_f32_32x32x16_bf16 v[80:95], v[44:47], v[176:179], v[80:95]
 ds_read_b64_tr_b16 v[56:57], v17 offset:24576
 ds_read_b64_tr_b16 v[58:59], v17 offset:25088
 s_waitcnt lgkmcnt(4)
 v_mfma_f32_32x32x16_bf16 v[96:111], v[48:51], v[176:179], v[96:111]
 ds_read_b64_tr_b16 v[60:61], v18 offset:24576
 ds_read_b64_tr_b16 v[62:63], v18 offset:25088
 s_waitcnt lgkmcnt(4)
 v_mfma_f32_32x32x16_bf16 v[112:127], v[52:55], v[176:179], v[112:127]
 ds_read_b64_tr_b16 v[40:41], v19 offset:24576
 ds_read_b64_tr_b16 v[42:43], v19 offset:25088
 s_waitcnt lgkmcnt(4)
 v_mfma_f32_32x32x16_bf16 v[64:79], v[56:59], v[180:183], v[64:79]
 ds_read_b64_tr_b16 v[44:45], v20 offset:24576
 ds_read_b64_tr_b16 v[46:47], v20 offset:25088
 s_waitcnt lgkmcnt(4)
 v_mfma_f32_32x32x16_bf16 v[80:95], v[60:63], v[180:183], v[80:95]
 s_waitcnt vmcnt(10)
 s_barrier
 ds_read_b128 v[184:187], v6 offset:0
 ds_read_b128 v[188:191], v7 offset:0
 ds_read_b64_tr_b16 v[48:49], v17 offset:45056
 ds_read_b64_tr_b16 v[50:51], v17 offset:45568
 s_add_u32 m0, s35, 0
 s_add_u32 s37, s88, 1105920
 buffer_load_dwordx4 v8, s[40:43], s37 offen lds
 s_waitcnt lgkmcnt(6)
 v_mfma_f32_32x32x16_bf16 v[96:111], v[40:43], v[180:183], v[96:111]
 ds_read_b64_tr_b16 v[52:53], v18 offset:45056
 ds_read_b64_tr_b16 v[54:55], v18 offset:45568
 s_add_u32 m0, s35, 8192
 s_add_u32 s37, s89, 1105920
 buffer_load_dwordx4 v9, s[56:59], s37 offen lds
 s_waitcnt lgkmcnt(6)
 v_mfma_f32_32x32x16_bf16 v[112:127], v[44:47], v[180:183], v[112:127]
 ds_read_b64_tr_b16 v[56:57], v19 offset:45056
 ds_read_b64_tr_b16 v[58:59], v19 offset:45568
 s_add_u32 s37, s62, 0
 s_cmp_lt_u32 s98, 4
 s_cselect_b32 m0, s37, s74
 s_nop 0
 buffer_load_dwordx4 v10, s[80:83], s90 offen lds
 s_add_u32 s90, s90, s63
 s_waitcnt lgkmcnt(4)
 v_mfma_f32_32x32x16_bf16 v[64:79], v[48:51], v[184:187], v[64:79]
 ds_read_b64_tr_b16 v[60:61], v20 offset:45056
 ds_read_b64_tr_b16 v[62:63], v20 offset:45568
 s_add_u32 m0, s36, 32768
 s_movk_i32 s37, 640
 buffer_load_dwordx4 v2, s[4:7], s37 offen lds
 s_waitcnt lgkmcnt(4)
 v_mfma_f32_32x32x16_bf16 v[80:95], v[52:55], v[184:187], v[80:95]
 ds_read_b64_tr_b16 v[40:41], v17 offset:47104
 ds_read_b64_tr_b16 v[42:43], v17 offset:47616
 s_add_u32 m0, s36, 33792
 s_movk_i32 s37, 640
 buffer_load_dwordx4 v3, s[4:7], s37 offen lds
 s_waitcnt lgkmcnt(4)
 v_mfma_f32_32x32x16_bf16 v[96:111], v[56:59], v[184:187], v[96:111]
 ds_read_b64_tr_b16 v[44:45], v18 offset:47104
 ds_read_b64_tr_b16 v[46:47], v18 offset:47616
 s_waitcnt lgkmcnt(4)
 v_mfma_f32_32x32x16_bf16 v[112:127], v[60:63], v[184:187], v[112:127]
 ds_read_b64_tr_b16 v[48:49], v19 offset:47104
 ds_read_b64_tr_b16 v[50:51], v19 offset:47616
 s_waitcnt lgkmcnt(4)
 v_mfma_f32_32x32x16_bf16 v[64:79], v[40:43], v[188:191], v[64:79]
 ds_read_b64_tr_b16 v[52:53], v20 offset:47104
 ds_read_b64_tr_b16 v[54:55], v20 offset:47616
 s_waitcnt lgkmcnt(4)
 v_mfma_f32_32x32x16_bf16 v[80:95], v[44:47], v[188:191], v[80:95]
 s_waitcnt vmcnt(8)
 s_barrier
 ds_read_b128 v[176:179], v4 offset:16384
 ds_read_b128 v[180:183], v5 offset:16384
 ds_read_b64_tr_b16 v[56:57], v21 offset:2048
 ds_read_b64_tr_b16 v[58:59], v21 offset:2560
 s_add_u32 m0, s35, 22528
 s_add_u32 s37, s88, 1216512
 buffer_load_dwordx4 v8, s[40:43], s37 offen lds
 s_waitcnt lgkmcnt(6)
 v_mfma_f32_32x32x16_bf16 v[96:111], v[48:51], v[188:191], v[96:111]
 ds_read_b64_tr_b16 v[60:61], v22 offset:2048
 ds_read_b64_tr_b16 v[62:63], v22 offset:2560
 s_add_u32 m0, s35, 30720
 s_add_u32 s37, s89, 1216512
 buffer_load_dwordx4 v9, s[56:59], s37 offen lds
 s_waitcnt lgkmcnt(6)
 v_mfma_f32_32x32x16_bf16 v[112:127], v[52:55], v[188:191], v[112:127]
 ds_read_b64_tr_b16 v[40:41], v23 offset:2048
 ds_read_b64_tr_b16 v[42:43], v23 offset:2560
 s_add_u32 s37, s62, 22528
 s_cmp_lt_u32 s98, 4
 s_cselect_b32 m0, s37, s74
 s_nop 0
 buffer_load_dwordx4 v10, s[80:83], s90 offen lds
 s_add_u32 s90, s90, s63
 s_waitcnt lgkmcnt(4)
 v_mfma_f32_32x32x16_bf16 v[64:79], v[56:59], v[176:179], v[64:79]
 ds_read_b64_tr_b16 v[44:45], v24 offset:2048
 ds_read_b64_tr_b16 v[46:47], v24 offset:2560
 s_waitcnt lgkmcnt(4)
 v_mfma_f32_32x32x16_bf16 v[80:95], v[60:63], v[176:179], v[80:95]
 ds_read_b64_tr_b16 v[48:49], v21 offset:4096
 ds_read_b64_tr_b16 v[50:51], v21 offset:4608
 s_waitcnt lgkmcnt(4)
 v_mfma_f32_32x32x16_bf16 v[96:111], v[40:43], v[176:179], v[96:111]
 ds_read_b64_tr_b16 v[52:53], v22 offset:4096
 ds_read_b64_tr_b16 v[54:55], v22 offset:4608
 s_waitcnt lgkmcnt(4)
 v_mfma_f32_32x32x16_bf16 v[112:127], v[44:47], v[176:179], v[112:127]
 ds_read_b64_tr_b16 v[56:57], v23 offset:4096
 ds_read_b64_tr_b16 v[58:59], v23 offset:4608
 s_waitcnt lgkmcnt(4)
 v_mfma_f32_32x32x16_bf16 v[64:79], v[48:51], v[180:183], v[64:79]
 ds_read_b64_tr_b16 v[60:61], v24 offset:4096
 ds_read_b64_tr_b16 v[62:63], v24 offset:4608
 s_waitcnt lgkmcnt(4)
 v_mfma_f32_32x32x16_bf16 v[80:95], v[52:55], v[180:183], v[80:95]
 s_waitcnt vmcnt(8)
 s_barrier
 ds_read_b128 v[184:187], v6 offset:16384
 ds_read_b128 v[188:191], v7 offset:16384
 ds_read_b64_tr_b16 v[40:41], v21 offset:24576
 ds_read_b64_tr_b16 v[42:43], v21 offset:25088
 s_add_u32 m0, s35, 45056
 s_add_u32 s37, s88, 1327104
 buffer_load_dwordx4 v8, s[40:43], s37 offen lds
 s_waitcnt lgkmcnt(6)
 v_mfma_f32_32x32x16_bf16 v[96:111], v[56:59], v[180:183], v[96:111]
 ds_read_b64_tr_b16 v[44:45], v22 offset:24576
 ds_read_b64_tr_b16 v[46:47], v22 offset:25088
 s_add_u32 m0, s35, 53248
 s_add_u32 s37, s89, 1327104
 buffer_load_dwordx4 v9, s[56:59], s37 offen lds
 s_waitcnt lgkmcnt(6)
 v_mfma_f32_32x32x16_bf16 v[112:127], v[60:63], v[180:183], v[112:127]
 ds_read_b64_tr_b16 v[48:49], v23 offset:24576
 ds_read_b64_tr_b16 v[50:51], v23 offset:25088
 s_add_u32 s37, s62, 45056
 s_cmp_lt_u32 s98, 4
 s_cselect_b32 m0, s37, s74
 s_nop 0
 buffer_load_dwordx4 v10, s[80:83], s90 offen lds
 s_add_u32 s90, s90, s63
 s_waitcnt lgkmcnt(4)
 v_mfma_f32_32x32x16_bf16 v[64:79], v[40:43], v[184:187], v[64:79]
 ds_read_b64_tr_b16 v[52:53], v24 offset:24576
 ds_read_b64_tr_b16 v[54:55], v24 offset:25088
 s_add_u32 m0, s36, 0
 s_movk_i32 s37, 768
 buffer_load_dwordx4 v2, s[4:7], s37 offen lds
 s_waitcnt lgkmcnt(4)
 v_mfma_f32_32x32x16_bf16 v[80:95], v[44:47], v[184:187], v[80:95]
 ds_read_b64_tr_b16 v[56:57], v21 offset:26624
 ds_read_b64_tr_b16 v[58:59], v21 offset:27136
 s_add_u32 m0, s36, 1024
 s_movk_i32 s37, 768
 buffer_load_dwordx4 v3, s[4:7], s37 offen lds
 s_waitcnt lgkmcnt(4)
 v_mfma_f32_32x32x16_bf16 v[96:111], v[48:51], v[184:187], v[96:111]
 ds_read_b64_tr_b16 v[60:61], v22 offset:26624
 ds_read_b64_tr_b16 v[62:63], v22 offset:27136
 s_waitcnt lgkmcnt(4)
 v_mfma_f32_32x32x16_bf16 v[112:127], v[52:55], v[184:187], v[112:127]
 ds_read_b64_tr_b16 v[40:41], v23 offset:26624
 ds_read_b64_tr_b16 v[42:43], v23 offset:27136
 s_waitcnt lgkmcnt(4)
 v_mfma_f32_32x32x16_bf16 v[64:79], v[56:59], v[188:191], v[64:79]
 ds_read_b64_tr_b16 v[44:45], v24 offset:26624
 ds_read_b64_tr_b16 v[46:47], v24 offset:27136
 s_waitcnt lgkmcnt(4)
 v_mfma_f32_32x32x16_bf16 v[80:95], v[60:63], v[188:191], v[80:95]
 s_waitcnt vmcnt(8)
 s_barrier
 ds_read_b128 v[176:179], v4 offset:32768
 ds_read_b128 v[180:183], v5 offset:32768
 ds_read_b64_tr_b16 v[48:49], v17 offset:0
 ds_read_b64_tr_b16 v[50:51], v17 offset:512
 s_add_u32 m0, s35, 67584
 s_add_u32 s37, s88, 1437696
 buffer_load_dwordx4 v8, s[40:43], s37 offen lds
 s_waitcnt lgkmcnt(6)
 v_mfma_f32_32x32x16_bf16 v[96:111], v[40:43], v[188:191], v[96:111]
 ds_read_b64_tr_b16 v[52:53], v18 offset:0
 ds_read_b64_tr_b16 v[54:55], v18 offset:512
 s_add_u32 m0, s35, 75776
 s_add_u32 s37, s89, 1437696
 buffer_load_dwordx4 v9, s[56:59], s37 offen lds
 s_waitcnt lgkmcnt(6)
 v_mfma_f32_32x32x16_bf16 v[112:127], v[44:47], v[188:191], v[112:127]
 ds_read_b64_tr_b16 v[56:57], v19 offset:0
 ds_read_b64_tr_b16 v[58:59], v19 offset:512
 s_add_u32 s37, s62, 67584
 s_cmp_lt_u32 s98, 4
 s_cselect_b32 m0, s37, s74
 s_nop 0
 buffer_load_dwordx4 v10, s[80:83], s90 offen lds
 s_add_u32 s90, s90, s63
 s_waitcnt lgkmcnt(4)
 v_mfma_f32_32x32x16_bf16 v[64:79], v[48:51], v[176:179], v[64:79]
 ds_read_b64_tr_b16 v[60:61], v20 offset:0
 ds_read_b64_tr_b16 v[62:63], v20 offset:512
 s_waitcnt lgkmcnt(4)
 v_mfma_f32_32x32x16_bf16 v[80:95], v[52:55], v[176:179], v[80:95]
 ds_read_b64_tr_b16 v[40:41], v17 offset:2048
 ds_read_b64_tr_b16 v[42:43], v17 offset:2560
 s_waitcnt lgkmcnt(4)
 v_mfma_f32_32x32x16_bf16 v[96:111], v[56:59], v[176:179], v[96:111]
 ds_read_b64_tr_b16 v[44:45], v18 offset:2048
 ds_read_b64_tr_b16 v[46:47], v18 offset:2560
 s_waitcnt lgkmcnt(4)
 v_mfma_f32_32x32x16_bf16 v[112:127], v[60:63], v[176:179], v[112:127]
 ds_read_b64_tr_b16 v[48:49], v19 offset:2048
 ds_read_b64_tr_b16 v[50:51], v19 offset:2560
 s_waitcnt lgkmcnt(4)
 v_mfma_f32_32x32x16_bf16 v[64:79], v[40:43], v[180:183], v[64:79]
 ds_read_b64_tr_b16 v[52:53], v20 offset:2048
 ds_read_b64_tr_b16 v[54:55], v20 offset:2560
 s_waitcnt lgkmcnt(4)
 v_mfma_f32_32x32x16_bf16 v[80:95], v[44:47], v[180:183], v[80:95]
 s_waitcnt vmcnt(8)
 s_barrier
 ds_read_b128 v[184:187], v6 offset:32768
 ds_read_b128 v[188:191], v7 offset:32768
 ds_read_b64_tr_b16 v[56:57], v17 offset:22528
 ds_read_b64_tr_b16 v[58:59], v17 offset:23040
 s_add_u32 m0, s35, 90112
 s_add_u32 s37, s88, 1548288
 buffer_load_dwordx4 v8, s[40:43], s37 offen lds
 s_waitcnt lgkmcnt(6)
 v_mfma_f32_32x32x16_bf16 v[96:111], v[48:51], v[180:183], v[96:111]
 ds_read_b64_tr_b16 v[60:61], v18 offset:22528
 ds_read_b64_tr_b16 v[62:63], v18 offset:23040
 s_add_u32 m0, s35, 98304
 s_add_u32 s37, s89, 1548288
 buffer_load_dwordx4 v9, s[56:59], s37 offen lds
 s_waitcnt lgkmcnt(6)
 v_mfma_f32_32x32x16_bf16 v[112:127], v[52:55], v[180:183], v[112:127]
 ds_read_b64_tr_b16 v[40:41], v19 offset:22528
 ds_read_b64_tr_b16 v[42:43], v19 offset:23040
 s_add_u32 s37, s62, 90112
 s_cmp_lt_u32 s98, 4
 s_cselect_b32 m0, s37, s74
 s_nop 0
 buffer_load_dwordx4 v10, s[80:83], s90 offen lds
 s_add_u32 s90, s90, s63
 s_waitcnt lgkmcnt(4)
 v_mfma_f32_32x32x16_bf16 v[64:79], v[56:59], v[184:187], v[64:79]
 ds_read_b64_tr_b16 v[44:45], v20 offset:22528
 ds_read_b64_tr_b16 v[46:47], v20 offset:23040
 s_add_u32 m0, s36, 16384
 s_movk_i32 s37, 896
 buffer_load_dwordx4 v2, s[4:7], s37 offen lds
 s_waitcnt lgkmcnt(4)
 v_mfma_f32_32x32x16_bf16 v[80:95], v[60:63], v[184:187], v[80:95]
 ds_read_b64_tr_b16 v[48:49], v17 offset:24576
 ds_read_b64_tr_b16 v[50:51], v17 offset:25088
 s_add_u32 m0, s36, 17408
 s_movk_i32 s37, 896
 buffer_load_dwordx4 v3, s[4:7], s37 offen lds
 s_waitcnt lgkmcnt(4)
 v_mfma_f32_32x32x16_bf16 v[96:111], v[40:43], v[184:187], v[96:111]
 ds_read_b64_tr_b16 v[52:53], v18 offset:24576
 ds_read_b64_tr_b16 v[54:55], v18 offset:25088
 s_waitcnt lgkmcnt(4)
 v_mfma_f32_32x32x16_bf16 v[112:127], v[44:47], v[184:187], v[112:127]
 ds_read_b64_tr_b16 v[56:57], v19 offset:24576
 ds_read_b64_tr_b16 v[58:59], v19 offset:25088
 s_waitcnt lgkmcnt(4)
 v_mfma_f32_32x32x16_bf16 v[64:79], v[48:51], v[188:191], v[64:79]
 ds_read_b64_tr_b16 v[60:61], v20 offset:24576
 ds_read_b64_tr_b16 v[62:63], v20 offset:25088
 s_waitcnt lgkmcnt(4)
 v_mfma_f32_32x32x16_bf16 v[80:95], v[52:55], v[188:191], v[80:95]
 s_waitcnt vmcnt(8)
 s_barrier
 ds_read_b128 v[176:179], v4 offset:0
 ds_read_b128 v[180:183], v5 offset:0
 ds_read_b64_tr_b16 v[40:41], v17 offset:45056
 ds_read_b64_tr_b16 v[42:43], v17 offset:45568
 s_add_u32 m0, s35, 0
 s_add_u32 s37, s88, 1658880
 buffer_load_dwordx4 v8, s[40:43], s37 offen lds
 s_waitcnt lgkmcnt(6)
 v_mfma_f32_32x32x16_bf16 v[96:111], v[56:59], v[188:191], v[96:111]
 ds_read_b64_tr_b16 v[44:45], v18 offset:45056
 ds_read_b64_tr_b16 v[46:47], v18 offset:45568
 s_add_u32 m0, s35, 8192
 s_add_u32 s37, s89, 1658880
 buffer_load_dwordx4 v9, s[56:59], s37 offen lds
 s_waitcnt lgkmcnt(6)
 v_mfma_f32_32x32x16_bf16 v[112:127], v[60:63], v[188:191], v[112:127]
 ds_read_b64_tr_b16 v[48:49], v19 offset:45056
 ds_read_b64_tr_b16 v[50:51], v19 offset:45568
 s_add_u32 s37, s62, 0
 s_cmp_lt_u32 s98, 4
 s_cselect_b32 m0, s37, s74
 s_nop 0
 buffer_load_dwordx4 v10, s[80:83], s90 offen lds
 s_add_u32 s90, s90, s63
 s_waitcnt lgkmcnt(4)
 v_mfma_f32_32x32x16_bf16 v[64:79], v[40:43], v[176:179], v[64:79]
 ds_read_b64_tr_b16 v[52:53], v20 offset:45056
 ds_read_b64_tr_b16 v[54:55], v20 offset:45568
 v_mov_b32 v217, 0
 v_mov_b32 v218, 0
 v_lshlrev_b32 v219, 16, v192
 s_waitcnt lgkmcnt(4)
 v_mfma_f32_32x32x16_bf16 v[80:95], v[44:47], v[176:179], v[80:95]
 ds_read_b64_tr_b16 v[56:57], v17 offset:47104
 ds_read_b64_tr_b16 v[58:59], v17 offset:47616
 v_and_b32 v220, 0xffff0000, v192
 v_lshlrev_b32 v221, 16, v196
 v_and_b32 v222, 0xffff0000, v196
 s_waitcnt lgkmcnt(4)
 v_mfma_f32_32x32x16_bf16 v[96:111], v[48:51], v[176:179], v[96:111]
 ds_read_b64_tr_b16 v[60:61], v18 offset:47104
 ds_read_b64_tr_b16 v[62:63], v18 offset:47616
 v_mul_f32 v219, v219, v221
 v_mul_f32 v220, v220, v222
 v_cvt_pk_bf16_f32 v219, v219, v220
 s_waitcnt lgkmcnt(4)
 v_mfma_f32_32x32x16_bf16 v[112:127], v[52:55], v[176:179], v[112:127]
 ds_read_b64_tr_b16 v[40:41], v19 offset:47104
 ds_read_b64_tr_b16 v[42:43], v19 offset:47616
 v_lshlrev_b32 v220, 16, v219
 v_and_b32 v219, 0xffff0000, v219
 v_add_f32 v217, v217, v220
 s_waitcnt lgkmcnt(4)
 v_mfma_f32_32x32x16_bf16 v[64:79], v[56:59], v[180:183], v[64:79]
 ds_read_b64_tr_b16 v[44:45], v20 offset:47104
 ds_read_b64_tr_b16 v[46:47], v20 offset:47616
 v_add_f32 v218, v218, v219
 v_lshlrev_b32 v219, 16, v193
 v_and_b32 v220, 0xffff0000, v193
 s_waitcnt lgkmcnt(4)
 v_mfma_f32_32x32x16_bf16 v[80:95], v[60:63], v[180:183], v[80:95]
 s_waitcnt vmcnt(8)
 s_barrier
 ds_read_b128 v[184:187], v6 offset:0
 ds_read_b128 v[188:191], v7 offset:0
 ds_read_b64_tr_b16 v[48:49], v21 offset:2048
 ds_read_b64_tr_b16 v[50:51], v21 offset:2560
 s_add_u32 m0, s35, 22528
 s_add_u32 s37, s88, 1769472
 buffer_load_dwordx4 v8, s[40:43], s37 offen lds
 s_waitcnt lgkmcnt(6)
 v_mfma_f32_32x32x16_bf16 v[96:111], v[40:43], v[180:183], v[96:111]
 ds_read_b64_tr_b16 v[52:53], v22 offset:2048
 ds_read_b64_tr_b16 v[54:55], v22 offset:2560
 s_add_u32 m0, s35, 30720
 s_add_u32 s37, s89, 1769472
 buffer_load_dwordx4 v9, s[56:59], s37 offen lds
 s_waitcnt lgkmcnt(6)
 v_mfma_f32_32x32x16_bf16 v[112:127], v[44:47], v[180:183], v[112:127]
 ds_read_b64_tr_b16 v[56:57], v23 offset:2048
 ds_read_b64_tr_b16 v[58:59], v23 offset:2560
 s_add_u32 s37, s62, 22528
 s_cmp_lt_u32 s98, 4
 s_cselect_b32 m0, s37, s74
 s_nop 0
 buffer_load_dwordx4 v10, s[80:83], s90 offen lds
 s_add_u32 s90, s90, s63
 s_waitcnt lgkmcnt(4)
 v_mfma_f32_32x32x16_bf16 v[64:79], v[48:51], v[184:187], v[64:79]
 ds_read_b64_tr_b16 v[60:61], v24 offset:2048
 ds_read_b64_tr_b16 v[62:63], v24 offset:2560
 s_add_u32 m0, s36, 32768
 s_movk_i32 s37, 1024
 buffer_load_dwordx4 v2, s[4:7], s37 offen lds
 s_waitcnt lgkmcnt(4)
 v_mfma_f32_32x32x16_bf16 v[80:95], v[52:55], v[184:187], v[80:95]
 ds_read_b64_tr_b16 v[40:41], v21 offset:4096
 ds_read_b64_tr_b16 v[42:43], v21 offset:4608
 s_add_u32 m0, s36, 33792
 s_movk_i32 s37, 1024
 buffer_load_dwordx4 v3, s[4:7], s37 offen lds
 s_waitcnt lgkmcnt(4)
 v_mfma_f32_32x32x16_bf16 v[96:111], v[56:59], v[184:187], v[96:111]
 ds_read_b64_tr_b16 v[44:45], v22 offset:4096
 ds_read_b64_tr_b16 v[46:47], v22 offset:4608
 v_lshlrev_b32 v221, 16, v197
 v_and_b32 v222, 0xffff0000, v197
 v_mul_f32 v219, v219, v221
 s_waitcnt lgkmcnt(4)
 v_mfma_f32_32x32x16_bf16 v[112:127], v[60:63], v[184:187], v[112:127]
 ds_read_b64_tr_b16 v[48:49], v23 offset:4096
 ds_read_b64_tr_b16 v[50:51], v23 offset:4608
 v_mul_f32 v220, v220, v222
 v_cvt_pk_bf16_f32 v219, v219, v220
 v_lshlrev_b32 v220, 16, v219
 s_waitcnt lgkmcnt(4)
 v_mfma_f32_32x32x16_bf16 v[64:79], v[40:43], v[188:191], v[64:79]
 ds_read_b64_tr_b16 v[52:53], v24 offset:4096
 ds_read_b64_tr_b16 v[54:55], v24 offset:4608
 v_and_b32 v219, 0xffff0000, v219
 v_add_f32 v217, v217, v220
 v_add_f32 v218, v218, v219
 s_waitcnt lgkmcnt(4)
 v_mfma_f32_32x32x16_bf16 v[80:95], v[44:47], v[188:191], v[80:95]
 s_waitcnt vmcnt(8)
 s_barrier
 ds_read_b128 v[176:179], v4 offset:16384
 ds_read_b128 v[180:183], v5 offset:16384
 ds_read_b64_tr_b16 v[56:57], v21 offset:24576
 ds_read_b64_tr_b16 v[58:59], v21 offset:25088
 s_add_u32 m0, s35, 45056
 s_add_u32 s37, s88, 1880064
 buffer_load_dwordx4 v8, s[40:43], s37 offen lds
 s_waitcnt lgkmcnt(6)
 v_mfma_f32_32x32x16_bf16 v[96:111], v[48:51], v[188:191], v[96:111]
 ds_read_b64_tr_b16 v[60:61], v22 offset:24576
 ds_read_b64_tr_b16 v[62:63], v22 offset:25088
 s_add_u32 m0, s35, 53248
 s_add_u32 s37, s89, 1880064
 buffer_load_dwordx4 v9, s[56:59], s37 offen lds
 s_waitcnt lgkmcnt(6)
 v_mfma_f32_32x32x16_bf16 v[112:127], v[52:55], v[188:191], v[112:127]
 ds_read_b64_tr_b16 v[40:41], v23 offset:24576
 ds_read_b64_tr_b16 v[42:43], v23 offset:25088
 s_add_u32 s37, s62, 45056
 s_cmp_lt_u32 s98, 4
 s_cselect_b32 m0, s37, s74
 s_nop 0
 buffer_load_dwordx4 v10, s[80:83], s90 offen lds
 s_add_u32 s90, s90, s63
 s_waitcnt lgkmcnt(4)
 v_mfma_f32_32x32x16_bf16 v[64:79], v[56:59], v[176:179], v[64:79]
 ds_read_b64_tr_b16 v[44:45], v24 offset:24576
 ds_read_b64_tr_b16 v[46:47], v24 offset:25088
 v_lshlrev_b32 v219, 16, v194
 v_and_b32 v220, 0xffff0000, v194
 v_lshlrev_b32 v221, 16, v198
 s_waitcnt lgkmcnt(4)
 v_mfma_f32_32x32x16_bf16 v[80:95], v[60:63], v[176:179], v[80:95]
 ds_read_b64_tr_b16 v[48:49], v21 offset:26624
 ds_read_b64_tr_b16 v[50:51], v21 offset:27136
 v_and_b32 v222, 0xffff0000, v198
 v_mul_f32 v219, v219, v221
 v_mul_f32 v220, v220, v222
 s_waitcnt lgkmcnt(4)
 v_mfma_f32_32x32x16_bf16 v[96:111], v[40:43], v[176:179], v[96:111]
 ds_read_b64_tr_b16 v[52:53], v22 offset:26624
 ds_read_b64_tr_b16 v[54:55], v22 offset:27136
 v_cvt_pk_bf16_f32 v219, v219, v220
 v_lshlrev_b32 v220, 16, v219
 v_and_b32 v219, 0xffff0000, v219
 s_waitcnt lgkmcnt(4)
 v_mfma_f32_32x32x16_bf16 v[112:127], v[44:47], v[176:179], v[112:127]
 ds_read_b64_tr_b16 v[56:57], v23 offset:26624
 ds_read_b64_tr_b16 v[58:59], v23 offset:27136
 v_add_f32 v217, v217, v220
 v_add_f32 v218, v218, v219
 v_lshlrev_b32 v219, 16, v195
 s_waitcnt lgkmcnt(4)
 v_mfma_f32_32x32x16_bf16 v[64:79], v[48:51], v[180:183], v[64:79]
 ds_read_b64_tr_b16 v[60:61], v24 offset:26624
 ds_read_b64_tr_b16 v[62:63], v24 offset:27136
 v_and_b32 v220, 0xffff0000, v195
 v_lshlrev_b32 v221, 16, v199
 v_and_b32 v222, 0xffff0000, v199
 s_waitcnt lgkmcnt(4)
 v_mfma_f32_32x32x16_bf16 v[80:95], v[52:55], v[180:183], v[80:95]
 s_waitcnt vmcnt(8)
 s_barrier
 ds_read_b128 v[184:187], v6 offset:16384
 ds_read_b128 v[188:191], v7 offset:16384
 ds_read_b64_tr_b16 v[40:41], v17 offset:0
 ds_read_b64_tr_b16 v[42:43], v17 offset:512
 s_add_u32 m0, s35, 67584
 s_add_u32 s37, s88, 1990656
 buffer_load_dwordx4 v8, s[40:43], s37 offen lds
 s_waitcnt lgkmcnt(6)
 v_mfma_f32_32x32x16_bf16 v[96:111], v[56:59], v[180:183], v[96:111]
 ds_read_b64_tr_b16 v[44:45], v18 offset:0
 ds_read_b64_tr_b16 v[46:47], v18 offset:512
 s_add_u32 m0, s35, 75776
 s_add_u32 s37, s89, 1990656
 buffer_load_dwordx4 v9, s[56:59], s37 offen lds
 s_waitcnt lgkmcnt(6)
 v_mfma_f32_32x32x16_bf16 v[112:127], v[60:63], v[180:183], v[112:127]
 ds_read_b64_tr_b16 v[48:49], v19 offset:0
 ds_read_b64_tr_b16 v[50:51], v19 offset:512
 s_add_u32 s37, s62, 67584
 s_cmp_lt_u32 s98, 4
 s_cselect_b32 m0, s37, s74
 s_nop 0
 buffer_load_dwordx4 v10, s[80:83], s90 offen lds
 s_add_u32 s90, s90, s63
 s_waitcnt lgkmcnt(4)
 v_mfma_f32_32x32x16_bf16 v[64:79], v[40:43], v[184:187], v[64:79]
 ds_read_b64_tr_b16 v[52:53], v20 offset:0
 ds_read_b64_tr_b16 v[54:55], v20 offset:512
 s_add_u32 m0, s36, 0
 s_movk_i32 s37, 1152
 buffer_load_dwordx4 v2, s[4:7], s37 offen lds
 s_waitcnt lgkmcnt(4)
 v_mfma_f32_32x32x16_bf16 v[80:95], v[44:47], v[184:187], v[80:95]
 ds_read_b64_tr_b16 v[56:57], v17 offset:2048
 ds_read_b64_tr_b16 v[58:59], v17 offset:2560
 s_add_u32 m0, s36, 1024
 s_movk_i32 s37, 1152
 buffer_load_dwordx4 v3, s[4:7], s37 offen lds
 s_waitcnt lgkmcnt(4)
 v_mfma_f32_32x32x16_bf16 v[96:111], v[48:51], v[184:187], v[96:111]
 ds_read_b64_tr_b16 v[60:61], v18 offset:2048
 ds_read_b64_tr_b16 v[62:63], v18 offset:2560
 v_mul_f32 v219, v219, v221
 v_mul_f32 v220, v220, v222
 v_cvt_pk_bf16_f32 v219, v219, v220
 s_waitcnt lgkmcnt(4)
 v_mfma_f32_32x32x16_bf16 v[112:127], v[52:55], v[184:187], v[112:127]
 ds_read_b64_tr_b16 v[40:41], v19 offset:2048
 ds_read_b64_tr_b16 v[42:43], v19 offset:2560
 v_lshlrev_b32 v220, 16, v219
 v_and_b32 v219, 0xffff0000, v219
 v_add_f32 v217, v217, v220
 s_waitcnt lgkmcnt(4)
 v_mfma_f32_32x32x16_bf16 v[64:79], v[56:59], v[188:191], v[64:79]
 ds_read_b64_tr_b16 v[44:45], v20 offset:2048
 ds_read_b64_tr_b16 v[46:47], v20 offset:2560
 v_add_f32 v218, v218, v219
 v_lshlrev_b32 v219, 16, v200
 v_and_b32 v220, 0xffff0000, v200
 s_waitcnt lgkmcnt(4)
 v_mfma_f32_32x32x16_bf16 v[80:95], v[60:63], v[188:191], v[80:95]
 s_waitcnt vmcnt(8)
 s_barrier
 ds_read_b128 v[176:179], v4 offset:32768
 ds_read_b128 v[180:183], v5 offset:32768
 ds_read_b64_tr_b16 v[48:49], v17 offset:22528
 ds_read_b64_tr_b16 v[50:51], v17 offset:23040
 s_add_u32 m0, s35, 90112
 s_add_u32 s37, s88, 2101248
 buffer_load_dwordx4 v8, s[40:43], s37 offen lds
 s_waitcnt lgkmcnt(6)
 v_mfma_f32_32x32x16_bf16 v[96:111], v[40:43], v[188:191], v[96:111]
 ds_read_b64_tr_b16 v[52:53], v18 offset:22528
 ds_read_b64_tr_b16 v[54:55], v18 offset:23040
 s_add_u32 m0, s35, 98304
 s_add_u32 s37, s89, 2101248
 buffer_load_dwordx4 v9, s[56:59], s37 offen lds
 s_waitcnt lgkmcnt(6)
 v_mfma_f32_32x32x16_bf16 v[112:127], v[44:47], v[188:191], v[112:127]
 ds_read_b64_tr_b16 v[56:57], v19 offset:22528
 ds_read_b64_tr_b16 v[58:59], v19 offset:23040
 s_add_u32 s37, s62, 90112
 s_cmp_lt_u32 s98, 4
 s_cselect_b32 m0, s37, s74
 s_nop 0
 buffer_load_dwordx4 v10, s[80:83], s90 offen lds
 s_add_u32 s90, s90, s63
 s_waitcnt lgkmcnt(4)
 v_mfma_f32_32x32x16_bf16 v[64:79], v[48:51], v[176:179], v[64:79]
 ds_read_b64_tr_b16 v[60:61], v20 offset:22528
 ds_read_b64_tr_b16 v[62:63], v20 offset:23040
 v_lshlrev_b32 v221, 16, v204
 v_and_b32 v222, 0xffff0000, v204
 v_mul_f32 v219, v219, v221
 s_waitcnt lgkmcnt(4)
 v_mfma_f32_32x32x16_bf16 v[80:95], v[52:55], v[176:179], v[80:95]
 ds_read_b64_tr_b16 v[40:41], v17 offset:24576
 ds_read_b64_tr_b16 v[42:43], v17 offset:25088
 v_mul_f32 v220, v220, v222
 v_cvt_pk_bf16_f32 v219, v219, v220
 v_lshlrev_b32 v220, 16, v219
 s_waitcnt lgkmcnt(4)
 v_mfma_f32_32x32x16_bf16 v[96:111], v[56:59], v[176:179], v[96:111]
 ds_read_b64_tr_b16 v[44:45], v18 offset:24576
 ds_read_b64_tr_b16 v[46:47], v18 offset:25088
 v_and_b32 v219, 0xffff0000, v219
 v_add_f32 v217, v217, v220
 v_add_f32 v218, v218, v219
 s_waitcnt lgkmcnt(4)
 v_mfma_f32_32x32x16_bf16 v[112:127], v[60:63], v[176:179], v[112:127]
 ds_read_b64_tr_b16 v[48:49], v19 offset:24576
 ds_read_b64_tr_b16 v[50:51], v19 offset:25088
 v_lshlrev_b32 v219, 16, v201
 v_and_b32 v220, 0xffff0000, v201
 v_lshlrev_b32 v221, 16, v205
 s_waitcnt lgkmcnt(4)
 v_mfma_f32_32x32x16_bf16 v[64:79], v[40:43], v[180:183], v[64:79]
 ds_read_b64_tr_b16 v[52:53], v20 offset:24576
 ds_read_b64_tr_b16 v[54:55], v20 offset:25088
 v_and_b32 v222, 0xffff0000, v205
 v_mul_f32 v219, v219, v221
 v_mul_f32 v220, v220, v222
 s_waitcnt lgkmcnt(4)
 v_mfma_f32_32x32x16_bf16 v[80:95], v[44:47], v[180:183], v[80:95]
 s_waitcnt vmcnt(8)
 s_barrier
 ds_read_b128 v[184:187], v6 offset:32768
 ds_read_b128 v[188:191], v7 offset:32768
 ds_read_b64_tr_b16 v[56:57], v17 offset:45056
 ds_read_b64_tr_b16 v[58:59], v17 offset:45568
 v_cvt_pk_bf16_f32 v219, v219, v220
 v_lshlrev_b32 v220, 16, v219
 v_and_b32 v219, 0xffff0000, v219
 s_waitcnt lgkmcnt(6)
 v_mfma_f32_32x32x16_bf16 v[96:111], v[48:51], v[180:183], v[96:111]
 ds_read_b64_tr_b16 v[60:61], v18 offset:45056
 ds_read_b64_tr_b16 v[62:63], v18 offset:45568
 v_add_f32 v217, v217, v220
 v_add_f32 v218, v218, v219
 v_lshlrev_b32 v219, 16, v202
 s_waitcnt lgkmcnt(6)
 v_mfma_f32_32x32x16_bf16 v[112:127], v[52:55], v[180:183], v[112:127]
 ds_read_b64_tr_b16 v[40:41], v19 offset:45056
 ds_read_b64_tr_b16 v[42:43], v19 offset:45568
 v_and_b32 v220, 0xffff0000, v202
 v_lshlrev_b32 v221, 16, v206
 v_and_b32 v222, 0xffff0000, v206
 s_waitcnt lgkmcnt(4)
 v_mfma_f32_32x32x16_bf16 v[64:79], v[56:59], v[184:187], v[64:79]
 ds_read_b64_tr_b16 v[44:45], v20 offset:45056
 ds_read_b64_tr_b16 v[46:47], v20 offset:45568
 v_mul_f32 v219, v219, v221
 v_mul_f32 v220, v220, v222
 v_cvt_pk_bf16_f32 v219, v219, v220
 s_waitcnt lgkmcnt(4)
 v_mfma_f32_32x32x16_bf16 v[80:95], v[60:63], v[184:187], v[80:95]
 ds_read_b64_tr_b16 v[48:49], v17 offset:47104
 ds_read_b64_tr_b16 v[50:51], v17 offset:47616
 v_lshlrev_b32 v220, 16, v219
 v_and_b32 v219, 0xffff0000, v219
 v_add_f32 v217, v217, v220
 s_waitcnt lgkmcnt(4)
 v_mfma_f32_32x32x16_bf16 v[96:111], v[40:43], v[184:187], v[96:111]
 ds_read_b64_tr_b16 v[52:53], v18 offset:47104
 ds_read_b64_tr_b16 v[54:55], v18 offset:47616
 v_add_f32 v218, v218, v219
 v_lshlrev_b32 v219, 16, v203
 v_and_b32 v220, 0xffff0000, v203
 s_waitcnt lgkmcnt(4)
 v_mfma_f32_32x32x16_bf16 v[112:127], v[44:47], v[184:187], v[112:127]
 ds_read_b64_tr_b16 v[56:57], v19 offset:47104
 ds_read_b64_tr_b16 v[58:59], v19 offset:47616
 v_lshlrev_b32 v221, 16, v207
 v_and_b32 v222, 0xffff0000, v207
 v_mul_f32 v219, v219, v221
 s_waitcnt lgkmcnt(4)
 v_mfma_f32_32x32x16_bf16 v[64:79], v[48:51], v[188:191], v[64:79]
 ds_read_b64_tr_b16 v[60:61], v20 offset:47104
 ds_read_b64_tr_b16 v[62:63], v20 offset:47616
 v_mul_f32 v220, v220, v222
 v_cvt_pk_bf16_f32 v219, v219, v220
 v_lshlrev_b32 v220, 16, v219
 s_waitcnt lgkmcnt(4)
 v_mfma_f32_32x32x16_bf16 v[80:95], v[52:55], v[188:191], v[80:95]
 s_waitcnt vmcnt(3)
 s_barrier
 ds_read_b128 v[176:179], v4 offset:0
 ds_read_b128 v[180:183], v5 offset:0
 ds_read_b64_tr_b16 v[40:41], v21 offset:2048
 ds_read_b64_tr_b16 v[42:43], v21 offset:2560
 v_and_b32 v219, 0xffff0000, v219
 v_add_f32 v217, v217, v220
 v_add_f32 v218, v218, v219
 s_waitcnt lgkmcnt(6)
 v_mfma_f32_32x32x16_bf16 v[96:111], v[56:59], v[188:191], v[96:111]
 ds_read_b64_tr_b16 v[44:45], v22 offset:2048
 ds_read_b64_tr_b16 v[46:47], v22 offset:2560
 v_lshlrev_b32 v219, 16, v208
 v_and_b32 v220, 0xffff0000, v208
 v_lshlrev_b32 v221, 16, v212
 s_waitcnt lgkmcnt(6)
 v_mfma_f32_32x32x16_bf16 v[112:127], v[60:63], v[188:191], v[112:127]
 ds_read_b64_tr_b16 v[48:49], v23 offset:2048
 ds_read_b64_tr_b16 v[50:51], v23 offset:2560
 v_and_b32 v222, 0xffff0000, v212
 v_mul_f32 v219, v219, v221
 v_mul_f32 v220, v220, v222
 s_waitcnt lgkmcnt(4)
 v_mfma_f32_32x32x16_bf16 v[64:79], v[40:43], v[176:179], v[64:79]
 ds_read_b64_tr_b16 v[52:53], v24 offset:2048
 ds_read_b64_tr_b16 v[54:55], v24 offset:2560
 v_cvt_pk_bf16_f32 v219, v219, v220
 v_lshlrev_b32 v220, 16, v219
 v_and_b32 v219, 0xffff0000, v219
 s_waitcnt lgkmcnt(4)
 v_mfma_f32_32x32x16_bf16 v[80:95], v[44:47], v[176:179], v[80:95]
 ds_read_b64_tr_b16 v[56:57], v21 offset:4096
 ds_read_b64_tr_b16 v[58:59], v21 offset:4608
 v_add_f32 v217, v217, v220
 v_add_f32 v218, v218, v219
 v_lshlrev_b32 v219, 16, v209
 s_waitcnt lgkmcnt(4)
 v_mfma_f32_32x32x16_bf16 v[96:111], v[48:51], v[176:179], v[96:111]
 ds_read_b64_tr_b16 v[60:61], v22 offset:4096
 ds_read_b64_tr_b16 v[62:63], v22 offset:4608
 v_and_b32 v220, 0xffff0000, v209
 v_lshlrev_b32 v221, 16, v213
 v_and_b32 v222, 0xffff0000, v213
 s_waitcnt lgkmcnt(4)
 v_mfma_f32_32x32x16_bf16 v[112:127], v[52:55], v[176:179], v[112:127]
 ds_read_b64_tr_b16 v[40:41], v23 offset:4096
 ds_read_b64_tr_b16 v[42:43], v23 offset:4608
 v_mul_f32 v219, v219, v221
 v_mul_f32 v220, v220, v222
 v_cvt_pk_bf16_f32 v219, v219, v220
 s_waitcnt lgkmcnt(4)
 v_mfma_f32_32x32x16_bf16 v[64:79], v[56:59], v[180:183], v[64:79]
 ds_read_b64_tr_b16 v[44:45], v24 offset:4096
 ds_read_b64_tr_b16 v[46:47], v24 offset:4608
 v_lshlrev_b32 v220, 16, v219
 v_and_b32 v219, 0xffff0000, v219
 v_add_f32 v217, v217, v220
 s_waitcnt lgkmcnt(4)
 v_mfma_f32_32x32x16_bf16 v[80:95], v[60:63], v[180:183], v[80:95]
 s_waitcnt vmcnt(0)
 s_barrier
 ds_read_b128 v[184:187], v6 offset:0
 ds_read_b128 v[188:191], v7 offset:0
 ds_read_b64_tr_b16 v[48:49], v21 offset:24576
 ds_read_b64_tr_b16 v[50:51], v21 offset:25088
 v_add_f32 v218, v218, v219
 v_lshlrev_b32 v219, 16, v210
 v_and_b32 v220, 0xffff0000, v210
 s_waitcnt lgkmcnt(6)
 v_mfma_f32_32x32x16_bf16 v[96:111], v[40:43], v[180:183], v[96:111]
 ds_read_b64_tr_b16 v[52:53], v22 offset:24576
 ds_read_b64_tr_b16 v[54:55], v22 offset:25088
 v_lshlrev_b32 v221, 16, v214
 v_and_b32 v222, 0xffff0000, v214
 v_mul_f32 v219, v219, v221
 s_waitcnt lgkmcnt(6)
 v_mfma_f32_32x32x16_bf16 v[112:127], v[44:47], v[180:183], v[112:127]
 ds_read_b64_tr_b16 v[56:57], v23 offset:24576
 ds_read_b64_tr_b16 v[58:59], v23 offset:25088
 v_mul_f32 v220, v220, v222
 v_cvt_pk_bf16_f32 v219, v219, v220
 v_lshlrev_b32 v220, 16, v219
 s_waitcnt lgkmcnt(4)
 v_mfma_f32_32x32x16_bf16 v[64:79], v[48:51], v[184:187], v[64:79]
 ds_read_b64_tr_b16 v[60:61], v24 offset:24576
 ds_read_b64_tr_b16 v[62:63], v24 offset:25088
 v_and_b32 v219, 0xffff0000, v219
 v_add_f32 v217, v217, v220
 v_add_f32 v218, v218, v219
 s_waitcnt lgkmcnt(4)
 v_mfma_f32_32x32x16_bf16 v[80:95], v[52:55], v[184:187], v[80:95]
 ds_read_b64_tr_b16 v[40:41], v21 offset:26624
 ds_read_b64_tr_b16 v[42:43], v21 offset:27136
 v_lshlrev_b32 v219, 16, v211
 v_and_b32 v220, 0xffff0000, v211
 v_lshlrev_b32 v221, 16, v215
 s_waitcnt lgkmcnt(4)
 v_mfma_f32_32x32x16_bf16 v[96:111], v[56:59], v[184:187], v[96:111]
 ds_read_b64_tr_b16 v[44:45], v22 offset:26624
 ds_read_b64_tr_b16 v[46:47], v22 offset:27136
 v_and_b32 v222, 0xffff0000, v215
 v_mul_f32 v219, v219, v221
 v_mul_f32 v220, v220, v222
 s_waitcnt lgkmcnt(4)
 v_mfma_f32_32x32x16_bf16 v[112:127], v[60:63], v[184:187], v[112:127]
 ds_read_b64_tr_b16 v[48:49], v23 offset:26624
 ds_read_b64_tr_b16 v[50:51], v23 offset:27136
 v_cvt_pk_bf16_f32 v219, v219, v220
 v_lshlrev_b32 v220, 16, v219
 v_and_b32 v219, 0xffff0000, v219
 s_waitcnt lgkmcnt(4)
 v_mfma_f32_32x32x16_bf16 v[64:79], v[40:43], v[188:191], v[64:79]
 ds_read_b64_tr_b16 v[52:53], v24 offset:26624
 ds_read_b64_tr_b16 v[54:55], v24 offset:27136
 v_add_f32 v217, v217, v220
 v_add_f32 v218, v218, v219
 v_add_f32 v217, v217, v218
 s_waitcnt lgkmcnt(4)
 v_mfma_f32_32x32x16_bf16 v[80:95], v[44:47], v[188:191], v[80:95]
 s_waitcnt lgkmcnt(2)
 v_mfma_f32_32x32x16_bf16 v[96:111], v[48:51], v[188:191], v[96:111]
 ds_swizzle_b32 v218, v217 offset:1055
 s_waitcnt lgkmcnt(1)
 v_mfma_f32_32x32x16_bf16 v[112:127], v[52:55], v[188:191], v[112:127]
 s_waitcnt lgkmcnt(0)
 v_add_f32 v217, v217, v218
 ds_swizzle_b32 v218, v217 offset:2079
 s_waitcnt lgkmcnt(0)
 v_add_f32 v217, v217, v218
 ds_swizzle_b32 v218, v217 offset:4127
 s_waitcnt lgkmcnt(0)
 v_add_f32 v217, v217, v218
 ds_swizzle_b32 v218, v217 offset:8223
 s_waitcnt lgkmcnt(0)
 v_add_f32 v217, v217, v218
 ds_swizzle_b32 v218, v217 offset:16415
 s_waitcnt lgkmcnt(0)
 v_add_f32 v217, v217, v218
 v_cvt_pk_bf16_f32 v217, v217, v217
 v_lshlrev_b32 v217, 16, v217
 v_mul_f32 v217, 0xbfb8aa3b, v217
 v_exp_f32 v217, v217
 v_lshlrev_b32 v219, 2, v216
 v_add_f32 v217, 1.0, v217
 v_rcp_f32 v217, v217
 s_mov_b32 s38, 20971520
 v_cvt_pk_bf16_f32 v217, v217, v217
 v_lshlrev_b32 v217, 16, v217
 buffer_store_dword v217, v219, s[16:19], s38 offen
 s_waitcnt lgkmcnt(0)
 s_barrier
 v_lshrrev_b32 v35, 1, v1
 v_mul_u32_u24 v35, 1280, v35
 v_and_b32 v36, 1, v1
 v_lshl_add_u32 v37, v36, 4, v35
 s_mul_i32 s24, s2, 12
 s_mul_i32 s25, s20, 3
 s_add_u32 s24, s24, s25
 s_mul_i32 s31, s20, 3072
 s_add_u32 s31, s31, 102592
 s_add_u32 s25, s24, 0
 s_min_u32 s25, s25, 2959
 s_mul_hi_u32 s80, s25, 107374183
 s_mul_i32 s26, s80, 40
 s_sub_u32 s81, s25, s26
 s_cmp_lt_u32 s80, 54
 s_cselect_b32 s76, s52, s46
 s_cselect_b32 s77, s53, s47
 s_mov_b32 s78, 819200
 s_cselect_b32 s78, 2211840, s78
 s_mov_b32 s79, 0x00020000
 s_cselect_b32 s26, 0, 54
 s_sub_u32 s26, s80, s26
 s_mul_i32 s26, s26, 40960
 s_lshl_b32 s27, s81, 5
 s_add_u32 s26, s26, s27
 s_add_u32 m0, s31, 0
 s_nop 0
 buffer_load_dwordx4 v37, s[76:79], s26 offen lds
 s_add_u32 s25, s24, 1
 s_min_u32 s25, s25, 2959
 s_mul_hi_u32 s82, s25, 107374183
 s_mul_i32 s26, s82, 40
 s_sub_u32 s83, s25, s26
 s_cmp_lt_u32 s82, 54
 s_cselect_b32 s76, s52, s46
 s_cselect_b32 s77, s53, s47
 s_mov_b32 s78, 819200
 s_cselect_b32 s78, 2211840, s78
 s_mov_b32 s79, 0x00020000
 s_cselect_b32 s26, 0, 54
 s_sub_u32 s26, s82, s26
 s_mul_i32 s26, s26, 40960
 s_lshl_b32 s27, s83, 5
 s_add_u32 s26, s26, s27
 s_add_u32 m0, s31, 1024
 s_nop 0
 buffer_load_dwordx4 v37, s[76:79], s26 offen lds
 s_add_u32 s25, s24, 2
 s_min_u32 s25, s25, 2959
 s_mul_hi_u32 s84, s25, 107374183
 s_mul_i32 s26, s84, 40
 s_sub_u32 s85, s25, s26
 s_cmp_lt_u32 s84, 54
 s_cselect_b32 s76, s52, s46
 s_cselect_b32 s77, s53, s47
 s_mov_b32 s78, 819200
 s_cselect_b32 s78, 2211840, s78
 s_mov_b32 s79, 0x00020000
 s_cselect_b32 s26, 0, 54
 s_sub_u32 s26, s84, s26
 s_mul_i32 s26, s26, 40960
 s_lshl_b32 s27, s85, 5
 s_add_u32 s26, s26, s27
 s_add_u32 m0, s31, 2048
 s_nop 0
 buffer_load_dwordx4 v37, s[76:79], s26 offen lds
 v_cvt_pk_bf16_f32 v161, v64, v65
 v_cvt_pk_bf16_f32 v163, v72, v73
 v_lshlrev_b32 v160, 16, v161
 v_and_b32 v161, 0xffff0000, v161
 v_mul_f32 v164, v160, v160
 v_mul_f32 v165, v161, v161
 v_fmamk_f32 v164, v164, 0xbdd2d3e8, v26
 v_fmamk_f32 v165, v165, 0xbdd2d3e8, v26
 v_mul_f32 v164, v164, v160
 v_mul_f32 v165, v165, v161
 v_exp_f32 v164, v164
 v_exp_f32 v165, v165
 v_lshlrev_b32 v162, 16, v163
 v_add_f32 v164, 1.0, v164
 v_add_f32 v165, 1.0, v165
 v_rcp_f32 v164, v164
 v_rcp_f32 v165, v165
 v_and_b32 v163, 0xffff0000, v163
 v_mul_f32 v164, v164, v160
 v_mul_f32 v165, v165, v161
 v_cvt_pk_bf16_f32 v165, v164, v165
 v_lshlrev_b32 v164, 16, v165
 v_and_b32 v165, 0xffff0000, v165
 v_mul_f32 v164, v164, v162
 v_mul_f32 v165, v165, v163
 v_cvt_pk_bf16_f32 v172, v164, v165
 v_cvt_pk_bf16_f32 v161, v66, v67
 v_cvt_pk_bf16_f32 v163, v74, v75
 v_lshlrev_b32 v160, 16, v161
 v_and_b32 v161, 0xffff0000, v161
 v_mul_f32 v164, v160, v160
 v_mul_f32 v165, v161, v161
 v_fmamk_f32 v164, v164, 0xbdd2d3e8, v26
 v_fmamk_f32 v165, v165, 0xbdd2d3e8, v26
 v_mul_f32 v164, v164, v160
 v_mul_f32 v165, v165, v161
 v_exp_f32 v164, v164
 v_exp_f32 v165, v165
 v_lshlrev_b32 v162, 16, v163
 v_add_f32 v164, 1.0, v164
 v_add_f32 v165, 1.0, v165
 v_rcp_f32 v164, v164
 v_rcp_f32 v165, v165
 v_and_b32 v163, 0xffff0000, v163
 v_mul_f32 v164, v164, v160
 v_mul_f32 v165, v165, v161
 v_cvt_pk_bf16_f32 v165, v164, v165
 v_lshlrev_b32 v164, 16, v165
 v_and_b32 v165, 0xffff0000, v165
 v_mul_f32 v164, v164, v162
 v_mul_f32 v165, v165, v163
 v_cvt_pk_bf16_f32 v173, v164, v165
 v_cvt_pk_bf16_f32 v161, v68, v69
 v_cvt_pk_bf16_f32 v163, v76, v77
 v_lshlrev_b32 v160, 16, v161
 v_and_b32 v161, 0xffff0000, v161
 v_mul_f32 v164, v160, v160
 v_mul_f32 v165, v161, v161
 v_fmamk_f32 v164, v164, 0xbdd2d3e8, v26
 v_fmamk_f32 v165, v165, 0xbdd2d3e8, v26
 v_mul_f32 v164, v164, v160
 v_mul_f32 v165, v165, v161
 v_exp_f32 v164, v164
 v_exp_f32 v165, v165
 v_lshlrev_b32 v162, 16, v163
 v_add_f32 v164, 1.0, v164
 v_add_f32 v165, 1.0, v165
 v_rcp_f32 v164, v164
 v_rcp_f32 v165, v165
 v_and_b32 v163, 0xffff0000, v163
 v_mul_f32 v164, v164, v160
 v_mul_f32 v165, v165, v161
 v_cvt_pk_bf16_f32 v165, v164, v165
 v_lshlrev_b32 v164, 16, v165
 v_and_b32 v165, 0xffff0000, v165
 v_mul_f32 v164, v164, v162
 v_mul_f32 v165, v165, v163
 v_cvt_pk_bf16_f32 v174, v164, v165
 v_cvt_pk_bf16_f32 v161, v70, v71
 v_cvt_pk_bf16_f32 v163, v78, v79
 v_lshlrev_b32 v160, 16, v161
 v_and_b32 v161, 0xffff0000, v161
 v_mul_f32 v164, v160, v160
 v_mul_f32 v165, v161, v161
 v_fmamk_f32 v164, v164, 0xbdd2d3e8, v26
 v_fmamk_f32 v165, v165, 0xbdd2d3e8, v26
 v_mul_f32 v164, v164, v160
 v_mul_f32 v165, v165, v161
 v_exp_f32 v164, v164
 v_exp_f32 v165, v165
 v_lshlrev_b32 v162, 16, v163
 v_add_f32 v164, 1.0, v164
 v_add_f32 v165, 1.0, v165
 v_rcp_f32 v164, v164
 v_rcp_f32 v165, v165
 v_and_b32 v163, 0xffff0000, v163
 v_mul_f32 v164, v164, v160
 v_mul_f32 v165, v165, v161
 v_cvt_pk_bf16_f32 v165, v164, v165
 v_lshlrev_b32 v164, 16, v165
 v_and_b32 v165, 0xffff0000, v165
 v_mul_f32 v164, v164, v162
 v_mul_f32 v165, v165, v163
 v_cvt_pk_bf16_f32 v175, v164, v165
 s_add_u32 s38, s34, 0
 buffer_store_dwordx4 v[172:175], v25, s[16:19], s38 offen sc0 sc1
 v_cvt_pk_bf16_f32 v177, v80, v81
 v_cvt_pk_bf16_f32 v179, v88, v89
 v_lshlrev_b32 v176, 16, v177
 v_and_b32 v177, 0xffff0000, v177
 v_mul_f32 v180, v176, v176
 v_mul_f32 v181, v177, v177
 v_fmamk_f32 v180, v180, 0xbdd2d3e8, v26
 v_fmamk_f32 v181, v181, 0xbdd2d3e8, v26
 v_mul_f32 v180, v180, v176
 v_mul_f32 v181, v181, v177
 v_exp_f32 v180, v180
 v_exp_f32 v181, v181
 v_lshlrev_b32 v178, 16, v179
 v_add_f32 v180, 1.0, v180
 v_add_f32 v181, 1.0, v181
 v_rcp_f32 v180, v180
 v_rcp_f32 v181, v181
 v_and_b32 v179, 0xffff0000, v179
 v_mul_f32 v180, v180, v176
 v_mul_f32 v181, v181, v177
 v_cvt_pk_bf16_f32 v181, v180, v181
 v_lshlrev_b32 v180, 16, v181
 v_and_b32 v181, 0xffff0000, v181
 v_mul_f32 v180, v180, v178
 v_mul_f32 v181, v181, v179
 v_cvt_pk_bf16_f32 v188, v180, v181
 v_cvt_pk_bf16_f32 v177, v82, v83
 v_cvt_pk_bf16_f32 v179, v90, v91
 v_lshlrev_b32 v176, 16, v177
 v_and_b32 v177, 0xffff0000, v177
 v_mul_f32 v180, v176, v176
 v_mul_f32 v181, v177, v177
 v_fmamk_f32 v180, v180, 0xbdd2d3e8, v26
 v_fmamk_f32 v181, v181, 0xbdd2d3e8, v26
 v_mul_f32 v180, v180, v176
 v_mul_f32 v181, v181, v177
 v_exp_f32 v180, v180
 v_exp_f32 v181, v181
 v_lshlrev_b32 v178, 16, v179
 v_add_f32 v180, 1.0, v180
 v_add_f32 v181, 1.0, v181
 v_rcp_f32 v180, v180
 v_rcp_f32 v181, v181
 v_and_b32 v179, 0xffff0000, v179
 v_mul_f32 v180, v180, v176
 v_mul_f32 v181, v181, v177
 v_cvt_pk_bf16_f32 v181, v180, v181
 v_lshlrev_b32 v180, 16, v181
 v_and_b32 v181, 0xffff0000, v181
 v_mul_f32 v180, v180, v178
 v_mul_f32 v181, v181, v179
 v_cvt_pk_bf16_f32 v189, v180, v181
 v_cvt_pk_bf16_f32 v177, v84, v85
 v_cvt_pk_bf16_f32 v179, v92, v93
 v_lshlrev_b32 v176, 16, v177
 v_and_b32 v177, 0xffff0000, v177
 v_mul_f32 v180, v176, v176
 v_mul_f32 v181, v177, v177
 v_fmamk_f32 v180, v180, 0xbdd2d3e8, v26
 v_fmamk_f32 v181, v181, 0xbdd2d3e8, v26
 v_mul_f32 v180, v180, v176
 v_mul_f32 v181, v181, v177
 v_exp_f32 v180, v180
 v_exp_f32 v181, v181
 v_lshlrev_b32 v178, 16, v179
 v_add_f32 v180, 1.0, v180
 v_add_f32 v181, 1.0, v181
 v_rcp_f32 v180, v180
 v_rcp_f32 v181, v181
 v_and_b32 v179, 0xffff0000, v179
 v_mul_f32 v180, v180, v176
 v_mul_f32 v181, v181, v177
 v_cvt_pk_bf16_f32 v181, v180, v181
 v_lshlrev_b32 v180, 16, v181
 v_and_b32 v181, 0xffff0000, v181
 v_mul_f32 v180, v180, v178
 v_mul_f32 v181, v181, v179
 v_cvt_pk_bf16_f32 v190, v180, v181
 v_cvt_pk_bf16_f32 v177, v86, v87
 v_cvt_pk_bf16_f32 v179, v94, v95
 v_lshlrev_b32 v176, 16, v177
 v_and_b32 v177, 0xffff0000, v177
 v_mul_f32 v180, v176, v176
 v_mul_f32 v181, v177, v177
 v_fmamk_f32 v180, v180, 0xbdd2d3e8, v26
 v_fmamk_f32 v181, v181, 0xbdd2d3e8, v26
 v_mul_f32 v180, v180, v176
 v_mul_f32 v181, v181, v177
 v_exp_f32 v180, v180
 v_exp_f32 v181, v181
 v_lshlrev_b32 v178, 16, v179
 v_add_f32 v180, 1.0, v180
 v_add_f32 v181, 1.0, v181
 v_rcp_f32 v180, v180
 v_rcp_f32 v181, v181
 v_and_b32 v179, 0xffff0000, v179
 v_mul_f32 v180, v180, v176
 v_mul_f32 v181, v181, v177
 v_cvt_pk_bf16_f32 v181, v180, v181
 v_lshlrev_b32 v180, 16, v181
 v_and_b32 v181, 0xffff0000, v181
 v_mul_f32 v180, v180, v178
 v_mul_f32 v181, v181, v179
 v_cvt_pk_bf16_f32 v191, v180, v181
 s_add_u32 s38, s34, 512
 buffer_store_dwordx4 v[188:191], v25, s[16:19], s38 offen sc0 sc1
 v_cvt_pk_bf16_f32 v161, v96, v97
 v_cvt_pk_bf16_f32 v163, v104, v105
 v_lshlrev_b32 v160, 16, v161
 v_and_b32 v161, 0xffff0000, v161
 v_mul_f32 v164, v160, v160
 v_mul_f32 v165, v161, v161
 v_fmamk_f32 v164, v164, 0xbdd2d3e8, v26
 v_fmamk_f32 v165, v165, 0xbdd2d3e8, v26
 v_mul_f32 v164, v164, v160
 v_mul_f32 v165, v165, v161
 v_exp_f32 v164, v164
 v_exp_f32 v165, v165
 v_lshlrev_b32 v162, 16, v163
 v_add_f32 v164, 1.0, v164
 v_add_f32 v165, 1.0, v165
 v_rcp_f32 v164, v164
 v_rcp_f32 v165, v165
 v_and_b32 v163, 0xffff0000, v163
 v_mul_f32 v164, v164, v160
 v_mul_f32 v165, v165, v161
 v_cvt_pk_bf16_f32 v165, v164, v165
 v_lshlrev_b32 v164, 16, v165
 v_and_b32 v165, 0xffff0000, v165
 v_mul_f32 v164, v164, v162
 v_mul_f32 v165, v165, v163
 v_cvt_pk_bf16_f32 v172, v164, v165
 v_cvt_pk_bf16_f32 v161, v98, v99
 v_cvt_pk_bf16_f32 v163, v106, v107
 v_lshlrev_b32 v160, 16, v161
 v_and_b32 v161, 0xffff0000, v161
 v_mul_f32 v164, v160, v160
 v_mul_f32 v165, v161, v161
 v_fmamk_f32 v164, v164, 0xbdd2d3e8, v26
 v_fmamk_f32 v165, v165, 0xbdd2d3e8, v26
 v_mul_f32 v164, v164, v160
 v_mul_f32 v165, v165, v161
 v_exp_f32 v164, v164
 v_exp_f32 v165, v165
 v_lshlrev_b32 v162, 16, v163
 v_add_f32 v164, 1.0, v164
 v_add_f32 v165, 1.0, v165
 v_rcp_f32 v164, v164
 v_rcp_f32 v165, v165
 v_and_b32 v163, 0xffff0000, v163
 v_mul_f32 v164, v164, v160
 v_mul_f32 v165, v165, v161
 v_cvt_pk_bf16_f32 v165, v164, v165
 v_lshlrev_b32 v164, 16, v165
 v_and_b32 v165, 0xffff0000, v165
 v_mul_f32 v164, v164, v162
 v_mul_f32 v165, v165, v163
 v_cvt_pk_bf16_f32 v173, v164, v165
 v_cvt_pk_bf16_f32 v161, v100, v101
 v_cvt_pk_bf16_f32 v163, v108, v109
 v_lshlrev_b32 v160, 16, v161
 v_and_b32 v161, 0xffff0000, v161
 v_mul_f32 v164, v160, v160
 v_mul_f32 v165, v161, v161
 v_fmamk_f32 v164, v164, 0xbdd2d3e8, v26
 v_fmamk_f32 v165, v165, 0xbdd2d3e8, v26
 v_mul_f32 v164, v164, v160
 v_mul_f32 v165, v165, v161
 v_exp_f32 v164, v164
 v_exp_f32 v165, v165
 v_lshlrev_b32 v162, 16, v163
 v_add_f32 v164, 1.0, v164
 v_add_f32 v165, 1.0, v165
 v_rcp_f32 v164, v164
 v_rcp_f32 v165, v165
 v_and_b32 v163, 0xffff0000, v163
 v_mul_f32 v164, v164, v160
 v_mul_f32 v165, v165, v161
 v_cvt_pk_bf16_f32 v165, v164, v165
 v_lshlrev_b32 v164, 16, v165
 v_and_b32 v165, 0xffff0000, v165
 v_mul_f32 v164, v164, v162
 v_mul_f32 v165, v165, v163
 v_cvt_pk_bf16_f32 v174, v164, v165
 v_cvt_pk_bf16_f32 v161, v102, v103
 v_cvt_pk_bf16_f32 v163, v110, v111
 v_lshlrev_b32 v160, 16, v161
 v_and_b32 v161, 0xffff0000, v161
 v_mul_f32 v164, v160, v160
 v_mul_f32 v165, v161, v161
 v_fmamk_f32 v164, v164, 0xbdd2d3e8, v26
 v_fmamk_f32 v165, v165, 0xbdd2d3e8, v26
 v_mul_f32 v164, v164, v160
 v_mul_f32 v165, v165, v161
 v_exp_f32 v164, v164
 v_exp_f32 v165, v165
 v_lshlrev_b32 v162, 16, v163
 v_add_f32 v164, 1.0, v164
 v_add_f32 v165, 1.0, v165
 v_rcp_f32 v164, v164
 v_rcp_f32 v165, v165
 v_and_b32 v163, 0xffff0000, v163
 v_mul_f32 v164, v164, v160
 v_mul_f32 v165, v165, v161
 v_cvt_pk_bf16_f32 v165, v164, v165
 v_lshlrev_b32 v164, 16, v165
 v_and_b32 v165, 0xffff0000, v165
 v_mul_f32 v164, v164, v162
 v_mul_f32 v165, v165, v163
 v_cvt_pk_bf16_f32 v175, v164, v165
 s_add_u32 s38, s34, 1024
 buffer_store_dwordx4 v[172:175], v25, s[16:19], s38 offen sc0 sc1
 v_cvt_pk_bf16_f32 v177, v112, v113
 v_cvt_pk_bf16_f32 v179, v120, v121
 v_lshlrev_b32 v176, 16, v177
 v_and_b32 v177, 0xffff0000, v177
 v_mul_f32 v180, v176, v176
 v_mul_f32 v181, v177, v177
 v_fmamk_f32 v180, v180, 0xbdd2d3e8, v26
 v_fmamk_f32 v181, v181, 0xbdd2d3e8, v26
 v_mul_f32 v180, v180, v176
 v_mul_f32 v181, v181, v177
 v_exp_f32 v180, v180
 v_exp_f32 v181, v181
 v_lshlrev_b32 v178, 16, v179
 v_add_f32 v180, 1.0, v180
 v_add_f32 v181, 1.0, v181
 v_rcp_f32 v180, v180
 v_rcp_f32 v181, v181
 v_and_b32 v179, 0xffff0000, v179
 v_mul_f32 v180, v180, v176
 v_mul_f32 v181, v181, v177
 v_cvt_pk_bf16_f32 v181, v180, v181
 v_lshlrev_b32 v180, 16, v181
 v_and_b32 v181, 0xffff0000, v181
 v_mul_f32 v180, v180, v178
 v_mul_f32 v181, v181, v179
 v_cvt_pk_bf16_f32 v188, v180, v181
 v_cvt_pk_bf16_f32 v177, v114, v115
 v_cvt_pk_bf16_f32 v179, v122, v123
 v_lshlrev_b32 v176, 16, v177
 v_and_b32 v177, 0xffff0000, v177
 v_mul_f32 v180, v176, v176
 v_mul_f32 v181, v177, v177
 v_fmamk_f32 v180, v180, 0xbdd2d3e8, v26
 v_fmamk_f32 v181, v181, 0xbdd2d3e8, v26
 v_mul_f32 v180, v180, v176
 v_mul_f32 v181, v181, v177
 v_exp_f32 v180, v180
 v_exp_f32 v181, v181
 v_lshlrev_b32 v178, 16, v179
 v_add_f32 v180, 1.0, v180
 v_add_f32 v181, 1.0, v181
 v_rcp_f32 v180, v180
 v_rcp_f32 v181, v181
 v_and_b32 v179, 0xffff0000, v179
 v_mul_f32 v180, v180, v176
 v_mul_f32 v181, v181, v177
 v_cvt_pk_bf16_f32 v181, v180, v181
 v_lshlrev_b32 v180, 16, v181
 v_and_b32 v181, 0xffff0000, v181
 v_mul_f32 v180, v180, v178
 v_mul_f32 v181, v181, v179
 v_cvt_pk_bf16_f32 v189, v180, v181
 v_cvt_pk_bf16_f32 v177, v116, v117
 v_cvt_pk_bf16_f32 v179, v124, v125
 v_lshlrev_b32 v176, 16, v177
 v_and_b32 v177, 0xffff0000, v177
 v_mul_f32 v180, v176, v176
 v_mul_f32 v181, v177, v177
 v_fmamk_f32 v180, v180, 0xbdd2d3e8, v26
 v_fmamk_f32 v181, v181, 0xbdd2d3e8, v26
 v_mul_f32 v180, v180, v176
 v_mul_f32 v181, v181, v177
 v_exp_f32 v180, v180
 v_exp_f32 v181, v181
 v_lshlrev_b32 v178, 16, v179
 v_add_f32 v180, 1.0, v180
 v_add_f32 v181, 1.0, v181
 v_rcp_f32 v180, v180
 v_rcp_f32 v181, v181
 v_and_b32 v179, 0xffff0000, v179
 v_mul_f32 v180, v180, v176
 v_mul_f32 v181, v181, v177
 v_cvt_pk_bf16_f32 v181, v180, v181
 v_lshlrev_b32 v180, 16, v181
 v_and_b32 v181, 0xffff0000, v181
 v_mul_f32 v180, v180, v178
 v_mul_f32 v181, v181, v179
 v_cvt_pk_bf16_f32 v190, v180, v181
 v_cvt_pk_bf16_f32 v177, v118, v119
 v_cvt_pk_bf16_f32 v179, v126, v127
 v_lshlrev_b32 v176, 16, v177
 v_and_b32 v177, 0xffff0000, v177
 v_mul_f32 v180, v176, v176
 v_mul_f32 v181, v177, v177
 v_fmamk_f32 v180, v180, 0xbdd2d3e8, v26
 v_fmamk_f32 v181, v181, 0xbdd2d3e8, v26
 v_mul_f32 v180, v180, v176
 v_mul_f32 v181, v181, v177
 v_exp_f32 v180, v180
 v_exp_f32 v181, v181
 v_lshlrev_b32 v178, 16, v179
 v_add_f32 v180, 1.0, v180
 v_add_f32 v181, 1.0, v181
 v_rcp_f32 v180, v180
 v_rcp_f32 v181, v181
 v_and_b32 v179, 0xffff0000, v179
 v_mul_f32 v180, v180, v176
 v_mul_f32 v181, v181, v177
 v_cvt_pk_bf16_f32 v181, v180, v181
 v_lshlrev_b32 v180, 16, v181
 v_and_b32 v181, 0xffff0000, v181
 v_mul_f32 v180, v180, v178
 v_mul_f32 v181, v181, v179
 v_cvt_pk_bf16_f32 v191, v180, v181
 s_add_u32 s38, s34, 1536
 buffer_store_dwordx4 v[188:191], v25, s[16:19], s38 offen sc0 sc1
 v_lshrrev_b32 v35, 4, v1
 v_bfe_u32 v36, v1, 2, 2
 v_and_b32 v37, 3, v1
 v_lshrrev_b32 v38, 1, v35
 v_lshlrev_b32 v38, 4, v38
 v_and_b32 v39, 1, v35
 v_lshl_add_u32 v38, v39, 2, v38
 v_add_u32 v38, v38, v36
 v_lshl_add_u32 v39, v35, 3, v36
 v_lshlrev_b32 v37, 3, v37
 s_mul_i32 s31, s20, 3072
 s_add_u32 s31, s31, 102592
 v_add_u32 v37, s31, v37
 v_lshl_add_u32 v38, v38, 5, v37
 v_lshl_add_u32 v39, v39, 5, v37
 v_add_u32 v35, 256, v38
 v_add_u32 v36, 128, v39
 v_lshlrev_b32 v160, 4, v1
 s_waitcnt vmcnt(4)
 s_cmp_lt_u32 s80, 54
 s_cselect_b64 vcc, -1, 0
 s_nop 1
 v_cndmask_b32 v161, v39, v38, vcc
 v_cndmask_b32 v162, v36, v35, vcc
 ds_read_b64_tr_b16 v[164:165], v161 offset:0
 ds_read_b64_tr_b16 v[166:167], v162 offset:0
 s_cmp_lt_u32 s82, 54
 s_cselect_b64 vcc, -1, 0
 s_nop 1
 v_cndmask_b32 v161, v39, v38, vcc
 v_cndmask_b32 v162, v36, v35, vcc
 ds_read_b64_tr_b16 v[168:169], v161 offset:1024
 ds_read_b64_tr_b16 v[170:171], v162 offset:1024
 s_cmp_lt_u32 s84, 54
 s_cselect_b64 vcc, -1, 0
 s_nop 1
 v_cndmask_b32 v161, v39, v38, vcc
 v_cndmask_b32 v162, v36, v35, vcc
 ds_read_b64_tr_b16 v[172:173], v161 offset:2048
 ds_read_b64_tr_b16 v[174:175], v162 offset:2048
 s_mul_hi_u32 s24, s81, 858993460
 s_mul_i32 s25, s24, 5
 s_sub_u32 s25, s81, s25
 s_mul_i32 s24, s24, 74
 s_add_u32 s24, s24, s80
 s_mul_i32 s24, s24, 5120
 s_lshl_b32 s25, s25, 10
 s_add_u32 s24, s24, s25
 s_add_u32 s24, s24, 12582912
 s_waitcnt lgkmcnt(4)
 buffer_store_dwordx4 v[164:167], v160, s[16:19], s24 offen sc0 sc1
 s_mul_hi_u32 s24, s83, 858993460
 s_mul_i32 s25, s24, 5
 s_sub_u32 s25, s83, s25
 s_mul_i32 s24, s24, 74
 s_add_u32 s24, s24, s82
 s_mul_i32 s24, s24, 5120
 s_lshl_b32 s25, s25, 10
 s_add_u32 s24, s24, s25
 s_add_u32 s24, s24, 12582912
 s_waitcnt lgkmcnt(2)
 buffer_store_dwordx4 v[168:171], v160, s[16:19], s24 offen sc0 sc1
 s_mul_hi_u32 s24, s85, 858993460
 s_mul_i32 s25, s24, 5
 s_sub_u32 s25, s85, s25
 s_mul_i32 s24, s24, 74
 s_add_u32 s24, s24, s84
 s_mul_i32 s24, s24, 5120
 s_lshl_b32 s25, s25, 10
 s_add_u32 s24, s24, s25
 s_add_u32 s24, s24, 12582912
 s_waitcnt lgkmcnt(0)
 buffer_store_dwordx4 v[172:175], v160, s[16:19], s24 offen sc0 sc1
 s_endpgm
L3_C_h1:
 s_and_b32 s74, s35, 1024
 s_add_u32 s74, s74, 161792
 s_add_u32 m0, s36, 0
 s_movk_i32 s37, 0
 buffer_load_dwordx4 v2, s[4:7], s37 offen lds
 s_add_u32 m0, s36, 1024
 s_movk_i32 s37, 0
 buffer_load_dwordx4 v3, s[4:7], s37 offen lds
 s_add_u32 m0, s35, 0
 s_add_u32 s37, s88, 0
 buffer_load_dwordx4 v8, s[40:43], s37 offen lds
 s_add_u32 m0, s35, 8192
 s_add_u32 s37, s89, 0
 buffer_load_dwordx4 v9, s[56:59], s37 offen lds
 s_add_u32 s37, s62, 0
 s_cmp_lt_u32 s98, 4
 s_cselect_b32 m0, s37, s74
 s_nop 0
 buffer_load_dwordx4 v10, s[80:83], s90 offen lds
 s_add_u32 s90, s90, s63
 s_add_u32 m0, s35, 22528
 s_add_u32 s37, s88, 110592
 buffer_load_dwordx4 v8, s[40:43], s37 offen lds
 s_add_u32 m0, s35, 30720
 s_add_u32 s37, s89, 110592
 buffer_load_dwordx4 v9, s[56:59], s37 offen lds
 s_add_u32 s37, s62, 22528
 s_cmp_lt_u32 s98, 4
 s_cselect_b32 m0, s37, s74
 s_nop 0
 buffer_load_dwordx4 v10, s[80:83], s90 offen lds
 s_add_u32 s90, s90, s63
 s_add_u32 m0, s36, 16384
 s_movk_i32 s37, 128
 buffer_load_dwordx4 v2, s[4:7], s37 offen lds
 s_add_u32 m0, s36, 17408
 s_movk_i32 s37, 128
 buffer_load_dwordx4 v3, s[4:7], s37 offen lds
 s_add_u32 m0, s35, 45056
 s_add_u32 s37, s88, 221184
 buffer_load_dwordx4 v8, s[40:43], s37 offen lds
 s_add_u32 m0, s35, 53248
 s_add_u32 s37, s89, 221184
 buffer_load_dwordx4 v9, s[56:59], s37 offen lds
 s_add_u32 s37, s62, 45056
 s_cmp_lt_u32 s98, 4
 s_cselect_b32 m0, s37, s74
 s_nop 0
 buffer_load_dwordx4 v10, s[80:83], s90 offen lds
 s_add_u32 s90, s90, s63
 v_and_b32 v35, 31, v1
 v_lshrrev_b32 v36, 5, v1
 v_bfe_u32 v37, v1, 1, 3
 v_xor_b32 v37, v37, v36
 v_lshlrev_b32 v38, 7, v35
 s_lshl_b32 s24, s20, 12
 s_add_u32 s24, s24, 112640
 v_add_u32 v38, s24, v38
 v_xor_b32 v39, 0, v37
 v_lshl_add_u32 v4, v39, 4, v38
 v_xor_b32 v39, 2, v37
 v_lshl_add_u32 v5, v39, 4, v38
 v_xor_b32 v39, 4, v37
 v_lshl_add_u32 v6, v39, 4, v38
 v_xor_b32 v39, 6, v37
 v_lshl_add_u32 v7, v39, 4, v38
 v_bfe_u32 v35, v1, 4, 1
 v_lshrrev_b32 v36, 5, v1
 v_bfe_u32 v37, v1, 2, 2
 v_and_b32 v38, 3, v1
 v_lshlrev_b32 v39, 12, v35
 v_lshl_add_u32 v39, v36, 10, v39
 v_lshl_add_u32 v39, v37, 7, v39
 v_lshl_add_u32 v39, v38, 3, v39
 v_lshrrev_b32 v37, 1, v37
 v_lshl_or_b32 v37, v35, 1, v37
 v_xor_b32 v38, 0, v37
 v_lshl_add_u32 v17, v38, 5, v39
 v_add_u32 v21, 0x10000, v17
 v_xor_b32 v38, 1, v37
 v_lshl_add_u32 v18, v38, 5, v39
 v_add_u32 v22, 0x10000, v18
 v_xor_b32 v38, 2, v37
 v_lshl_add_u32 v19, v38, 5, v39
 v_add_u32 v23, 0x10000, v19
 v_xor_b32 v38, 3, v37
 v_lshl_add_u32 v20, v38, 5, v39
 v_add_u32 v24, 0x10000, v20
 s_lshl_b32 s24, s20, 1
 v_add_u32 v35, s24, v35
 s_mov_b32 s25, 55296
 v_mul_lo_u32 v35, v35, s25
 v_and_b32 v37, 15, v1
 v_lshl_add_u32 v37, v36, 4, v37
 v_lshl_add_u32 v25, v37, 4, v35
 s_mul_i32 s34, s21, 442368
 s_add_u32 s34, s34, 0
 s_lshl_b32 s24, s96, 11
 s_add_u32 s33, s34, s24
 s_lshl_b32 s24, s97, 9
 s_add_u32 s33, s33, s24
 s_lshl_b32 s24, s23, 11
 s_add_u32 s34, s34, s24
 v_mov_b32 v26, 0xc0135761
 v_mov_b32 v244, 0xbdd2d3e8
 v_mov_b32 v245, 0xbdd2d3e8
 v_mov_b32 v246, 0xc0135761
 v_mov_b32 v247, 0xc0135761
 v_bfe_u32 v35, v1, 4, 1
 v_bfe_u32 v37, v1, 2, 2
 v_and_b32 v38, 3, v1
 v_lshlrev_b32 v39, 11, v35
 v_lshl_add_u32 v39, v36, 9, v39
 v_lshl_add_u32 v39, v37, 6, v39
 v_lshl_add_u32 v39, v38, 3, v39
 v_lshl_add_u32 v252, v35, 5, v39
 v_xor_b32 v253, 32, v252
 v_add_u32 v254, 0x10000, v252
 v_add_u32 v255, 0x10000, v253
 s_cmp_eq_u32 s20, 0
 s_cselect_b32 s76, s8, s12
 s_cselect_b32 s77, s9, s13
 s_mov_b32 s78, 2211840
 s_mov_b32 s61, 221184
 s_mul_i32 s60, s2, 864
 s_cmp_eq_u32 s20, 2
 s_cselect_b32 s76, s64, s76
 s_cselect_b32 s77, s65, s77
 s_cselect_b32 s78, 2457600, s78
 s_cselect_b32 s61, 245760, s61
 s_mul_i32 s24, s2, 960
 s_cselect_b32 s60, s24, s60
 s_cmp_eq_u32 s20, 3
 s_cselect_b32 s76, s4, s76
 s_cselect_b32 s77, s5, s77
 s_cselect_b32 s78, 2621440, s78
 s_cselect_b32 s61, 128, s61
 s_mul_i32 s24, s2, 10240
 s_cselect_b32 s60, s24, s60
 s_mov_b32 s79, 0x00020000
 s_movk_i32 s24, 128
 s_cselect_b32 s24, 1280, s24
 v_mul_lo_u32 v35, v1, s24
 v_mov_b32 v36, 0x80000000
 v_cmp_gt_u32 vcc, 8, v1
 s_nop 1
 v_cndmask_b32 v251, v36, v35, vcc
 s_add_u32 s60, s60, s61
 buffer_load_dword v250, v251, s[76:79], s60 offen
 s_add_u32 s60, s60, s61
 buffer_load_dword v250, v251, s[76:79], s60 offen
 s_add_u32 s60, s60, s61
 s_setprio 1
 s_waitcnt vmcnt(10)
 s_barrier
 buffer_load_dword v250, v251, s[76:79], s60 offen
 s_add_u32 s60, s60, s61
 ds_read_b128 v[176:179], v4 offset:0
 ds_read_b128 v[180:183], v5 offset:0
 ds_read_b64_tr_b16 v[40:41], v17 offset:8192
 ds_read_b64_tr_b16 v[42:43], v17 offset:8704
 s_add_u32 m0, s35, 67584
 s_add_u32 s37, s88, 331776
 buffer_load_dwordx4 v8, s[40:43], s37 offen lds
 ds_read_b64_tr_b16 v[44:45], v18 offset:8192
 ds_read_b64_tr_b16 v[46:47], v18 offset:8704
 s_add_u32 m0, s35, 75776
 s_add_u32 s37, s89, 331776
 buffer_load_dwordx4 v9, s[56:59], s37 offen lds
 ds_read_b64_tr_b16 v[48:49], v19 offset:8192
 ds_read_b64_tr_b16 v[50:51], v19 offset:8704
 s_add_u32 s37, s62, 67584
 s_cmp_lt_u32 s98, 4
 s_cselect_b32 m0, s37, s74
 s_nop 0
 buffer_load_dwordx4 v10, s[80:83], s90 offen lds
 s_add_u32 s90, s90, s63
 s_waitcnt lgkmcnt(4)
 v_mfma_f32_32x32x16_bf16 v[64:79], v[40:43], v[176:179], 0
 ds_read_b64_tr_b16 v[52:53], v20 offset:8192
 ds_read_b64_tr_b16 v[54:55], v20 offset:8704
 s_waitcnt lgkmcnt(4)
 v_mfma_f32_32x32x16_bf16 v[80:95], v[44:47], v[176:179], 0
 ds_read_b64_tr_b16 v[56:57], v252 offset:16384
 ds_read_b64_tr_b16 v[58:59], v252 offset:16640
 s_waitcnt lgkmcnt(4)
 v_mfma_f32_32x32x16_bf16 v[96:111], v[48:51], v[176:179], 0
 ds_read_b64_tr_b16 v[60:61], v253 offset:16384
 ds_read_b64_tr_b16 v[62:63], v253 offset:16640
 s_waitcnt lgkmcnt(4)
 v_mfma_f32_32x32x16_bf16 v[112:127], v[52:55], v[176:179], 0
 ds_read_b64_tr_b16 v[40:41], v17 offset:10240
 ds_read_b64_tr_b16 v[42:43], v17 offset:10752
 s_waitcnt lgkmcnt(4)
 v_mfma_f32_32x32x16_bf16 v[128:143], v[56:59], v[176:179], 0
 ds_read_b64_tr_b16 v[44:45], v18 offset:10240
 ds_read_b64_tr_b16 v[46:47], v18 offset:10752
 s_waitcnt lgkmcnt(4)
 v_mfma_f32_32x32x16_bf16 v[144:159], v[60:63], v[176:179], 0
 ds_read_b64_tr_b16 v[48:49], v19 offset:10240
 ds_read_b64_tr_b16 v[50:51], v19 offset:10752
 s_waitcnt lgkmcnt(4)
 v_mfma_f32_32x32x16_bf16 v[64:79], v[40:43], v[180:183], v[64:79]
 ds_read_b64_tr_b16 v[52:53], v20 offset:10240
 ds_read_b64_tr_b16 v[54:55], v20 offset:10752
 s_waitcnt lgkmcnt(4)
 v_mfma_f32_32x32x16_bf16 v[80:95], v[44:47], v[180:183], v[80:95]
 ds_read_b64_tr_b16 v[56:57], v252 offset:17408
 ds_read_b64_tr_b16 v[58:59], v252 offset:17664
 s_waitcnt lgkmcnt(4)
 v_mfma_f32_32x32x16_bf16 v[96:111], v[48:51], v[180:183], v[96:111]
 ds_read_b64_tr_b16 v[60:61], v253 offset:17408
 ds_read_b64_tr_b16 v[62:63], v253 offset:17664
 s_waitcnt lgkmcnt(4)
 v_mfma_f32_32x32x16_bf16 v[112:127], v[52:55], v[180:183], v[112:127]
 s_waitcnt vmcnt(11)
 s_barrier
 ds_read_b128 v[184:187], v6 offset:0
 ds_read_b128 v[188:191], v7 offset:0
 ds_read_b64_tr_b16 v[40:41], v17 offset:30720
 ds_read_b64_tr_b16 v[42:43], v17 offset:31232
 s_add_u32 m0, s35, 90112
 s_add_u32 s37, s88, 442368
 buffer_load_dwordx4 v8, s[40:43], s37 offen lds
 s_waitcnt lgkmcnt(6)
 v_mfma_f32_32x32x16_bf16 v[128:143], v[56:59], v[180:183], v[128:143]
 ds_read_b64_tr_b16 v[44:45], v18 offset:30720
 ds_read_b64_tr_b16 v[46:47], v18 offset:31232
 s_add_u32 m0, s35, 98304
 s_add_u32 s37, s89, 442368
 buffer_load_dwordx4 v9, s[56:59], s37 offen lds
 s_waitcnt lgkmcnt(6)
 v_mfma_f32_32x32x16_bf16 v[144:159], v[60:63], v[180:183], v[144:159]
 ds_read_b64_tr_b16 v[48:49], v19 offset:30720
 ds_read_b64_tr_b16 v[50:51], v19 offset:31232
 s_add_u32 s37, s62, 90112
 s_cmp_lt_u32 s98, 4
 s_cselect_b32 m0, s37, s74
 s_nop 0
 buffer_load_dwordx4 v10, s[80:83], s90 offen lds
 s_add_u32 s90, s90, s63
 s_waitcnt lgkmcnt(4)
 v_mfma_f32_32x32x16_bf16 v[64:79], v[40:43], v[184:187], v[64:79]
 ds_read_b64_tr_b16 v[52:53], v20 offset:30720
 ds_read_b64_tr_b16 v[54:55], v20 offset:31232
 s_add_u32 m0, s36, 32768
 s_movk_i32 s37, 256
 buffer_load_dwordx4 v2, s[4:7], s37 offen lds
 s_waitcnt lgkmcnt(4)
 v_mfma_f32_32x32x16_bf16 v[80:95], v[44:47], v[184:187], v[80:95]
 ds_read_b64_tr_b16 v[56:57], v252 offset:38912
 ds_read_b64_tr_b16 v[58:59], v252 offset:39168
 s_add_u32 m0, s36, 33792
 s_movk_i32 s37, 256
 buffer_load_dwordx4 v3, s[4:7], s37 offen lds
 s_waitcnt lgkmcnt(4)
 v_mfma_f32_32x32x16_bf16 v[96:111], v[48:51], v[184:187], v[96:111]
 ds_read_b64_tr_b16 v[60:61], v253 offset:38912
 ds_read_b64_tr_b16 v[62:63], v253 offset:39168
 s_waitcnt lgkmcnt(4)
 v_mfma_f32_32x32x16_bf16 v[112:127], v[52:55], v[184:187], v[112:127]
 ds_read_b64_tr_b16 v[40:41], v17 offset:32768
 ds_read_b64_tr_b16 v[42:43], v17 offset:33280
 s_waitcnt lgkmcnt(4)
 v_mfma_f32_32x32x16_bf16 v[128:143], v[56:59], v[184:187], v[128:143]
 ds_read_b64_tr_b16 v[44:45], v18 offset:32768
 ds_read_b64_tr_b16 v[46:47], v18 offset:33280
 s_waitcnt lgkmcnt(4)
 v_mfma_f32_32x32x16_bf16 v[144:159], v[60:63], v[184:187], v[144:159]
 ds_read_b64_tr_b16 v[48:49], v19 offset:32768
 ds_read_b64_tr_b16 v[50:51], v19 offset:33280
 s_waitcnt lgkmcnt(4)
 v_mfma_f32_32x32x16_bf16 v[64:79], v[40:43], v[188:191], v[64:79]
 ds_read_b64_tr_b16 v[52:53], v20 offset:32768
 ds_read_b64_tr_b16 v[54:55], v20 offset:33280
 s_waitcnt lgkmcnt(4)
 v_mfma_f32_32x32x16_bf16 v[80:95], v[44:47], v[188:191], v[80:95]
 ds_read_b64_tr_b16 v[56:57], v252 offset:39936
 ds_read_b64_tr_b16 v[58:59], v252 offset:40192
 s_waitcnt lgkmcnt(4)
 v_mfma_f32_32x32x16_bf16 v[96:111], v[48:51], v[188:191], v[96:111]
 ds_read_b64_tr_b16 v[60:61], v253 offset:39936
 ds_read_b64_tr_b16 v[62:63], v253 offset:40192
 s_waitcnt lgkmcnt(4)
 v_mfma_f32_32x32x16_bf16 v[112:127], v[52:55], v[188:191], v[112:127]
 s_waitcnt vmcnt(11)
 s_barrier
 buffer_load_dword v250, v251, s[76:79], s60 offen
 s_add_u32 s60, s60, s61
 ds_read_b128 v[176:179], v4 offset:16384
 ds_read_b128 v[180:183], v5 offset:16384
 ds_read_b64_tr_b16 v[40:41], v17 offset:53248
 ds_read_b64_tr_b16 v[42:43], v17 offset:53760
 s_add_u32 m0, s35, 0
 s_add_u32 s37, s88, 552960
 buffer_load_dwordx4 v8, s[40:43], s37 offen lds
 s_waitcnt lgkmcnt(6)
 v_mfma_f32_32x32x16_bf16 v[128:143], v[56:59], v[188:191], v[128:143]
 ds_read_b64_tr_b16 v[44:45], v18 offset:53248
 ds_read_b64_tr_b16 v[46:47], v18 offset:53760
 s_add_u32 m0, s35, 8192
 s_add_u32 s37, s89, 552960
 buffer_load_dwordx4 v9, s[56:59], s37 offen lds
 s_waitcnt lgkmcnt(6)
 v_mfma_f32_32x32x16_bf16 v[144:159], v[60:63], v[188:191], v[144:159]
 ds_read_b64_tr_b16 v[48:49], v19 offset:53248
 ds_read_b64_tr_b16 v[50:51], v19 offset:53760
 s_add_u32 s37, s62, 0
 s_cmp_lt_u32 s98, 4
 s_cselect_b32 m0, s37, s74
 s_nop 0
 buffer_load_dwordx4 v10, s[80:83], s90 offen lds
 s_add_u32 s90, s90, s63
 s_waitcnt lgkmcnt(4)
 v_mfma_f32_32x32x16_bf16 v[64:79], v[40:43], v[176:179], v[64:79]
 ds_read_b64_tr_b16 v[52:53], v20 offset:53248
 ds_read_b64_tr_b16 v[54:55], v20 offset:53760
 s_waitcnt lgkmcnt(4)
 v_mfma_f32_32x32x16_bf16 v[80:95], v[44:47], v[176:179], v[80:95]
 ds_read_b64_tr_b16 v[56:57], v252 offset:61440
 ds_read_b64_tr_b16 v[58:59], v252 offset:61696
 s_waitcnt lgkmcnt(4)
 v_mfma_f32_32x32x16_bf16 v[96:111], v[48:51], v[176:179], v[96:111]
 ds_read_b64_tr_b16 v[60:61], v253 offset:61440
 ds_read_b64_tr_b16 v[62:63], v253 offset:61696
 s_waitcnt lgkmcnt(4)
 v_mfma_f32_32x32x16_bf16 v[112:127], v[52:55], v[176:179], v[112:127]
 ds_read_b64_tr_b16 v[40:41], v17 offset:55296
 ds_read_b64_tr_b16 v[42:43], v17 offset:55808
 s_waitcnt lgkmcnt(4)
 v_mfma_f32_32x32x16_bf16 v[128:143], v[56:59], v[176:179], v[128:143]
 ds_read_b64_tr_b16 v[44:45], v18 offset:55296
 ds_read_b64_tr_b16 v[46:47], v18 offset:55808
 s_waitcnt lgkmcnt(4)
 v_mfma_f32_32x32x16_bf16 v[144:159], v[60:63], v[176:179], v[144:159]
 ds_read_b64_tr_b16 v[48:49], v19 offset:55296
 ds_read_b64_tr_b16 v[50:51], v19 offset:55808
 s_waitcnt lgkmcnt(4)
 v_mfma_f32_32x32x16_bf16 v[64:79], v[40:43], v[180:183], v[64:79]
 ds_read_b64_tr_b16 v[52:53], v20 offset:55296
 ds_read_b64_tr_b16 v[54:55], v20 offset:55808
 s_waitcnt lgkmcnt(4)
 v_mfma_f32_32x32x16_bf16 v[80:95], v[44:47], v[180:183], v[80:95]
 ds_read_b64_tr_b16 v[56:57], v252 offset:62464
 ds_read_b64_tr_b16 v[58:59], v252 offset:62720
 s_waitcnt lgkmcnt(4)
 v_mfma_f32_32x32x16_bf16 v[96:111], v[48:51], v[180:183], v[96:111]
 ds_read_b64_tr_b16 v[60:61], v253 offset:62464
 ds_read_b64_tr_b16 v[62:63], v253 offset:62720
 s_waitcnt lgkmcnt(4)
 v_mfma_f32_32x32x16_bf16 v[112:127], v[52:55], v[180:183], v[112:127]
 s_waitcnt vmcnt(9)
 s_barrier
 ds_read_b128 v[184:187], v6 offset:16384
 ds_read_b128 v[188:191], v7 offset:16384
 ds_read_b64_tr_b16 v[40:41], v21 offset:10240
 ds_read_b64_tr_b16 v[42:43], v21 offset:10752
 s_add_u32 m0, s35, 22528
 s_add_u32 s37, s88, 663552
 buffer_load_dwordx4 v8, s[40:43], s37 offen lds
 s_waitcnt lgkmcnt(6)
 v_mfma_f32_32x32x16_bf16 v[128:143], v[56:59], v[180:183], v[128:143]
 ds_read_b64_tr_b16 v[44:45], v22 offset:10240
 ds_read_b64_tr_b16 v[46:47], v22 offset:10752
 s_add_u32 m0, s35, 30720
 s_add_u32 s37, s89, 663552
 buffer_load_dwordx4 v9, s[56:59], s37 offen lds
 s_waitcnt lgkmcnt(6)
 v_mfma_f32_32x32x16_bf16 v[144:159], v[60:63], v[180:183], v[144:159]
 ds_read_b64_tr_b16 v[48:49], v23 offset:10240
 ds_read_b64_tr_b16 v[50:51], v23 offset:10752
 s_add_u32 s37, s62, 22528
 s_cmp_lt_u32 s98, 4
 s_cselect_b32 m0, s37, s74
 s_nop 0
 buffer_load_dwordx4 v10, s[80:83], s90 offen lds
 s_add_u32 s90, s90, s63
 s_waitcnt lgkmcnt(4)
 v_mfma_f32_32x32x16_bf16 v[64:79], v[40:43], v[184:187], v[64:79]
 ds_read_b64_tr_b16 v[52:53], v24 offset:10240
 ds_read_b64_tr_b16 v[54:55], v24 offset:10752
 s_add_u32 m0, s36, 0
 s_movk_i32 s37, 384
 buffer_load_dwordx4 v2, s[4:7], s37 offen lds
 s_waitcnt lgkmcnt(4)
 v_mfma_f32_32x32x16_bf16 v[80:95], v[44:47], v[184:187], v[80:95]
 ds_read_b64_tr_b16 v[56:57], v254 offset:18432
 ds_read_b64_tr_b16 v[58:59], v254 offset:18688
 s_add_u32 m0, s36, 1024
 s_movk_i32 s37, 384
 buffer_load_dwordx4 v3, s[4:7], s37 offen lds
 s_waitcnt lgkmcnt(4)
 v_mfma_f32_32x32x16_bf16 v[96:111], v[48:51], v[184:187], v[96:111]
 ds_read_b64_tr_b16 v[60:61], v255 offset:18432
 ds_read_b64_tr_b16 v[62:63], v255 offset:18688
 s_waitcnt lgkmcnt(4)
 v_mfma_f32_32x32x16_bf16 v[112:127], v[52:55], v[184:187], v[112:127]
 ds_read_b64_tr_b16 v[40:41], v21 offset:12288
 ds_read_b64_tr_b16 v[42:43], v21 offset:12800
 s_waitcnt lgkmcnt(4)
 v_mfma_f32_32x32x16_bf16 v[128:143], v[56:59], v[184:187], v[128:143]
 ds_read_b64_tr_b16 v[44:45], v22 offset:12288
 ds_read_b64_tr_b16 v[46:47], v22 offset:12800
 s_waitcnt lgkmcnt(4)
 v_mfma_f32_32x32x16_bf16 v[144:159], v[60:63], v[184:187], v[144:159]
 ds_read_b64_tr_b16 v[48:49], v23 offset:12288
 ds_read_b64_tr_b16 v[50:51], v23 offset:12800
 s_waitcnt lgkmcnt(4)
 v_mfma_f32_32x32x16_bf16 v[64:79], v[40:43], v[188:191], v[64:79]
 ds_read_b64_tr_b16 v[52:53], v24 offset:12288
 ds_read_b64_tr_b16 v[54:55], v24 offset:12800
 s_waitcnt lgkmcnt(4)
 v_mfma_f32_32x32x16_bf16 v[80:95], v[44:47], v[188:191], v[80:95]
 ds_read_b64_tr_b16 v[56:57], v254 offset:19456
 ds_read_b64_tr_b16 v[58:59], v254 offset:19712
 s_waitcnt lgkmcnt(4)
 v_mfma_f32_32x32x16_bf16 v[96:111], v[48:51], v[188:191], v[96:111]
 ds_read_b64_tr_b16 v[60:61], v255 offset:19456
 ds_read_b64_tr_b16 v[62:63], v255 offset:19712
 s_waitcnt lgkmcnt(4)
 v_mfma_f32_32x32x16_bf16 v[112:127], v[52:55], v[188:191], v[112:127]
 s_waitcnt vmcnt(9)
 s_barrier
 buffer_load_dword v250, v251, s[76:79], s60 offen
 s_add_u32 s60, s60, s61
 ds_read_b128 v[176:179], v4 offset:32768
 ds_read_b128 v[180:183], v5 offset:32768
 ds_read_b64_tr_b16 v[40:41], v21 offset:32768
 ds_read_b64_tr_b16 v[42:43], v21 offset:33280
 s_add_u32 m0, s35, 45056
 s_add_u32 s37, s88, 774144
 buffer_load_dwordx4 v8, s[40:43], s37 offen lds
 s_waitcnt lgkmcnt(6)
 v_mfma_f32_32x32x16_bf16 v[128:143], v[56:59], v[188:191], v[128:143]
 ds_read_b64_tr_b16 v[44:45], v22 offset:32768
 ds_read_b64_tr_b16 v[46:47], v22 offset:33280
 s_add_u32 m0, s35, 53248
 s_add_u32 s37, s89, 774144
 buffer_load_dwordx4 v9, s[56:59], s37 offen lds
 s_waitcnt lgkmcnt(6)
 v_mfma_f32_32x32x16_bf16 v[144:159], v[60:63], v[188:191], v[144:159]
 ds_read_b64_tr_b16 v[48:49], v23 offset:32768
 ds_read_b64_tr_b16 v[50:51], v23 offset:33280
 s_add_u32 s37, s62, 45056
 s_cmp_lt_u32 s98, 4
 s_cselect_b32 m0, s37, s74
 s_nop 0
 buffer_load_dwordx4 v10, s[80:83], s90 offen lds
 s_add_u32 s90, s90, s63
 s_waitcnt lgkmcnt(4)
 v_mfma_f32_32x32x16_bf16 v[64:79], v[40:43], v[176:179], v[64:79]
 ds_read_b64_tr_b16 v[52:53], v24 offset:32768
 ds_read_b64_tr_b16 v[54:55], v24 offset:33280
 s_waitcnt lgkmcnt(4)
 v_mfma_f32_32x32x16_bf16 v[80:95], v[44:47], v[176:179], v[80:95]
 ds_read_b64_tr_b16 v[56:57], v254 offset:40960
 ds_read_b64_tr_b16 v[58:59], v254 offset:41216
 s_waitcnt lgkmcnt(4)
 v_mfma_f32_32x32x16_bf16 v[96:111], v[48:51], v[176:179], v[96:111]
 ds_read_b64_tr_b16 v[60:61], v255 offset:40960
 ds_read_b64_tr_b16 v[62:63], v255 offset:41216
 s_waitcnt lgkmcnt(4)
 v_mfma_f32_32x32x16_bf16 v[112:127], v[52:55], v[176:179], v[112:127]
 ds_read_b64_tr_b16 v[40:41], v21 offset:34816
 ds_read_b64_tr_b16 v[42:43], v21 offset:35328
 s_waitcnt lgkmcnt(4)
 v_mfma_f32_32x32x16_bf16 v[128:143], v[56:59], v[176:179], v[128:143]
 ds_read_b64_tr_b16 v[44:45], v22 offset:34816
 ds_read_b64_tr_b16 v[46:47], v22 offset:35328
 s_waitcnt lgkmcnt(4)
 v_mfma_f32_32x32x16_bf16 v[144:159], v[60:63], v[176:179], v[144:159]
 ds_read_b64_tr_b16 v[48:49], v23 offset:34816
 ds_read_b64_tr_b16 v[50:51], v23 offset:35328
 s_waitcnt lgkmcnt(4)
 v_mfma_f32_32x32x16_bf16 v[64:79], v[40:43], v[180:183], v[64:79]
 ds_read_b64_tr_b16 v[52:53], v24 offset:34816
 ds_read_b64_tr_b16 v[54:55], v24 offset:35328
 s_waitcnt lgkmcnt(4)
 v_mfma_f32_32x32x16_bf16 v[80:95], v[44:47], v[180:183], v[80:95]
 ds_read_b64_tr_b16 v[56:57], v254 offset:41984
 ds_read_b64_tr_b16 v[58:59], v254 offset:42240
 s_waitcnt lgkmcnt(4)
 v_mfma_f32_32x32x16_bf16 v[96:111], v[48:51], v[180:183], v[96:111]
 ds_read_b64_tr_b16 v[60:61], v255 offset:41984
 ds_read_b64_tr_b16 v[62:63], v255 offset:42240
 s_waitcnt lgkmcnt(4)
 v_mfma_f32_32x32x16_bf16 v[112:127], v[52:55], v[180:183], v[112:127]
 s_waitcnt vmcnt(9)
 s_barrier
 ds_read_b128 v[184:187], v6 offset:32768
 ds_read_b128 v[188:191], v7 offset:32768
 ds_read_b64_tr_b16 v[40:41], v17 offset:8192
 ds_read_b64_tr_b16 v[42:43], v17 offset:8704
 s_add_u32 m0, s35, 67584
 s_add_u32 s37, s88, 884736
 buffer_load_dwordx4 v8, s[40:43], s37 offen lds
 s_waitcnt lgkmcnt(6)
 v_mfma_f32_32x32x16_bf16 v[128:143], v[56:59], v[180:183], v[128:143]
 ds_read_b64_tr_b16 v[44:45], v18 offset:8192
 ds_read_b64_tr_b16 v[46:47], v18 offset:8704
 s_add_u32 m0, s35, 75776
 s_add_u32 s37, s89, 884736
 buffer_load_dwordx4 v9, s[56:59], s37 offen lds
 s_waitcnt lgkmcnt(6)
 v_mfma_f32_32x32x16_bf16 v[144:159], v[60:63], v[180:183], v[144:159]
 ds_read_b64_tr_b16 v[48:49], v19 offset:8192
 ds_read_b64_tr_b16 v[50:51], v19 offset:8704
 s_add_u32 s37, s62, 67584
 s_cmp_lt_u32 s98, 4
 s_cselect_b32 m0, s37, s74
 s_nop 0
 buffer_load_dwordx4 v10, s[80:83], s90 offen lds
 s_add_u32 s90, s90, s63
 s_waitcnt lgkmcnt(4)
 v_mfma_f32_32x32x16_bf16 v[64:79], v[40:43], v[184:187], v[64:79]
 ds_read_b64_tr_b16 v[52:53], v20 offset:8192
 ds_read_b64_tr_b16 v[54:55], v20 offset:8704
 s_add_u32 m0, s36, 16384
 s_movk_i32 s37, 512
 buffer_load_dwordx4 v2, s[4:7], s37 offen lds
 s_waitcnt lgkmcnt(4)
 v_mfma_f32_32x32x16_bf16 v[80:95], v[44:47], v[184:187], v[80:95]
 ds_read_b64_tr_b16 v[56:57], v252 offset:16384
 ds_read_b64_tr_b16 v[58:59], v252 offset:16640
 s_add_u32 m0, s36, 17408
 s_movk_i32 s37, 512
 buffer_load_dwordx4 v3, s[4:7], s37 offen lds
 s_waitcnt lgkmcnt(4)
 v_mfma_f32_32x32x16_bf16 v[96:111], v[48:51], v[184:187], v[96:111]
 ds_read_b64_tr_b16 v[60:61], v253 offset:16384
 ds_read_b64_tr_b16 v[62:63], v253 offset:16640
 s_waitcnt lgkmcnt(4)
 v_mfma_f32_32x32x16_bf16 v[112:127], v[52:55], v[184:187], v[112:127]
 ds_read_b64_tr_b16 v[40:41], v17 offset:10240
 ds_read_b64_tr_b16 v[42:43], v17 offset:10752
 s_waitcnt lgkmcnt(4)
 v_mfma_f32_32x32x16_bf16 v[128:143], v[56:59], v[184:187], v[128:143]
 ds_read_b64_tr_b16 v[44:45], v18 offset:10240
 ds_read_b64_tr_b16 v[46:47], v18 offset:10752
 s_waitcnt lgkmcnt(4)
 v_mfma_f32_32x32x16_bf16 v[144:159], v[60:63], v[184:187], v[144:159]
 ds_read_b64_tr_b16 v[48:49], v19 offset:10240
 ds_read_b64_tr_b16 v[50:51], v19 offset:10752
 s_waitcnt lgkmcnt(4)
 v_mfma_f32_32x32x16_bf16 v[64:79], v[40:43], v[188:191], v[64:79]
 ds_read_b64_tr_b16 v[52:53], v20 offset:10240
 ds_read_b64_tr_b16 v[54:55], v20 offset:10752
 s_waitcnt lgkmcnt(4)
 v_mfma_f32_32x32x16_bf16 v[80:95], v[44:47], v[188:191], v[80:95]
 ds_read_b64_tr_b16 v[56:57], v252 offset:17408
 ds_read_b64_tr_b16 v[58:59], v252 offset:17664
 s_waitcnt lgkmcnt(4)
 v_mfma_f32_32x32x16_bf16 v[96:111], v[48:51], v[188:191], v[96:111]
 ds_read_b64_tr_b16 v[60:61], v253 offset:17408
 ds_read_b64_tr_b16 v[62:63], v253 offset:17664
 s_waitcnt lgkmcnt(4)
 v_mfma_f32_32x32x16_bf16 v[112:127], v[52:55], v[188:191], v[112:127]
 s_waitcnt vmcnt(9)
 s_barrier
 buffer_load_dword v250, v251, s[76:79], s60 offen
 s_add_u32 s60, s60, s61
 ds_read_b128 v[176:179], v4 offset:0
 ds_read_b128 v[180:183], v5 offset:0
 ds_read_b64_tr_b16 v[40:41], v17 offset:30720
 ds_read_b64_tr_b16 v[42:43], v17 offset:31232
 s_add_u32 m0, s35, 90112
 s_add_u32 s37, s88, 995328
 buffer_load_dwordx4 v8, s[40:43], s37 offen lds
 s_waitcnt lgkmcnt(6)
 v_mfma_f32_32x32x16_bf16 v[128:143], v[56:59], v[188:191], v[128:143]
 ds_read_b64_tr_b16 v[44:45], v18 offset:30720
 ds_read_b64_tr_b16 v[46:47], v18 offset:31232
 s_add_u32 m0, s35, 98304
 s_add_u32 s37, s89, 995328
 buffer_load_dwordx4 v9, s[56:59], s37 offen lds
 s_waitcnt lgkmcnt(6)
 v_mfma_f32_32x32x16_bf16 v[144:159], v[60:63], v[188:191], v[144:159]
 ds_read_b64_tr_b16 v[48:49], v19 offset:30720
 ds_read_b64_tr_b16 v[50:51], v19 offset:31232
 s_add_u32 s37, s62, 90112
 s_cmp_lt_u32 s98, 4
 s_cselect_b32 m0, s37, s74
 s_nop 0
 buffer_load_dwordx4 v10, s[80:83], s90 offen lds
 s_add_u32 s90, s90, s63
 s_waitcnt lgkmcnt(4)
 v_mfma_f32_32x32x16_bf16 v[64:79], v[40:43], v[176:179], v[64:79]
 ds_read_b64_tr_b16 v[52:53], v20 offset:30720
 ds_read_b64_tr_b16 v[54:55], v20 offset:31232
 s_waitcnt lgkmcnt(4)
 v_mfma_f32_32x32x16_bf16 v[80:95], v[44:47], v[176:179], v[80:95]
 ds_read_b64_tr_b16 v[56:57], v252 offset:38912
 ds_read_b64_tr_b16 v[58:59], v252 offset:39168
 s_waitcnt lgkmcnt(4)
 v_mfma_f32_32x32x16_bf16 v[96:111], v[48:51], v[176:179], v[96:111]
 ds_read_b64_tr_b16 v[60:61], v253 offset:38912
 ds_read_b64_tr_b16 v[62:63], v253 offset:39168
 s_waitcnt lgkmcnt(4)
 v_mfma_f32_32x32x16_bf16 v[112:127], v[52:55], v[176:179], v[112:127]
 ds_read_b64_tr_b16 v[40:41], v17 offset:32768
 ds_read_b64_tr_b16 v[42:43], v17 offset:33280
 s_waitcnt lgkmcnt(4)
 v_mfma_f32_32x32x16_bf16 v[128:143], v[56:59], v[176:179], v[128:143]
 ds_read_b64_tr_b16 v[44:45], v18 offset:32768
 ds_read_b64_tr_b16 v[46:47], v18 offset:33280
 s_waitcnt lgkmcnt(4)
 v_mfma_f32_32x32x16_bf16 v[144:159], v[60:63], v[176:179], v[144:159]
 ds_read_b64_tr_b16 v[48:49], v19 offset:32768
 ds_read_b64_tr_b16 v[50:51], v19 offset:33280
 s_waitcnt lgkmcnt(4)
 v_mfma_f32_32x32x16_bf16 v[64:79], v[40:43], v[180:183], v[64:79]
 ds_read_b64_tr_b16 v[52:53], v20 offset:32768
 ds_read_b64_tr_b16 v[54:55], v20 offset:33280
 s_waitcnt lgkmcnt(4)
 v_mfma_f32_32x32x16_bf16 v[80:95], v[44:47], v[180:183], v[80:95]
 ds_read_b64_tr_b16 v[56:57], v252 offset:39936
 ds_read_b64_tr_b16 v[58:59], v252 offset:40192
 s_waitcnt lgkmcnt(4)
 v_mfma_f32_32x32x16_bf16 v[96:111], v[48:51], v[180:183], v[96:111]
 ds_read_b64_tr_b16 v[60:61], v253 offset:39936
 ds_read_b64_tr_b16 v[62:63], v253 offset:40192
 s_waitcnt lgkmcnt(4)
 v_mfma_f32_32x32x16_bf16 v[112:127], v[52:55], v[180:183], v[112:127]
 s_waitcnt vmcnt(9)
 s_barrier
 ds_read_b128 v[184:187], v6 offset:0
 ds_read_b128 v[188:191], v7 offset:0
 ds_read_b64_tr_b16 v[40:41], v17 offset:53248
 ds_read_b64_tr_b16 v[42:43], v17 offset:53760
 s_add_u32 m0, s35, 0
 s_add_u32 s37, s88, 1105920
 buffer_load_dwordx4 v8, s[40:43], s37 offen lds
 s_waitcnt lgkmcnt(6)
 v_mfma_f32_32x32x16_bf16 v[128:143], v[56:59], v[180:183], v[128:143]
 ds_read_b64_tr_b16 v[44:45], v18 offset:53248
 ds_read_b64_tr_b16 v[46:47], v18 offset:53760
 s_add_u32 m0, s35, 8192
 s_add_u32 s37, s89, 1105920
 buffer_load_dwordx4 v9, s[56:59], s37 offen lds
 s_waitcnt lgkmcnt(6)
 v_mfma_f32_32x32x16_bf16 v[144:159], v[60:63], v[180:183], v[144:159]
 ds_read_b64_tr_b16 v[48:49], v19 offset:53248
 ds_read_b64_tr_b16 v[50:51], v19 offset:53760
 s_add_u32 s37, s62, 0
 s_cmp_lt_u32 s98, 4
 s_cselect_b32 m0, s37, s74
 s_nop 0
 buffer_load_dwordx4 v10, s[80:83], s90 offen lds
 s_add_u32 s90, s90, s63
 s_waitcnt lgkmcnt(4)
 v_mfma_f32_32x32x16_bf16 v[64:79], v[40:43], v[184:187], v[64:79]
 ds_read_b64_tr_b16 v[52:53], v20 offset:53248
 ds_read_b64_tr_b16 v[54:55], v20 offset:53760
 s_add_u32 m0, s36, 32768
 s_movk_i32 s37, 640
 buffer_load_dwordx4 v2, s[4:7], s37 offen lds
 s_waitcnt lgkmcnt(4)
 v_mfma_f32_32x32x16_bf16 v[80:95], v[44:47], v[184:187], v[80:95]
 ds_read_b64_tr_b16 v[56:57], v252 offset:61440
 ds_read_b64_tr_b16 v[58:59], v252 offset:61696
 s_add_u32 m0, s36, 33792
 s_movk_i32 s37, 640
 buffer_load_dwordx4 v3, s[4:7], s37 offen lds
 s_waitcnt lgkmcnt(4)
 v_mfma_f32_32x32x16_bf16 v[96:111], v[48:51], v[184:187], v[96:111]
 ds_read_b64_tr_b16 v[60:61], v253 offset:61440
 ds_read_b64_tr_b16 v[62:63], v253 offset:61696
 s_waitcnt lgkmcnt(4)
 v_mfma_f32_32x32x16_bf16 v[112:127], v[52:55], v[184:187], v[112:127]
 ds_read_b64_tr_b16 v[40:41], v17 offset:55296
 ds_read_b64_tr_b16 v[42:43], v17 offset:55808
 s_waitcnt lgkmcnt(4)
 v_mfma_f32_32x32x16_bf16 v[128:143], v[56:59], v[184:187], v[128:143]
 ds_read_b64_tr_b16 v[44:45], v18 offset:55296
 ds_read_b64_tr_b16 v[46:47], v18 offset:55808
 s_waitcnt lgkmcnt(4)
 v_mfma_f32_32x32x16_bf16 v[144:159], v[60:63], v[184:187], v[144:159]
 ds_read_b64_tr_b16 v[48:49], v19 offset:55296
 ds_read_b64_tr_b16 v[50:51], v19 offset:55808
 s_waitcnt lgkmcnt(4)
 v_mfma_f32_32x32x16_bf16 v[64:79], v[40:43], v[188:191], v[64:79]
 ds_read_b64_tr_b16 v[52:53], v20 offset:55296
 ds_read_b64_tr_b16 v[54:55], v20 offset:55808
 s_waitcnt lgkmcnt(4)
 v_mfma_f32_32x32x16_bf16 v[80:95], v[44:47], v[188:191], v[80:95]
 ds_read_b64_tr_b16 v[56:57], v252 offset:62464
 ds_read_b64_tr_b16 v[58:59], v252 offset:62720
 s_waitcnt lgkmcnt(4)
 v_mfma_f32_32x32x16_bf16 v[96:111], v[48:51], v[188:191], v[96:111]
 ds_read_b64_tr_b16 v[60:61], v253 offset:62464
 ds_read_b64_tr_b16 v[62:63], v253 offset:62720
 s_waitcnt lgkmcnt(4)
 v_mfma_f32_32x32x16_bf16 v[112:127], v[52:55], v[188:191], v[112:127]
 s_waitcnt vmcnt(9)
 s_barrier
 buffer_load_dword v250, v251, s[76:79], s60 offen
 s_add_u32 s60, s60, s61
 ds_read_b128 v[176:179], v4 offset:16384
 ds_read_b128 v[180:183], v5 offset:16384
 ds_read_b64_tr_b16 v[40:41], v21 offset:10240
 ds_read_b64_tr_b16 v[42:43], v21 offset:10752
 s_add_u32 m0, s35, 22528
 s_add_u32 s37, s88, 1216512
 buffer_load_dwordx4 v8, s[40:43], s37 offen lds
 s_waitcnt lgkmcnt(6)
 v_mfma_f32_32x32x16_bf16 v[128:143], v[56:59], v[188:191], v[128:143]
 ds_read_b64_tr_b16 v[44:45], v22 offset:10240
 ds_read_b64_tr_b16 v[46:47], v22 offset:10752
 s_add_u32 m0, s35, 30720
 s_add_u32 s37, s89, 1216512
 buffer_load_dwordx4 v9, s[56:59], s37 offen lds
 s_waitcnt lgkmcnt(6)
 v_mfma_f32_32x32x16_bf16 v[144:159], v[60:63], v[188:191], v[144:159]
 ds_read_b64_tr_b16 v[48:49], v23 offset:10240
 ds_read_b64_tr_b16 v[50:51], v23 offset:10752
 s_add_u32 s37, s62, 22528
 s_cmp_lt_u32 s98, 4
 s_cselect_b32 m0, s37, s74
 s_nop 0
 buffer_load_dwordx4 v10, s[80:83], s90 offen lds
 s_add_u32 s90, s90, s63
 s_waitcnt lgkmcnt(4)
 v_mfma_f32_32x32x16_bf16 v[64:79], v[40:43], v[176:179], v[64:79]
 ds_read_b64_tr_b16 v[52:53], v24 offset:10240
 ds_read_b64_tr_b16 v[54:55], v24 offset:10752
 s_waitcnt lgkmcnt(4)
 v_mfma_f32_32x32x16_bf16 v[80:95], v[44:47], v[176:179], v[80:95]
 ds_read_b64_tr_b16 v[56:57], v254 offset:18432
 ds_read_b64_tr_b16 v[58:59], v254 offset:18688
 s_waitcnt lgkmcnt(4)
 v_mfma_f32_32x32x16_bf16 v[96:111], v[48:51], v[176:179], v[96:111]
 ds_read_b64_tr_b16 v[60:61], v255 offset:18432
 ds_read_b64_tr_b16 v[62:63], v255 offset:18688
 s_waitcnt lgkmcnt(4)
 v_mfma_f32_32x32x16_bf16 v[112:127], v[52:55], v[176:179], v[112:127]
 ds_read_b64_tr_b16 v[40:41], v21 offset:12288
 ds_read_b64_tr_b16 v[42:43], v21 offset:12800
 s_waitcnt lgkmcnt(4)
 v_mfma_f32_32x32x16_bf16 v[128:143], v[56:59], v[176:179], v[128:143]
 ds_read_b64_tr_b16 v[44:45], v22 offset:12288
 ds_read_b64_tr_b16 v[46:47], v22 offset:12800
 s_waitcnt lgkmcnt(4)
 v_mfma_f32_32x32x16_bf16 v[144:159], v[60:63], v[176:179], v[144:159]
 ds_read_b64_tr_b16 v[48:49], v23 offset:12288
 ds_read_b64_tr_b16 v[50:51], v23 offset:12800
 s_waitcnt lgkmcnt(4)
 v_mfma_f32_32x32x16_bf16 v[64:79], v[40:43], v[180:183], v[64:79]
 ds_read_b64_tr_b16 v[52:53], v24 offset:12288
 ds_read_b64_tr_b16 v[54:55], v24 offset:12800
 s_waitcnt lgkmcnt(4)
 v_mfma_f32_32x32x16_bf16 v[80:95], v[44:47], v[180:183], v[80:95]
 ds_read_b64_tr_b16 v[56:57], v254 offset:19456
 ds_read_b64_tr_b16 v[58:59], v254 offset:19712
 s_waitcnt lgkmcnt(4)
 v_mfma_f32_32x32x16_bf16 v[96:111], v[48:51], v[180:183], v[96:111]
 ds_read_b64_tr_b16 v[60:61], v255 offset:19456
 ds_read_b64_tr_b16 v[62:63], v255 offset:19712
 s_waitcnt lgkmcnt(4)
 v_mfma_f32_32x32x16_bf16 v[112:127], v[52:55], v[180:183], v[112:127]
 s_waitcnt vmcnt(9)
 s_barrier
 ds_read_b128 v[184:187], v6 offset:16384
 ds_read_b128 v[188:191], v7 offset:16384
 ds_read_b64_tr_b16 v[40:41], v21 offset:32768
 ds_read_b64_tr_b16 v[42:43], v21 offset:33280
 s_add_u32 m0, s35, 45056
 s_add_u32 s37, s88, 1327104
 buffer_load_dwordx4 v8, s[40:43], s37 offen lds
 s_waitcnt lgkmcnt(6)
 v_mfma_f32_32x32x16_bf16 v[128:143], v[56:59], v[180:183], v[128:143]
 ds_read_b64_tr_b16 v[44:45], v22 offset:32768
 ds_read_b64_tr_b16 v[46:47], v22 offset:33280
 s_add_u32 m0, s35, 53248
 s_add_u32 s37, s89, 1327104
 buffer_load_dwordx4 v9, s[56:59], s37 offen lds
 s_waitcnt lgkmcnt(6)
 v_mfma_f32_32x32x16_bf16 v[144:159], v[60:63], v[180:183], v[144:159]
 ds_read_b64_tr_b16 v[48:49], v23 offset:32768
 ds_read_b64_tr_b16 v[50:51], v23 offset:33280
 s_add_u32 s37, s62, 45056
 s_cmp_lt_u32 s98, 4
 s_cselect_b32 m0, s37, s74
 s_nop 0
 buffer_load_dwordx4 v10, s[80:83], s90 offen lds
 s_add_u32 s90, s90, s63
 s_waitcnt lgkmcnt(4)
 v_mfma_f32_32x32x16_bf16 v[64:79], v[40:43], v[184:187], v[64:79]
 ds_read_b64_tr_b16 v[52:53], v24 offset:32768
 ds_read_b64_tr_b16 v[54:55], v24 offset:33280
 s_add_u32 m0, s36, 0
 s_movk_i32 s37, 768
 buffer_load_dwordx4 v2, s[4:7], s37 offen lds
 s_waitcnt lgkmcnt(4)
 v_mfma_f32_32x32x16_bf16 v[80:95], v[44:47], v[184:187], v[80:95]
 ds_read_b64_tr_b16 v[56:57], v254 offset:40960
 ds_read_b64_tr_b16 v[58:59], v254 offset:41216
 s_add_u32 m0, s36, 1024
 s_movk_i32 s37, 768
 buffer_load_dwordx4 v3, s[4:7], s37 offen lds
 s_waitcnt lgkmcnt(4)
 v_mfma_f32_32x32x16_bf16 v[96:111], v[48:51], v[184:187], v[96:111]
 ds_read_b64_tr_b16 v[60:61], v255 offset:40960
 ds_read_b64_tr_b16 v[62:63], v255 offset:41216
 s_waitcnt lgkmcnt(4)
 v_mfma_f32_32x32x16_bf16 v[112:127], v[52:55], v[184:187], v[112:127]
 ds_read_b64_tr_b16 v[40:41], v21 offset:34816
 ds_read_b64_tr_b16 v[42:43], v21 offset:35328
 s_waitcnt lgkmcnt(4)
 v_mfma_f32_32x32x16_bf16 v[128:143], v[56:59], v[184:187], v[128:143]
 ds_read_b64_tr_b16 v[44:45], v22 offset:34816
 ds_read_b64_tr_b16 v[46:47], v22 offset:35328
 s_waitcnt lgkmcnt(4)
 v_mfma_f32_32x32x16_bf16 v[144:159], v[60:63], v[184:187], v[144:159]
 ds_read_b64_tr_b16 v[48:49], v23 offset:34816
 ds_read_b64_tr_b16 v[50:51], v23 offset:35328
 s_waitcnt lgkmcnt(4)
 v_mfma_f32_32x32x16_bf16 v[64:79], v[40:43], v[188:191], v[64:79]
 ds_read_b64_tr_b16 v[52:53], v24 offset:34816
 ds_read_b64_tr_b16 v[54:55], v24 offset:35328
 s_waitcnt lgkmcnt(4)
 v_mfma_f32_32x32x16_bf16 v[80:95], v[44:47], v[188:191], v[80:95]
 ds_read_b64_tr_b16 v[56:57], v254 offset:41984
 ds_read_b64_tr_b16 v[58:59], v254 offset:42240
 s_waitcnt lgkmcnt(4)
 v_mfma_f32_32x32x16_bf16 v[96:111], v[48:51], v[188:191], v[96:111]
 ds_read_b64_tr_b16 v[60:61], v255 offset:41984
 ds_read_b64_tr_b16 v[62:63], v255 offset:42240
 s_waitcnt lgkmcnt(4)
 v_mfma_f32_32x32x16_bf16 v[112:127], v[52:55], v[188:191], v[112:127]
 s_waitcnt vmcnt(9)
 s_barrier
 buffer_load_dword v250, v251, s[76:79], s60 offen
 s_add_u32 s60, s60, s61
 ds_read_b128 v[176:179], v4 offset:32768
 ds_read_b128 v[180:183], v5 offset:32768
 ds_read_b64_tr_b16 v[40:41], v17 offset:8192
 ds_read_b64_tr_b16 v[42:43], v17 offset:8704
 s_add_u32 m0, s35, 67584
 s_add_u32 s37, s88, 1437696
 buffer_load_dwordx4 v8, s[40:43], s37 offen lds
 s_waitcnt lgkmcnt(6)
 v_mfma_f32_32x32x16_bf16 v[128:143], v[56:59], v[188:191], v[128:143]
 ds_read_b64_tr_b16 v[44:45], v18 offset:8192
 ds_read_b64_tr_b16 v[46:47], v18 offset:8704
 s_add_u32 m0, s35, 75776
 s_add_u32 s37, s89, 1437696
 buffer_load_dwordx4 v9, s[56:59], s37 offen lds
 s_waitcnt lgkmcnt(6)
 v_mfma_f32_32x32x16_bf16 v[144:159], v[60:63], v[188:191], v[144:159]
 ds_read_b64_tr_b16 v[48:49], v19 offset:8192
 ds_read_b64_tr_b16 v[50:51], v19 offset:8704
 s_add_u32 s37, s62, 67584
 s_cmp_lt_u32 s98, 4
 s_cselect_b32 m0, s37, s74
 s_nop 0
 buffer_load_dwordx4 v10, s[80:83], s90 offen lds
 s_add_u32 s90, s90, s63
 s_waitcnt lgkmcnt(4)
 v_mfma_f32_32x32x16_bf16 v[64:79], v[40:43], v[176:179], v[64:79]
 ds_read_b64_tr_b16 v[52:53], v20 offset:8192
 ds_read_b64_tr_b16 v[54:55], v20 offset:8704
 s_waitcnt lgkmcnt(4)
 v_mfma_f32_32x32x16_bf16 v[80:95], v[44:47], v[176:179], v[80:95]
 ds_read_b64_tr_b16 v[56:57], v252 offset:16384
 ds_read_b64_tr_b16 v[58:59], v252 offset:16640
 s_waitcnt lgkmcnt(4)
 v_mfma_f32_32x32x16_bf16 v[96:111], v[48:51], v[176:179], v[96:111]
 ds_read_b64_tr_b16 v[60:61], v253 offset:16384
 ds_read_b64_tr_b16 v[62:63], v253 offset:16640
 s_waitcnt lgkmcnt(4)
 v_mfma_f32_32x32x16_bf16 v[112:127], v[52:55], v[176:179], v[112:127]
 ds_read_b64_tr_b16 v[40:41], v17 offset:10240
 ds_read_b64_tr_b16 v[42:43], v17 offset:10752
 s_waitcnt lgkmcnt(4)
 v_mfma_f32_32x32x16_bf16 v[128:143], v[56:59], v[176:179], v[128:143]
 ds_read_b64_tr_b16 v[44:45], v18 offset:10240
 ds_read_b64_tr_b16 v[46:47], v18 offset:10752
 s_waitcnt lgkmcnt(4)
 v_mfma_f32_32x32x16_bf16 v[144:159], v[60:63], v[176:179], v[144:159]
 ds_read_b64_tr_b16 v[48:49], v19 offset:10240
 ds_read_b64_tr_b16 v[50:51], v19 offset:10752
 s_waitcnt lgkmcnt(4)
 v_mfma_f32_32x32x16_bf16 v[64:79], v[40:43], v[180:183], v[64:79]
 ds_read_b64_tr_b16 v[52:53], v20 offset:10240
 ds_read_b64_tr_b16 v[54:55], v20 offset:10752
 s_waitcnt lgkmcnt(4)
 v_mfma_f32_32x32x16_bf16 v[80:95], v[44:47], v[180:183], v[80:95]
 ds_read_b64_tr_b16 v[56:57], v252 offset:17408
 ds_read_b64_tr_b16 v[58:59], v252 offset:17664
 s_waitcnt lgkmcnt(4)
 v_mfma_f32_32x32x16_bf16 v[96:111], v[48:51], v[180:183], v[96:111]
 ds_read_b64_tr_b16 v[60:61], v253 offset:17408
 ds_read_b64_tr_b16 v[62:63], v253 offset:17664
 s_waitcnt lgkmcnt(4)
 v_mfma_f32_32x32x16_bf16 v[112:127], v[52:55], v[180:183], v[112:127]
 s_waitcnt vmcnt(9)
 s_barrier
 ds_read_b128 v[184:187], v6 offset:32768
 ds_read_b128 v[188:191], v7 offset:32768
 ds_read_b64_tr_b16 v[40:41], v17 offset:30720
 ds_read_b64_tr_b16 v[42:43], v17 offset:31232
 s_add_u32 m0, s35, 90112
 s_add_u32 s37, s88, 1548288
 buffer_load_dwordx4 v8, s[40:43], s37 offen lds
 s_waitcnt lgkmcnt(6)
 v_mfma_f32_32x32x16_bf16 v[128:143], v[56:59], v[180:183], v[128:143]
 ds_read_b64_tr_b16 v[44:45], v18 offset:30720
 ds_read_b64_tr_b16 v[46:47], v18 offset:31232
 s_add_u32 m0, s35, 98304
 s_add_u32 s37, s89, 1548288
 buffer_load_dwordx4 v9, s[56:59], s37 offen lds
 s_waitcnt lgkmcnt(6)
 v_mfma_f32_32x32x16_bf16 v[144:159], v[60:63], v[180:183], v[144:159]
 ds_read_b64_tr_b16 v[48:49], v19 offset:30720
 ds_read_b64_tr_b16 v[50:51], v19 offset:31232
 s_add_u32 s37, s62, 90112
 s_cmp_lt_u32 s98, 4
 s_cselect_b32 m0, s37, s74
 s_nop 0
 buffer_load_dwordx4 v10, s[80:83], s90 offen lds
 s_add_u32 s90, s90, s63
 s_waitcnt lgkmcnt(4)
 v_mfma_f32_32x32x16_bf16 v[64:79], v[40:43], v[184:187], v[64:79]
 ds_read_b64_tr_b16 v[52:53], v20 offset:30720
 ds_read_b64_tr_b16 v[54:55], v20 offset:31232
 s_add_u32 m0, s36, 16384
 s_movk_i32 s37, 896
 buffer_load_dwordx4 v2, s[4:7], s37 offen lds
 s_waitcnt lgkmcnt(4)
 v_mfma_f32_32x32x16_bf16 v[80:95], v[44:47], v[184:187], v[80:95]
 ds_read_b64_tr_b16 v[56:57], v252 offset:38912
 ds_read_b64_tr_b16 v[58:59], v252 offset:39168
 s_add_u32 m0, s36, 17408
 s_movk_i32 s37, 896
 buffer_load_dwordx4 v3, s[4:7], s37 offen lds
 s_waitcnt lgkmcnt(4)
 v_mfma_f32_32x32x16_bf16 v[96:111], v[48:51], v[184:187], v[96:111]
 ds_read_b64_tr_b16 v[60:61], v253 offset:38912
 ds_read_b64_tr_b16 v[62:63], v253 offset:39168
 s_waitcnt lgkmcnt(4)
 v_mfma_f32_32x32x16_bf16 v[112:127], v[52:55], v[184:187], v[112:127]
 ds_read_b64_tr_b16 v[40:41], v17 offset:32768
 ds_read_b64_tr_b16 v[42:43], v17 offset:33280
 s_waitcnt lgkmcnt(4)
 v_mfma_f32_32x32x16_bf16 v[128:143], v[56:59], v[184:187], v[128:143]
 ds_read_b64_tr_b16 v[44:45], v18 offset:32768
 ds_read_b64_tr_b16 v[46:47], v18 offset:33280
 s_waitcnt lgkmcnt(4)
 v_mfma_f32_32x32x16_bf16 v[144:159], v[60:63], v[184:187], v[144:159]
 ds_read_b64_tr_b16 v[48:49], v19 offset:32768
 ds_read_b64_tr_b16 v[50:51], v19 offset:33280
 s_waitcnt lgkmcnt(4)
 v_mfma_f32_32x32x16_bf16 v[64:79], v[40:43], v[188:191], v[64:79]
 ds_read_b64_tr_b16 v[52:53], v20 offset:32768
 ds_read_b64_tr_b16 v[54:55], v20 offset:33280
 s_waitcnt lgkmcnt(4)
 v_mfma_f32_32x32x16_bf16 v[80:95], v[44:47], v[188:191], v[80:95]
 ds_read_b64_tr_b16 v[56:57], v252 offset:39936
 ds_read_b64_tr_b16 v[58:59], v252 offset:40192
 s_waitcnt lgkmcnt(4)
 v_mfma_f32_32x32x16_bf16 v[96:111], v[48:51], v[188:191], v[96:111]
 ds_read_b64_tr_b16 v[60:61], v253 offset:39936
 ds_read_b64_tr_b16 v[62:63], v253 offset:40192
 s_waitcnt lgkmcnt(4)
 v_mfma_f32_32x32x16_bf16 v[112:127], v[52:55], v[188:191], v[112:127]
 s_waitcnt vmcnt(9)
 s_barrier
 buffer_load_dword v250, v251, s[76:79], s60 offen
 s_add_u32 s60, s60, s61
 ds_read_b128 v[176:179], v4 offset:0
 ds_read_b128 v[180:183], v5 offset:0
 ds_read_b64_tr_b16 v[40:41], v17 offset:53248
 ds_read_b64_tr_b16 v[42:43], v17 offset:53760
 s_add_u32 m0, s35, 0
 s_add_u32 s37, s88, 1658880
 buffer_load_dwordx4 v8, s[40:43], s37 offen lds
 s_waitcnt lgkmcnt(6)
 v_mfma_f32_32x32x16_bf16 v[128:143], v[56:59], v[188:191], v[128:143]
 ds_read_b64_tr_b16 v[44:45], v18 offset:53248
 ds_read_b64_tr_b16 v[46:47], v18 offset:53760
 s_add_u32 m0, s35, 8192
 s_add_u32 s37, s89, 1658880
 buffer_load_dwordx4 v9, s[56:59], s37 offen lds
 s_waitcnt lgkmcnt(6)
 v_mfma_f32_32x32x16_bf16 v[144:159], v[60:63], v[188:191], v[144:159]
 ds_read_b64_tr_b16 v[48:49], v19 offset:53248
 ds_read_b64_tr_b16 v[50:51], v19 offset:53760
 s_add_u32 s37, s62, 0
 s_cmp_lt_u32 s98, 4
 s_cselect_b32 m0, s37, s74
 s_nop 0
 buffer_load_dwordx4 v10, s[80:83], s90 offen lds
 s_add_u32 s90, s90, s63
 s_waitcnt lgkmcnt(4)
 v_mfma_f32_32x32x16_bf16 v[64:79], v[40:43], v[176:179], v[64:79]
 ds_read_b64_tr_b16 v[52:53], v20 offset:53248
 ds_read_b64_tr_b16 v[54:55], v20 offset:53760
 s_waitcnt lgkmcnt(4)
 v_mfma_f32_32x32x16_bf16 v[80:95], v[44:47], v[176:179], v[80:95]
 ds_read_b64_tr_b16 v[56:57], v252 offset:61440
 ds_read_b64_tr_b16 v[58:59], v252 offset:61696
 s_waitcnt lgkmcnt(4)
 v_mfma_f32_32x32x16_bf16 v[96:111], v[48:51], v[176:179], v[96:111]
 ds_read_b64_tr_b16 v[60:61], v253 offset:61440
 ds_read_b64_tr_b16 v[62:63], v253 offset:61696
 s_waitcnt lgkmcnt(4)
 v_mfma_f32_32x32x16_bf16 v[112:127], v[52:55], v[176:179], v[112:127]
 ds_read_b64_tr_b16 v[40:41], v17 offset:55296
 ds_read_b64_tr_b16 v[42:43], v17 offset:55808
 s_waitcnt lgkmcnt(4)
 v_mfma_f32_32x32x16_bf16 v[128:143], v[56:59], v[176:179], v[128:143]
 ds_read_b64_tr_b16 v[44:45], v18 offset:55296
 ds_read_b64_tr_b16 v[46:47], v18 offset:55808
 s_waitcnt lgkmcnt(4)
 v_mfma_f32_32x32x16_bf16 v[144:159], v[60:63], v[176:179], v[144:159]
 ds_read_b64_tr_b16 v[48:49], v19 offset:55296
 ds_read_b64_tr_b16 v[50:51], v19 offset:55808
 s_waitcnt lgkmcnt(4)
 v_mfma_f32_32x32x16_bf16 v[64:79], v[40:43], v[180:183], v[64:79]
 ds_read_b64_tr_b16 v[52:53], v20 offset:55296
 ds_read_b64_tr_b16 v[54:55], v20 offset:55808
 s_waitcnt lgkmcnt(4)
 v_mfma_f32_32x32x16_bf16 v[80:95], v[44:47], v[180:183], v[80:95]
 ds_read_b64_tr_b16 v[56:57], v252 offset:62464
 ds_read_b64_tr_b16 v[58:59], v252 offset:62720
 s_waitcnt lgkmcnt(4)
 v_mfma_f32_32x32x16_bf16 v[96:111], v[48:51], v[180:183], v[96:111]
 ds_read_b64_tr_b16 v[60:61], v253 offset:62464
 ds_read_b64_tr_b16 v[62:63], v253 offset:62720
 s_waitcnt lgkmcnt(4)
 v_mfma_f32_32x32x16_bf16 v[112:127], v[52:55], v[180:183], v[112:127]
 s_waitcnt vmcnt(9)
 s_barrier
 ds_read_b128 v[184:187], v6 offset:0
 ds_read_b128 v[188:191], v7 offset:0
 ds_read_b64_tr_b16 v[40:41], v21 offset:10240
 ds_read_b64_tr_b16 v[42:43], v21 offset:10752
 s_add_u32 m0, s35, 22528
 s_add_u32 s37, s88, 1769472
 buffer_load_dwordx4 v8, s[40:43], s37 offen lds
 s_waitcnt lgkmcnt(6)
 v_mfma_f32_32x32x16_bf16 v[128:143], v[56:59], v[180:183], v[128:143]
 ds_read_b64_tr_b16 v[44:45], v22 offset:10240
 ds_read_b64_tr_b16 v[46:47], v22 offset:10752
 s_add_u32 m0, s35, 30720
 s_add_u32 s37, s89, 1769472
 buffer_load_dwordx4 v9, s[56:59], s37 offen lds
 s_waitcnt lgkmcnt(6)
 v_mfma_f32_32x32x16_bf16 v[144:159], v[60:63], v[180:183], v[144:159]
 ds_read_b64_tr_b16 v[48:49], v23 offset:10240
 ds_read_b64_tr_b16 v[50:51], v23 offset:10752
 s_add_u32 s37, s62, 22528
 s_cmp_lt_u32 s98, 4
 s_cselect_b32 m0, s37, s74
 s_nop 0
 buffer_load_dwordx4 v10, s[80:83], s90 offen lds
 s_add_u32 s90, s90, s63
 s_waitcnt lgkmcnt(4)
 v_mfma_f32_32x32x16_bf16 v[64:79], v[40:43], v[184:187], v[64:79]
 ds_read_b64_tr_b16 v[52:53], v24 offset:10240
 ds_read_b64_tr_b16 v[54:55], v24 offset:10752
 s_add_u32 m0, s36, 32768
 s_movk_i32 s37, 1024
 buffer_load_dwordx4 v2, s[4:7], s37 offen lds
 s_waitcnt lgkmcnt(4)
 v_mfma_f32_32x32x16_bf16 v[80:95], v[44:47], v[184:187], v[80:95]
 ds_read_b64_tr_b16 v[56:57], v254 offset:18432
 ds_read_b64_tr_b16 v[58:59], v254 offset:18688
 s_add_u32 m0, s36, 33792
 s_movk_i32 s37, 1024
 buffer_load_dwordx4 v3, s[4:7], s37 offen lds
 s_waitcnt lgkmcnt(4)
 v_mfma_f32_32x32x16_bf16 v[96:111], v[48:51], v[184:187], v[96:111]
 ds_read_b64_tr_b16 v[60:61], v255 offset:18432
 ds_read_b64_tr_b16 v[62:63], v255 offset:18688
 s_waitcnt lgkmcnt(4)
 v_mfma_f32_32x32x16_bf16 v[112:127], v[52:55], v[184:187], v[112:127]
 ds_read_b64_tr_b16 v[40:41], v21 offset:12288
 ds_read_b64_tr_b16 v[42:43], v21 offset:12800
 s_waitcnt lgkmcnt(4)
 v_mfma_f32_32x32x16_bf16 v[128:143], v[56:59], v[184:187], v[128:143]
 ds_read_b64_tr_b16 v[44:45], v22 offset:12288
 ds_read_b64_tr_b16 v[46:47], v22 offset:12800
 s_waitcnt lgkmcnt(4)
 v_mfma_f32_32x32x16_bf16 v[144:159], v[60:63], v[184:187], v[144:159]
 ds_read_b64_tr_b16 v[48:49], v23 offset:12288
 ds_read_b64_tr_b16 v[50:51], v23 offset:12800
 s_waitcnt lgkmcnt(4)
 v_mfma_f32_32x32x16_bf16 v[64:79], v[40:43], v[188:191], v[64:79]
 ds_read_b64_tr_b16 v[52:53], v24 offset:12288
 ds_read_b64_tr_b16 v[54:55], v24 offset:12800
 s_waitcnt lgkmcnt(4)
 v_mfma_f32_32x32x16_bf16 v[80:95], v[44:47], v[188:191], v[80:95]
 ds_read_b64_tr_b16 v[56:57], v254 offset:19456
 ds_read_b64_tr_b16 v[58:59], v254 offset:19712
 s_waitcnt lgkmcnt(4)
 v_mfma_f32_32x32x16_bf16 v[96:111], v[48:51], v[188:191], v[96:111]
 ds_read_b64_tr_b16 v[60:61], v255 offset:19456
 ds_read_b64_tr_b16 v[62:63], v255 offset:19712
 s_waitcnt lgkmcnt(4)
 v_mfma_f32_32x32x16_bf16 v[112:127], v[52:55], v[188:191], v[112:127]
 s_waitcnt vmcnt(9)
 s_barrier
 ds_read_b128 v[176:179], v4 offset:16384
 ds_read_b128 v[180:183], v5 offset:16384
 ds_read_b64_tr_b16 v[40:41], v21 offset:32768
 ds_read_b64_tr_b16 v[42:43], v21 offset:33280
 s_add_u32 m0, s35, 45056
 s_add_u32 s37, s88, 1880064
 buffer_load_dwordx4 v8, s[40:43], s37 offen lds
 s_waitcnt lgkmcnt(6)
 v_mfma_f32_32x32x16_bf16 v[128:143], v[56:59], v[188:191], v[128:143]
 ds_read_b64_tr_b16 v[44:45], v22 offset:32768
 ds_read_b64_tr_b16 v[46:47], v22 offset:33280
 s_add_u32 m0, s35, 53248
 s_add_u32 s37, s89, 1880064
 buffer_load_dwordx4 v9, s[56:59], s37 offen lds
 s_waitcnt lgkmcnt(6)
 v_mfma_f32_32x32x16_bf16 v[144:159], v[60:63], v[188:191], v[144:159]
 ds_read_b64_tr_b16 v[48:49], v23 offset:32768
 ds_read_b64_tr_b16 v[50:51], v23 offset:33280
 s_add_u32 s37, s62, 45056
 s_cmp_lt_u32 s98, 4
 s_cselect_b32 m0, s37, s74
 s_nop 0
 buffer_load_dwordx4 v10, s[80:83], s90 offen lds
 s_add_u32 s90, s90, s63
 s_waitcnt lgkmcnt(4)
 v_mfma_f32_32x32x16_bf16 v[64:79], v[40:43], v[176:179], v[64:79]
 ds_read_b64_tr_b16 v[52:53], v24 offset:32768
 ds_read_b64_tr_b16 v[54:55], v24 offset:33280
 s_waitcnt lgkmcnt(4)
 v_mfma_f32_32x32x16_bf16 v[80:95], v[44:47], v[176:179], v[80:95]
 ds_read_b64_tr_b16 v[56:57], v254 offset:40960
 ds_read_b64_tr_b16 v[58:59], v254 offset:41216
 s_waitcnt lgkmcnt(4)
 v_mfma_f32_32x32x16_bf16 v[96:111], v[48:51], v[176:179], v[96:111]
 ds_read_b64_tr_b16 v[60:61], v255 offset:40960
 ds_read_b64_tr_b16 v[62:63], v255 offset:41216
 s_waitcnt lgkmcnt(4)
 v_mfma_f32_32x32x16_bf16 v[112:127], v[52:55], v[176:179], v[112:127]
 ds_read_b64_tr_b16 v[40:41], v21 offset:34816
 ds_read_b64_tr_b16 v[42:43], v21 offset:35328
 s_waitcnt lgkmcnt(4)
 v_mfma_f32_32x32x16_bf16 v[128:143], v[56:59], v[176:179], v[128:143]
 ds_read_b64_tr_b16 v[44:45], v22 offset:34816
 ds_read_b64_tr_b16 v[46:47], v22 offset:35328
 s_waitcnt lgkmcnt(4)
 v_mfma_f32_32x32x16_bf16 v[144:159], v[60:63], v[176:179], v[144:159]
 ds_read_b64_tr_b16 v[48:49], v23 offset:34816
 ds_read_b64_tr_b16 v[50:51], v23 offset:35328
 s_waitcnt lgkmcnt(4)
 v_mfma_f32_32x32x16_bf16 v[64:79], v[40:43], v[180:183], v[64:79]
 ds_read_b64_tr_b16 v[52:53], v24 offset:34816
 ds_read_b64_tr_b16 v[54:55], v24 offset:35328
 s_waitcnt lgkmcnt(4)
 v_mfma_f32_32x32x16_bf16 v[80:95], v[44:47], v[180:183], v[80:95]
 ds_read_b64_tr_b16 v[56:57], v254 offset:41984
 ds_read_b64_tr_b16 v[58:59], v254 offset:42240
 s_waitcnt lgkmcnt(4)
 v_mfma_f32_32x32x16_bf16 v[96:111], v[48:51], v[180:183], v[96:111]
 ds_read_b64_tr_b16 v[60:61], v255 offset:41984
 ds_read_b64_tr_b16 v[62:63], v255 offset:42240
 s_waitcnt lgkmcnt(4)
 v_mfma_f32_32x32x16_bf16 v[112:127], v[52:55], v[180:183], v[112:127]
 s_waitcnt vmcnt(8)
 s_barrier
 ds_read_b128 v[184:187], v6 offset:16384
 ds_read_b128 v[188:191], v7 offset:16384
 ds_read_b64_tr_b16 v[40:41], v17 offset:8192
 ds_read_b64_tr_b16 v[42:43], v17 offset:8704
 s_add_u32 m0, s35, 67584
 s_add_u32 s37, s88, 1990656
 buffer_load_dwordx4 v8, s[40:43], s37 offen lds
 s_waitcnt lgkmcnt(6)
 v_mfma_f32_32x32x16_bf16 v[128:143], v[56:59], v[180:183], v[128:143]
 ds_read_b64_tr_b16 v[44:45], v18 offset:8192
 ds_read_b64_tr_b16 v[46:47], v18 offset:8704
 s_add_u32 m0, s35, 75776
 s_add_u32 s37, s89, 1990656
 buffer_load_dwordx4 v9, s[56:59], s37 offen lds
 s_waitcnt lgkmcnt(6)
 v_mfma_f32_32x32x16_bf16 v[144:159], v[60:63], v[180:183], v[144:159]
 ds_read_b64_tr_b16 v[48:49], v19 offset:8192
 ds_read_b64_tr_b16 v[50:51], v19 offset:8704
 s_add_u32 s37, s62, 67584
 s_cmp_lt_u32 s98, 4
 s_cselect_b32 m0, s37, s74
 s_nop 0
 buffer_load_dwordx4 v10, s[80:83], s90 offen lds
 s_add_u32 s90, s90, s63
 s_waitcnt lgkmcnt(4)
 v_mfma_f32_32x32x16_bf16 v[64:79], v[40:43], v[184:187], v[64:79]
 ds_read_b64_tr_b16 v[52:53], v20 offset:8192
 ds_read_b64_tr_b16 v[54:55], v20 offset:8704
 s_add_u32 m0, s36, 0
 s_movk_i32 s37, 1152
 buffer_load_dwordx4 v2, s[4:7], s37 offen lds
 s_waitcnt lgkmcnt(4)
 v_mfma_f32_32x32x16_bf16 v[80:95], v[44:47], v[184:187], v[80:95]
 ds_read_b64_tr_b16 v[56:57], v252 offset:16384
 ds_read_b64_tr_b16 v[58:59], v252 offset:16640
 s_add_u32 m0, s36, 1024
 s_movk_i32 s37, 1152
 buffer_load_dwordx4 v3, s[4:7], s37 offen lds
 s_waitcnt lgkmcnt(4)
 v_mfma_f32_32x32x16_bf16 v[96:111], v[48:51], v[184:187], v[96:111]
 ds_read_b64_tr_b16 v[60:61], v253 offset:16384
 ds_read_b64_tr_b16 v[62:63], v253 offset:16640
 s_waitcnt lgkmcnt(4)
 v_mfma_f32_32x32x16_bf16 v[112:127], v[52:55], v[184:187], v[112:127]
 ds_read_b64_tr_b16 v[40:41], v17 offset:10240
 ds_read_b64_tr_b16 v[42:43], v17 offset:10752
 s_waitcnt lgkmcnt(4)
 v_mfma_f32_32x32x16_bf16 v[128:143], v[56:59], v[184:187], v[128:143]
 ds_read_b64_tr_b16 v[44:45], v18 offset:10240
 ds_read_b64_tr_b16 v[46:47], v18 offset:10752
 s_waitcnt lgkmcnt(4)
 v_mfma_f32_32x32x16_bf16 v[144:159], v[60:63], v[184:187], v[144:159]
 ds_read_b64_tr_b16 v[48:49], v19 offset:10240
 ds_read_b64_tr_b16 v[50:51], v19 offset:10752
 s_waitcnt lgkmcnt(4)
 v_mfma_f32_32x32x16_bf16 v[64:79], v[40:43], v[188:191], v[64:79]
 ds_read_b64_tr_b16 v[52:53], v20 offset:10240
 ds_read_b64_tr_b16 v[54:55], v20 offset:10752
 s_waitcnt lgkmcnt(4)
 v_mfma_f32_32x32x16_bf16 v[80:95], v[44:47], v[188:191], v[80:95]
 ds_read_b64_tr_b16 v[56:57], v252 offset:17408
 ds_read_b64_tr_b16 v[58:59], v252 offset:17664
 s_waitcnt lgkmcnt(4)
 v_mfma_f32_32x32x16_bf16 v[96:111], v[48:51], v[188:191], v[96:111]
 ds_read_b64_tr_b16 v[60:61], v253 offset:17408
 ds_read_b64_tr_b16 v[62:63], v253 offset:17664
 s_waitcnt lgkmcnt(4)
 v_mfma_f32_32x32x16_bf16 v[112:127], v[52:55], v[188:191], v[112:127]
 s_waitcnt vmcnt(8)
 s_barrier
 ds_read_b128 v[176:179], v4 offset:32768
 ds_read_b128 v[180:183], v5 offset:32768
 ds_read_b64_tr_b16 v[40:41], v17 offset:30720
 ds_read_b64_tr_b16 v[42:43], v17 offset:31232
 s_add_u32 m0, s35, 90112
 s_add_u32 s37, s88, 2101248
 buffer_load_dwordx4 v8, s[40:43], s37 offen lds
 s_waitcnt lgkmcnt(6)
 v_mfma_f32_32x32x16_bf16 v[128:143], v[56:59], v[188:191], v[128:143]
 ds_read_b64_tr_b16 v[44:45], v18 offset:30720
 ds_read_b64_tr_b16 v[46:47], v18 offset:31232
 s_add_u32 m0, s35, 98304
 s_add_u32 s37, s89, 2101248
 buffer_load_dwordx4 v9, s[56:59], s37 offen lds
 s_waitcnt lgkmcnt(6)
 v_mfma_f32_32x32x16_bf16 v[144:159], v[60:63], v[188:191], v[144:159]
 ds_read_b64_tr_b16 v[48:49], v19 offset:30720
 ds_read_b64_tr_b16 v[50:51], v19 offset:31232
 s_add_u32 s37, s62, 90112
 s_cmp_lt_u32 s98, 4
 s_cselect_b32 m0, s37, s74
 s_nop 0
 buffer_load_dwordx4 v10, s[80:83], s90 offen lds
 s_add_u32 s90, s90, s63
 s_waitcnt lgkmcnt(4)
 v_mfma_f32_32x32x16_bf16 v[64:79], v[40:43], v[176:179], v[64:79]
 ds_read_b64_tr_b16 v[52:53], v20 offset:30720
 ds_read_b64_tr_b16 v[54:55], v20 offset:31232
 s_waitcnt lgkmcnt(4)
 v_mfma_f32_32x32x16_bf16 v[80:95], v[44:47], v[176:179], v[80:95]
 ds_read_b64_tr_b16 v[56:57], v252 offset:38912
 ds_read_b64_tr_b16 v[58:59], v252 offset:39168
 s_waitcnt lgkmcnt(4)
 v_mfma_f32_32x32x16_bf16 v[96:111], v[48:51], v[176:179], v[96:111]
 ds_read_b64_tr_b16 v[60:61], v253 offset:38912
 ds_read_b64_tr_b16 v[62:63], v253 offset:39168
 s_waitcnt lgkmcnt(4)
 v_mfma_f32_32x32x16_bf16 v[112:127], v[52:55], v[176:179], v[112:127]
 ds_read_b64_tr_b16 v[40:41], v17 offset:32768
 ds_read_b64_tr_b16 v[42:43], v17 offset:33280
 s_waitcnt lgkmcnt(4)
 v_mfma_f32_32x32x16_bf16 v[128:143], v[56:59], v[176:179], v[128:143]
 ds_read_b64_tr_b16 v[44:45], v18 offset:32768
 ds_read_b64_tr_b16 v[46:47], v18 offset:33280
 s_waitcnt lgkmcnt(4)
 v_mfma_f32_32x32x16_bf16 v[144:159], v[60:63], v[176:179], v[144:159]
 ds_read_b64_tr_b16 v[48:49], v19 offset:32768
 ds_read_b64_tr_b16 v[50:51], v19 offset:33280
 s_waitcnt lgkmcnt(4)
 v_mfma_f32_32x32x16_bf16 v[64:79], v[40:43], v[180:183], v[64:79]
 ds_read_b64_tr_b16 v[52:53], v20 offset:32768
 ds_read_b64_tr_b16 v[54:55], v20 offset:33280
 s_waitcnt lgkmcnt(4)
 v_mfma_f32_32x32x16_bf16 v[80:95], v[44:47], v[180:183], v[80:95]
 ds_read_b64_tr_b16 v[56:57], v252 offset:39936
 ds_read_b64_tr_b16 v[58:59], v252 offset:40192
 s_waitcnt lgkmcnt(4)
 v_mfma_f32_32x32x16_bf16 v[96:111], v[48:51], v[180:183], v[96:111]
 ds_read_b64_tr_b16 v[60:61], v253 offset:39936
 ds_read_b64_tr_b16 v[62:63], v253 offset:40192
 s_waitcnt lgkmcnt(4)
 v_mfma_f32_32x32x16_bf16 v[112:127], v[52:55], v[180:183], v[112:127]
 s_waitcnt vmcnt(8)
 s_barrier
 ds_read_b128 v[184:187], v6 offset:32768
 ds_read_b128 v[188:191], v7 offset:32768
 ds_read_b64_tr_b16 v[40:41], v17 offset:53248
 ds_read_b64_tr_b16 v[42:43], v17 offset:53760
 s_waitcnt lgkmcnt(6)
 v_mfma_f32_32x32x16_bf16 v[128:143], v[56:59], v[180:183], v[128:143]
 ds_read_b64_tr_b16 v[44:45], v18 offset:53248
 ds_read_b64_tr_b16 v[46:47], v18 offset:53760
 s_waitcnt lgkmcnt(6)
 v_mfma_f32_32x32x16_bf16 v[144:159], v[60:63], v[180:183], v[144:159]
 ds_read_b64_tr_b16 v[48:49], v19 offset:53248
 ds_read_b64_tr_b16 v[50:51], v19 offset:53760
 s_waitcnt lgkmcnt(4)
 v_mfma_f32_32x32x16_bf16 v[64:79], v[40:43], v[184:187], v[64:79]
 ds_read_b64_tr_b16 v[52:53], v20 offset:53248
 ds_read_b64_tr_b16 v[54:55], v20 offset:53760
 s_waitcnt lgkmcnt(4)
 v_mfma_f32_32x32x16_bf16 v[80:95], v[44:47], v[184:187], v[80:95]
 ds_read_b64_tr_b16 v[56:57], v252 offset:61440
 ds_read_b64_tr_b16 v[58:59], v252 offset:61696
 s_waitcnt lgkmcnt(4)
 v_mfma_f32_32x32x16_bf16 v[96:111], v[48:51], v[184:187], v[96:111]
 ds_read_b64_tr_b16 v[60:61], v253 offset:61440
 ds_read_b64_tr_b16 v[62:63], v253 offset:61696
 s_waitcnt lgkmcnt(4)
 v_mfma_f32_32x32x16_bf16 v[112:127], v[52:55], v[184:187], v[112:127]
 ds_read_b64_tr_b16 v[40:41], v17 offset:55296
 ds_read_b64_tr_b16 v[42:43], v17 offset:55808
 s_waitcnt lgkmcnt(4)
 v_mfma_f32_32x32x16_bf16 v[128:143], v[56:59], v[184:187], v[128:143]
 ds_read_b64_tr_b16 v[44:45], v18 offset:55296
 ds_read_b64_tr_b16 v[46:47], v18 offset:55808
 s_waitcnt lgkmcnt(4)
 v_mfma_f32_32x32x16_bf16 v[144:159], v[60:63], v[184:187], v[144:159]
 ds_read_b64_tr_b16 v[48:49], v19 offset:55296
 ds_read_b64_tr_b16 v[50:51], v19 offset:55808
 s_waitcnt lgkmcnt(4)
 v_mfma_f32_32x32x16_bf16 v[64:79], v[40:43], v[188:191], v[64:79]
 ds_read_b64_tr_b16 v[52:53], v20 offset:55296
 ds_read_b64_tr_b16 v[54:55], v20 offset:55808
 s_waitcnt lgkmcnt(4)
 v_mfma_f32_32x32x16_bf16 v[80:95], v[44:47], v[188:191], v[80:95]
 ds_read_b64_tr_b16 v[56:57], v252 offset:62464
 ds_read_b64_tr_b16 v[58:59], v252 offset:62720
 s_waitcnt lgkmcnt(4)
 v_mfma_f32_32x32x16_bf16 v[96:111], v[48:51], v[188:191], v[96:111]
 ds_read_b64_tr_b16 v[60:61], v253 offset:62464
 ds_read_b64_tr_b16 v[62:63], v253 offset:62720
 s_waitcnt lgkmcnt(4)
 v_mfma_f32_32x32x16_bf16 v[112:127], v[52:55], v[188:191], v[112:127]
 s_waitcnt vmcnt(3)
 s_barrier
 ds_read_b128 v[176:179], v4 offset:0
 ds_read_b128 v[180:183], v5 offset:0
 ds_read_b64_tr_b16 v[40:41], v21 offset:10240
 ds_read_b64_tr_b16 v[42:43], v21 offset:10752
 s_waitcnt lgkmcnt(6)
 v_mfma_f32_32x32x16_bf16 v[128:143], v[56:59], v[188:191], v[128:143]
 ds_read_b64_tr_b16 v[44:45], v22 offset:10240
 ds_read_b64_tr_b16 v[46:47], v22 offset:10752
 s_waitcnt lgkmcnt(6)
 v_mfma_f32_32x32x16_bf16 v[144:159], v[60:63], v[188:191], v[144:159]
 ds_read_b64_tr_b16 v[48:49], v23 offset:10240
 ds_read_b64_tr_b16 v[50:51], v23 offset:10752
 s_waitcnt lgkmcnt(4)
 v_mfma_f32_32x32x16_bf16 v[64:79], v[40:43], v[176:179], v[64:79]
 ds_read_b64_tr_b16 v[52:53], v24 offset:10240
 ds_read_b64_tr_b16 v[54:55], v24 offset:10752
 s_waitcnt lgkmcnt(4)
 v_mfma_f32_32x32x16_bf16 v[80:95], v[44:47], v[176:179], v[80:95]
 ds_read_b64_tr_b16 v[56:57], v254 offset:18432
 ds_read_b64_tr_b16 v[58:59], v254 offset:18688
 s_waitcnt lgkmcnt(4)
 v_mfma_f32_32x32x16_bf16 v[96:111], v[48:51], v[176:179], v[96:111]
 ds_read_b64_tr_b16 v[60:61], v255 offset:18432
 ds_read_b64_tr_b16 v[62:63], v255 offset:18688
 s_waitcnt lgkmcnt(4)
 v_mfma_f32_32x32x16_bf16 v[112:127], v[52:55], v[176:179], v[112:127]
 ds_read_b64_tr_b16 v[40:41], v21 offset:12288
 ds_read_b64_tr_b16 v[42:43], v21 offset:12800
 s_waitcnt lgkmcnt(4)
 v_mfma_f32_32x32x16_bf16 v[128:143], v[56:59], v[176:179], v[128:143]
 ds_read_b64_tr_b16 v[44:45], v22 offset:12288
 ds_read_b64_tr_b16 v[46:47], v22 offset:12800
 s_waitcnt lgkmcnt(4)
 v_mfma_f32_32x32x16_bf16 v[144:159], v[60:63], v[176:179], v[144:159]
 ds_read_b64_tr_b16 v[48:49], v23 offset:12288
 ds_read_b64_tr_b16 v[50:51], v23 offset:12800
 s_waitcnt lgkmcnt(4)
 v_mfma_f32_32x32x16_bf16 v[64:79], v[40:43], v[180:183], v[64:79]
 ds_read_b64_tr_b16 v[52:53], v24 offset:12288
 ds_read_b64_tr_b16 v[54:55], v24 offset:12800
 s_waitcnt lgkmcnt(4)
 v_mfma_f32_32x32x16_bf16 v[80:95], v[44:47], v[180:183], v[80:95]
 ds_read_b64_tr_b16 v[56:57], v254 offset:19456
 ds_read_b64_tr_b16 v[58:59], v254 offset:19712
 s_waitcnt lgkmcnt(4)
 v_mfma_f32_32x32x16_bf16 v[96:111], v[48:51], v[180:183], v[96:111]
 ds_read_b64_tr_b16 v[60:61], v255 offset:19456
 ds_read_b64_tr_b16 v[62:63], v255 offset:19712
 s_waitcnt lgkmcnt(4)
 v_mfma_f32_32x32x16_bf16 v[112:127], v[52:55], v[180:183], v[112:127]
 s_waitcnt vmcnt(0)
 s_barrier
 ds_read_b128 v[184:187], v6 offset:0
 ds_read_b128 v[188:191], v7 offset:0
 ds_read_b64_tr_b16 v[40:41], v21 offset:32768
 ds_read_b64_tr_b16 v[42:43], v21 offset:33280
 s_waitcnt lgkmcnt(6)
 v_mfma_f32_32x32x16_bf16 v[128:143], v[56:59], v[180:183], v[128:143]
 ds_read_b64_tr_b16 v[44:45], v22 offset:32768
 ds_read_b64_tr_b16 v[46:47], v22 offset:33280
 s_waitcnt lgkmcnt(6)
 v_mfma_f32_32x32x16_bf16 v[144:159], v[60:63], v[180:183], v[144:159]
 ds_read_b64_tr_b16 v[48:49], v23 offset:32768
 ds_read_b64_tr_b16 v[50:51], v23 offset:33280
 s_waitcnt lgkmcnt(4)
 v_mfma_f32_32x32x16_bf16 v[64:79], v[40:43], v[184:187], v[64:79]
 ds_read_b64_tr_b16 v[52:53], v24 offset:32768
 ds_read_b64_tr_b16 v[54:55], v24 offset:33280
 s_waitcnt lgkmcnt(4)
 v_mfma_f32_32x32x16_bf16 v[80:95], v[44:47], v[184:187], v[80:95]
 ds_read_b64_tr_b16 v[56:57], v254 offset:40960
 ds_read_b64_tr_b16 v[58:59], v254 offset:41216
 s_waitcnt lgkmcnt(4)
 v_mfma_f32_32x32x16_bf16 v[96:111], v[48:51], v[184:187], v[96:111]
 ds_read_b64_tr_b16 v[60:61], v255 offset:40960
 ds_read_b64_tr_b16 v[62:63], v255 offset:41216
 s_waitcnt lgkmcnt(4)
 v_mfma_f32_32x32x16_bf16 v[112:127], v[52:55], v[184:187], v[112:127]
 ds_read_b64_tr_b16 v[40:41], v21 offset:34816
 ds_read_b64_tr_b16 v[42:43], v21 offset:35328
 s_waitcnt lgkmcnt(4)
 v_mfma_f32_32x32x16_bf16 v[128:143], v[56:59], v[184:187], v[128:143]
 ds_read_b64_tr_b16 v[44:45], v22 offset:34816
 ds_read_b64_tr_b16 v[46:47], v22 offset:35328
 s_waitcnt lgkmcnt(4)
 v_mfma_f32_32x32x16_bf16 v[144:159], v[60:63], v[184:187], v[144:159]
 ds_read_b64_tr_b16 v[48:49], v23 offset:34816
 ds_read_b64_tr_b16 v[50:51], v23 offset:35328
 s_waitcnt lgkmcnt(4)
 v_mfma_f32_32x32x16_bf16 v[64:79], v[40:43], v[188:191], v[64:79]
 ds_read_b64_tr_b16 v[52:53], v24 offset:34816
 ds_read_b64_tr_b16 v[54:55], v24 offset:35328
 s_waitcnt lgkmcnt(4)
 v_mfma_f32_32x32x16_bf16 v[80:95], v[44:47], v[188:191], v[80:95]
 ds_read_b64_tr_b16 v[56:57], v254 offset:41984
 ds_read_b64_tr_b16 v[58:59], v254 offset:42240
 s_waitcnt lgkmcnt(4)
 v_mfma_f32_32x32x16_bf16 v[96:111], v[48:51], v[188:191], v[96:111]
 ds_read_b64_tr_b16 v[60:61], v255 offset:41984
 ds_read_b64_tr_b16 v[62:63], v255 offset:42240
 s_waitcnt lgkmcnt(4)
 v_mfma_f32_32x32x16_bf16 v[112:127], v[52:55], v[188:191], v[112:127]
 s_waitcnt lgkmcnt(2)
 v_mfma_f32_32x32x16_bf16 v[128:143], v[56:59], v[188:191], v[128:143]
 s_waitcnt lgkmcnt(0)
 v_mfma_f32_32x32x16_bf16 v[144:159], v[60:63], v[188:191], v[144:159]
 s_setprio 0
 s_waitcnt lgkmcnt(0)
 s_barrier
 v_cvt_pk_bf16_f32 v161, v64, v65
 v_cvt_pk_bf16_f32 v163, v72, v73
 v_lshlrev_b32 v160, 16, v161
 v_and_b32 v161, 0xffff0000, v161
 v_mul_f32 v164, v160, v160
 v_mul_f32 v165, v161, v161
 v_fmamk_f32 v164, v164, 0xbdd2d3e8, v26
 v_fmamk_f32 v165, v165, 0xbdd2d3e8, v26
 v_mul_f32 v164, v164, v160
 v_mul_f32 v165, v165, v161
 v_exp_f32 v164, v164
 v_exp_f32 v165, v165
 v_lshlrev_b32 v162, 16, v163
 v_add_f32 v164, 1.0, v164
 v_add_f32 v165, 1.0, v165
 v_rcp_f32 v164, v164
 v_rcp_f32 v165, v165
 v_and_b32 v163, 0xffff0000, v163
 v_mul_f32 v164, v164, v160
 v_mul_f32 v165, v165, v161
 v_cvt_pk_bf16_f32 v165, v164, v165
 v_lshlrev_b32 v164, 16, v165
 v_and_b32 v165, 0xffff0000, v165
 v_mul_f32 v164, v164, v162
 v_mul_f32 v165, v165, v163
 v_cvt_pk_bf16_f32 v172, v164, v165
 v_cvt_pk_bf16_f32 v161, v66, v67
 v_cvt_pk_bf16_f32 v163, v74, v75
 v_lshlrev_b32 v160, 16, v161
 v_and_b32 v161, 0xffff0000, v161
 v_mul_f32 v164, v160, v160
 v_mul_f32 v165, v161, v161
 v_fmamk_f32 v164, v164, 0xbdd2d3e8, v26
 v_fmamk_f32 v165, v165, 0xbdd2d3e8, v26
 v_mul_f32 v164, v164, v160
 v_mul_f32 v165, v165, v161
 v_exp_f32 v164, v164
 v_exp_f32 v165, v165
 v_lshlrev_b32 v162, 16, v163
 v_add_f32 v164, 1.0, v164
 v_add_f32 v165, 1.0, v165
 v_rcp_f32 v164, v164
 v_rcp_f32 v165, v165
 v_and_b32 v163, 0xffff0000, v163
 v_mul_f32 v164, v164, v160
 v_mul_f32 v165, v165, v161
 v_cvt_pk_bf16_f32 v165, v164, v165
 v_lshlrev_b32 v164, 16, v165
 v_and_b32 v165, 0xffff0000, v165
 v_mul_f32 v164, v164, v162
 v_mul_f32 v165, v165, v163
 v_cvt_pk_bf16_f32 v173, v164, v165
 v_cvt_pk_bf16_f32 v161, v68, v69
 v_cvt_pk_bf16_f32 v163, v76, v77
 v_lshlrev_b32 v160, 16, v161
 v_and_b32 v161, 0xffff0000, v161
 v_mul_f32 v164, v160, v160
 v_mul_f32 v165, v161, v161
 v_fmamk_f32 v164, v164, 0xbdd2d3e8, v26
 v_fmamk_f32 v165, v165, 0xbdd2d3e8, v26
 v_mul_f32 v164, v164, v160
 v_mul_f32 v165, v165, v161
 v_exp_f32 v164, v164
 v_exp_f32 v165, v165
 v_lshlrev_b32 v162, 16, v163
 v_add_f32 v164, 1.0, v164
 v_add_f32 v165, 1.0, v165
 v_rcp_f32 v164, v164
 v_rcp_f32 v165, v165
 v_and_b32 v163, 0xffff0000, v163
 v_mul_f32 v164, v164, v160
 v_mul_f32 v165, v165, v161
 v_cvt_pk_bf16_f32 v165, v164, v165
 v_lshlrev_b32 v164, 16, v165
 v_and_b32 v165, 0xffff0000, v165
 v_mul_f32 v164, v164, v162
 v_mul_f32 v165, v165, v163
 v_cvt_pk_bf16_f32 v174, v164, v165
 v_cvt_pk_bf16_f32 v161, v70, v71
 v_cvt_pk_bf16_f32 v163, v78, v79
 v_lshlrev_b32 v160, 16, v161
 v_and_b32 v161, 0xffff0000, v161
 v_mul_f32 v164, v160, v160
 v_mul_f32 v165, v161, v161
 v_fmamk_f32 v164, v164, 0xbdd2d3e8, v26
 v_fmamk_f32 v165, v165, 0xbdd2d3e8, v26
 v_mul_f32 v164, v164, v160
 v_mul_f32 v165, v165, v161
 v_exp_f32 v164, v164
 v_exp_f32 v165, v165
 v_lshlrev_b32 v162, 16, v163
 v_add_f32 v164, 1.0, v164
 v_add_f32 v165, 1.0, v165
 v_rcp_f32 v164, v164
 v_rcp_f32 v165, v165
 v_and_b32 v163, 0xffff0000, v163
 v_mul_f32 v164, v164, v160
 v_mul_f32 v165, v165, v161
 v_cvt_pk_bf16_f32 v165, v164, v165
 v_lshlrev_b32 v164, 16, v165
 v_and_b32 v165, 0xffff0000, v165
 v_mul_f32 v164, v164, v162
 v_mul_f32 v165, v165, v163
 v_cvt_pk_bf16_f32 v175, v164, v165
 s_add_u32 s38, s34, 2048
 buffer_store_dwordx4 v[172:175], v25, s[16:19], s38 offen sc0 sc1
 v_cvt_pk_bf16_f32 v177, v80, v81
 v_cvt_pk_bf16_f32 v179, v88, v89
 v_lshlrev_b32 v176, 16, v177
 v_and_b32 v177, 0xffff0000, v177
 v_mul_f32 v180, v176, v176
 v_mul_f32 v181, v177, v177
 v_fmamk_f32 v180, v180, 0xbdd2d3e8, v26
 v_fmamk_f32 v181, v181, 0xbdd2d3e8, v26
 v_mul_f32 v180, v180, v176
 v_mul_f32 v181, v181, v177
 v_exp_f32 v180, v180
 v_exp_f32 v181, v181
 v_lshlrev_b32 v178, 16, v179
 v_add_f32 v180, 1.0, v180
 v_add_f32 v181, 1.0, v181
 v_rcp_f32 v180, v180
 v_rcp_f32 v181, v181
 v_and_b32 v179, 0xffff0000, v179
 v_mul_f32 v180, v180, v176
 v_mul_f32 v181, v181, v177
 v_cvt_pk_bf16_f32 v181, v180, v181
 v_lshlrev_b32 v180, 16, v181
 v_and_b32 v181, 0xffff0000, v181
 v_mul_f32 v180, v180, v178
 v_mul_f32 v181, v181, v179
 v_cvt_pk_bf16_f32 v188, v180, v181
 v_cvt_pk_bf16_f32 v177, v82, v83
 v_cvt_pk_bf16_f32 v179, v90, v91
 v_lshlrev_b32 v176, 16, v177
 v_and_b32 v177, 0xffff0000, v177
 v_mul_f32 v180, v176, v176
 v_mul_f32 v181, v177, v177
 v_fmamk_f32 v180, v180, 0xbdd2d3e8, v26
 v_fmamk_f32 v181, v181, 0xbdd2d3e8, v26
 v_mul_f32 v180, v180, v176
 v_mul_f32 v181, v181, v177
 v_exp_f32 v180, v180
 v_exp_f32 v181, v181
 v_lshlrev_b32 v178, 16, v179
 v_add_f32 v180, 1.0, v180
 v_add_f32 v181, 1.0, v181
 v_rcp_f32 v180, v180
 v_rcp_f32 v181, v181
 v_and_b32 v179, 0xffff0000, v179
 v_mul_f32 v180, v180, v176
 v_mul_f32 v181, v181, v177
 v_cvt_pk_bf16_f32 v181, v180, v181
 v_lshlrev_b32 v180, 16, v181
 v_and_b32 v181, 0xffff0000, v181
 v_mul_f32 v180, v180, v178
 v_mul_f32 v181, v181, v179
 v_cvt_pk_bf16_f32 v189, v180, v181
 v_cvt_pk_bf16_f32 v177, v84, v85
 v_cvt_pk_bf16_f32 v179, v92, v93
 v_lshlrev_b32 v176, 16, v177
 v_and_b32 v177, 0xffff0000, v177
 v_mul_f32 v180, v176, v176
 v_mul_f32 v181, v177, v177
 v_fmamk_f32 v180, v180, 0xbdd2d3e8, v26
 v_fmamk_f32 v181, v181, 0xbdd2d3e8, v26
 v_mul_f32 v180, v180, v176
 v_mul_f32 v181, v181, v177
 v_exp_f32 v180, v180
 v_exp_f32 v181, v181
 v_lshlrev_b32 v178, 16, v179
 v_add_f32 v180, 1.0, v180
 v_add_f32 v181, 1.0, v181
 v_rcp_f32 v180, v180
 v_rcp_f32 v181, v181
 v_and_b32 v179, 0xffff0000, v179
 v_mul_f32 v180, v180, v176
 v_mul_f32 v181, v181, v177
 v_cvt_pk_bf16_f32 v181, v180, v181
 v_lshlrev_b32 v180, 16, v181
 v_and_b32 v181, 0xffff0000, v181
 v_mul_f32 v180, v180, v178
 v_mul_f32 v181, v181, v179
 v_cvt_pk_bf16_f32 v190, v180, v181
 v_cvt_pk_bf16_f32 v177, v86, v87
 v_cvt_pk_bf16_f32 v179, v94, v95
 v_lshlrev_b32 v176, 16, v177
 v_and_b32 v177, 0xffff0000, v177
 v_mul_f32 v180, v176, v176
 v_mul_f32 v181, v177, v177
 v_fmamk_f32 v180, v180, 0xbdd2d3e8, v26
 v_fmamk_f32 v181, v181, 0xbdd2d3e8, v26
 v_mul_f32 v180, v180, v176
 v_mul_f32 v181, v181, v177
 v_exp_f32 v180, v180
 v_exp_f32 v181, v181
 v_lshlrev_b32 v178, 16, v179
 v_add_f32 v180, 1.0, v180
 v_add_f32 v181, 1.0, v181
 v_rcp_f32 v180, v180
 v_rcp_f32 v181, v181
 v_and_b32 v179, 0xffff0000, v179
 v_mul_f32 v180, v180, v176
 v_mul_f32 v181, v181, v177
 v_cvt_pk_bf16_f32 v181, v180, v181
 v_lshlrev_b32 v180, 16, v181
 v_and_b32 v181, 0xffff0000, v181
 v_mul_f32 v180, v180, v178
 v_mul_f32 v181, v181, v179
 v_cvt_pk_bf16_f32 v191, v180, v181
 s_add_u32 s38, s34, 2560
 buffer_store_dwordx4 v[188:191], v25, s[16:19], s38 offen sc0 sc1
 v_cvt_pk_bf16_f32 v161, v96, v97
 v_cvt_pk_bf16_f32 v163, v104, v105
 v_lshlrev_b32 v160, 16, v161
 v_and_b32 v161, 0xffff0000, v161
 v_mul_f32 v164, v160, v160
 v_mul_f32 v165, v161, v161
 v_fmamk_f32 v164, v164, 0xbdd2d3e8, v26
 v_fmamk_f32 v165, v165, 0xbdd2d3e8, v26
 v_mul_f32 v164, v164, v160
 v_mul_f32 v165, v165, v161
 v_exp_f32 v164, v164
 v_exp_f32 v165, v165
 v_lshlrev_b32 v162, 16, v163
 v_add_f32 v164, 1.0, v164
 v_add_f32 v165, 1.0, v165
 v_rcp_f32 v164, v164
 v_rcp_f32 v165, v165
 v_and_b32 v163, 0xffff0000, v163
 v_mul_f32 v164, v164, v160
 v_mul_f32 v165, v165, v161
 v_cvt_pk_bf16_f32 v165, v164, v165
 v_lshlrev_b32 v164, 16, v165
 v_and_b32 v165, 0xffff0000, v165
 v_mul_f32 v164, v164, v162
 v_mul_f32 v165, v165, v163
 v_cvt_pk_bf16_f32 v172, v164, v165
 v_cvt_pk_bf16_f32 v161, v98, v99
 v_cvt_pk_bf16_f32 v163, v106, v107
 v_lshlrev_b32 v160, 16, v161
 v_and_b32 v161, 0xffff0000, v161
 v_mul_f32 v164, v160, v160
 v_mul_f32 v165, v161, v161
 v_fmamk_f32 v164, v164, 0xbdd2d3e8, v26
 v_fmamk_f32 v165, v165, 0xbdd2d3e8, v26
 v_mul_f32 v164, v164, v160
 v_mul_f32 v165, v165, v161
 v_exp_f32 v164, v164
 v_exp_f32 v165, v165
 v_lshlrev_b32 v162, 16, v163
 v_add_f32 v164, 1.0, v164
 v_add_f32 v165, 1.0, v165
 v_rcp_f32 v164, v164
 v_rcp_f32 v165, v165
 v_and_b32 v163, 0xffff0000, v163
 v_mul_f32 v164, v164, v160
 v_mul_f32 v165, v165, v161
 v_cvt_pk_bf16_f32 v165, v164, v165
 v_lshlrev_b32 v164, 16, v165
 v_and_b32 v165, 0xffff0000, v165
 v_mul_f32 v164, v164, v162
 v_mul_f32 v165, v165, v163
 v_cvt_pk_bf16_f32 v173, v164, v165
 v_cvt_pk_bf16_f32 v161, v100, v101
 v_cvt_pk_bf16_f32 v163, v108, v109
 v_lshlrev_b32 v160, 16, v161
 v_and_b32 v161, 0xffff0000, v161
 v_mul_f32 v164, v160, v160
 v_mul_f32 v165, v161, v161
 v_fmamk_f32 v164, v164, 0xbdd2d3e8, v26
 v_fmamk_f32 v165, v165, 0xbdd2d3e8, v26
 v_mul_f32 v164, v164, v160
 v_mul_f32 v165, v165, v161
 v_exp_f32 v164, v164
 v_exp_f32 v165, v165
 v_lshlrev_b32 v162, 16, v163
 v_add_f32 v164, 1.0, v164
 v_add_f32 v165, 1.0, v165
 v_rcp_f32 v164, v164
 v_rcp_f32 v165, v165
 v_and_b32 v163, 0xffff0000, v163
 v_mul_f32 v164, v164, v160
 v_mul_f32 v165, v165, v161
 v_cvt_pk_bf16_f32 v165, v164, v165
 v_lshlrev_b32 v164, 16, v165
 v_and_b32 v165, 0xffff0000, v165
 v_mul_f32 v164, v164, v162
 v_mul_f32 v165, v165, v163
 v_cvt_pk_bf16_f32 v174, v164, v165
 v_cvt_pk_bf16_f32 v161, v102, v103
 v_cvt_pk_bf16_f32 v163, v110, v111
 v_lshlrev_b32 v160, 16, v161
 v_and_b32 v161, 0xffff0000, v161
 v_mul_f32 v164, v160, v160
 v_mul_f32 v165, v161, v161
 v_fmamk_f32 v164, v164, 0xbdd2d3e8, v26
 v_fmamk_f32 v165, v165, 0xbdd2d3e8, v26
 v_mul_f32 v164, v164, v160
 v_mul_f32 v165, v165, v161
 v_exp_f32 v164, v164
 v_exp_f32 v165, v165
 v_lshlrev_b32 v162, 16, v163
 v_add_f32 v164, 1.0, v164
 v_add_f32 v165, 1.0, v165
 v_rcp_f32 v164, v164
 v_rcp_f32 v165, v165
 v_and_b32 v163, 0xffff0000, v163
 v_mul_f32 v164, v164, v160
 v_mul_f32 v165, v165, v161
 v_cvt_pk_bf16_f32 v165, v164, v165
 v_lshlrev_b32 v164, 16, v165
 v_and_b32 v165, 0xffff0000, v165
 v_mul_f32 v164, v164, v162
 v_mul_f32 v165, v165, v163
 v_cvt_pk_bf16_f32 v175, v164, v165
 s_add_u32 s38, s34, 3072
 buffer_store_dwordx4 v[172:175], v25, s[16:19], s38 offen sc0 sc1
 v_cvt_pk_bf16_f32 v177, v112, v113
 v_cvt_pk_bf16_f32 v179, v120, v121
 v_lshlrev_b32 v176, 16, v177
 v_and_b32 v177, 0xffff0000, v177
 v_mul_f32 v180, v176, v176
 v_mul_f32 v181, v177, v177
 v_fmamk_f32 v180, v180, 0xbdd2d3e8, v26
 v_fmamk_f32 v181, v181, 0xbdd2d3e8, v26
 v_mul_f32 v180, v180, v176
 v_mul_f32 v181, v181, v177
 v_exp_f32 v180, v180
 v_exp_f32 v181, v181
 v_lshlrev_b32 v178, 16, v179
 v_add_f32 v180, 1.0, v180
 v_add_f32 v181, 1.0, v181
 v_rcp_f32 v180, v180
 v_rcp_f32 v181, v181
 v_and_b32 v179, 0xffff0000, v179
 v_mul_f32 v180, v180, v176
 v_mul_f32 v181, v181, v177
 v_cvt_pk_bf16_f32 v181, v180, v181
 v_lshlrev_b32 v180, 16, v181
 v_and_b32 v181, 0xffff0000, v181
 v_mul_f32 v180, v180, v178
 v_mul_f32 v181, v181, v179
 v_cvt_pk_bf16_f32 v188, v180, v181
 v_cvt_pk_bf16_f32 v177, v114, v115
 v_cvt_pk_bf16_f32 v179, v122, v123
 v_lshlrev_b32 v176, 16, v177
 v_and_b32 v177, 0xffff0000, v177
 v_mul_f32 v180, v176, v176
 v_mul_f32 v181, v177, v177
 v_fmamk_f32 v180, v180, 0xbdd2d3e8, v26
 v_fmamk_f32 v181, v181, 0xbdd2d3e8, v26
 v_mul_f32 v180, v180, v176
 v_mul_f32 v181, v181, v177
 v_exp_f32 v180, v180
 v_exp_f32 v181, v181
 v_lshlrev_b32 v178, 16, v179
 v_add_f32 v180, 1.0, v180
 v_add_f32 v181, 1.0, v181
 v_rcp_f32 v180, v180
 v_rcp_f32 v181, v181
 v_and_b32 v179, 0xffff0000, v179
 v_mul_f32 v180, v180, v176
 v_mul_f32 v181, v181, v177
 v_cvt_pk_bf16_f32 v181, v180, v181
 v_lshlrev_b32 v180, 16, v181
 v_and_b32 v181, 0xffff0000, v181
 v_mul_f32 v180, v180, v178
 v_mul_f32 v181, v181, v179
 v_cvt_pk_bf16_f32 v189, v180, v181
 v_cvt_pk_bf16_f32 v177, v116, v117
 v_cvt_pk_bf16_f32 v179, v124, v125
 v_lshlrev_b32 v176, 16, v177
 v_and_b32 v177, 0xffff0000, v177
 v_mul_f32 v180, v176, v176
 v_mul_f32 v181, v177, v177
 v_fmamk_f32 v180, v180, 0xbdd2d3e8, v26
 v_fmamk_f32 v181, v181, 0xbdd2d3e8, v26
 v_mul_f32 v180, v180, v176
 v_mul_f32 v181, v181, v177
 v_exp_f32 v180, v180
 v_exp_f32 v181, v181
 v_lshlrev_b32 v178, 16, v179
 v_add_f32 v180, 1.0, v180
 v_add_f32 v181, 1.0, v181
 v_rcp_f32 v180, v180
 v_rcp_f32 v181, v181
 v_and_b32 v179, 0xffff0000, v179
 v_mul_f32 v180, v180, v176
 v_mul_f32 v181, v181, v177
 v_cvt_pk_bf16_f32 v181, v180, v181
 v_lshlrev_b32 v180, 16, v181
 v_and_b32 v181, 0xffff0000, v181
 v_mul_f32 v180, v180, v178
 v_mul_f32 v181, v181, v179
 v_cvt_pk_bf16_f32 v190, v180, v181
 v_cvt_pk_bf16_f32 v177, v118, v119
 v_cvt_pk_bf16_f32 v179, v126, v127
 v_lshlrev_b32 v176, 16, v177
 v_and_b32 v177, 0xffff0000, v177
 v_mul_f32 v180, v176, v176
 v_mul_f32 v181, v177, v177
 v_fmamk_f32 v180, v180, 0xbdd2d3e8, v26
 v_fmamk_f32 v181, v181, 0xbdd2d3e8, v26
 v_mul_f32 v180, v180, v176
 v_mul_f32 v181, v181, v177
 v_exp_f32 v180, v180
 v_exp_f32 v181, v181
 v_lshlrev_b32 v178, 16, v179
 v_add_f32 v180, 1.0, v180
 v_add_f32 v181, 1.0, v181
 v_rcp_f32 v180, v180
 v_rcp_f32 v181, v181
 v_and_b32 v179, 0xffff0000, v179
 v_mul_f32 v180, v180, v176
 v_mul_f32 v181, v181, v177
 v_cvt_pk_bf16_f32 v181, v180, v181
 v_lshlrev_b32 v180, 16, v181
 v_and_b32 v181, 0xffff0000, v181
 v_mul_f32 v180, v180, v178
 v_mul_f32 v181, v181, v179
 v_cvt_pk_bf16_f32 v191, v180, v181
 s_add_u32 s38, s34, 3584
 buffer_store_dwordx4 v[188:191], v25, s[16:19], s38 offen sc0 sc1
 v_cvt_pk_bf16_f32 v161, v128, v129
 v_cvt_pk_bf16_f32 v163, v136, v137
 v_lshlrev_b32 v160, 16, v161
 v_and_b32 v161, 0xffff0000, v161
 v_mul_f32 v164, v160, v160
 v_mul_f32 v165, v161, v161
 v_fmamk_f32 v164, v164, 0xbdd2d3e8, v26
 v_fmamk_f32 v165, v165, 0xbdd2d3e8, v26
 v_mul_f32 v164, v164, v160
 v_mul_f32 v165, v165, v161
 v_exp_f32 v164, v164
 v_exp_f32 v165, v165
 v_lshlrev_b32 v162, 16, v163
 v_add_f32 v164, 1.0, v164
 v_add_f32 v165, 1.0, v165
 v_rcp_f32 v164, v164
 v_rcp_f32 v165, v165
 v_and_b32 v163, 0xffff0000, v163
 v_mul_f32 v164, v164, v160
 v_mul_f32 v165, v165, v161
 v_cvt_pk_bf16_f32 v165, v164, v165
 v_lshlrev_b32 v164, 16, v165
 v_and_b32 v165, 0xffff0000, v165
 v_mul_f32 v164, v164, v162
 v_mul_f32 v165, v165, v163
 v_cvt_pk_bf16_f32 v172, v164, v165
 v_cvt_pk_bf16_f32 v161, v130, v131
 v_cvt_pk_bf16_f32 v163, v138, v139
 v_lshlrev_b32 v160, 16, v161
 v_and_b32 v161, 0xffff0000, v161
 v_mul_f32 v164, v160, v160
 v_mul_f32 v165, v161, v161
 v_fmamk_f32 v164, v164, 0xbdd2d3e8, v26
 v_fmamk_f32 v165, v165, 0xbdd2d3e8, v26
 v_mul_f32 v164, v164, v160
 v_mul_f32 v165, v165, v161
 v_exp_f32 v164, v164
 v_exp_f32 v165, v165
 v_lshlrev_b32 v162, 16, v163
 v_add_f32 v164, 1.0, v164
 v_add_f32 v165, 1.0, v165
 v_rcp_f32 v164, v164
 v_rcp_f32 v165, v165
 v_and_b32 v163, 0xffff0000, v163
 v_mul_f32 v164, v164, v160
 v_mul_f32 v165, v165, v161
 v_cvt_pk_bf16_f32 v165, v164, v165
 v_lshlrev_b32 v164, 16, v165
 v_and_b32 v165, 0xffff0000, v165
 v_mul_f32 v164, v164, v162
 v_mul_f32 v165, v165, v163
 v_cvt_pk_bf16_f32 v173, v164, v165
 v_cvt_pk_bf16_f32 v161, v132, v133
 v_cvt_pk_bf16_f32 v163, v140, v141
 v_lshlrev_b32 v160, 16, v161
 v_and_b32 v161, 0xffff0000, v161
 v_mul_f32 v164, v160, v160
 v_mul_f32 v165, v161, v161
 v_fmamk_f32 v164, v164, 0xbdd2d3e8, v26
 v_fmamk_f32 v165, v165, 0xbdd2d3e8, v26
 v_mul_f32 v164, v164, v160
 v_mul_f32 v165, v165, v161
 v_exp_f32 v164, v164
 v_exp_f32 v165, v165
 v_lshlrev_b32 v162, 16, v163
 v_add_f32 v164, 1.0, v164
 v_add_f32 v165, 1.0, v165
 v_rcp_f32 v164, v164
 v_rcp_f32 v165, v165
 v_and_b32 v163, 0xffff0000, v163
 v_mul_f32 v164, v164, v160
 v_mul_f32 v165, v165, v161
 v_cvt_pk_bf16_f32 v165, v164, v165
 v_lshlrev_b32 v164, 16, v165
 v_and_b32 v165, 0xffff0000, v165
 v_mul_f32 v164, v164, v162
 v_mul_f32 v165, v165, v163
 v_cvt_pk_bf16_f32 v174, v164, v165
 v_cvt_pk_bf16_f32 v161, v134, v135
 v_cvt_pk_bf16_f32 v163, v142, v143
 v_lshlrev_b32 v160, 16, v161
 v_and_b32 v161, 0xffff0000, v161
 v_mul_f32 v164, v160, v160
 v_mul_f32 v165, v161, v161
 v_fmamk_f32 v164, v164, 0xbdd2d3e8, v26
 v_fmamk_f32 v165, v165, 0xbdd2d3e8, v26
 v_mul_f32 v164, v164, v160
 v_mul_f32 v165, v165, v161
 v_exp_f32 v164, v164
 v_exp_f32 v165, v165
 v_lshlrev_b32 v162, 16, v163
 v_add_f32 v164, 1.0, v164
 v_add_f32 v165, 1.0, v165
 v_rcp_f32 v164, v164
 v_rcp_f32 v165, v165
 v_and_b32 v163, 0xffff0000, v163
 v_mul_f32 v164, v164, v160
 v_mul_f32 v165, v165, v161
 v_cvt_pk_bf16_f32 v165, v164, v165
 v_lshlrev_b32 v164, 16, v165
 v_and_b32 v165, 0xffff0000, v165
 v_mul_f32 v164, v164, v162
 v_mul_f32 v165, v165, v163
 v_cvt_pk_bf16_f32 v175, v164, v165
 s_add_u32 s38, s33, 0
 buffer_store_dwordx4 v[172:175], v25, s[16:19], s38 offen sc0 sc1
 v_cvt_pk_bf16_f32 v177, v144, v145
 v_cvt_pk_bf16_f32 v179, v152, v153
 v_lshlrev_b32 v176, 16, v177
 v_and_b32 v177, 0xffff0000, v177
 v_mul_f32 v180, v176, v176
 v_mul_f32 v181, v177, v177
 v_fmamk_f32 v180, v180, 0xbdd2d3e8, v26
 v_fmamk_f32 v181, v181, 0xbdd2d3e8, v26
 v_mul_f32 v180, v180, v176
 v_mul_f32 v181, v181, v177
 v_exp_f32 v180, v180
 v_exp_f32 v181, v181
 v_lshlrev_b32 v178, 16, v179
 v_add_f32 v180, 1.0, v180
 v_add_f32 v181, 1.0, v181
 v_rcp_f32 v180, v180
 v_rcp_f32 v181, v181
 v_and_b32 v179, 0xffff0000, v179
 v_mul_f32 v180, v180, v176
 v_mul_f32 v181, v181, v177
 v_cvt_pk_bf16_f32 v181, v180, v181
 v_lshlrev_b32 v180, 16, v181
 v_and_b32 v181, 0xffff0000, v181
 v_mul_f32 v180, v180, v178
 v_mul_f32 v181, v181, v179
 v_cvt_pk_bf16_f32 v188, v180, v181
 v_cvt_pk_bf16_f32 v177, v146, v147
 v_cvt_pk_bf16_f32 v179, v154, v155
 v_lshlrev_b32 v176, 16, v177
 v_and_b32 v177, 0xffff0000, v177
 v_mul_f32 v180, v176, v176
 v_mul_f32 v181, v177, v177
 v_fmamk_f32 v180, v180, 0xbdd2d3e8, v26
 v_fmamk_f32 v181, v181, 0xbdd2d3e8, v26
 v_mul_f32 v180, v180, v176
 v_mul_f32 v181, v181, v177
 v_exp_f32 v180, v180
 v_exp_f32 v181, v181
 v_lshlrev_b32 v178, 16, v179
 v_add_f32 v180, 1.0, v180
 v_add_f32 v181, 1.0, v181
 v_rcp_f32 v180, v180
 v_rcp_f32 v181, v181
 v_and_b32 v179, 0xffff0000, v179
 v_mul_f32 v180, v180, v176
 v_mul_f32 v181, v181, v177
 v_cvt_pk_bf16_f32 v181, v180, v181
 v_lshlrev_b32 v180, 16, v181
 v_and_b32 v181, 0xffff0000, v181
 v_mul_f32 v180, v180, v178
 v_mul_f32 v181, v181, v179
 v_cvt_pk_bf16_f32 v189, v180, v181
 v_cvt_pk_bf16_f32 v177, v148, v149
 v_cvt_pk_bf16_f32 v179, v156, v157
 v_lshlrev_b32 v176, 16, v177
 v_and_b32 v177, 0xffff0000, v177
 v_mul_f32 v180, v176, v176
 v_mul_f32 v181, v177, v177
 v_fmamk_f32 v180, v180, 0xbdd2d3e8, v26
 v_fmamk_f32 v181, v181, 0xbdd2d3e8, v26
 v_mul_f32 v180, v180, v176
 v_mul_f32 v181, v181, v177
 v_exp_f32 v180, v180
 v_exp_f32 v181, v181
 v_lshlrev_b32 v178, 16, v179
 v_add_f32 v180, 1.0, v180
 v_add_f32 v181, 1.0, v181
 v_rcp_f32 v180, v180
 v_rcp_f32 v181, v181
 v_and_b32 v179, 0xffff0000, v179
 v_mul_f32 v180, v180, v176
 v_mul_f32 v181, v181, v177
 v_cvt_pk_bf16_f32 v181, v180, v181
 v_lshlrev_b32 v180, 16, v181
 v_and_b32 v181, 0xffff0000, v181
 v_mul_f32 v180, v180, v178
 v_mul_f32 v181, v181, v179
 v_cvt_pk_bf16_f32 v190, v180, v181
 v_cvt_pk_bf16_f32 v177, v150, v151
 v_cvt_pk_bf16_f32 v179, v158, v159
 v_lshlrev_b32 v176, 16, v177
 v_and_b32 v177, 0xffff0000, v177
 v_mul_f32 v180, v176, v176
 v_mul_f32 v181, v177, v177
 v_fmamk_f32 v180, v180, 0xbdd2d3e8, v26
 v_fmamk_f32 v181, v181, 0xbdd2d3e8, v26
 v_mul_f32 v180, v180, v176
 v_mul_f32 v181, v181, v177
 v_exp_f32 v180, v180
 v_exp_f32 v181, v181
 v_lshlrev_b32 v178, 16, v179
 v_add_f32 v180, 1.0, v180
 v_add_f32 v181, 1.0, v181
 v_rcp_f32 v180, v180
 v_rcp_f32 v181, v181
 v_and_b32 v179, 0xffff0000, v179
 v_mul_f32 v180, v180, v176
 v_mul_f32 v181, v181, v177
 v_cvt_pk_bf16_f32 v181, v180, v181
 v_lshlrev_b32 v180, 16, v181
 v_and_b32 v181, 0xffff0000, v181
 v_mul_f32 v180, v180, v178
 v_mul_f32 v181, v181, v179
 v_cvt_pk_bf16_f32 v191, v180, v181
 s_add_u32 s38, s33, 512
 buffer_store_dwordx4 v[188:191], v25, s[16:19], s38 offen sc0 sc1
 s_endpgm
L_k1_F2:
 v_and_b32 v1, 63, v0
 v_lshrrev_b32 v35, 3, v1
 v_and_b32 v36, 7, v1
 v_lshrrev_b32 v37, 4, v1
 v_xor_b32 v37, v36, v37
 v_lshlrev_b32 v37, 4, v37
 s_lshl_b32 s24, s21, 7
 s_lshl_b32 s25, s98, 4
 s_add_u32 s24, s24, s25
 v_add_u32 v38, s24, v35
 v_mul_u32_u24 v38, 1280, v38
 v_add_u32 v2, v38, v37
 v_xor_b32 v37, 64, v37
 v_add_u32 v3, v38, v37
 v_add_u32 v3, 10240, v3
 s_lshl_b32 s36, s98, 11
 s_add_u32 s36, s36, 112640
 s_lshl_b32 s35, s98, 10
 v_lshrrev_b32 v35, 3, v1
 v_and_b32 v36, 7, v1
 v_bfe_u32 v37, v1, 4, 1
 v_lshlrev_b32 v37, 1, v37
 v_xor_b32 v37, v37, v36
 s_and_b32 s24, s98, 4
 v_xor_b32 v37, s24, v37
 v_lshlrev_b32 v37, 4, v37
 s_lshl_b32 s24, s20, 3
 v_add_u32 v35, s24, v35
 v_mul_u32_u24 v35, 3456, v35
 v_add_u32 v8, v35, v37
 s_lshl_b32 s88, s23, 7
 s_cmp_lt_u32 s98, 4
 s_cselect_b32 s40, s8, s12
 s_cselect_b32 s41, s9, s13
 s_mov_b32 s42, 2211840
 s_mov_b32 s43, 0x00020000
 v_lshrrev_b32 v35, 3, v1
 v_and_b32 v36, 7, v1
 v_bfe_u32 v37, v1, 4, 1
 v_lshlrev_b32 v37, 1, v37
 v_xor_b32 v37, v37, v36
 s_and_b32 s24, s98, 4
 v_xor_b32 v37, s24, v37
 v_lshlrev_b32 v37, 4, v37
 s_lshl_b32 s24, s20, 3
 v_add_u32 v35, s24, v35
 v_mul_u32_u24 v35, 3456, v35
 v_add_u32 v9, v35, v37
 s_lshl_b32 s89, s99, 7
 s_cmp_lt_u32 s98, 4
 s_cselect_b32 s56, s8, s12
 s_cselect_b32 s57, s9, s13
 s_mov_b32 s58, 2211840
 s_mov_b32 s59, 0x00020000
 s_cmp_ge_u32 s98, 4
 s_cbranch_scc1 L3_D_h1
 s_and_b32 s74, s35, 1024
 s_add_u32 s74, s74, 161792
 s_add_u32 m0, s36, 0
 s_movk_i32 s37, 0
 buffer_load_dwordx4 v2, s[4:7], s37 offen lds
 s_add_u32 m0, s36, 1024
 s_movk_i32 s37, 0
 buffer_load_dwordx4 v3, s[4:7], s37 offen lds
 s_add_u32 m0, s35, 0
 s_add_u32 s37, s88, 0
 buffer_load_dwordx4 v8, s[40:43], s37 offen lds
 s_add_u32 m0, s35, 8192
 s_add_u32 s37, s89, 0
 buffer_load_dwordx4 v9, s[56:59], s37 offen lds
 s_add_u32 m0, s35, 22528
 s_add_u32 s37, s88, 110592
 buffer_load_dwordx4 v8, s[40:43], s37 offen lds
 s_add_u32 m0, s35, 30720
 s_add_u32 s37, s89, 110592
 buffer_load_dwordx4 v9, s[56:59], s37 offen lds
 s_add_u32 m0, s36, 16384
 s_movk_i32 s37, 128
 buffer_load_dwordx4 v2, s[4:7], s37 offen lds
 s_add_u32 m0, s36, 17408
 s_movk_i32 s37, 128
 buffer_load_dwordx4 v3, s[4:7], s37 offen lds
 s_add_u32 m0, s35, 45056
 s_add_u32 s37, s88, 221184
 buffer_load_dwordx4 v8, s[40:43], s37 offen lds
 s_add_u32 m0, s35, 53248
 s_add_u32 s37, s89, 221184
 buffer_load_dwordx4 v9, s[56:59], s37 offen lds
 v_and_b32 v35, 31, v1
 v_lshrrev_b32 v36, 5, v1
 v_bfe_u32 v37, v1, 1, 3
 v_xor_b32 v37, v37, v36
 v_lshlrev_b32 v38, 7, v35
 s_lshl_b32 s24, s20, 12
 s_add_u32 s24, s24, 112640
 v_add_u32 v38, s24, v38
 v_xor_b32 v39, 0, v37
 v_lshl_add_u32 v4, v39, 4, v38
 v_xor_b32 v39, 2, v37
 v_lshl_add_u32 v5, v39, 4, v38
 v_xor_b32 v39, 4, v37
 v_lshl_add_u32 v6, v39, 4, v38
 v_xor_b32 v39, 6, v37
 v_lshl_add_u32 v7, v39, 4, v38
 v_bfe_u32 v35, v1, 4, 1
 v_lshrrev_b32 v36, 5, v1
 v_bfe_u32 v37, v1, 2, 2
 v_and_b32 v38, 3, v1
 v_lshlrev_b32 v39, 12, v35
 v_lshl_add_u32 v39, v36, 10, v39
 v_lshl_add_u32 v39, v37, 7, v39
 v_lshl_add_u32 v39, v38, 3, v39
 v_lshrrev_b32 v37, 1, v37
 v_lshl_or_b32 v37, v35, 1, v37
 v_xor_b32 v38, 0, v37
 v_lshl_add_u32 v17, v38, 5, v39
 v_add_u32 v21, 0x10000, v17
 v_xor_b32 v38, 1, v37
 v_lshl_add_u32 v18, v38, 5, v39
 v_add_u32 v22, 0x10000, v18
 v_xor_b32 v38, 2, v37
 v_lshl_add_u32 v19, v38, 5, v39
 v_add_u32 v23, 0x10000, v19
 v_xor_b32 v38, 3, v37
 v_lshl_add_u32 v20, v38, 5, v39
 v_add_u32 v24, 0x10000, v20
 s_lshl_b32 s24, s20, 1
 v_add_u32 v35, s24, v35
 s_mov_b32 s25, 55296
 v_mul_lo_u32 v35, v35, s25
 v_and_b32 v37, 15, v1
 v_lshl_add_u32 v37, v36, 4, v37
 v_lshl_add_u32 v25, v37, 4, v35
 s_mul_i32 s34, s21, 442368
 s_add_u32 s34, s34, 0
 s_lshl_b32 s24, s96, 11
 s_add_u32 s33, s34, s24
 s_lshl_b32 s24, s97, 9
 s_add_u32 s33, s33, s24
 s_lshl_b32 s24, s23, 11
 s_add_u32 s34, s34, s24
 v_mov_b32 v26, 0xc0135761
 v_mov_b32 v244, 0xbdd2d3e8
 v_mov_b32 v245, 0xbdd2d3e8
 v_mov_b32 v246, 0xc0135761
 v_mov_b32 v247, 0xc0135761
 v_bfe_u32 v35, v1, 4, 1
 v_bfe_u32 v37, v1, 2, 2
 v_and_b32 v38, 3, v1
 v_lshlrev_b32 v39, 11, v35
 v_lshl_add_u32 v39, v36, 9, v39
 v_lshl_add_u32 v39, v37, 6, v39
 v_lshl_add_u32 v39, v38, 3, v39
 v_lshl_add_u32 v252, v35, 5, v39
 v_xor_b32 v253, 32, v252
 v_add_u32 v254, 0x10000, v252
 v_add_u32 v255, 0x10000, v253
 s_waitcnt vmcnt(6)
 s_barrier
 ds_read_b128 v[176:179], v4 offset:0
 ds_read_b128 v[180:183], v5 offset:0
 ds_read_b64_tr_b16 v[40:41], v17 offset:0
 ds_read_b64_tr_b16 v[42:43], v17 offset:512
 s_add_u32 m0, s35, 67584
 s_add_u32 s37, s88, 331776
 buffer_load_dwordx4 v8, s[40:43], s37 offen lds
 ds_read_b64_tr_b16 v[44:45], v18 offset:0
 ds_read_b64_tr_b16 v[46:47], v18 offset:512
 s_add_u32 m0, s35, 75776
 s_add_u32 s37, s89, 331776
 buffer_load_dwordx4 v9, s[56:59], s37 offen lds
 ds_read_b64_tr_b16 v[48:49], v19 offset:0
 ds_read_b64_tr_b16 v[50:51], v19 offset:512
 s_waitcnt lgkmcnt(4)
 v_mfma_f32_32x32x16_bf16 v[64:79], v[40:43], v[176:179], 0
 ds_read_b64_tr_b16 v[52:53], v20 offset:0
 ds_read_b64_tr_b16 v[54:55], v20 offset:512
 s_mov_b32 s84, s54
 s_mov_b32 s85, s55
 s_mov_b32 s86, 1280
 s_waitcnt lgkmcnt(4)
 v_mfma_f32_32x32x16_bf16 v[80:95], v[44:47], v[176:179], 0
 ds_read_b64_tr_b16 v[56:57], v17 offset:2048
 ds_read_b64_tr_b16 v[58:59], v17 offset:2560
 s_mov_b32 s87, 0x00020000
 s_lshl_b32 s24, s2, 3
 s_lshl_b32 s25, s20, 1
 s_waitcnt lgkmcnt(4)
 v_mfma_f32_32x32x16_bf16 v[96:111], v[48:51], v[176:179], 0
 ds_read_b64_tr_b16 v[60:61], v18 offset:2048
 ds_read_b64_tr_b16 v[62:63], v18 offset:2560
 s_add_u32 s24, s24, s25
 v_lshrrev_b32 v35, 5, v1
 v_add_u32 v216, s24, v35
 s_waitcnt lgkmcnt(4)
 v_mfma_f32_32x32x16_bf16 v[112:127], v[52:55], v[176:179], 0
 ds_read_b64_tr_b16 v[40:41], v19 offset:2048
 ds_read_b64_tr_b16 v[42:43], v19 offset:2560
 v_mul_u32_u24 v35, 1280, v216
 v_and_b32 v36, 31, v1
 v_lshlrev_b32 v36, 4, v36
 s_waitcnt lgkmcnt(4)
 v_mfma_f32_32x32x16_bf16 v[64:79], v[56:59], v[180:183], v[64:79]
 ds_read_b64_tr_b16 v[44:45], v20 offset:2048
 ds_read_b64_tr_b16 v[46:47], v20 offset:2560
 v_add_u32 v35, v35, v36
 v_mov_b32 v37, 0x80000000
 v_cmp_gt_u32 vcc, 256, v36
 s_waitcnt lgkmcnt(4)
 v_mfma_f32_32x32x16_bf16 v[80:95], v[60:63], v[180:183], v[80:95]
 s_waitcnt vmcnt(6)
 s_barrier
 ds_read_b128 v[184:187], v6 offset:0
 ds_read_b128 v[188:191], v7 offset:0
 ds_read_b64_tr_b16 v[48:49], v17 offset:22528
 ds_read_b64_tr_b16 v[50:51], v17 offset:23040
 s_add_u32 m0, s35, 90112
 s_add_u32 s37, s88, 442368
 buffer_load_dwordx4 v8, s[40:43], s37 offen lds
 s_waitcnt lgkmcnt(6)
 v_mfma_f32_32x32x16_bf16 v[96:111], v[40:43], v[180:183], v[96:111]
 ds_read_b64_tr_b16 v[52:53], v18 offset:22528
 ds_read_b64_tr_b16 v[54:55], v18 offset:23040
 s_add_u32 m0, s35, 98304
 s_add_u32 s37, s89, 442368
 buffer_load_dwordx4 v9, s[56:59], s37 offen lds
 s_waitcnt lgkmcnt(6)
 v_mfma_f32_32x32x16_bf16 v[112:127], v[44:47], v[180:183], v[112:127]
 ds_read_b64_tr_b16 v[56:57], v19 offset:22528
 ds_read_b64_tr_b16 v[58:59], v19 offset:23040
 s_add_u32 m0, s36, 32768
 s_movk_i32 s37, 256
 buffer_load_dwordx4 v2, s[4:7], s37 offen lds
 s_waitcnt lgkmcnt(4)
 v_mfma_f32_32x32x16_bf16 v[64:79], v[48:51], v[184:187], v[64:79]
 ds_read_b64_tr_b16 v[60:61], v20 offset:22528
 ds_read_b64_tr_b16 v[62:63], v20 offset:23040
 s_add_u32 m0, s36, 33792
 s_movk_i32 s37, 256
 buffer_load_dwordx4 v3, s[4:7], s37 offen lds
 s_waitcnt lgkmcnt(4)
 v_mfma_f32_32x32x16_bf16 v[80:95], v[52:55], v[184:187], v[80:95]
 ds_read_b64_tr_b16 v[40:41], v17 offset:24576
 ds_read_b64_tr_b16 v[42:43], v17 offset:25088
 s_nop 1
 v_cndmask_b32 v38, v37, v35, vcc
 v_cndmask_b32 v39, v37, v36, vcc
 s_waitcnt lgkmcnt(4)
 v_mfma_f32_32x32x16_bf16 v[96:111], v[56:59], v[184:187], v[96:111]
 ds_read_b64_tr_b16 v[44:45], v18 offset:24576
 ds_read_b64_tr_b16 v[46:47], v18 offset:25088
 buffer_load_dwordx4 v[192:195], v35, s[4:7], 0 offen offset:0
 s_waitcnt lgkmcnt(4)
 v_mfma_f32_32x32x16_bf16 v[112:127], v[60:63], v[184:187], v[112:127]
 ds_read_b64_tr_b16 v[48:49], v19 offset:24576
 ds_read_b64_tr_b16 v[50:51], v19 offset:25088
 buffer_load_dwordx4 v[196:199], v36, s[84:87], 0 offen offset:0
 s_waitcnt lgkmcnt(4)
 v_mfma_f32_32x32x16_bf16 v[64:79], v[40:43], v[188:191], v[64:79]
 ds_read_b64_tr_b16 v[52:53], v20 offset:24576
 ds_read_b64_tr_b16 v[54:55], v20 offset:25088
 buffer_load_dwordx4 v[200:203], v35, s[4:7], 0 offen offset:512
 s_waitcnt lgkmcnt(4)
 v_mfma_f32_32x32x16_bf16 v[80:95], v[44:47], v[188:191], v[80:95]
 s_waitcnt vmcnt(9)
 s_barrier
 ds_read_b128 v[176:179], v4 offset:16384
 ds_read_b128 v[180:183], v5 offset:16384
 ds_read_b64_tr_b16 v[56:57], v17 offset:45056
 ds_read_b64_tr_b16 v[58:59], v17 offset:45568
 s_add_u32 m0, s35, 0
 s_add_u32 s37, s88, 552960
 buffer_load_dwordx4 v8, s[40:43], s37 offen lds
 s_waitcnt lgkmcnt(6)
 v_mfma_f32_32x32x16_bf16 v[96:111], v[48:51], v[188:191], v[96:111]
 ds_read_b64_tr_b16 v[60:61], v18 offset:45056
 ds_read_b64_tr_b16 v[62:63], v18 offset:45568
 s_add_u32 m0, s35, 8192
 s_add_u32 s37, s89, 552960
 buffer_load_dwordx4 v9, s[56:59], s37 offen lds
 s_waitcnt lgkmcnt(6)
 v_mfma_f32_32x32x16_bf16 v[112:127], v[52:55], v[188:191], v[112:127]
 ds_read_b64_tr_b16 v[40:41], v19 offset:45056
 ds_read_b64_tr_b16 v[42:43], v19 offset:45568
 buffer_load_dwordx4 v[204:207], v36, s[84:87], 0 offen offset:512
 s_waitcnt lgkmcnt(4)
 v_mfma_f32_32x32x16_bf16 v[64:79], v[56:59], v[176:179], v[64:79]
 ds_read_b64_tr_b16 v[44:45], v20 offset:45056
 ds_read_b64_tr_b16 v[46:47], v20 offset:45568
 buffer_load_dwordx4 v[208:211], v38, s[4:7], 0 offen offset:1024
 s_waitcnt lgkmcnt(4)
 v_mfma_f32_32x32x16_bf16 v[80:95], v[60:63], v[176:179], v[80:95]
 ds_read_b64_tr_b16 v[48:49], v17 offset:47104
 ds_read_b64_tr_b16 v[50:51], v17 offset:47616
 buffer_load_dwordx4 v[212:215], v39, s[84:87], 0 offen offset:1024
 s_waitcnt lgkmcnt(4)
 v_mfma_f32_32x32x16_bf16 v[96:111], v[40:43], v[176:179], v[96:111]
 ds_read_b64_tr_b16 v[52:53], v18 offset:47104
 ds_read_b64_tr_b16 v[54:55], v18 offset:47616
 s_mul_i32 s24, s2, 10240
 s_add_u32 s24, s24, 15728640
 s_add_u32 s25, s24, 4096
 s_waitcnt lgkmcnt(4)
 v_mfma_f32_32x32x16_bf16 v[112:127], v[44:47], v[176:179], v[112:127]
 ds_read_b64_tr_b16 v[56:57], v19 offset:47104
 ds_read_b64_tr_b16 v[58:59], v19 offset:47616
 s_add_u32 s26, s24, 8192
 v_lshlrev_b32 v35, 4, v0
 v_cmp_gt_u32 vcc, 128, v0
 s_waitcnt lgkmcnt(4)
 v_mfma_f32_32x32x16_bf16 v[64:79], v[48:51], v[180:183], v[64:79]
 ds_read_b64_tr_b16 v[60:61], v20 offset:47104
 ds_read_b64_tr_b16 v[62:63], v20 offset:47616
 v_mov_b32 v218, -1
 v_mov_b32 v219, -1
 v_mov_b32 v220, -1
 s_waitcnt lgkmcnt(4)
 v_mfma_f32_32x32x16_bf16 v[80:95], v[52:55], v[180:183], v[80:95]
 s_waitcnt vmcnt(12)
 s_barrier
 ds_read_b128 v[184:187], v6 offset:16384
 ds_read_b128 v[188:191], v7 offset:16384
 ds_read_b64_tr_b16 v[40:41], v21 offset:2048
 ds_read_b64_tr_b16 v[42:43], v21 offset:2560
 s_add_u32 m0, s35, 22528
 s_add_u32 s37, s88, 663552
 buffer_load_dwordx4 v8, s[40:43], s37 offen lds
 s_waitcnt lgkmcnt(6)
 v_mfma_f32_32x32x16_bf16 v[96:111], v[56:59], v[180:183], v[96:111]
 ds_read_b64_tr_b16 v[44:45], v22 offset:2048
 ds_read_b64_tr_b16 v[46:47], v22 offset:2560
 s_add_u32 m0, s35, 30720
 s_add_u32 s37, s89, 663552
 buffer_load_dwordx4 v9, s[56:59], s37 offen lds
 s_waitcnt lgkmcnt(6)
 v_mfma_f32_32x32x16_bf16 v[112:127], v[60:63], v[180:183], v[112:127]
 ds_read_b64_tr_b16 v[48:49], v23 offset:2048
 ds_read_b64_tr_b16 v[50:51], v23 offset:2560
 s_add_u32 m0, s36, 0
 s_movk_i32 s37, 384
 buffer_load_dwordx4 v2, s[4:7], s37 offen lds
 s_waitcnt lgkmcnt(4)
 v_mfma_f32_32x32x16_bf16 v[64:79], v[40:43], v[184:187], v[64:79]
 ds_read_b64_tr_b16 v[52:53], v24 offset:2048
 ds_read_b64_tr_b16 v[54:55], v24 offset:2560
 s_add_u32 m0, s36, 1024
 s_movk_i32 s37, 384
 buffer_load_dwordx4 v3, s[4:7], s37 offen lds
 s_waitcnt lgkmcnt(4)
 v_mfma_f32_32x32x16_bf16 v[80:95], v[44:47], v[184:187], v[80:95]
 ds_read_b64_tr_b16 v[56:57], v21 offset:4096
 ds_read_b64_tr_b16 v[58:59], v21 offset:4608
 v_mov_b32 v221, -1
 v_cndmask_b32 v36, v37, v35, vcc
 buffer_store_dwordx4 v[218:221], v35, s[16:19], s24 offen
 s_waitcnt lgkmcnt(4)
 v_mfma_f32_32x32x16_bf16 v[96:111], v[48:51], v[184:187], v[96:111]
 ds_read_b64_tr_b16 v[60:61], v22 offset:4096
 ds_read_b64_tr_b16 v[62:63], v22 offset:4608
 buffer_store_dwordx4 v[218:221], v35, s[16:19], s25 offen
 s_waitcnt lgkmcnt(4)
 v_mfma_f32_32x32x16_bf16 v[112:127], v[52:55], v[184:187], v[112:127]
 ds_read_b64_tr_b16 v[40:41], v23 offset:4096
 ds_read_b64_tr_b16 v[42:43], v23 offset:4608
 buffer_store_dwordx4 v[218:221], v36, s[16:19], s26 offen
 s_waitcnt lgkmcnt(4)
 v_mfma_f32_32x32x16_bf16 v[64:79], v[56:59], v[188:191], v[64:79]
 ds_read_b64_tr_b16 v[44:45], v24 offset:4096
 ds_read_b64_tr_b16 v[46:47], v24 offset:4608
 s_waitcnt lgkmcnt(4)
 v_mfma_f32_32x32x16_bf16 v[80:95], v[60:63], v[188:191], v[80:95]
 s_waitcnt vmcnt(15)
 s_barrier
 ds_read_b128 v[176:179], v4 offset:32768
 ds_read_b128 v[180:183], v5 offset:32768
 ds_read_b64_tr_b16 v[48:49], v21 offset:24576
 ds_read_b64_tr_b16 v[50:51], v21 offset:25088
 s_add_u32 m0, s35, 45056
 s_add_u32 s37, s88, 774144
 buffer_load_dwordx4 v8, s[40:43], s37 offen lds
 s_waitcnt lgkmcnt(6)
 v_mfma_f32_32x32x16_bf16 v[96:111], v[40:43], v[188:191], v[96:111]
 ds_read_b64_tr_b16 v[52:53], v22 offset:24576
 ds_read_b64_tr_b16 v[54:55], v22 offset:25088
 s_add_u32 m0, s35, 53248
 s_add_u32 s37, s89, 774144
 buffer_load_dwordx4 v9, s[56:59], s37 offen lds
 s_waitcnt lgkmcnt(6)
 v_mfma_f32_32x32x16_bf16 v[112:127], v[44:47], v[188:191], v[112:127]
 ds_read_b64_tr_b16 v[56:57], v23 offset:24576
 ds_read_b64_tr_b16 v[58:59], v23 offset:25088
 s_waitcnt lgkmcnt(4)
 v_mfma_f32_32x32x16_bf16 v[64:79], v[48:51], v[176:179], v[64:79]
 ds_read_b64_tr_b16 v[60:61], v24 offset:24576
 ds_read_b64_tr_b16 v[62:63], v24 offset:25088
 s_waitcnt lgkmcnt(4)
 v_mfma_f32_32x32x16_bf16 v[80:95], v[52:55], v[176:179], v[80:95]
 ds_read_b64_tr_b16 v[40:41], v21 offset:26624
 ds_read_b64_tr_b16 v[42:43], v21 offset:27136
 s_waitcnt lgkmcnt(4)
 v_mfma_f32_32x32x16_bf16 v[96:111], v[56:59], v[176:179], v[96:111]
 ds_read_b64_tr_b16 v[44:45], v22 offset:26624
 ds_read_b64_tr_b16 v[46:47], v22 offset:27136
 s_waitcnt lgkmcnt(4)
 v_mfma_f32_32x32x16_bf16 v[112:127], v[60:63], v[176:179], v[112:127]
 ds_read_b64_tr_b16 v[48:49], v23 offset:26624
 ds_read_b64_tr_b16 v[50:51], v23 offset:27136
 s_waitcnt lgkmcnt(4)
 v_mfma_f32_32x32x16_bf16 v[64:79], v[40:43], v[180:183], v[64:79]
 ds_read_b64_tr_b16 v[52:53], v24 offset:26624
 ds_read_b64_tr_b16 v[54:55], v24 offset:27136
 s_waitcnt lgkmcnt(4)
 v_mfma_f32_32x32x16_bf16 v[80:95], v[44:47], v[180:183], v[80:95]
 s_waitcnt vmcnt(12)
 s_barrier
 ds_read_b128 v[184:187], v6 offset:32768
 ds_read_b128 v[188:191], v7 offset:32768
 ds_read_b64_tr_b16 v[56:57], v17 offset:0
 ds_read_b64_tr_b16 v[58:59], v17 offset:512
 s_add_u32 m0, s35, 67584
 s_add_u32 s37, s88, 884736
 buffer_load_dwordx4 v8, s[40:43], s37 offen lds
 s_waitcnt lgkmcnt(6)
 v_mfma_f32_32x32x16_bf16 v[96:111], v[48:51], v[180:183], v[96:111]
 ds_read_b64_tr_b16 v[60:61], v18 offset:0
 ds_read_b64_tr_b16 v[62:63], v18 offset:512
 s_add_u32 m0, s35, 75776
 s_add_u32 s37, s89, 884736
 buffer_load_dwordx4 v9, s[56:59], s37 offen lds
 s_waitcnt lgkmcnt(6)
 v_mfma_f32_32x32x16_bf16 v[112:127], v[52:55], v[180:183], v[112:127]
 ds_read_b64_tr_b16 v[40:41], v19 offset:0
 ds_read_b64_tr_b16 v[42:43], v19 offset:512
 s_add_u32 m0, s36, 16384
 s_movk_i32 s37, 512
 buffer_load_dwordx4 v2, s[4:7], s37 offen lds
 s_waitcnt lgkmcnt(4)
 v_mfma_f32_32x32x16_bf16 v[64:79], v[56:59], v[184:187], v[64:79]
 ds_read_b64_tr_b16 v[44:45], v20 offset:0
 ds_read_b64_tr_b16 v[46:47], v20 offset:512
 s_add_u32 m0, s36, 17408
 s_movk_i32 s37, 512
 buffer_load_dwordx4 v3, s[4:7], s37 offen lds
 s_waitcnt lgkmcnt(4)
 v_mfma_f32_32x32x16_bf16 v[80:95], v[60:63], v[184:187], v[80:95]
 ds_read_b64_tr_b16 v[48:49], v17 offset:2048
 ds_read_b64_tr_b16 v[50:51], v17 offset:2560
 s_waitcnt lgkmcnt(4)
 v_mfma_f32_32x32x16_bf16 v[96:111], v[40:43], v[184:187], v[96:111]
 ds_read_b64_tr_b16 v[52:53], v18 offset:2048
 ds_read_b64_tr_b16 v[54:55], v18 offset:2560
 s_waitcnt lgkmcnt(4)
 v_mfma_f32_32x32x16_bf16 v[112:127], v[44:47], v[184:187], v[112:127]
 ds_read_b64_tr_b16 v[56:57], v19 offset:2048
 ds_read_b64_tr_b16 v[58:59], v19 offset:2560
 s_waitcnt lgkmcnt(4)
 v_mfma_f32_32x32x16_bf16 v[64:79], v[48:51], v[188:191], v[64:79]
 ds_read_b64_tr_b16 v[60:61], v20 offset:2048
 ds_read_b64_tr_b16 v[62:63], v20 offset:2560
 s_waitcnt lgkmcnt(4)
 v_mfma_f32_32x32x16_bf16 v[80:95], v[52:55], v[188:191], v[80:95]
 s_waitcnt vmcnt(9)
 s_barrier
 ds_read_b128 v[176:179], v4 offset:0
 ds_read_b128 v[180:183], v5 offset:0
 ds_read_b64_tr_b16 v[40:41], v17 offset:22528
 ds_read_b64_tr_b16 v[42:43], v17 offset:23040
 s_add_u32 m0, s35, 90112
 s_add_u32 s37, s88, 995328
 buffer_load_dwordx4 v8, s[40:43], s37 offen lds
 s_waitcnt lgkmcnt(6)
 v_mfma_f32_32x32x16_bf16 v[96:111], v[56:59], v[188:191], v[96:111]
 ds_read_b64_tr_b16 v[44:45], v18 offset:22528
 ds_read_b64_tr_b16 v[46:47], v18 offset:23040
 s_add_u32 m0, s35, 98304
 s_add_u32 s37, s89, 995328
 buffer_load_dwordx4 v9, s[56:59], s37 offen lds
 s_waitcnt lgkmcnt(6)
 v_mfma_f32_32x32x16_bf16 v[112:127], v[60:63], v[188:191], v[112:127]
 ds_read_b64_tr_b16 v[48:49], v19 offset:22528
 ds_read_b64_tr_b16 v[50:51], v19 offset:23040
 s_waitcnt lgkmcnt(4)
 v_mfma_f32_32x32x16_bf16 v[64:79], v[40:43], v[176:179], v[64:79]
 ds_read_b64_tr_b16 v[52:53], v20 offset:22528
 ds_read_b64_tr_b16 v[54:55], v20 offset:23040
 s_waitcnt lgkmcnt(4)
 v_mfma_f32_32x32x16_bf16 v[80:95], v[44:47], v[176:179], v[80:95]
 ds_read_b64_tr_b16 v[56:57], v17 offset:24576
 ds_read_b64_tr_b16 v[58:59], v17 offset:25088
 s_waitcnt lgkmcnt(4)
 v_mfma_f32_32x32x16_bf16 v[96:111], v[48:51], v[176:179], v[96:111]
 ds_read_b64_tr_b16 v[60:61], v18 offset:24576
 ds_read_b64_tr_b16 v[62:63], v18 offset:25088
 s_waitcnt lgkmcnt(4)
 v_mfma_f32_32x32x16_bf16 v[112:127], v[52:55], v[176:179], v[112:127]
 ds_read_b64_tr_b16 v[40:41], v19 offset:24576
 ds_read_b64_tr_b16 v[42:43], v19 offset:25088
 s_waitcnt lgkmcnt(4)
 v_mfma_f32_32x32x16_bf16 v[64:79], v[56:59], v[180:183], v[64:79]
 ds_read_b64_tr_b16 v[44:45], v20 offset:24576
 ds_read_b64_tr_b16 v[46:47], v20 offset:25088
 s_waitcnt lgkmcnt(4)
 v_mfma_f32_32x32x16_bf16 v[80:95], v[60:63], v[180:183], v[80:95]
 s_waitcnt vmcnt(6)
 s_barrier
 ds_read_b128 v[184:187], v6 offset:0
 ds_read_b128 v[188:191], v7 offset:0
 ds_read_b64_tr_b16 v[48:49], v17 offset:45056
 ds_read_b64_tr_b16 v[50:51], v17 offset:45568
 s_add_u32 m0, s35, 0
 s_add_u32 s37, s88, 1105920
 buffer_load_dwordx4 v8, s[40:43], s37 offen lds
 s_waitcnt lgkmcnt(6)
 v_mfma_f32_32x32x16_bf16 v[96:111], v[40:43], v[180:183], v[96:111]
 ds_read_b64_tr_b16 v[52:53], v18 offset:45056
 ds_read_b64_tr_b16 v[54:55], v18 offset:45568
 s_add_u32 m0, s35, 8192
 s_add_u32 s37, s89, 1105920
 buffer_load_dwordx4 v9, s[56:59], s37 offen lds
 s_waitcnt lgkmcnt(6)
 v_mfma_f32_32x32x16_bf16 v[112:127], v[44:47], v[180:183], v[112:127]
 ds_read_b64_tr_b16 v[56:57], v19 offset:45056
 ds_read_b64_tr_b16 v[58:59], v19 offset:45568
 s_add_u32 m0, s36, 32768
 s_movk_i32 s37, 640
 buffer_load_dwordx4 v2, s[4:7], s37 offen lds
 s_waitcnt lgkmcnt(4)
 v_mfma_f32_32x32x16_bf16 v[64:79], v[48:51], v[184:187], v[64:79]
 ds_read_b64_tr_b16 v[60:61], v20 offset:45056
 ds_read_b64_tr_b16 v[62:63], v20 offset:45568
 s_add_u32 m0, s36, 33792
 s_movk_i32 s37, 640
 buffer_load_dwordx4 v3, s[4:7], s37 offen lds
 s_waitcnt lgkmcnt(4)
 v_mfma_f32_32x32x16_bf16 v[80:95], v[52:55], v[184:187], v[80:95]
 ds_read_b64_tr_b16 v[40:41], v17 offset:47104
 ds_read_b64_tr_b16 v[42:43], v17 offset:47616
 s_waitcnt lgkmcnt(4)
 v_mfma_f32_32x32x16_bf16 v[96:111], v[56:59], v[184:187], v[96:111]
 ds_read_b64_tr_b16 v[44:45], v18 offset:47104
 ds_read_b64_tr_b16 v[46:47], v18 offset:47616
 s_waitcnt lgkmcnt(4)
 v_mfma_f32_32x32x16_bf16 v[112:127], v[60:63], v[184:187], v[112:127]
 ds_read_b64_tr_b16 v[48:49], v19 offset:47104
 ds_read_b64_tr_b16 v[50:51], v19 offset:47616
 s_waitcnt lgkmcnt(4)
 v_mfma_f32_32x32x16_bf16 v[64:79], v[40:43], v[188:191], v[64:79]
 ds_read_b64_tr_b16 v[52:53], v20 offset:47104
 ds_read_b64_tr_b16 v[54:55], v20 offset:47616
 s_waitcnt lgkmcnt(4)
 v_mfma_f32_32x32x16_bf16 v[80:95], v[44:47], v[188:191], v[80:95]
 s_waitcnt vmcnt(6)
 s_barrier
 ds_read_b128 v[176:179], v4 offset:16384
 ds_read_b128 v[180:183], v5 offset:16384
 ds_read_b64_tr_b16 v[56:57], v21 offset:2048
 ds_read_b64_tr_b16 v[58:59], v21 offset:2560
 s_add_u32 m0, s35, 22528
 s_add_u32 s37, s88, 1216512
 buffer_load_dwordx4 v8, s[40:43], s37 offen lds
 s_waitcnt lgkmcnt(6)
 v_mfma_f32_32x32x16_bf16 v[96:111], v[48:51], v[188:191], v[96:111]
 ds_read_b64_tr_b16 v[60:61], v22 offset:2048
 ds_read_b64_tr_b16 v[62:63], v22 offset:2560
 s_add_u32 m0, s35, 30720
 s_add_u32 s37, s89, 1216512
 buffer_load_dwordx4 v9, s[56:59], s37 offen lds
 s_waitcnt lgkmcnt(6)
 v_mfma_f32_32x32x16_bf16 v[112:127], v[52:55], v[188:191], v[112:127]
 ds_read_b64_tr_b16 v[40:41], v23 offset:2048
 ds_read_b64_tr_b16 v[42:43], v23 offset:2560
 s_waitcnt lgkmcnt(4)
 v_mfma_f32_32x32x16_bf16 v[64:79], v[56:59], v[176:179], v[64:79]
 ds_read_b64_tr_b16 v[44:45], v24 offset:2048
 ds_read_b64_tr_b16 v[46:47], v24 offset:2560
 s_waitcnt lgkmcnt(4)
 v_mfma_f32_32x32x16_bf16 v[80:95], v[60:63], v[176:179], v[80:95]
 ds_read_b64_tr_b16 v[48:49], v21 offset:4096
 ds_read_b64_tr_b16 v[50:51], v21 offset:4608
 s_waitcnt lgkmcnt(4)
 v_mfma_f32_32x32x16_bf16 v[96:111], v[40:43], v[176:179], v[96:111]
 ds_read_b64_tr_b16 v[52:53], v22 offset:4096
 ds_read_b64_tr_b16 v[54:55], v22 offset:4608
 s_waitcnt lgkmcnt(4)
 v_mfma_f32_32x32x16_bf16 v[112:127], v[44:47], v[176:179], v[112:127]
 ds_read_b64_tr_b16 v[56:57], v23 offset:4096
 ds_read_b64_tr_b16 v[58:59], v23 offset:4608
 s_waitcnt lgkmcnt(4)
 v_mfma_f32_32x32x16_bf16 v[64:79], v[48:51], v[180:183], v[64:79]
 ds_read_b64_tr_b16 v[60:61], v24 offset:4096
 ds_read_b64_tr_b16 v[62:63], v24 offset:4608
 s_waitcnt lgkmcnt(4)
 v_mfma_f32_32x32x16_bf16 v[80:95], v[52:55], v[180:183], v[80:95]
 s_waitcnt vmcnt(6)
 s_barrier
 ds_read_b128 v[184:187], v6 offset:16384
 ds_read_b128 v[188:191], v7 offset:16384
 ds_read_b64_tr_b16 v[40:41], v21 offset:24576
 ds_read_b64_tr_b16 v[42:43], v21 offset:25088
 s_add_u32 m0, s35, 45056
 s_add_u32 s37, s88, 1327104
 buffer_load_dwordx4 v8, s[40:43], s37 offen lds
 s_waitcnt lgkmcnt(6)
 v_mfma_f32_32x32x16_bf16 v[96:111], v[56:59], v[180:183], v[96:111]
 ds_read_b64_tr_b16 v[44:45], v22 offset:24576
 ds_read_b64_tr_b16 v[46:47], v22 offset:25088
 s_add_u32 m0, s35, 53248
 s_add_u32 s37, s89, 1327104
 buffer_load_dwordx4 v9, s[56:59], s37 offen lds
 s_waitcnt lgkmcnt(6)
 v_mfma_f32_32x32x16_bf16 v[112:127], v[60:63], v[180:183], v[112:127]
 ds_read_b64_tr_b16 v[48:49], v23 offset:24576
 ds_read_b64_tr_b16 v[50:51], v23 offset:25088
 s_add_u32 m0, s36, 0
 s_movk_i32 s37, 768
 buffer_load_dwordx4 v2, s[4:7], s37 offen lds
 s_waitcnt lgkmcnt(4)
 v_mfma_f32_32x32x16_bf16 v[64:79], v[40:43], v[184:187], v[64:79]
 ds_read_b64_tr_b16 v[52:53], v24 offset:24576
 ds_read_b64_tr_b16 v[54:55], v24 offset:25088
 s_add_u32 m0, s36, 1024
 s_movk_i32 s37, 768
 buffer_load_dwordx4 v3, s[4:7], s37 offen lds
 s_waitcnt lgkmcnt(4)
 v_mfma_f32_32x32x16_bf16 v[80:95], v[44:47], v[184:187], v[80:95]
 ds_read_b64_tr_b16 v[56:57], v21 offset:26624
 ds_read_b64_tr_b16 v[58:59], v21 offset:27136
 s_waitcnt lgkmcnt(4)
 v_mfma_f32_32x32x16_bf16 v[96:111], v[48:51], v[184:187], v[96:111]
 ds_read_b64_tr_b16 v[60:61], v22 offset:26624
 ds_read_b64_tr_b16 v[62:63], v22 offset:27136
 s_waitcnt lgkmcnt(4)
 v_mfma_f32_32x32x16_bf16 v[112:127], v[52:55], v[184:187], v[112:127]
 ds_read_b64_tr_b16 v[40:41], v23 offset:26624
 ds_read_b64_tr_b16 v[42:43], v23 offset:27136
 s_waitcnt lgkmcnt(4)
 v_mfma_f32_32x32x16_bf16 v[64:79], v[56:59], v[188:191], v[64:79]
 ds_read_b64_tr_b16 v[44:45], v24 offset:26624
 ds_read_b64_tr_b16 v[46:47], v24 offset:27136
 v_mov_b32 v217, 0
 v_mov_b32 v218, 0
 v_lshlrev_b32 v219, 16, v192
 s_waitcnt lgkmcnt(4)
 v_mfma_f32_32x32x16_bf16 v[80:95], v[60:63], v[188:191], v[80:95]
 s_waitcnt vmcnt(6)
 s_barrier
 ds_read_b128 v[176:179], v4 offset:32768
 ds_read_b128 v[180:183], v5 offset:32768
 ds_read_b64_tr_b16 v[48:49], v17 offset:0
 ds_read_b64_tr_b16 v[50:51], v17 offset:512
 s_add_u32 m0, s35, 67584
 s_add_u32 s37, s88, 1437696
 buffer_load_dwordx4 v8, s[40:43], s37 offen lds
 s_waitcnt lgkmcnt(6)
 v_mfma_f32_32x32x16_bf16 v[96:111], v[40:43], v[188:191], v[96:111]
 ds_read_b64_tr_b16 v[52:53], v18 offset:0
 ds_read_b64_tr_b16 v[54:55], v18 offset:512
 s_add_u32 m0, s35, 75776
 s_add_u32 s37, s89, 1437696
 buffer_load_dwordx4 v9, s[56:59], s37 offen lds
 s_waitcnt lgkmcnt(6)
 v_mfma_f32_32x32x16_bf16 v[112:127], v[44:47], v[188:191], v[112:127]
 ds_read_b64_tr_b16 v[56:57], v19 offset:0
 ds_read_b64_tr_b16 v[58:59], v19 offset:512
 v_and_b32 v220, 0xffff0000, v192
 v_lshlrev_b32 v221, 16, v196
 v_and_b32 v222, 0xffff0000, v196
 s_waitcnt lgkmcnt(4)
 v_mfma_f32_32x32x16_bf16 v[64:79], v[48:51], v[176:179], v[64:79]
 ds_read_b64_tr_b16 v[60:61], v20 offset:0
 ds_read_b64_tr_b16 v[62:63], v20 offset:512
 v_mul_f32 v219, v219, v221
 v_mul_f32 v220, v220, v222
 v_cvt_pk_bf16_f32 v219, v219, v220
 s_waitcnt lgkmcnt(4)
 v_mfma_f32_32x32x16_bf16 v[80:95], v[52:55], v[176:179], v[80:95]
 ds_read_b64_tr_b16 v[40:41], v17 offset:2048
 ds_read_b64_tr_b16 v[42:43], v17 offset:2560
 v_lshlrev_b32 v220, 16, v219
 v_and_b32 v219, 0xffff0000, v219
 v_add_f32 v217, v217, v220
 s_waitcnt lgkmcnt(4)
 v_mfma_f32_32x32x16_bf16 v[96:111], v[56:59], v[176:179], v[96:111]
 ds_read_b64_tr_b16 v[44:45], v18 offset:2048
 ds_read_b64_tr_b16 v[46:47], v18 offset:2560
 v_add_f32 v218, v218, v219
 v_lshlrev_b32 v219, 16, v193
 v_and_b32 v220, 0xffff0000, v193
 s_waitcnt lgkmcnt(4)
 v_mfma_f32_32x32x16_bf16 v[112:127], v[60:63], v[176:179], v[112:127]
 ds_read_b64_tr_b16 v[48:49], v19 offset:2048
 ds_read_b64_tr_b16 v[50:51], v19 offset:2560
 v_lshlrev_b32 v221, 16, v197
 v_and_b32 v222, 0xffff0000, v197
 v_mul_f32 v219, v219, v221
 s_waitcnt lgkmcnt(4)
 v_mfma_f32_32x32x16_bf16 v[64:79], v[40:43], v[180:183], v[64:79]
 ds_read_b64_tr_b16 v[52:53], v20 offset:2048
 ds_read_b64_tr_b16 v[54:55], v20 offset:2560
 v_mul_f32 v220, v220, v222
 v_cvt_pk_bf16_f32 v219, v219, v220
 v_lshlrev_b32 v220, 16, v219
 s_waitcnt lgkmcnt(4)
 v_mfma_f32_32x32x16_bf16 v[80:95], v[44:47], v[180:183], v[80:95]
 s_waitcnt vmcnt(6)
 s_barrier
 ds_read_b128 v[184:187], v6 offset:32768
 ds_read_b128 v[188:191], v7 offset:32768
 ds_read_b64_tr_b16 v[56:57], v17 offset:22528
 ds_read_b64_tr_b16 v[58:59], v17 offset:23040
 s_add_u32 m0, s35, 90112
 s_add_u32 s37, s88, 1548288
 buffer_load_dwordx4 v8, s[40:43], s37 offen lds
 s_waitcnt lgkmcnt(6)
 v_mfma_f32_32x32x16_bf16 v[96:111], v[48:51], v[180:183], v[96:111]
 ds_read_b64_tr_b16 v[60:61], v18 offset:22528
 ds_read_b64_tr_b16 v[62:63], v18 offset:23040
 s_add_u32 m0, s35, 98304
 s_add_u32 s37, s89, 1548288
 buffer_load_dwordx4 v9, s[56:59], s37 offen lds
 s_waitcnt lgkmcnt(6)
 v_mfma_f32_32x32x16_bf16 v[112:127], v[52:55], v[180:183], v[112:127]
 ds_read_b64_tr_b16 v[40:41], v19 offset:22528
 ds_read_b64_tr_b16 v[42:43], v19 offset:23040
 s_add_u32 m0, s36, 16384
 s_movk_i32 s37, 896
 buffer_load_dwordx4 v2, s[4:7], s37 offen lds
 s_waitcnt lgkmcnt(4)
 v_mfma_f32_32x32x16_bf16 v[64:79], v[56:59], v[184:187], v[64:79]
 ds_read_b64_tr_b16 v[44:45], v20 offset:22528
 ds_read_b64_tr_b16 v[46:47], v20 offset:23040
 s_add_u32 m0, s36, 17408
 s_movk_i32 s37, 896
 buffer_load_dwordx4 v3, s[4:7], s37 offen lds
 s_waitcnt lgkmcnt(4)
 v_mfma_f32_32x32x16_bf16 v[80:95], v[60:63], v[184:187], v[80:95]
 ds_read_b64_tr_b16 v[48:49], v17 offset:24576
 ds_read_b64_tr_b16 v[50:51], v17 offset:25088
 v_and_b32 v219, 0xffff0000, v219
 v_add_f32 v217, v217, v220
 v_add_f32 v218, v218, v219
 s_waitcnt lgkmcnt(4)
 v_mfma_f32_32x32x16_bf16 v[96:111], v[40:43], v[184:187], v[96:111]
 ds_read_b64_tr_b16 v[52:53], v18 offset:24576
 ds_read_b64_tr_b16 v[54:55], v18 offset:25088
 v_lshlrev_b32 v219, 16, v194
 v_and_b32 v220, 0xffff0000, v194
 v_lshlrev_b32 v221, 16, v198
 s_waitcnt lgkmcnt(4)
 v_mfma_f32_32x32x16_bf16 v[112:127], v[44:47], v[184:187], v[112:127]
 ds_read_b64_tr_b16 v[56:57], v19 offset:24576
 ds_read_b64_tr_b16 v[58:59], v19 offset:25088
 v_and_b32 v222, 0xffff0000, v198
 v_mul_f32 v219, v219, v221
 v_mul_f32 v220, v220, v222
 s_waitcnt lgkmcnt(4)
 v_mfma_f32_32x32x16_bf16 v[64:79], v[48:51], v[188:191], v[64:79]
 ds_read_b64_tr_b16 v[60:61], v20 offset:24576
 ds_read_b64_tr_b16 v[62:63], v20 offset:25088
 v_cvt_pk_bf16_f32 v219, v219, v220
 v_lshlrev_b32 v220, 16, v219
 v_and_b32 v219, 0xffff0000, v219
 s_waitcnt lgkmcnt(4)
 v_mfma_f32_32x32x16_bf16 v[80:95], v[52:55], v[188:191], v[80:95]
 s_waitcnt vmcnt(6)
 s_barrier
 ds_read_b128 v[176:179], v4 offset:0
 ds_read_b128 v[180:183], v5 offset:0
 ds_read_b64_tr_b16 v[40:41], v17 offset:45056
 ds_read_b64_tr_b16 v[42:43], v17 offset:45568
 s_add_u32 m0, s35, 0
 s_add_u32 s37, s88, 1658880
 buffer_load_dwordx4 v8, s[40:43], s37 offen lds
 s_waitcnt lgkmcnt(6)
 v_mfma_f32_32x32x16_bf16 v[96:111], v[56:59], v[188:191], v[96:111]
 ds_read_b64_tr_b16 v[44:45], v18 offset:45056
 ds_read_b64_tr_b16 v[46:47], v18 offset:45568
 s_add_u32 m0, s35, 8192
 s_add_u32 s37, s89, 1658880
 buffer_load_dwordx4 v9, s[56:59], s37 offen lds
 s_waitcnt lgkmcnt(6)
 v_mfma_f32_32x32x16_bf16 v[112:127], v[60:63], v[188:191], v[112:127]
 ds_read_b64_tr_b16 v[48:49], v19 offset:45056
 ds_read_b64_tr_b16 v[50:51], v19 offset:45568
 v_add_f32 v217, v217, v220
 v_add_f32 v218, v218, v219
 v_lshlrev_b32 v219, 16, v195
 s_waitcnt lgkmcnt(4)
 v_mfma_f32_32x32x16_bf16 v[64:79], v[40:43], v[176:179], v[64:79]
 ds_read_b64_tr_b16 v[52:53], v20 offset:45056
 ds_read_b64_tr_b16 v[54:55], v20 offset:45568
 v_and_b32 v220, 0xffff0000, v195
 v_lshlrev_b32 v221, 16, v199
 v_and_b32 v222, 0xffff0000, v199
 s_waitcnt lgkmcnt(4)
 v_mfma_f32_32x32x16_bf16 v[80:95], v[44:47], v[176:179], v[80:95]
 ds_read_b64_tr_b16 v[56:57], v17 offset:47104
 ds_read_b64_tr_b16 v[58:59], v17 offset:47616
 v_mul_f32 v219, v219, v221
 v_mul_f32 v220, v220, v222
 v_cvt_pk_bf16_f32 v219, v219, v220
 s_waitcnt lgkmcnt(4)
 v_mfma_f32_32x32x16_bf16 v[96:111], v[48:51], v[176:179], v[96:111]
 ds_read_b64_tr_b16 v[60:61], v18 offset:47104
 ds_read_b64_tr_b16 v[62:63], v18 offset:47616
 v_lshlrev_b32 v220, 16, v219
 v_and_b32 v219, 0xffff0000, v219
 v_add_f32 v217, v217, v220
 s_waitcnt lgkmcnt(4)
 v_mfma_f32_32x32x16_bf16 v[112:127], v[52:55], v[176:179], v[112:127]
 ds_read_b64_tr_b16 v[40:41], v19 offset:47104
 ds_read_b64_tr_b16 v[42:43], v19 offset:47616
 v_add_f32 v218, v218, v219
 v_lshlrev_b32 v219, 16, v200
 v_and_b32 v220, 0xffff0000, v200
 s_waitcnt lgkmcnt(4)
 v_mfma_f32_32x32x16_bf16 v[64:79], v[56:59], v[180:183], v[64:79]
 ds_read_b64_tr_b16 v[44:45], v20 offset:47104
 ds_read_b64_tr_b16 v[46:47], v20 offset:47616
 v_lshlrev_b32 v221, 16, v204
 v_and_b32 v222, 0xffff0000, v204
 v_mul_f32 v219, v219, v221
 s_waitcnt lgkmcnt(4)
 v_mfma_f32_32x32x16_bf16 v[80:95], v[60:63], v[180:183], v[80:95]
 s_waitcnt vmcnt(6)
 s_barrier
 ds_read_b128 v[184:187], v6 offset:0
 ds_read_b128 v[188:191], v7 offset:0
 ds_read_b64_tr_b16 v[48:49], v21 offset:2048
 ds_read_b64_tr_b16 v[50:51], v21 offset:2560
 s_add_u32 m0, s35, 22528
 s_add_u32 s37, s88, 1769472
 buffer_load_dwordx4 v8, s[40:43], s37 offen lds
 s_waitcnt lgkmcnt(6)
 v_mfma_f32_32x32x16_bf16 v[96:111], v[40:43], v[180:183], v[96:111]
 ds_read_b64_tr_b16 v[52:53], v22 offset:2048
 ds_read_b64_tr_b16 v[54:55], v22 offset:2560
 s_add_u32 m0, s35, 30720
 s_add_u32 s37, s89, 1769472
 buffer_load_dwordx4 v9, s[56:59], s37 offen lds
 s_waitcnt lgkmcnt(6)
 v_mfma_f32_32x32x16_bf16 v[112:127], v[44:47], v[180:183], v[112:127]
 ds_read_b64_tr_b16 v[56:57], v23 offset:2048
 ds_read_b64_tr_b16 v[58:59], v23 offset:2560
 s_add_u32 m0, s36, 32768
 s_movk_i32 s37, 1024
 buffer_load_dwordx4 v2, s[4:7], s37 offen lds
 s_waitcnt lgkmcnt(4)
 v_mfma_f32_32x32x16_bf16 v[64:79], v[48:51], v[184:187], v[64:79]
 ds_read_b64_tr_b16 v[60:61], v24 offset:2048
 ds_read_b64_tr_b16 v[62:63], v24 offset:2560
 s_add_u32 m0, s36, 33792
 s_movk_i32 s37, 1024
 buffer_load_dwordx4 v3, s[4:7], s37 offen lds
 s_waitcnt lgkmcnt(4)
 v_mfma_f32_32x32x16_bf16 v[80:95], v[52:55], v[184:187], v[80:95]
 ds_read_b64_tr_b16 v[40:41], v21 offset:4096
 ds_read_b64_tr_b16 v[42:43], v21 offset:4608
 v_mul_f32 v220, v220, v222
 v_cvt_pk_bf16_f32 v219, v219, v220
 v_lshlrev_b32 v220, 16, v219
 s_waitcnt lgkmcnt(4)
 v_mfma_f32_32x32x16_bf16 v[96:111], v[56:59], v[184:187], v[96:111]
 ds_read_b64_tr_b16 v[44:45], v22 offset:4096
 ds_read_b64_tr_b16 v[46:47], v22 offset:4608
 v_and_b32 v219, 0xffff0000, v219
 v_add_f32 v217, v217, v220
 v_add_f32 v218, v218, v219
 s_waitcnt lgkmcnt(4)
 v_mfma_f32_32x32x16_bf16 v[112:127], v[60:63], v[184:187], v[112:127]
 ds_read_b64_tr_b16 v[48:49], v23 offset:4096
 ds_read_b64_tr_b16 v[50:51], v23 offset:4608
 v_lshlrev_b32 v219, 16, v201
 v_and_b32 v220, 0xffff0000, v201
 v_lshlrev_b32 v221, 16, v205
 s_waitcnt lgkmcnt(4)
 v_mfma_f32_32x32x16_bf16 v[64:79], v[40:43], v[188:191], v[64:79]
 ds_read_b64_tr_b16 v[52:53], v24 offset:4096
 ds_read_b64_tr_b16 v[54:55], v24 offset:4608
 v_and_b32 v222, 0xffff0000, v205
 v_mul_f32 v219, v219, v221
 v_mul_f32 v220, v220, v222
 s_waitcnt lgkmcnt(4)
 v_mfma_f32_32x32x16_bf16 v[80:95], v[44:47], v[188:191], v[80:95]
 s_waitcnt vmcnt(6)
 s_barrier
 ds_read_b128 v[176:179], v4 offset:16384
 ds_read_b128 v[180:183], v5 offset:16384
 ds_read_b64_tr_b16 v[56:57], v21 offset:24576
 ds_read_b64_tr_b16 v[58:59], v21 offset:25088
 s_add_u32 m0, s35, 45056
 s_add_u32 s37, s88, 1880064
 buffer_load_dwordx4 v8, s[40:43], s37 offen lds
 s_waitcnt lgkmcnt(6)
 v_mfma_f32_32x32x16_bf16 v[96:111], v[48:51], v[188:191], v[96:111]
 ds_read_b64_tr_b16 v[60:61], v22 offset:24576
 ds_read_b64_tr_b16 v[62:63], v22 offset:25088
 s_add_u32 m0, s35, 53248
 s_add_u32 s37, s89, 1880064
 buffer_load_dwordx4 v9, s[56:59], s37 offen lds
 s_waitcnt lgkmcnt(6)
 v_mfma_f32_32x32x16_bf16 v[112:127], v[52:55], v[188:191], v[112:127]
 ds_read_b64_tr_b16 v[40:41], v23 offset:24576
 ds_read_b64_tr_b16 v[42:43], v23 offset:25088
 v_cvt_pk_bf16_f32 v219, v219, v220
 v_lshlrev_b32 v220, 16, v219
 v_and_b32 v219, 0xffff0000, v219
 s_waitcnt lgkmcnt(4)
 v_mfma_f32_32x32x16_bf16 v[64:79], v[56:59], v[176:179], v[64:79]
 ds_read_b64_tr_b16 v[44:45], v24 offset:24576
 ds_read_b64_tr_b16 v[46:47], v24 offset:25088
 v_add_f32 v217, v217, v220
 v_add_f32 v218, v218, v219
 v_lshlrev_b32 v219, 16, v202
 s_waitcnt lgkmcnt(4)
 v_mfma_f32_32x32x16_bf16 v[80:95], v[60:63], v[176:179], v[80:95]
 ds_read_b64_tr_b16 v[48:49], v21 offset:26624
 ds_read_b64_tr_b16 v[50:51], v21 offset:27136
 v_and_b32 v220, 0xffff0000, v202
 v_lshlrev_b32 v221, 16, v206
 v_and_b32 v222, 0xffff0000, v206
 s_waitcnt lgkmcnt(4)
 v_mfma_f32_32x32x16_bf16 v[96:111], v[40:43], v[176:179], v[96:111]
 ds_read_b64_tr_b16 v[52:53], v22 offset:26624
 ds_read_b64_tr_b16 v[54:55], v22 offset:27136
 v_mul_f32 v219, v219, v221
 v_mul_f32 v220, v220, v222
 v_cvt_pk_bf16_f32 v219, v219, v220
 s_waitcnt lgkmcnt(4)
 v_mfma_f32_32x32x16_bf16 v[112:127], v[44:47], v[176:179], v[112:127]
 ds_read_b64_tr_b16 v[56:57], v23 offset:26624
 ds_read_b64_tr_b16 v[58:59], v23 offset:27136
 v_lshlrev_b32 v220, 16, v219
 v_and_b32 v219, 0xffff0000, v219
 v_add_f32 v217, v217, v220
 s_waitcnt lgkmcnt(4)
 v_mfma_f32_32x32x16_bf16 v[64:79], v[48:51], v[180:183], v[64:79]
 ds_read_b64_tr_b16 v[60:61], v24 offset:26624
 ds_read_b64_tr_b16 v[62:63], v24 offset:27136
 v_add_f32 v218, v218, v219
 v_lshlrev_b32 v219, 16, v203
 v_and_b32 v220, 0xffff0000, v203
 s_waitcnt lgkmcnt(4)
 v_mfma_f32_32x32x16_bf16 v[80:95], v[52:55], v[180:183], v[80:95]
 s_waitcnt vmcnt(6)
 s_barrier
 ds_read_b128 v[184:187], v6 offset:16384
 ds_read_b128 v[188:191], v7 offset:16384
 ds_read_b64_tr_b16 v[40:41], v17 offset:0
 ds_read_b64_tr_b16 v[42:43], v17 offset:512
 s_add_u32 m0, s35, 67584
 s_add_u32 s37, s88, 1990656
 buffer_load_dwordx4 v8, s[40:43], s37 offen lds
 s_waitcnt lgkmcnt(6)
 v_mfma_f32_32x32x16_bf16 v[96:111], v[56:59], v[180:183], v[96:111]
 ds_read_b64_tr_b16 v[44:45], v18 offset:0
 ds_read_b64_tr_b16 v[46:47], v18 offset:512
 s_add_u32 m0, s35, 75776
 s_add_u32 s37, s89, 1990656
 buffer_load_dwordx4 v9, s[56:59], s37 offen lds
 s_waitcnt lgkmcnt(6)
 v_mfma_f32_32x32x16_bf16 v[112:127], v[60:63], v[180:183], v[112:127]
 ds_read_b64_tr_b16 v[48:49], v19 offset:0
 ds_read_b64_tr_b16 v[50:51], v19 offset:512
 s_add_u32 m0, s36, 0
 s_movk_i32 s37, 1152
 buffer_load_dwordx4 v2, s[4:7], s37 offen lds
 s_waitcnt lgkmcnt(4)
 v_mfma_f32_32x32x16_bf16 v[64:79], v[40:43], v[184:187], v[64:79]
 ds_read_b64_tr_b16 v[52:53], v20 offset:0
 ds_read_b64_tr_b16 v[54:55], v20 offset:512
 s_add_u32 m0, s36, 1024
 s_movk_i32 s37, 1152
 buffer_load_dwordx4 v3, s[4:7], s37 offen lds
 s_waitcnt lgkmcnt(4)
 v_mfma_f32_32x32x16_bf16 v[80:95], v[44:47], v[184:187], v[80:95]
 ds_read_b64_tr_b16 v[56:57], v17 offset:2048
 ds_read_b64_tr_b16 v[58:59], v17 offset:2560
 v_lshlrev_b32 v221, 16, v207
 v_and_b32 v222, 0xffff0000, v207
 v_mul_f32 v219, v219, v221
 s_waitcnt lgkmcnt(4)
 v_mfma_f32_32x32x16_bf16 v[96:111], v[48:51], v[184:187], v[96:111]
 ds_read_b64_tr_b16 v[60:61], v18 offset:2048
 ds_read_b64_tr_b16 v[62:63], v18 offset:2560
 v_mul_f32 v220, v220, v222
 v_cvt_pk_bf16_f32 v219, v219, v220
 v_lshlrev_b32 v220, 16, v219
 s_waitcnt lgkmcnt(4)
 v_mfma_f32_32x32x16_bf16 v[112:127], v[52:55], v[184:187], v[112:127]
 ds_read_b64_tr_b16 v[40:41], v19 offset:2048
 ds_read_b64_tr_b16 v[42:43], v19 offset:2560
 v_and_b32 v219, 0xffff0000, v219
 v_add_f32 v217, v217, v220
 v_add_f32 v218, v218, v219
 s_waitcnt lgkmcnt(4)
 v_mfma_f32_32x32x16_bf16 v[64:79], v[56:59], v[188:191], v[64:79]
 ds_read_b64_tr_b16 v[44:45], v20 offset:2048
 ds_read_b64_tr_b16 v[46:47], v20 offset:2560
 v_lshlrev_b32 v219, 16, v208
 v_and_b32 v220, 0xffff0000, v208
 v_lshlrev_b32 v221, 16, v212
 s_waitcnt lgkmcnt(4)
 v_mfma_f32_32x32x16_bf16 v[80:95], v[60:63], v[188:191], v[80:95]
 s_waitcnt vmcnt(6)
 s_barrier
 ds_read_b128 v[176:179], v4 offset:32768
 ds_read_b128 v[180:183], v5 offset:32768
 ds_read_b64_tr_b16 v[48:49], v17 offset:22528
 ds_read_b64_tr_b16 v[50:51], v17 offset:23040
 s_add_u32 m0, s35, 90112
 s_add_u32 s37, s88, 2101248
 buffer_load_dwordx4 v8, s[40:43], s37 offen lds
 s_waitcnt lgkmcnt(6)
 v_mfma_f32_32x32x16_bf16 v[96:111], v[40:43], v[188:191], v[96:111]
 ds_read_b64_tr_b16 v[52:53], v18 offset:22528
 ds_read_b64_tr_b16 v[54:55], v18 offset:23040
 s_add_u32 m0, s35, 98304
 s_add_u32 s37, s89, 2101248
 buffer_load_dwordx4 v9, s[56:59], s37 offen lds
 s_waitcnt lgkmcnt(6)
 v_mfma_f32_32x32x16_bf16 v[112:127], v[44:47], v[188:191], v[112:127]
 ds_read_b64_tr_b16 v[56:57], v19 offset:22528
 ds_read_b64_tr_b16 v[58:59], v19 offset:23040
 v_and_b32 v222, 0xffff0000, v212
 v_mul_f32 v219, v219, v221
 v_mul_f32 v220, v220, v222
 s_waitcnt lgkmcnt(4)
 v_mfma_f32_32x32x16_bf16 v[64:79], v[48:51], v[176:179], v[64:79]
 ds_read_b64_tr_b16 v[60:61], v20 offset:22528
 ds_read_b64_tr_b16 v[62:63], v20 offset:23040
 v_cvt_pk_bf16_f32 v219, v219, v220
 v_lshlrev_b32 v220, 16, v219
 v_and_b32 v219, 0xffff0000, v219
 s_waitcnt lgkmcnt(4)
 v_mfma_f32_32x32x16_bf16 v[80:95], v[52:55], v[176:179], v[80:95]
 ds_read_b64_tr_b16 v[40:41], v17 offset:24576
 ds_read_b64_tr_b16 v[42:43], v17 offset:25088
 v_add_f32 v217, v217, v220
 v_add_f32 v218, v218, v219
 v_lshlrev_b32 v219, 16, v209
 s_waitcnt lgkmcnt(4)
 v_mfma_f32_32x32x16_bf16 v[96:111], v[56:59], v[176:179], v[96:111]
 ds_read_b64_tr_b16 v[44:45], v18 offset:24576
 ds_read_b64_tr_b16 v[46:47], v18 offset:25088
 v_and_b32 v220, 0xffff0000, v209
 v_lshlrev_b32 v221, 16, v213
 v_and_b32 v222, 0xffff0000, v213
 s_waitcnt lgkmcnt(4)
 v_mfma_f32_32x32x16_bf16 v[112:127], v[60:63], v[176:179], v[112:127]
 ds_read_b64_tr_b16 v[48:49], v19 offset:24576
 ds_read_b64_tr_b16 v[50:51], v19 offset:25088
 v_mul_f32 v219, v219, v221
 v_mul_f32 v220, v220, v222
 v_cvt_pk_bf16_f32 v219, v219, v220
 s_waitcnt lgkmcnt(4)
 v_mfma_f32_32x32x16_bf16 v[64:79], v[40:43], v[180:183], v[64:79]
 ds_read_b64_tr_b16 v[52:53], v20 offset:24576
 ds_read_b64_tr_b16 v[54:55], v20 offset:25088
 v_lshlrev_b32 v220, 16, v219
 v_and_b32 v219, 0xffff0000, v219
 v_add_f32 v217, v217, v220
 s_waitcnt lgkmcnt(4)
 v_mfma_f32_32x32x16_bf16 v[80:95], v[44:47], v[180:183], v[80:95]
 s_waitcnt vmcnt(6)
 s_barrier
 ds_read_b128 v[184:187], v6 offset:32768
 ds_read_b128 v[188:191], v7 offset:32768
 ds_read_b64_tr_b16 v[56:57], v17 offset:45056
 ds_read_b64_tr_b16 v[58:59], v17 offset:45568
 v_add_f32 v218, v218, v219
 v_lshlrev_b32 v219, 16, v210
 v_and_b32 v220, 0xffff0000, v210
 s_waitcnt lgkmcnt(6)
 v_mfma_f32_32x32x16_bf16 v[96:111], v[48:51], v[180:183], v[96:111]
 ds_read_b64_tr_b16 v[60:61], v18 offset:45056
 ds_read_b64_tr_b16 v[62:63], v18 offset:45568
 v_lshlrev_b32 v221, 16, v214
 v_and_b32 v222, 0xffff0000, v214
 v_mul_f32 v219, v219, v221
 s_waitcnt lgkmcnt(6)
 v_mfma_f32_32x32x16_bf16 v[112:127], v[52:55], v[180:183], v[112:127]
 ds_read_b64_tr_b16 v[40:41], v19 offset:45056
 ds_read_b64_tr_b16 v[42:43], v19 offset:45568
 v_mul_f32 v220, v220, v222
 v_cvt_pk_bf16_f32 v219, v219, v220
 v_lshlrev_b32 v220, 16, v219
 s_waitcnt lgkmcnt(4)
 v_mfma_f32_32x32x16_bf16 v[64:79], v[56:59], v[184:187], v[64:79]
 ds_read_b64_tr_b16 v[44:45], v20 offset:45056
 ds_read_b64_tr_b16 v[46:47], v20 offset:45568
 v_and_b32 v219, 0xffff0000, v219
 v_add_f32 v217, v217, v220
 v_add_f32 v218, v218, v219
 s_waitcnt lgkmcnt(4)
 v_mfma_f32_32x32x16_bf16 v[80:95], v[60:63], v[184:187], v[80:95]
 ds_read_b64_tr_b16 v[48:49], v17 offset:47104
 ds_read_b64_tr_b16 v[50:51], v17 offset:47616
 v_lshlrev_b32 v219, 16, v211
 v_and_b32 v220, 0xffff0000, v211
 v_lshlrev_b32 v221, 16, v215
 s_waitcnt lgkmcnt(4)
 v_mfma_f32_32x32x16_bf16 v[96:111], v[40:43], v[184:187], v[96:111]
 ds_read_b64_tr_b16 v[52:53], v18 offset:47104
 ds_read_b64_tr_b16 v[54:55], v18 offset:47616
 v_and_b32 v222, 0xffff0000, v215
 v_mul_f32 v219, v219, v221
 v_mul_f32 v220, v220, v222
 s_waitcnt lgkmcnt(4)
 v_mfma_f32_32x32x16_bf16 v[112:127], v[44:47], v[184:187], v[112:127]
 ds_read_b64_tr_b16 v[56:57], v19 offset:47104
 ds_read_b64_tr_b16 v[58:59], v19 offset:47616
 v_cvt_pk_bf16_f32 v219, v219, v220
 v_lshlrev_b32 v220, 16, v219
 v_and_b32 v219, 0xffff0000, v219
 s_waitcnt lgkmcnt(4)
 v_mfma_f32_32x32x16_bf16 v[64:79], v[48:51], v[188:191], v[64:79]
 ds_read_b64_tr_b16 v[60:61], v20 offset:47104
 ds_read_b64_tr_b16 v[62:63], v20 offset:47616
 v_add_f32 v217, v217, v220
 v_add_f32 v218, v218, v219
 v_add_f32 v217, v217, v218
 s_waitcnt lgkmcnt(4)
 v_mfma_f32_32x32x16_bf16 v[80:95], v[52:55], v[188:191], v[80:95]
 s_waitcnt vmcnt(2)
 s_barrier
 ds_read_b128 v[176:179], v4 offset:0
 ds_read_b128 v[180:183], v5 offset:0
 ds_read_b64_tr_b16 v[40:41], v21 offset:2048
 ds_read_b64_tr_b16 v[42:43], v21 offset:2560
 s_waitcnt lgkmcnt(6)
 v_mfma_f32_32x32x16_bf16 v[96:111], v[56:59], v[188:191], v[96:111]
 ds_read_b64_tr_b16 v[44:45], v22 offset:2048
 ds_read_b64_tr_b16 v[46:47], v22 offset:2560
 ds_swizzle_b32 v218, v217 offset:1055
 s_waitcnt lgkmcnt(7)
 v_mfma_f32_32x32x16_bf16 v[112:127], v[60:63], v[188:191], v[112:127]
 ds_read_b64_tr_b16 v[48:49], v23 offset:2048
 ds_read_b64_tr_b16 v[50:51], v23 offset:2560
 s_waitcnt lgkmcnt(5)
 v_mfma_f32_32x32x16_bf16 v[64:79], v[40:43], v[176:179], v[64:79]
 ds_read_b64_tr_b16 v[52:53], v24 offset:2048
 ds_read_b64_tr_b16 v[54:55], v24 offset:2560
 s_waitcnt lgkmcnt(5)
 v_mfma_f32_32x32x16_bf16 v[80:95], v[44:47], v[176:179], v[80:95]
 ds_read_b64_tr_b16 v[56:57], v21 offset:4096
 ds_read_b64_tr_b16 v[58:59], v21 offset:4608
 s_waitcnt lgkmcnt(6)
 v_add_f32 v217, v217, v218
 s_waitcnt lgkmcnt(4)
 v_mfma_f32_32x32x16_bf16 v[96:111], v[48:51], v[176:179], v[96:111]
 ds_read_b64_tr_b16 v[60:61], v22 offset:4096
 ds_read_b64_tr_b16 v[62:63], v22 offset:4608
 ds_swizzle_b32 v218, v217 offset:2079
 s_waitcnt lgkmcnt(5)
 v_mfma_f32_32x32x16_bf16 v[112:127], v[52:55], v[176:179], v[112:127]
 ds_read_b64_tr_b16 v[40:41], v23 offset:4096
 ds_read_b64_tr_b16 v[42:43], v23 offset:4608
 s_waitcnt lgkmcnt(5)
 v_mfma_f32_32x32x16_bf16 v[64:79], v[56:59], v[180:183], v[64:79]
 ds_read_b64_tr_b16 v[44:45], v24 offset:4096
 ds_read_b64_tr_b16 v[46:47], v24 offset:4608
 s_waitcnt lgkmcnt(5)
 v_mfma_f32_32x32x16_bf16 v[80:95], v[60:63], v[180:183], v[80:95]
 s_waitcnt vmcnt(0)
 s_barrier
 ds_read_b128 v[184:187], v6 offset:0
 ds_read_b128 v[188:191], v7 offset:0
 ds_read_b64_tr_b16 v[48:49], v21 offset:24576
 ds_read_b64_tr_b16 v[50:51], v21 offset:25088
 s_waitcnt lgkmcnt(8)
 v_add_f32 v217, v217, v218
 s_waitcnt lgkmcnt(6)
 v_mfma_f32_32x32x16_bf16 v[96:111], v[40:43], v[180:183], v[96:111]
 ds_read_b64_tr_b16 v[52:53], v22 offset:24576
 ds_read_b64_tr_b16 v[54:55], v22 offset:25088
 ds_swizzle_b32 v218, v217 offset:4127
 s_waitcnt lgkmcnt(7)
 v_mfma_f32_32x32x16_bf16 v[112:127], v[44:47], v[180:183], v[112:127]
 ds_read_b64_tr_b16 v[56:57], v23 offset:24576
 ds_read_b64_tr_b16 v[58:59], v23 offset:25088
 s_waitcnt lgkmcnt(5)
 v_mfma_f32_32x32x16_bf16 v[64:79], v[48:51], v[184:187], v[64:79]
 ds_read_b64_tr_b16 v[60:61], v24 offset:24576
 ds_read_b64_tr_b16 v[62:63], v24 offset:25088
 s_waitcnt lgkmcnt(5)
 v_mfma_f32_32x32x16_bf16 v[80:95], v[52:55], v[184:187], v[80:95]
 ds_read_b64_tr_b16 v[40:41], v21 offset:26624
 ds_read_b64_tr_b16 v[42:43], v21 offset:27136
 s_waitcnt lgkmcnt(6)
 v_add_f32 v217, v217, v218
 s_waitcnt lgkmcnt(4)
 v_mfma_f32_32x32x16_bf16 v[96:111], v[56:59], v[184:187], v[96:111]
 ds_read_b64_tr_b16 v[44:45], v22 offset:26624
 ds_read_b64_tr_b16 v[46:47], v22 offset:27136
 ds_swizzle_b32 v218, v217 offset:8223
 s_waitcnt lgkmcnt(5)
 v_mfma_f32_32x32x16_bf16 v[112:127], v[60:63], v[184:187], v[112:127]
 ds_read_b64_tr_b16 v[48:49], v23 offset:26624
 ds_read_b64_tr_b16 v[50:51], v23 offset:27136
 s_waitcnt lgkmcnt(5)
 v_mfma_f32_32x32x16_bf16 v[64:79], v[40:43], v[188:191], v[64:79]
 ds_read_b64_tr_b16 v[52:53], v24 offset:26624
 ds_read_b64_tr_b16 v[54:55], v24 offset:27136
 s_waitcnt lgkmcnt(5)
 v_mfma_f32_32x32x16_bf16 v[80:95], v[44:47], v[188:191], v[80:95]
 s_waitcnt lgkmcnt(4)
 v_add_f32 v217, v217, v218
 s_waitcnt lgkmcnt(2)
 v_mfma_f32_32x32x16_bf16 v[96:111], v[48:51], v[188:191], v[96:111]
 ds_swizzle_b32 v218, v217 offset:16415
 s_waitcnt lgkmcnt(1)
 v_mfma_f32_32x32x16_bf16 v[112:127], v[52:55], v[188:191], v[112:127]
 s_waitcnt lgkmcnt(0)
 v_add_f32 v217, v217, v218
 v_cvt_pk_bf16_f32 v217, v217, v217
 v_lshlrev_b32 v217, 16, v217
 v_mul_f32 v217, 0xbfb8aa3b, v217
 v_exp_f32 v217, v217
 v_lshlrev_b32 v219, 2, v216
 v_add_f32 v217, 1.0, v217
 v_rcp_f32 v217, v217
 s_mov_b32 s38, 20971520
 v_cvt_pk_bf16_f32 v217, v217, v217
 v_lshlrev_b32 v217, 16, v217
 buffer_store_dword v217, v219, s[16:19], s38 offen
 s_waitcnt lgkmcnt(0)
 s_barrier
 v_lshrrev_b32 v35, 1, v1
 v_mul_u32_u24 v35, 1280, v35
 v_and_b32 v36, 1, v1
 v_lshl_add_u32 v37, v36, 4, v35
 s_mul_i32 s24, s2, 12
 s_mul_i32 s25, s20, 3
 s_add_u32 s24, s24, s25
 s_mul_i32 s31, s20, 3072
 s_add_u32 s31, s31, 102592
 s_add_u32 s25, s24, 0
 s_min_u32 s25, s25, 2959
 s_mul_hi_u32 s80, s25, 107374183
 s_mul_i32 s26, s80, 40
 s_sub_u32 s81, s25, s26
 s_cmp_lt_u32 s80, 54
 s_cselect_b32 s76, s52, s46
 s_cselect_b32 s77, s53, s47
 s_mov_b32 s78, 819200
 s_cselect_b32 s78, 2211840, s78
 s_mov_b32 s79, 0x00020000
 s_cselect_b32 s26, 0, 54
 s_sub_u32 s26, s80, s26
 s_mul_i32 s26, s26, 40960
 s_lshl_b32 s27, s81, 5
 s_add_u32 s26, s26, s27
 s_add_u32 m0, s31, 0
 s_nop 0
 buffer_load_dwordx4 v37, s[76:79], s26 offen lds
 s_add_u32 s25, s24, 1
 s_min_u32 s25, s25, 2959
 s_mul_hi_u32 s82, s25, 107374183
 s_mul_i32 s26, s82, 40
 s_sub_u32 s83, s25, s26
 s_cmp_lt_u32 s82, 54
 s_cselect_b32 s76, s52, s46
 s_cselect_b32 s77, s53, s47
 s_mov_b32 s78, 819200
 s_cselect_b32 s78, 2211840, s78
 s_mov_b32 s79, 0x00020000
 s_cselect_b32 s26, 0, 54
 s_sub_u32 s26, s82, s26
 s_mul_i32 s26, s26, 40960
 s_lshl_b32 s27, s83, 5
 s_add_u32 s26, s26, s27
 s_add_u32 m0, s31, 1024
 s_nop 0
 buffer_load_dwordx4 v37, s[76:79], s26 offen lds
 s_add_u32 s25, s24, 2
 s_min_u32 s25, s25, 2959
 s_mul_hi_u32 s84, s25, 107374183
 s_mul_i32 s26, s84, 40
 s_sub_u32 s85, s25, s26
 s_cmp_lt_u32 s84, 54
 s_cselect_b32 s76, s52, s46
 s_cselect_b32 s77, s53, s47
 s_mov_b32 s78, 819200
 s_cselect_b32 s78, 2211840, s78
 s_mov_b32 s79, 0x00020000
 s_cselect_b32 s26, 0, 54
 s_sub_u32 s26, s84, s26
 s_mul_i32 s26, s26, 40960
 s_lshl_b32 s27, s85, 5
 s_add_u32 s26, s26, s27
 s_add_u32 m0, s31, 2048
 s_nop 0
 buffer_load_dwordx4 v37, s[76:79], s26 offen lds
 v_cvt_pk_bf16_f32 v161, v64, v65
 v_cvt_pk_bf16_f32 v163, v72, v73
 v_lshlrev_b32 v160, 16, v161
 v_and_b32 v161, 0xffff0000, v161
 v_mul_f32 v164, v160, v160
 v_mul_f32 v165, v161, v161
 v_fmamk_f32 v164, v164, 0xbdd2d3e8, v26
 v_fmamk_f32 v165, v165, 0xbdd2d3e8, v26
 v_mul_f32 v164, v164, v160
 v_mul_f32 v165, v165, v161
 v_exp_f32 v164, v164
 v_exp_f32 v165, v165
 v_lshlrev_b32 v162, 16, v163
 v_add_f32 v164, 1.0, v164
 v_add_f32 v165, 1.0, v165
 v_rcp_f32 v164, v164
 v_rcp_f32 v165, v165
 v_and_b32 v163, 0xffff0000, v163
 v_mul_f32 v164, v164, v160
 v_mul_f32 v165, v165, v161
 v_cvt_pk_bf16_f32 v165, v164, v165
 v_lshlrev_b32 v164, 16, v165
 v_and_b32 v165, 0xffff0000, v165
 v_mul_f32 v164, v164, v162
 v_mul_f32 v165, v165, v163
 v_cvt_pk_bf16_f32 v172, v164, v165
 v_cvt_pk_bf16_f32 v161, v66, v67
 v_cvt_pk_bf16_f32 v163, v74, v75
 v_lshlrev_b32 v160, 16, v161
 v_and_b32 v161, 0xffff0000, v161
 v_mul_f32 v164, v160, v160
 v_mul_f32 v165, v161, v161
 v_fmamk_f32 v164, v164, 0xbdd2d3e8, v26
 v_fmamk_f32 v165, v165, 0xbdd2d3e8, v26
 v_mul_f32 v164, v164, v160
 v_mul_f32 v165, v165, v161
 v_exp_f32 v164, v164
 v_exp_f32 v165, v165
 v_lshlrev_b32 v162, 16, v163
 v_add_f32 v164, 1.0, v164
 v_add_f32 v165, 1.0, v165
 v_rcp_f32 v164, v164
 v_rcp_f32 v165, v165
 v_and_b32 v163, 0xffff0000, v163
 v_mul_f32 v164, v164, v160
 v_mul_f32 v165, v165, v161
 v_cvt_pk_bf16_f32 v165, v164, v165
 v_lshlrev_b32 v164, 16, v165
 v_and_b32 v165, 0xffff0000, v165
 v_mul_f32 v164, v164, v162
 v_mul_f32 v165, v165, v163
 v_cvt_pk_bf16_f32 v173, v164, v165
 v_cvt_pk_bf16_f32 v161, v68, v69
 v_cvt_pk_bf16_f32 v163, v76, v77
 v_lshlrev_b32 v160, 16, v161
 v_and_b32 v161, 0xffff0000, v161
 v_mul_f32 v164, v160, v160
 v_mul_f32 v165, v161, v161
 v_fmamk_f32 v164, v164, 0xbdd2d3e8, v26
 v_fmamk_f32 v165, v165, 0xbdd2d3e8, v26
 v_mul_f32 v164, v164, v160
 v_mul_f32 v165, v165, v161
 v_exp_f32 v164, v164
 v_exp_f32 v165, v165
 v_lshlrev_b32 v162, 16, v163
 v_add_f32 v164, 1.0, v164
 v_add_f32 v165, 1.0, v165
 v_rcp_f32 v164, v164
 v_rcp_f32 v165, v165
 v_and_b32 v163, 0xffff0000, v163
 v_mul_f32 v164, v164, v160
 v_mul_f32 v165, v165, v161
 v_cvt_pk_bf16_f32 v165, v164, v165
 v_lshlrev_b32 v164, 16, v165
 v_and_b32 v165, 0xffff0000, v165
 v_mul_f32 v164, v164, v162
 v_mul_f32 v165, v165, v163
 v_cvt_pk_bf16_f32 v174, v164, v165
 v_cvt_pk_bf16_f32 v161, v70, v71
 v_cvt_pk_bf16_f32 v163, v78, v79
 v_lshlrev_b32 v160, 16, v161
 v_and_b32 v161, 0xffff0000, v161
 v_mul_f32 v164, v160, v160
 v_mul_f32 v165, v161, v161
 v_fmamk_f32 v164, v164, 0xbdd2d3e8, v26
 v_fmamk_f32 v165, v165, 0xbdd2d3e8, v26
 v_mul_f32 v164, v164, v160
 v_mul_f32 v165, v165, v161
 v_exp_f32 v164, v164
 v_exp_f32 v165, v165
 v_lshlrev_b32 v162, 16, v163
 v_add_f32 v164, 1.0, v164
 v_add_f32 v165, 1.0, v165
 v_rcp_f32 v164, v164
 v_rcp_f32 v165, v165
 v_and_b32 v163, 0xffff0000, v163
 v_mul_f32 v164, v164, v160
 v_mul_f32 v165, v165, v161
 v_cvt_pk_bf16_f32 v165, v164, v165
 v_lshlrev_b32 v164, 16, v165
 v_and_b32 v165, 0xffff0000, v165
 v_mul_f32 v164, v164, v162
 v_mul_f32 v165, v165, v163
 v_cvt_pk_bf16_f32 v175, v164, v165
 s_add_u32 s38, s34, 0
 buffer_store_dwordx4 v[172:175], v25, s[16:19], s38 offen sc0 sc1
 v_cvt_pk_bf16_f32 v177, v80, v81
 v_cvt_pk_bf16_f32 v179, v88, v89
 v_lshlrev_b32 v176, 16, v177
 v_and_b32 v177, 0xffff0000, v177
 v_mul_f32 v180, v176, v176
 v_mul_f32 v181, v177, v177
 v_fmamk_f32 v180, v180, 0xbdd2d3e8, v26
 v_fmamk_f32 v181, v181, 0xbdd2d3e8, v26
 v_mul_f32 v180, v180, v176
 v_mul_f32 v181, v181, v177
 v_exp_f32 v180, v180
 v_exp_f32 v181, v181
 v_lshlrev_b32 v178, 16, v179
 v_add_f32 v180, 1.0, v180
 v_add_f32 v181, 1.0, v181
 v_rcp_f32 v180, v180
 v_rcp_f32 v181, v181
 v_and_b32 v179, 0xffff0000, v179
 v_mul_f32 v180, v180, v176
 v_mul_f32 v181, v181, v177
 v_cvt_pk_bf16_f32 v181, v180, v181
 v_lshlrev_b32 v180, 16, v181
 v_and_b32 v181, 0xffff0000, v181
 v_mul_f32 v180, v180, v178
 v_mul_f32 v181, v181, v179
 v_cvt_pk_bf16_f32 v188, v180, v181
 v_cvt_pk_bf16_f32 v177, v82, v83
 v_cvt_pk_bf16_f32 v179, v90, v91
 v_lshlrev_b32 v176, 16, v177
 v_and_b32 v177, 0xffff0000, v177
 v_mul_f32 v180, v176, v176
 v_mul_f32 v181, v177, v177
 v_fmamk_f32 v180, v180, 0xbdd2d3e8, v26
 v_fmamk_f32 v181, v181, 0xbdd2d3e8, v26
 v_mul_f32 v180, v180, v176
 v_mul_f32 v181, v181, v177
 v_exp_f32 v180, v180
 v_exp_f32 v181, v181
 v_lshlrev_b32 v178, 16, v179
 v_add_f32 v180, 1.0, v180
 v_add_f32 v181, 1.0, v181
 v_rcp_f32 v180, v180
 v_rcp_f32 v181, v181
 v_and_b32 v179, 0xffff0000, v179
 v_mul_f32 v180, v180, v176
 v_mul_f32 v181, v181, v177
 v_cvt_pk_bf16_f32 v181, v180, v181
 v_lshlrev_b32 v180, 16, v181
 v_and_b32 v181, 0xffff0000, v181
 v_mul_f32 v180, v180, v178
 v_mul_f32 v181, v181, v179
 v_cvt_pk_bf16_f32 v189, v180, v181
 v_cvt_pk_bf16_f32 v177, v84, v85
 v_cvt_pk_bf16_f32 v179, v92, v93
 v_lshlrev_b32 v176, 16, v177
 v_and_b32 v177, 0xffff0000, v177
 v_mul_f32 v180, v176, v176
 v_mul_f32 v181, v177, v177
 v_fmamk_f32 v180, v180, 0xbdd2d3e8, v26
 v_fmamk_f32 v181, v181, 0xbdd2d3e8, v26
 v_mul_f32 v180, v180, v176
 v_mul_f32 v181, v181, v177
 v_exp_f32 v180, v180
 v_exp_f32 v181, v181
 v_lshlrev_b32 v178, 16, v179
 v_add_f32 v180, 1.0, v180
 v_add_f32 v181, 1.0, v181
 v_rcp_f32 v180, v180
 v_rcp_f32 v181, v181
 v_and_b32 v179, 0xffff0000, v179
 v_mul_f32 v180, v180, v176
 v_mul_f32 v181, v181, v177
 v_cvt_pk_bf16_f32 v181, v180, v181
 v_lshlrev_b32 v180, 16, v181
 v_and_b32 v181, 0xffff0000, v181
 v_mul_f32 v180, v180, v178
 v_mul_f32 v181, v181, v179
 v_cvt_pk_bf16_f32 v190, v180, v181
 v_cvt_pk_bf16_f32 v177, v86, v87
 v_cvt_pk_bf16_f32 v179, v94, v95
 v_lshlrev_b32 v176, 16, v177
 v_and_b32 v177, 0xffff0000, v177
 v_mul_f32 v180, v176, v176
 v_mul_f32 v181, v177, v177
 v_fmamk_f32 v180, v180, 0xbdd2d3e8, v26
 v_fmamk_f32 v181, v181, 0xbdd2d3e8, v26
 v_mul_f32 v180, v180, v176
 v_mul_f32 v181, v181, v177
 v_exp_f32 v180, v180
 v_exp_f32 v181, v181
 v_lshlrev_b32 v178, 16, v179
 v_add_f32 v180, 1.0, v180
 v_add_f32 v181, 1.0, v181
 v_rcp_f32 v180, v180
 v_rcp_f32 v181, v181
 v_and_b32 v179, 0xffff0000, v179
 v_mul_f32 v180, v180, v176
 v_mul_f32 v181, v181, v177
 v_cvt_pk_bf16_f32 v181, v180, v181
 v_lshlrev_b32 v180, 16, v181
 v_and_b32 v181, 0xffff0000, v181
 v_mul_f32 v180, v180, v178
 v_mul_f32 v181, v181, v179
 v_cvt_pk_bf16_f32 v191, v180, v181
 s_add_u32 s38, s34, 512
 buffer_store_dwordx4 v[188:191], v25, s[16:19], s38 offen sc0 sc1
 v_cvt_pk_bf16_f32 v161, v96, v97
 v_cvt_pk_bf16_f32 v163, v104, v105
 v_lshlrev_b32 v160, 16, v161
 v_and_b32 v161, 0xffff0000, v161
 v_mul_f32 v164, v160, v160
 v_mul_f32 v165, v161, v161
 v_fmamk_f32 v164, v164, 0xbdd2d3e8, v26
 v_fmamk_f32 v165, v165, 0xbdd2d3e8, v26
 v_mul_f32 v164, v164, v160
 v_mul_f32 v165, v165, v161
 v_exp_f32 v164, v164
 v_exp_f32 v165, v165
 v_lshlrev_b32 v162, 16, v163
 v_add_f32 v164, 1.0, v164
 v_add_f32 v165, 1.0, v165
 v_rcp_f32 v164, v164
 v_rcp_f32 v165, v165
 v_and_b32 v163, 0xffff0000, v163
 v_mul_f32 v164, v164, v160
 v_mul_f32 v165, v165, v161
 v_cvt_pk_bf16_f32 v165, v164, v165
 v_lshlrev_b32 v164, 16, v165
 v_and_b32 v165, 0xffff0000, v165
 v_mul_f32 v164, v164, v162
 v_mul_f32 v165, v165, v163
 v_cvt_pk_bf16_f32 v172, v164, v165
 v_cvt_pk_bf16_f32 v161, v98, v99
 v_cvt_pk_bf16_f32 v163, v106, v107
 v_lshlrev_b32 v160, 16, v161
 v_and_b32 v161, 0xffff0000, v161
 v_mul_f32 v164, v160, v160
 v_mul_f32 v165, v161, v161
 v_fmamk_f32 v164, v164, 0xbdd2d3e8, v26
 v_fmamk_f32 v165, v165, 0xbdd2d3e8, v26
 v_mul_f32 v164, v164, v160
 v_mul_f32 v165, v165, v161
 v_exp_f32 v164, v164
 v_exp_f32 v165, v165
 v_lshlrev_b32 v162, 16, v163
 v_add_f32 v164, 1.0, v164
 v_add_f32 v165, 1.0, v165
 v_rcp_f32 v164, v164
 v_rcp_f32 v165, v165
 v_and_b32 v163, 0xffff0000, v163
 v_mul_f32 v164, v164, v160
 v_mul_f32 v165, v165, v161
 v_cvt_pk_bf16_f32 v165, v164, v165
 v_lshlrev_b32 v164, 16, v165
 v_and_b32 v165, 0xffff0000, v165
 v_mul_f32 v164, v164, v162
 v_mul_f32 v165, v165, v163
 v_cvt_pk_bf16_f32 v173, v164, v165
 v_cvt_pk_bf16_f32 v161, v100, v101
 v_cvt_pk_bf16_f32 v163, v108, v109
 v_lshlrev_b32 v160, 16, v161
 v_and_b32 v161, 0xffff0000, v161
 v_mul_f32 v164, v160, v160
 v_mul_f32 v165, v161, v161
 v_fmamk_f32 v164, v164, 0xbdd2d3e8, v26
 v_fmamk_f32 v165, v165, 0xbdd2d3e8, v26
 v_mul_f32 v164, v164, v160
 v_mul_f32 v165, v165, v161
 v_exp_f32 v164, v164
 v_exp_f32 v165, v165
 v_lshlrev_b32 v162, 16, v163
 v_add_f32 v164, 1.0, v164
 v_add_f32 v165, 1.0, v165
 v_rcp_f32 v164, v164
 v_rcp_f32 v165, v165
 v_and_b32 v163, 0xffff0000, v163
 v_mul_f32 v164, v164, v160
 v_mul_f32 v165, v165, v161
 v_cvt_pk_bf16_f32 v165, v164, v165
 v_lshlrev_b32 v164, 16, v165
 v_and_b32 v165, 0xffff0000, v165
 v_mul_f32 v164, v164, v162
 v_mul_f32 v165, v165, v163
 v_cvt_pk_bf16_f32 v174, v164, v165
 v_cvt_pk_bf16_f32 v161, v102, v103
 v_cvt_pk_bf16_f32 v163, v110, v111
 v_lshlrev_b32 v160, 16, v161
 v_and_b32 v161, 0xffff0000, v161
 v_mul_f32 v164, v160, v160
 v_mul_f32 v165, v161, v161
 v_fmamk_f32 v164, v164, 0xbdd2d3e8, v26
 v_fmamk_f32 v165, v165, 0xbdd2d3e8, v26
 v_mul_f32 v164, v164, v160
 v_mul_f32 v165, v165, v161
 v_exp_f32 v164, v164
 v_exp_f32 v165, v165
 v_lshlrev_b32 v162, 16, v163
 v_add_f32 v164, 1.0, v164
 v_add_f32 v165, 1.0, v165
 v_rcp_f32 v164, v164
 v_rcp_f32 v165, v165
 v_and_b32 v163, 0xffff0000, v163
 v_mul_f32 v164, v164, v160
 v_mul_f32 v165, v165, v161
 v_cvt_pk_bf16_f32 v165, v164, v165
 v_lshlrev_b32 v164, 16, v165
 v_and_b32 v165, 0xffff0000, v165
 v_mul_f32 v164, v164, v162
 v_mul_f32 v165, v165, v163
 v_cvt_pk_bf16_f32 v175, v164, v165
 s_add_u32 s38, s34, 1024
 buffer_store_dwordx4 v[172:175], v25, s[16:19], s38 offen sc0 sc1
 v_cvt_pk_bf16_f32 v177, v112, v113
 v_cvt_pk_bf16_f32 v179, v120, v121
 v_lshlrev_b32 v176, 16, v177
 v_and_b32 v177, 0xffff0000, v177
 v_mul_f32 v180, v176, v176
 v_mul_f32 v181, v177, v177
 v_fmamk_f32 v180, v180, 0xbdd2d3e8, v26
 v_fmamk_f32 v181, v181, 0xbdd2d3e8, v26
 v_mul_f32 v180, v180, v176
 v_mul_f32 v181, v181, v177
 v_exp_f32 v180, v180
 v_exp_f32 v181, v181
 v_lshlrev_b32 v178, 16, v179
 v_add_f32 v180, 1.0, v180
 v_add_f32 v181, 1.0, v181
 v_rcp_f32 v180, v180
 v_rcp_f32 v181, v181
 v_and_b32 v179, 0xffff0000, v179
 v_mul_f32 v180, v180, v176
 v_mul_f32 v181, v181, v177
 v_cvt_pk_bf16_f32 v181, v180, v181
 v_lshlrev_b32 v180, 16, v181
 v_and_b32 v181, 0xffff0000, v181
 v_mul_f32 v180, v180, v178
 v_mul_f32 v181, v181, v179
 v_cvt_pk_bf16_f32 v188, v180, v181
 v_cvt_pk_bf16_f32 v177, v114, v115
 v_cvt_pk_bf16_f32 v179, v122, v123
 v_lshlrev_b32 v176, 16, v177
 v_and_b32 v177, 0xffff0000, v177
 v_mul_f32 v180, v176, v176
 v_mul_f32 v181, v177, v177
 v_fmamk_f32 v180, v180, 0xbdd2d3e8, v26
 v_fmamk_f32 v181, v181, 0xbdd2d3e8, v26
 v_mul_f32 v180, v180, v176
 v_mul_f32 v181, v181, v177
 v_exp_f32 v180, v180
 v_exp_f32 v181, v181
 v_lshlrev_b32 v178, 16, v179
 v_add_f32 v180, 1.0, v180
 v_add_f32 v181, 1.0, v181
 v_rcp_f32 v180, v180
 v_rcp_f32 v181, v181
 v_and_b32 v179, 0xffff0000, v179
 v_mul_f32 v180, v180, v176
 v_mul_f32 v181, v181, v177
 v_cvt_pk_bf16_f32 v181, v180, v181
 v_lshlrev_b32 v180, 16, v181
 v_and_b32 v181, 0xffff0000, v181
 v_mul_f32 v180, v180, v178
 v_mul_f32 v181, v181, v179
 v_cvt_pk_bf16_f32 v189, v180, v181
 v_cvt_pk_bf16_f32 v177, v116, v117
 v_cvt_pk_bf16_f32 v179, v124, v125
 v_lshlrev_b32 v176, 16, v177
 v_and_b32 v177, 0xffff0000, v177
 v_mul_f32 v180, v176, v176
 v_mul_f32 v181, v177, v177
 v_fmamk_f32 v180, v180, 0xbdd2d3e8, v26
 v_fmamk_f32 v181, v181, 0xbdd2d3e8, v26
 v_mul_f32 v180, v180, v176
 v_mul_f32 v181, v181, v177
 v_exp_f32 v180, v180
 v_exp_f32 v181, v181
 v_lshlrev_b32 v178, 16, v179
 v_add_f32 v180, 1.0, v180
 v_add_f32 v181, 1.0, v181
 v_rcp_f32 v180, v180
 v_rcp_f32 v181, v181
 v_and_b32 v179, 0xffff0000, v179
 v_mul_f32 v180, v180, v176
 v_mul_f32 v181, v181, v177
 v_cvt_pk_bf16_f32 v181, v180, v181
 v_lshlrev_b32 v180, 16, v181
 v_and_b32 v181, 0xffff0000, v181
 v_mul_f32 v180, v180, v178
 v_mul_f32 v181, v181, v179
 v_cvt_pk_bf16_f32 v190, v180, v181
 v_cvt_pk_bf16_f32 v177, v118, v119
 v_cvt_pk_bf16_f32 v179, v126, v127
 v_lshlrev_b32 v176, 16, v177
 v_and_b32 v177, 0xffff0000, v177
 v_mul_f32 v180, v176, v176
 v_mul_f32 v181, v177, v177
 v_fmamk_f32 v180, v180, 0xbdd2d3e8, v26
 v_fmamk_f32 v181, v181, 0xbdd2d3e8, v26
 v_mul_f32 v180, v180, v176
 v_mul_f32 v181, v181, v177
 v_exp_f32 v180, v180
 v_exp_f32 v181, v181
 v_lshlrev_b32 v178, 16, v179
 v_add_f32 v180, 1.0, v180
 v_add_f32 v181, 1.0, v181
 v_rcp_f32 v180, v180
 v_rcp_f32 v181, v181
 v_and_b32 v179, 0xffff0000, v179
 v_mul_f32 v180, v180, v176
 v_mul_f32 v181, v181, v177
 v_cvt_pk_bf16_f32 v181, v180, v181
 v_lshlrev_b32 v180, 16, v181
 v_and_b32 v181, 0xffff0000, v181
 v_mul_f32 v180, v180, v178
 v_mul_f32 v181, v181, v179
 v_cvt_pk_bf16_f32 v191, v180, v181
 s_add_u32 s38, s34, 1536
 buffer_store_dwordx4 v[188:191], v25, s[16:19], s38 offen sc0 sc1
 v_lshrrev_b32 v35, 4, v1
 v_bfe_u32 v36, v1, 2, 2
 v_and_b32 v37, 3, v1
 v_lshrrev_b32 v38, 1, v35
 v_lshlrev_b32 v38, 4, v38
 v_and_b32 v39, 1, v35
 v_lshl_add_u32 v38, v39, 2, v38
 v_add_u32 v38, v38, v36
 v_lshl_add_u32 v39, v35, 3, v36
 v_lshlrev_b32 v37, 3, v37
 s_mul_i32 s31, s20, 3072
 s_add_u32 s31, s31, 102592
 v_add_u32 v37, s31, v37
 v_lshl_add_u32 v38, v38, 5, v37
 v_lshl_add_u32 v39, v39, 5, v37
 v_add_u32 v35, 256, v38
 v_add_u32 v36, 128, v39
 v_lshlrev_b32 v160, 4, v1
 s_waitcnt vmcnt(4)
 s_cmp_lt_u32 s80, 54
 s_cselect_b64 vcc, -1, 0
 s_nop 1
 v_cndmask_b32 v161, v39, v38, vcc
 v_cndmask_b32 v162, v36, v35, vcc
 ds_read_b64_tr_b16 v[164:165], v161 offset:0
 ds_read_b64_tr_b16 v[166:167], v162 offset:0
 s_cmp_lt_u32 s82, 54
 s_cselect_b64 vcc, -1, 0
 s_nop 1
 v_cndmask_b32 v161, v39, v38, vcc
 v_cndmask_b32 v162, v36, v35, vcc
 ds_read_b64_tr_b16 v[168:169], v161 offset:1024
 ds_read_b64_tr_b16 v[170:171], v162 offset:1024
 s_cmp_lt_u32 s84, 54
 s_cselect_b64 vcc, -1, 0
 s_nop 1
 v_cndmask_b32 v161, v39, v38, vcc
 v_cndmask_b32 v162, v36, v35, vcc
 ds_read_b64_tr_b16 v[172:173], v161 offset:2048
 ds_read_b64_tr_b16 v[174:175], v162 offset:2048
 s_mul_hi_u32 s24, s81, 858993460
 s_mul_i32 s25, s24, 5
 s_sub_u32 s25, s81, s25
 s_mul_i32 s24, s24, 74
 s_add_u32 s24, s24, s80
 s_mul_i32 s24, s24, 5120
 s_lshl_b32 s25, s25, 10
 s_add_u32 s24, s24, s25
 s_add_u32 s24, s24, 12582912
 s_waitcnt lgkmcnt(4)
 buffer_store_dwordx4 v[164:167], v160, s[16:19], s24 offen sc0 sc1
 s_mul_hi_u32 s24, s83, 858993460
 s_mul_i32 s25, s24, 5
 s_sub_u32 s25, s83, s25
 s_mul_i32 s24, s24, 74
 s_add_u32 s24, s24, s82
 s_mul_i32 s24, s24, 5120
 s_lshl_b32 s25, s25, 10
 s_add_u32 s24, s24, s25
 s_add_u32 s24, s24, 12582912
 s_waitcnt lgkmcnt(2)
 buffer_store_dwordx4 v[168:171], v160, s[16:19], s24 offen sc0 sc1
 s_mul_hi_u32 s24, s85, 858993460
 s_mul_i32 s25, s24, 5
 s_sub_u32 s25, s85, s25
 s_mul_i32 s24, s24, 74
 s_add_u32 s24, s24, s84
 s_mul_i32 s24, s24, 5120
 s_lshl_b32 s25, s25, 10
 s_add_u32 s24, s24, s25
 s_add_u32 s24, s24, 12582912
 s_waitcnt lgkmcnt(0)
 buffer_store_dwordx4 v[172:175], v160, s[16:19], s24 offen sc0 sc1
 s_endpgm
L3_D_h1:
 s_and_b32 s74, s35, 1024
 s_add_u32 s74, s74, 161792
 s_add_u32 m0, s36, 0
 s_movk_i32 s37, 0
 buffer_load_dwordx4 v2, s[4:7], s37 offen lds
 s_add_u32 m0, s36, 1024
 s_movk_i32 s37, 0
 buffer_load_dwordx4 v3, s[4:7], s37 offen lds
 s_add_u32 m0, s35, 0
 s_add_u32 s37, s88, 0
 buffer_load_dwordx4 v8, s[40:43], s37 offen lds
 s_add_u32 m0, s35, 8192
 s_add_u32 s37, s89, 0
 buffer_load_dwordx4 v9, s[56:59], s37 offen lds
 s_add_u32 m0, s35, 22528
 s_add_u32 s37, s88, 110592
 buffer_load_dwordx4 v8, s[40:43], s37 offen lds
 s_add_u32 m0, s35, 30720
 s_add_u32 s37, s89, 110592
 buffer_load_dwordx4 v9, s[56:59], s37 offen lds
 s_add_u32 m0, s36, 16384
 s_movk_i32 s37, 128
 buffer_load_dwordx4 v2, s[4:7], s37 offen lds
 s_add_u32 m0, s36, 17408
 s_movk_i32 s37, 128
 buffer_load_dwordx4 v3, s[4:7], s37 offen lds
 s_add_u32 m0, s35, 45056
 s_add_u32 s37, s88, 221184
 buffer_load_dwordx4 v8, s[40:43], s37 offen lds
 s_add_u32 m0, s35, 53248
 s_add_u32 s37, s89, 221184
 buffer_load_dwordx4 v9, s[56:59], s37 offen lds
 v_and_b32 v35, 31, v1
 v_lshrrev_b32 v36, 5, v1
 v_bfe_u32 v37, v1, 1, 3
 v_xor_b32 v37, v37, v36
 v_lshlrev_b32 v38, 7, v35
 s_lshl_b32 s24, s20, 12
 s_add_u32 s24, s24, 112640
 v_add_u32 v38, s24, v38
 v_xor_b32 v39, 0, v37
 v_lshl_add_u32 v4, v39, 4, v38
 v_xor_b32 v39, 2, v37
 v_lshl_add_u32 v5, v39, 4, v38
 v_xor_b32 v39, 4, v37
 v_lshl_add_u32 v6, v39, 4, v38
 v_xor_b32 v39, 6, v37
 v_lshl_add_u32 v7, v39, 4, v38
 v_bfe_u32 v35, v1, 4, 1
 v_lshrrev_b32 v36, 5, v1
 v_bfe_u32 v37, v1, 2, 2
 v_and_b32 v38, 3, v1
 v_lshlrev_b32 v39, 12, v35
 v_lshl_add_u32 v39, v36, 10, v39
 v_lshl_add_u32 v39, v37, 7, v39
 v_lshl_add_u32 v39, v38, 3, v39
 v_lshrrev_b32 v37, 1, v37
 v_lshl_or_b32 v37, v35, 1, v37
 v_xor_b32 v38, 0, v37
 v_lshl_add_u32 v17, v38, 5, v39
 v_add_u32 v21, 0x10000, v17
 v_xor_b32 v38, 1, v37
 v_lshl_add_u32 v18, v38, 5, v39
 v_add_u32 v22, 0x10000, v18
 v_xor_b32 v38, 2, v37
 v_lshl_add_u32 v19, v38, 5, v39
 v_add_u32 v23, 0x10000, v19
 v_xor_b32 v38, 3, v37
 v_lshl_add_u32 v20, v38, 5, v39
 v_add_u32 v24, 0x10000, v20
 s_lshl_b32 s24, s20, 1
 v_add_u32 v35, s24, v35
 s_mov_b32 s25, 55296
 v_mul_lo_u32 v35, v35, s25
 v_and_b32 v37, 15, v1
 v_lshl_add_u32 v37, v36, 4, v37
 v_lshl_add_u32 v25, v37, 4, v35
 s_mul_i32 s34, s21, 442368
 s_add_u32 s34, s34, 0
 s_lshl_b32 s24, s96, 11
 s_add_u32 s33, s34, s24
 s_lshl_b32 s24, s97, 9
 s_add_u32 s33, s33, s24
 s_lshl_b32 s24, s23, 11
 s_add_u32 s34, s34, s24
 v_mov_b32 v26, 0xc0135761
 v_mov_b32 v244, 0xbdd2d3e8
 v_mov_b32 v245, 0xbdd2d3e8
 v_mov_b32 v246, 0xc0135761
 v_mov_b32 v247, 0xc0135761
 v_bfe_u32 v35, v1, 4, 1
 v_bfe_u32 v37, v1, 2, 2
 v_and_b32 v38, 3, v1
 v_lshlrev_b32 v39, 11, v35
 v_lshl_add_u32 v39, v36, 9, v39
 v_lshl_add_u32 v39, v37, 6, v39
 v_lshl_add_u32 v39, v38, 3, v39
 v_lshl_add_u32 v252, v35, 5, v39
 v_xor_b32 v253, 32, v252
 v_add_u32 v254, 0x10000, v252
 v_add_u32 v255, 0x10000, v253
 s_cmp_eq_u32 s20, 0
 s_cselect_b32 s76, s8, s12
 s_cselect_b32 s77, s9, s13
 s_mov_b32 s78, 2211840
 s_mov_b32 s61, 221184
 s_mul_i32 s60, s2, 864
 s_cmp_eq_u32 s20, 2
 s_cselect_b32 s76, s64, s76
 s_cselect_b32 s77, s65, s77
 s_cselect_b32 s78, 2457600, s78
 s_cselect_b32 s61, 245760, s61
 s_mul_i32 s24, s2, 960
 s_cselect_b32 s60, s24, s60
 s_cmp_eq_u32 s20, 3
 s_cselect_b32 s76, s4, s76
 s_cselect_b32 s77, s5, s77
 s_cselect_b32 s78, 2621440, s78
 s_cselect_b32 s61, 128, s61
 s_mul_i32 s24, s2, 10240
 s_cselect_b32 s60, s24, s60
 s_mov_b32 s79, 0x00020000
 s_movk_i32 s24, 128
 s_cselect_b32 s24, 1280, s24
 v_mul_lo_u32 v35, v1, s24
 v_mov_b32 v36, 0x80000000
 v_cmp_gt_u32 vcc, 8, v1
 s_nop 1
 v_cndmask_b32 v251, v36, v35, vcc
 s_add_u32 s60, s60, s61
 buffer_load_dword v250, v251, s[76:79], s60 offen
 s_add_u32 s60, s60, s61
 buffer_load_dword v250, v251, s[76:79], s60 offen
 s_add_u32 s60, s60, s61
 s_setprio 1
 s_waitcnt vmcnt(8)
 s_barrier
 buffer_load_dword v250, v251, s[76:79], s60 offen
 s_add_u32 s60, s60, s61
 ds_read_b128 v[176:179], v4 offset:0
 ds_read_b128 v[180:183], v5 offset:0
 ds_read_b64_tr_b16 v[40:41], v17 offset:8192
 ds_read_b64_tr_b16 v[42:43], v17 offset:8704
 s_add_u32 m0, s35, 67584
 s_add_u32 s37, s88, 331776
 buffer_load_dwordx4 v8, s[40:43], s37 offen lds
 ds_read_b64_tr_b16 v[44:45], v18 offset:8192
 ds_read_b64_tr_b16 v[46:47], v18 offset:8704
 s_add_u32 m0, s35, 75776
 s_add_u32 s37, s89, 331776
 buffer_load_dwordx4 v9, s[56:59], s37 offen lds
 ds_read_b64_tr_b16 v[48:49], v19 offset:8192
 ds_read_b64_tr_b16 v[50:51], v19 offset:8704
 s_waitcnt lgkmcnt(4)
 v_mfma_f32_32x32x16_bf16 v[64:79], v[40:43], v[176:179], 0
 ds_read_b64_tr_b16 v[52:53], v20 offset:8192
 ds_read_b64_tr_b16 v[54:55], v20 offset:8704
 s_waitcnt lgkmcnt(4)
 v_mfma_f32_32x32x16_bf16 v[80:95], v[44:47], v[176:179], 0
 ds_read_b64_tr_b16 v[56:57], v17 offset:10240
 ds_read_b64_tr_b16 v[58:59], v17 offset:10752
 s_waitcnt lgkmcnt(4)
 v_mfma_f32_32x32x16_bf16 v[96:111], v[48:51], v[176:179], 0
 ds_read_b64_tr_b16 v[60:61], v18 offset:10240
 ds_read_b64_tr_b16 v[62:63], v18 offset:10752
 s_waitcnt lgkmcnt(4)
 v_mfma_f32_32x32x16_bf16 v[112:127], v[52:55], v[176:179], 0
 ds_read_b64_tr_b16 v[40:41], v19 offset:10240
 ds_read_b64_tr_b16 v[42:43], v19 offset:10752
 s_waitcnt lgkmcnt(4)
 v_mfma_f32_32x32x16_bf16 v[64:79], v[56:59], v[180:183], v[64:79]
 ds_read_b64_tr_b16 v[44:45], v20 offset:10240
 ds_read_b64_tr_b16 v[46:47], v20 offset:10752
 s_waitcnt lgkmcnt(4)
 v_mfma_f32_32x32x16_bf16 v[80:95], v[60:63], v[180:183], v[80:95]
 s_waitcnt vmcnt(9)
 s_barrier
 ds_read_b128 v[184:187], v6 offset:0
 ds_read_b128 v[188:191], v7 offset:0
 ds_read_b64_tr_b16 v[48:49], v17 offset:30720
 ds_read_b64_tr_b16 v[50:51], v17 offset:31232
 s_add_u32 m0, s35, 90112
 s_add_u32 s37, s88, 442368
 buffer_load_dwordx4 v8, s[40:43], s37 offen lds
 s_waitcnt lgkmcnt(6)
 v_mfma_f32_32x32x16_bf16 v[96:111], v[40:43], v[180:183], v[96:111]
 ds_read_b64_tr_b16 v[52:53], v18 offset:30720
 ds_read_b64_tr_b16 v[54:55], v18 offset:31232
 s_add_u32 m0, s35, 98304
 s_add_u32 s37, s89, 442368
 buffer_load_dwordx4 v9, s[56:59], s37 offen lds
 s_waitcnt lgkmcnt(6)
 v_mfma_f32_32x32x16_bf16 v[112:127], v[44:47], v[180:183], v[112:127]
 ds_read_b64_tr_b16 v[56:57], v19 offset:30720
 ds_read_b64_tr_b16 v[58:59], v19 offset:31232
 s_add_u32 m0, s36, 32768
 s_movk_i32 s37, 256
 buffer_load_dwordx4 v2, s[4:7], s37 offen lds
 s_waitcnt lgkmcnt(4)
 v_mfma_f32_32x32x16_bf16 v[64:79], v[48:51], v[184:187], v[64:79]
 ds_read_b64_tr_b16 v[60:61], v20 offset:30720
 ds_read_b64_tr_b16 v[62:63], v20 offset:31232
 s_add_u32 m0, s36, 33792
 s_movk_i32 s37, 256
 buffer_load_dwordx4 v3, s[4:7], s37 offen lds
 s_waitcnt lgkmcnt(4)
 v_mfma_f32_32x32x16_bf16 v[80:95], v[52:55], v[184:187], v[80:95]
 ds_read_b64_tr_b16 v[40:41], v17 offset:32768
 ds_read_b64_tr_b16 v[42:43], v17 offset:33280
 s_waitcnt lgkmcnt(4)
 v_mfma_f32_32x32x16_bf16 v[96:111], v[56:59], v[184:187], v[96:111]
 ds_read_b64_tr_b16 v[44:45], v18 offset:32768
 ds_read_b64_tr_b16 v[46:47], v18 offset:33280
 s_waitcnt lgkmcnt(4)
 v_mfma_f32_32x32x16_bf16 v[112:127], v[60:63], v[184:187], v[112:127]
 ds_read_b64_tr_b16 v[48:49], v19 offset:32768
 ds_read_b64_tr_b16 v[50:51], v19 offset:33280
 s_waitcnt lgkmcnt(4)
 v_mfma_f32_32x32x16_bf16 v[64:79], v[40:43], v[188:191], v[64:79]
 ds_read_b64_tr_b16 v[52:53], v20 offset:32768
 ds_read_b64_tr_b16 v[54:55], v20 offset:33280
 s_waitcnt lgkmcnt(4)
 v_mfma_f32_32x32x16_bf16 v[80:95], v[44:47], v[188:191], v[80:95]
 s_waitcnt vmcnt(9)
 s_barrier
 buffer_load_dword v250, v251, s[76:79], s60 offen
 s_add_u32 s60, s60, s61
 ds_read_b128 v[176:179], v4 offset:16384
 ds_read_b128 v[180:183], v5 offset:16384
 ds_read_b64_tr_b16 v[56:57], v17 offset:53248
 ds_read_b64_tr_b16 v[58:59], v17 offset:53760
 s_add_u32 m0, s35, 0
 s_add_u32 s37, s88, 552960
 buffer_load_dwordx4 v8, s[40:43], s37 offen lds
 s_waitcnt lgkmcnt(6)
 v_mfma_f32_32x32x16_bf16 v[96:111], v[48:51], v[188:191], v[96:111]
 ds_read_b64_tr_b16 v[60:61], v18 offset:53248
 ds_read_b64_tr_b16 v[62:63], v18 offset:53760
 s_add_u32 m0, s35, 8192
 s_add_u32 s37, s89, 552960
 buffer_load_dwordx4 v9, s[56:59], s37 offen lds
 s_waitcnt lgkmcnt(6)
 v_mfma_f32_32x32x16_bf16 v[112:127], v[52:55], v[188:191], v[112:127]
 ds_read_b64_tr_b16 v[40:41], v19 offset:53248
 ds_read_b64_tr_b16 v[42:43], v19 offset:53760
 s_waitcnt lgkmcnt(4)
 v_mfma_f32_32x32x16_bf16 v[64:79], v[56:59], v[176:179], v[64:79]
 ds_read_b64_tr_b16 v[44:45], v20 offset:53248
 ds_read_b64_tr_b16 v[46:47], v20 offset:53760
 s_waitcnt lgkmcnt(4)
 v_mfma_f32_32x32x16_bf16 v[80:95], v[60:63], v[176:179], v[80:95]
 ds_read_b64_tr_b16 v[48:49], v17 offset:55296
 ds_read_b64_tr_b16 v[50:51], v17 offset:55808
 s_waitcnt lgkmcnt(4)
 v_mfma_f32_32x32x16_bf16 v[96:111], v[40:43], v[176:179], v[96:111]
 ds_read_b64_tr_b16 v[52:53], v18 offset:55296
 ds_read_b64_tr_b16 v[54:55], v18 offset:55808
 s_waitcnt lgkmcnt(4)
 v_mfma_f32_32x32x16_bf16 v[112:127], v[44:47], v[176:179], v[112:127]
 ds_read_b64_tr_b16 v[56:57], v19 offset:55296
 ds_read_b64_tr_b16 v[58:59], v19 offset:55808
 s_waitcnt lgkmcnt(4)
 v_mfma_f32_32x32x16_bf16 v[64:79], v[48:51], v[180:183], v[64:79]
 ds_read_b64_tr_b16 v[60:61], v20 offset:55296
 ds_read_b64_tr_b16 v[62:63], v20 offset:55808
 s_waitcnt lgkmcnt(4)
 v_mfma_f32_32x32x16_bf16 v[80:95], v[52:55], v[180:183], v[80:95]
 s_waitcnt vmcnt(7)
 s_barrier
 ds_read_b128 v[184:187], v6 offset:16384
 ds_read_b128 v[188:191], v7 offset:16384
 ds_read_b64_tr_b16 v[40:41], v21 offset:10240
 ds_read_b64_tr_b16 v[42:43], v21 offset:10752
 s_add_u32 m0, s35, 22528
 s_add_u32 s37, s88, 663552
 buffer_load_dwordx4 v8, s[40:43], s37 offen lds
 s_waitcnt lgkmcnt(6)
 v_mfma_f32_32x32x16_bf16 v[96:111], v[56:59], v[180:183], v[96:111]
 ds_read_b64_tr_b16 v[44:45], v22 offset:10240
 ds_read_b64_tr_b16 v[46:47], v22 offset:10752
 s_add_u32 m0, s35, 30720
 s_add_u32 s37, s89, 663552
 buffer_load_dwordx4 v9, s[56:59], s37 offen lds
 s_waitcnt lgkmcnt(6)
 v_mfma_f32_32x32x16_bf16 v[112:127], v[60:63], v[180:183], v[112:127]
 ds_read_b64_tr_b16 v[48:49], v23 offset:10240
 ds_read_b64_tr_b16 v[50:51], v23 offset:10752
 s_add_u32 m0, s36, 0
 s_movk_i32 s37, 384
 buffer_load_dwordx4 v2, s[4:7], s37 offen lds
 s_waitcnt lgkmcnt(4)
 v_mfma_f32_32x32x16_bf16 v[64:79], v[40:43], v[184:187], v[64:79]
 ds_read_b64_tr_b16 v[52:53], v24 offset:10240
 ds_read_b64_tr_b16 v[54:55], v24 offset:10752
 s_add_u32 m0, s36, 1024
 s_movk_i32 s37, 384
 buffer_load_dwordx4 v3, s[4:7], s37 offen lds
 s_waitcnt lgkmcnt(4)
 v_mfma_f32_32x32x16_bf16 v[80:95], v[44:47], v[184:187], v[80:95]
 ds_read_b64_tr_b16 v[56:57], v21 offset:12288
 ds_read_b64_tr_b16 v[58:59], v21 offset:12800
 s_waitcnt lgkmcnt(4)
 v_mfma_f32_32x32x16_bf16 v[96:111], v[48:51], v[184:187], v[96:111]
 ds_read_b64_tr_b16 v[60:61], v22 offset:12288
 ds_read_b64_tr_b16 v[62:63], v22 offset:12800
 s_waitcnt lgkmcnt(4)
 v_mfma_f32_32x32x16_bf16 v[112:127], v[52:55], v[184:187], v[112:127]
 ds_read_b64_tr_b16 v[40:41], v23 offset:12288
 ds_read_b64_tr_b16 v[42:43], v23 offset:12800
 s_waitcnt lgkmcnt(4)
 v_mfma_f32_32x32x16_bf16 v[64:79], v[56:59], v[188:191], v[64:79]
 ds_read_b64_tr_b16 v[44:45], v24 offset:12288
 ds_read_b64_tr_b16 v[46:47], v24 offset:12800
 s_waitcnt lgkmcnt(4)
 v_mfma_f32_32x32x16_bf16 v[80:95], v[60:63], v[188:191], v[80:95]
 s_waitcnt vmcnt(7)
 s_barrier
 buffer_load_dword v250, v251, s[76:79], s60 offen
 s_add_u32 s60, s60, s61
 ds_read_b128 v[176:179], v4 offset:32768
 ds_read_b128 v[180:183], v5 offset:32768
 ds_read_b64_tr_b16 v[48:49], v21 offset:32768
 ds_read_b64_tr_b16 v[50:51], v21 offset:33280
 s_add_u32 m0, s35, 45056
 s_add_u32 s37, s88, 774144
 buffer_load_dwordx4 v8, s[40:43], s37 offen lds
 s_waitcnt lgkmcnt(6)
 v_mfma_f32_32x32x16_bf16 v[96:111], v[40:43], v[188:191], v[96:111]
 ds_read_b64_tr_b16 v[52:53], v22 offset:32768
 ds_read_b64_tr_b16 v[54:55], v22 offset:33280
 s_add_u32 m0, s35, 53248
 s_add_u32 s37, s89, 774144
 buffer_load_dwordx4 v9, s[56:59], s37 offen lds
 s_waitcnt lgkmcnt(6)
 v_mfma_f32_32x32x16_bf16 v[112:127], v[44:47], v[188:191], v[112:127]
 ds_read_b64_tr_b16 v[56:57], v23 offset:32768
 ds_read_b64_tr_b16 v[58:59], v23 offset:33280
 s_waitcnt lgkmcnt(4)
 v_mfma_f32_32x32x16_bf16 v[64:79], v[48:51], v[176:179], v[64:79]
 ds_read_b64_tr_b16 v[60:61], v24 offset:32768
 ds_read_b64_tr_b16 v[62:63], v24 offset:33280
 s_waitcnt lgkmcnt(4)
 v_mfma_f32_32x32x16_bf16 v[80:95], v[52:55], v[176:179], v[80:95]
 ds_read_b64_tr_b16 v[40:41], v21 offset:34816
 ds_read_b64_tr_b16 v[42:43], v21 offset:35328
 s_waitcnt lgkmcnt(4)
 v_mfma_f32_32x32x16_bf16 v[96:111], v[56:59], v[176:179], v[96:111]
 ds_read_b64_tr_b16 v[44:45], v22 offset:34816
 ds_read_b64_tr_b16 v[46:47], v22 offset:35328
 s_waitcnt lgkmcnt(4)
 v_mfma_f32_32x32x16_bf16 v[112:127], v[60:63], v[176:179], v[112:127]
 ds_read_b64_tr_b16 v[48:49], v23 offset:34816
 ds_read_b64_tr_b16 v[50:51], v23 offset:35328
 s_waitcnt lgkmcnt(4)
 v_mfma_f32_32x32x16_bf16 v[64:79], v[40:43], v[180:183], v[64:79]
 ds_read_b64_tr_b16 v[52:53], v24 offset:34816
 ds_read_b64_tr_b16 v[54:55], v24 offset:35328
 s_waitcnt lgkmcnt(4)
 v_mfma_f32_32x32x16_bf16 v[80:95], v[44:47], v[180:183], v[80:95]
 s_waitcnt vmcnt(7)
 s_barrier
 ds_read_b128 v[184:187], v6 offset:32768
 ds_read_b128 v[188:191], v7 offset:32768
 ds_read_b64_tr_b16 v[56:57], v17 offset:8192
 ds_read_b64_tr_b16 v[58:59], v17 offset:8704
 s_add_u32 m0, s35, 67584
 s_add_u32 s37, s88, 884736
 buffer_load_dwordx4 v8, s[40:43], s37 offen lds
 s_waitcnt lgkmcnt(6)
 v_mfma_f32_32x32x16_bf16 v[96:111], v[48:51], v[180:183], v[96:111]
 ds_read_b64_tr_b16 v[60:61], v18 offset:8192
 ds_read_b64_tr_b16 v[62:63], v18 offset:8704
 s_add_u32 m0, s35, 75776
 s_add_u32 s37, s89, 884736
 buffer_load_dwordx4 v9, s[56:59], s37 offen lds
 s_waitcnt lgkmcnt(6)
 v_mfma_f32_32x32x16_bf16 v[112:127], v[52:55], v[180:183], v[112:127]
 ds_read_b64_tr_b16 v[40:41], v19 offset:8192
 ds_read_b64_tr_b16 v[42:43], v19 offset:8704
 s_add_u32 m0, s36, 16384
 s_movk_i32 s37, 512
 buffer_load_dwordx4 v2, s[4:7], s37 offen lds
 s_waitcnt lgkmcnt(4)
 v_mfma_f32_32x32x16_bf16 v[64:79], v[56:59], v[184:187], v[64:79]
 ds_read_b64_tr_b16 v[44:45], v20 offset:8192
 ds_read_b64_tr_b16 v[46:47], v20 offset:8704
 s_add_u32 m0, s36, 17408
 s_movk_i32 s37, 512
 buffer_load_dwordx4 v3, s[4:7], s37 offen lds
 s_waitcnt lgkmcnt(4)
 v_mfma_f32_32x32x16_bf16 v[80:95], v[60:63], v[184:187], v[80:95]
 ds_read_b64_tr_b16 v[48:49], v17 offset:10240
 ds_read_b64_tr_b16 v[50:51], v17 offset:10752
 s_waitcnt lgkmcnt(4)
 v_mfma_f32_32x32x16_bf16 v[96:111], v[40:43], v[184:187], v[96:111]
 ds_read_b64_tr_b16 v[52:53], v18 offset:10240
 ds_read_b64_tr_b16 v[54:55], v18 offset:10752
 s_waitcnt lgkmcnt(4)
 v_mfma_f32_32x32x16_bf16 v[112:127], v[44:47], v[184:187], v[112:127]
 ds_read_b64_tr_b16 v[56:57], v19 offset:10240
 ds_read_b64_tr_b16 v[58:59], v19 offset:10752
 s_waitcnt lgkmcnt(4)
 v_mfma_f32_32x32x16_bf16 v[64:79], v[48:51], v[188:191], v[64:79]
 ds_read_b64_tr_b16 v[60:61], v20 offset:10240
 ds_read_b64_tr_b16 v[62:63], v20 offset:10752
 s_waitcnt lgkmcnt(4)
 v_mfma_f32_32x32x16_bf16 v[80:95], v[52:55], v[188:191], v[80:95]
 s_waitcnt vmcnt(7)
 s_barrier
 buffer_load_dword v250, v251, s[76:79], s60 offen
 s_add_u32 s60, s60, s61
 ds_read_b128 v[176:179], v4 offset:0
 ds_read_b128 v[180:183], v5 offset:0
 ds_read_b64_tr_b16 v[40:41], v17 offset:30720
 ds_read_b64_tr_b16 v[42:43], v17 offset:31232
 s_add_u32 m0, s35, 90112
 s_add_u32 s37, s88, 995328
 buffer_load_dwordx4 v8, s[40:43], s37 offen lds
 s_waitcnt lgkmcnt(6)
 v_mfma_f32_32x32x16_bf16 v[96:111], v[56:59], v[188:191], v[96:111]
 ds_read_b64_tr_b16 v[44:45], v18 offset:30720
 ds_read_b64_tr_b16 v[46:47], v18 offset:31232
 s_add_u32 m0, s35, 98304
 s_add_u32 s37, s89, 995328
 buffer_load_dwordx4 v9, s[56:59], s37 offen lds
 s_waitcnt lgkmcnt(6)
 v_mfma_f32_32x32x16_bf16 v[112:127], v[60:63], v[188:191], v[112:127]
 ds_read_b64_tr_b16 v[48:49], v19 offset:30720
 ds_read_b64_tr_b16 v[50:51], v19 offset:31232
 s_waitcnt lgkmcnt(4)
 v_mfma_f32_32x32x16_bf16 v[64:79], v[40:43], v[176:179], v[64:79]
 ds_read_b64_tr_b16 v[52:53], v20 offset:30720
 ds_read_b64_tr_b16 v[54:55], v20 offset:31232
 s_waitcnt lgkmcnt(4)
 v_mfma_f32_32x32x16_bf16 v[80:95], v[44:47], v[176:179], v[80:95]
 ds_read_b64_tr_b16 v[56:57], v17 offset:32768
 ds_read_b64_tr_b16 v[58:59], v17 offset:33280
 s_waitcnt lgkmcnt(4)
 v_mfma_f32_32x32x16_bf16 v[96:111], v[48:51], v[176:179], v[96:111]
 ds_read_b64_tr_b16 v[60:61], v18 offset:32768
 ds_read_b64_tr_b16 v[62:63], v18 offset:33280
 s_waitcnt lgkmcnt(4)
 v_mfma_f32_32x32x16_bf16 v[112:127], v[52:55], v[176:179], v[112:127]
 ds_read_b64_tr_b16 v[40:41], v19 offset:32768
 ds_read_b64_tr_b16 v[42:43], v19 offset:33280
 s_waitcnt lgkmcnt(4)
 v_mfma_f32_32x32x16_bf16 v[64:79], v[56:59], v[180:183], v[64:79]
 ds_read_b64_tr_b16 v[44:45], v20 offset:32768
 ds_read_b64_tr_b16 v[46:47], v20 offset:33280
 s_waitcnt lgkmcnt(4)
 v_mfma_f32_32x32x16_bf16 v[80:95], v[60:63], v[180:183], v[80:95]
 s_waitcnt vmcnt(7)
 s_barrier
 ds_read_b128 v[184:187], v6 offset:0
 ds_read_b128 v[188:191], v7 offset:0
 ds_read_b64_tr_b16 v[48:49], v17 offset:53248
 ds_read_b64_tr_b16 v[50:51], v17 offset:53760
 s_add_u32 m0, s35, 0
 s_add_u32 s37, s88, 1105920
 buffer_load_dwordx4 v8, s[40:43], s37 offen lds
 s_waitcnt lgkmcnt(6)
 v_mfma_f32_32x32x16_bf16 v[96:111], v[40:43], v[180:183], v[96:111]
 ds_read_b64_tr_b16 v[52:53], v18 offset:53248
 ds_read_b64_tr_b16 v[54:55], v18 offset:53760
 s_add_u32 m0, s35, 8192
 s_add_u32 s37, s89, 1105920
 buffer_load_dwordx4 v9, s[56:59], s37 offen lds
 s_waitcnt lgkmcnt(6)
 v_mfma_f32_32x32x16_bf16 v[112:127], v[44:47], v[180:183], v[112:127]
 ds_read_b64_tr_b16 v[56:57], v19 offset:53248
 ds_read_b64_tr_b16 v[58:59], v19 offset:53760
 s_add_u32 m0, s36, 32768
 s_movk_i32 s37, 640
 buffer_load_dwordx4 v2, s[4:7], s37 offen lds
 s_waitcnt lgkmcnt(4)
 v_mfma_f32_32x32x16_bf16 v[64:79], v[48:51], v[184:187], v[64:79]
 ds_read_b64_tr_b16 v[60:61], v20 offset:53248
 ds_read_b64_tr_b16 v[62:63], v20 offset:53760
 s_add_u32 m0, s36, 33792
 s_movk_i32 s37, 640
 buffer_load_dwordx4 v3, s[4:7], s37 offen lds
 s_waitcnt lgkmcnt(4)
 v_mfma_f32_32x32x16_bf16 v[80:95], v[52:55], v[184:187], v[80:95]
 ds_read_b64_tr_b16 v[40:41], v17 offset:55296
 ds_read_b64_tr_b16 v[42:43], v17 offset:55808
 s_waitcnt lgkmcnt(4)
 v_mfma_f32_32x32x16_bf16 v[96:111], v[56:59], v[184:187], v[96:111]
 ds_read_b64_tr_b16 v[44:45], v18 offset:55296
 ds_read_b64_tr_b16 v[46:47], v18 offset:55808
 s_waitcnt lgkmcnt(4)
 v_mfma_f32_32x32x16_bf16 v[112:127], v[60:63], v[184:187], v[112:127]
 ds_read_b64_tr_b16 v[48:49], v19 offset:55296
 ds_read_b64_tr_b16 v[50:51], v19 offset:55808
 s_waitcnt lgkmcnt(4)
 v_mfma_f32_32x32x16_bf16 v[64:79], v[40:43], v[188:191], v[64:79]
 ds_read_b64_tr_b16 v[52:53], v20 offset:55296
 ds_read_b64_tr_b16 v[54:55], v20 offset:55808
 s_waitcnt lgkmcnt(4)
 v_mfma_f32_32x32x16_bf16 v[80:95], v[44:47], v[188:191], v[80:95]
 s_waitcnt vmcnt(7)
 s_barrier
 buffer_load_dword v250, v251, s[76:79], s60 offen
 s_add_u32 s60, s60, s61
 ds_read_b128 v[176:179], v4 offset:16384
 ds_read_b128 v[180:183], v5 offset:16384
 ds_read_b64_tr_b16 v[56:57], v21 offset:10240
 ds_read_b64_tr_b16 v[58:59], v21 offset:10752
 s_add_u32 m0, s35, 22528
 s_add_u32 s37, s88, 1216512
 buffer_load_dwordx4 v8, s[40:43], s37 offen lds
 s_waitcnt lgkmcnt(6)
 v_mfma_f32_32x32x16_bf16 v[96:111], v[48:51], v[188:191], v[96:111]
 ds_read_b64_tr_b16 v[60:61], v22 offset:10240
 ds_read_b64_tr_b16 v[62:63], v22 offset:10752
 s_add_u32 m0, s35, 30720
 s_add_u32 s37, s89, 1216512
 buffer_load_dwordx4 v9, s[56:59], s37 offen lds
 s_waitcnt lgkmcnt(6)
 v_mfma_f32_32x32x16_bf16 v[112:127], v[52:55], v[188:191], v[112:127]
 ds_read_b64_tr_b16 v[40:41], v23 offset:10240
 ds_read_b64_tr_b16 v[42:43], v23 offset:10752
 s_waitcnt lgkmcnt(4)
 v_mfma_f32_32x32x16_bf16 v[64:79], v[56:59], v[176:179], v[64:79]
 ds_read_b64_tr_b16 v[44:45], v24 offset:10240
 ds_read_b64_tr_b16 v[46:47], v24 offset:10752
 s_waitcnt lgkmcnt(4)
 v_mfma_f32_32x32x16_bf16 v[80:95], v[60:63], v[176:179], v[80:95]
 ds_read_b64_tr_b16 v[48:49], v21 offset:12288
 ds_read_b64_tr_b16 v[50:51], v21 offset:12800
 s_waitcnt lgkmcnt(4)
 v_mfma_f32_32x32x16_bf16 v[96:111], v[40:43], v[176:179], v[96:111]
 ds_read_b64_tr_b16 v[52:53], v22 offset:12288
 ds_read_b64_tr_b16 v[54:55], v22 offset:12800
 s_waitcnt lgkmcnt(4)
 v_mfma_f32_32x32x16_bf16 v[112:127], v[44:47], v[176:179], v[112:127]
 ds_read_b64_tr_b16 v[56:57], v23 offset:12288
 ds_read_b64_tr_b16 v[58:59], v23 offset:12800
 s_waitcnt lgkmcnt(4)
 v_mfma_f32_32x32x16_bf16 v[64:79], v[48:51], v[180:183], v[64:79]
 ds_read_b64_tr_b16 v[60:61], v24 offset:12288
 ds_read_b64_tr_b16 v[62:63], v24 offset:12800
 s_waitcnt lgkmcnt(4)
 v_mfma_f32_32x32x16_bf16 v[80:95], v[52:55], v[180:183], v[80:95]
 s_waitcnt vmcnt(7)
 s_barrier
 ds_read_b128 v[184:187], v6 offset:16384
 ds_read_b128 v[188:191], v7 offset:16384
 ds_read_b64_tr_b16 v[40:41], v21 offset:32768
 ds_read_b64_tr_b16 v[42:43], v21 offset:33280
 s_add_u32 m0, s35, 45056
 s_add_u32 s37, s88, 1327104
 buffer_load_dwordx4 v8, s[40:43], s37 offen lds
 s_waitcnt lgkmcnt(6)
 v_mfma_f32_32x32x16_bf16 v[96:111], v[56:59], v[180:183], v[96:111]
 ds_read_b64_tr_b16 v[44:45], v22 offset:32768
 ds_read_b64_tr_b16 v[46:47], v22 offset:33280
 s_add_u32 m0, s35, 53248
 s_add_u32 s37, s89, 1327104
 buffer_load_dwordx4 v9, s[56:59], s37 offen lds
 s_waitcnt lgkmcnt(6)
 v_mfma_f32_32x32x16_bf16 v[112:127], v[60:63], v[180:183], v[112:127]
 ds_read_b64_tr_b16 v[48:49], v23 offset:32768
 ds_read_b64_tr_b16 v[50:51], v23 offset:33280
 s_add_u32 m0, s36, 0
 s_movk_i32 s37, 768
 buffer_load_dwordx4 v2, s[4:7], s37 offen lds
 s_waitcnt lgkmcnt(4)
 v_mfma_f32_32x32x16_bf16 v[64:79], v[40:43], v[184:187], v[64:79]
 ds_read_b64_tr_b16 v[52:53], v24 offset:32768
 ds_read_b64_tr_b16 v[54:55], v24 offset:33280
 s_add_u32 m0, s36, 1024
 s_movk_i32 s37, 768
 buffer_load_dwordx4 v3, s[4:7], s37 offen lds
 s_waitcnt lgkmcnt(4)
 v_mfma_f32_32x32x16_bf16 v[80:95], v[44:47], v[184:187], v[80:95]
 ds_read_b64_tr_b16 v[56:57], v21 offset:34816
 ds_read_b64_tr_b16 v[58:59], v21 offset:35328
 s_waitcnt lgkmcnt(4)
 v_mfma_f32_32x32x16_bf16 v[96:111], v[48:51], v[184:187], v[96:111]
 ds_read_b64_tr_b16 v[60:61], v22 offset:34816
 ds_read_b64_tr_b16 v[62:63], v22 offset:35328
 s_waitcnt lgkmcnt(4)
 v_mfma_f32_32x32x16_bf16 v[112:127], v[52:55], v[184:187], v[112:127]
 ds_read_b64_tr_b16 v[40:41], v23 offset:34816
 ds_read_b64_tr_b16 v[42:43], v23 offset:35328
 s_waitcnt lgkmcnt(4)
 v_mfma_f32_32x32x16_bf16 v[64:79], v[56:59], v[188:191], v[64:79]
 ds_read_b64_tr_b16 v[44:45], v24 offset:34816
 ds_read_b64_tr_b16 v[46:47], v24 offset:35328
 s_waitcnt lgkmcnt(4)
 v_mfma_f32_32x32x16_bf16 v[80:95], v[60:63], v[188:191], v[80:95]
 s_waitcnt vmcnt(7)
 s_barrier
 buffer_load_dword v250, v251, s[76:79], s60 offen
 s_add_u32 s60, s60, s61
 ds_read_b128 v[176:179], v4 offset:32768
 ds_read_b128 v[180:183], v5 offset:32768
 ds_read_b64_tr_b16 v[48:49], v17 offset:8192
 ds_read_b64_tr_b16 v[50:51], v17 offset:8704
 s_add_u32 m0, s35, 67584
 s_add_u32 s37, s88, 1437696
 buffer_load_dwordx4 v8, s[40:43], s37 offen lds
 s_waitcnt lgkmcnt(6)
 v_mfma_f32_32x32x16_bf16 v[96:111], v[40:43], v[188:191], v[96:111]
 ds_read_b64_tr_b16 v[52:53], v18 offset:8192
 ds_read_b64_tr_b16 v[54:55], v18 offset:8704
 s_add_u32 m0, s35, 75776
 s_add_u32 s37, s89, 1437696
 buffer_load_dwordx4 v9, s[56:59], s37 offen lds
 s_waitcnt lgkmcnt(6)
 v_mfma_f32_32x32x16_bf16 v[112:127], v[44:47], v[188:191], v[112:127]
 ds_read_b64_tr_b16 v[56:57], v19 offset:8192
 ds_read_b64_tr_b16 v[58:59], v19 offset:8704
 s_waitcnt lgkmcnt(4)
 v_mfma_f32_32x32x16_bf16 v[64:79], v[48:51], v[176:179], v[64:79]
 ds_read_b64_tr_b16 v[60:61], v20 offset:8192
 ds_read_b64_tr_b16 v[62:63], v20 offset:8704
 s_waitcnt lgkmcnt(4)
 v_mfma_f32_32x32x16_bf16 v[80:95], v[52:55], v[176:179], v[80:95]
 ds_read_b64_tr_b16 v[40:41], v17 offset:10240
 ds_read_b64_tr_b16 v[42:43], v17 offset:10752
 s_waitcnt lgkmcnt(4)
 v_mfma_f32_32x32x16_bf16 v[96:111], v[56:59], v[176:179], v[96:111]
 ds_read_b64_tr_b16 v[44:45], v18 offset:10240
 ds_read_b64_tr_b16 v[46:47], v18 offset:10752
 s_waitcnt lgkmcnt(4)
 v_mfma_f32_32x32x16_bf16 v[112:127], v[60:63], v[176:179], v[112:127]
 ds_read_b64_tr_b16 v[48:49], v19 offset:10240
 ds_read_b64_tr_b16 v[50:51], v19 offset:10752
 s_waitcnt lgkmcnt(4)
 v_mfma_f32_32x32x16_bf16 v[64:79], v[40:43], v[180:183], v[64:79]
 ds_read_b64_tr_b16 v[52:53], v20 offset:10240
 ds_read_b64_tr_b16 v[54:55], v20 offset:10752
 s_waitcnt lgkmcnt(4)
 v_mfma_f32_32x32x16_bf16 v[80:95], v[44:47], v[180:183], v[80:95]
 s_waitcnt vmcnt(7)
 s_barrier
 ds_read_b128 v[184:187], v6 offset:32768
 ds_read_b128 v[188:191], v7 offset:32768
 ds_read_b64_tr_b16 v[56:57], v17 offset:30720
 ds_read_b64_tr_b16 v[58:59], v17 offset:31232
 s_add_u32 m0, s35, 90112
 s_add_u32 s37, s88, 1548288
 buffer_load_dwordx4 v8, s[40:43], s37 offen lds
 s_waitcnt lgkmcnt(6)
 v_mfma_f32_32x32x16_bf16 v[96:111], v[48:51], v[180:183], v[96:111]
 ds_read_b64_tr_b16 v[60:61], v18 offset:30720
 ds_read_b64_tr_b16 v[62:63], v18 offset:31232
 s_add_u32 m0, s35, 98304
 s_add_u32 s37, s89, 1548288
 buffer_load_dwordx4 v9, s[56:59], s37 offen lds
 s_waitcnt lgkmcnt(6)
 v_mfma_f32_32x32x16_bf16 v[112:127], v[52:55], v[180:183], v[112:127]
 ds_read_b64_tr_b16 v[40:41], v19 offset:30720
 ds_read_b64_tr_b16 v[42:43], v19 offset:31232
 s_add_u32 m0, s36, 16384
 s_movk_i32 s37, 896
 buffer_load_dwordx4 v2, s[4:7], s37 offen lds
 s_waitcnt lgkmcnt(4)
 v_mfma_f32_32x32x16_bf16 v[64:79], v[56:59], v[184:187], v[64:79]
 ds_read_b64_tr_b16 v[44:45], v20 offset:30720
 ds_read_b64_tr_b16 v[46:47], v20 offset:31232
 s_add_u32 m0, s36, 17408
 s_movk_i32 s37, 896
 buffer_load_dwordx4 v3, s[4:7], s37 offen lds
 s_waitcnt lgkmcnt(4)
 v_mfma_f32_32x32x16_bf16 v[80:95], v[60:63], v[184:187], v[80:95]
 ds_read_b64_tr_b16 v[48:49], v17 offset:32768
 ds_read_b64_tr_b16 v[50:51], v17 offset:33280
 s_waitcnt lgkmcnt(4)
 v_mfma_f32_32x32x16_bf16 v[96:111], v[40:43], v[184:187], v[96:111]
 ds_read_b64_tr_b16 v[52:53], v18 offset:32768
 ds_read_b64_tr_b16 v[54:55], v18 offset:33280
 s_waitcnt lgkmcnt(4)
 v_mfma_f32_32x32x16_bf16 v[112:127], v[44:47], v[184:187], v[112:127]
 ds_read_b64_tr_b16 v[56:57], v19 offset:32768
 ds_read_b64_tr_b16 v[58:59], v19 offset:33280
 s_waitcnt lgkmcnt(4)
 v_mfma_f32_32x32x16_bf16 v[64:79], v[48:51], v[188:191], v[64:79]
 ds_read_b64_tr_b16 v[60:61], v20 offset:32768
 ds_read_b64_tr_b16 v[62:63], v20 offset:33280
 s_waitcnt lgkmcnt(4)
 v_mfma_f32_32x32x16_bf16 v[80:95], v[52:55], v[188:191], v[80:95]
 s_waitcnt vmcnt(7)
 s_barrier
 buffer_load_dword v250, v251, s[76:79], s60 offen
 s_add_u32 s60, s60, s61
 ds_read_b128 v[176:179], v4 offset:0
 ds_read_b128 v[180:183], v5 offset:0
 ds_read_b64_tr_b16 v[40:41], v17 offset:53248
 ds_read_b64_tr_b16 v[42:43], v17 offset:53760
 s_add_u32 m0, s35, 0
 s_add_u32 s37, s88, 1658880
 buffer_load_dwordx4 v8, s[40:43], s37 offen lds
 s_waitcnt lgkmcnt(6)
 v_mfma_f32_32x32x16_bf16 v[96:111], v[56:59], v[188:191], v[96:111]
 ds_read_b64_tr_b16 v[44:45], v18 offset:53248
 ds_read_b64_tr_b16 v[46:47], v18 offset:53760
 s_add_u32 m0, s35, 8192
 s_add_u32 s37, s89, 1658880
 buffer_load_dwordx4 v9, s[56:59], s37 offen lds
 s_waitcnt lgkmcnt(6)
 v_mfma_f32_32x32x16_bf16 v[112:127], v[60:63], v[188:191], v[112:127]
 ds_read_b64_tr_b16 v[48:49], v19 offset:53248
 ds_read_b64_tr_b16 v[50:51], v19 offset:53760
 s_waitcnt lgkmcnt(4)
 v_mfma_f32_32x32x16_bf16 v[64:79], v[40:43], v[176:179], v[64:79]
 ds_read_b64_tr_b16 v[52:53], v20 offset:53248
 ds_read_b64_tr_b16 v[54:55], v20 offset:53760
 s_waitcnt lgkmcnt(4)
 v_mfma_f32_32x32x16_bf16 v[80:95], v[44:47], v[176:179], v[80:95]
 ds_read_b64_tr_b16 v[56:57], v17 offset:55296
 ds_read_b64_tr_b16 v[58:59], v17 offset:55808
 s_waitcnt lgkmcnt(4)
 v_mfma_f32_32x32x16_bf16 v[96:111], v[48:51], v[176:179], v[96:111]
 ds_read_b64_tr_b16 v[60:61], v18 offset:55296
 ds_read_b64_tr_b16 v[62:63], v18 offset:55808
 s_waitcnt lgkmcnt(4)
 v_mfma_f32_32x32x16_bf16 v[112:127], v[52:55], v[176:179], v[112:127]
 ds_read_b64_tr_b16 v[40:41], v19 offset:55296
 ds_read_b64_tr_b16 v[42:43], v19 offset:55808
 s_waitcnt lgkmcnt(4)
 v_mfma_f32_32x32x16_bf16 v[64:79], v[56:59], v[180:183], v[64:79]
 ds_read_b64_tr_b16 v[44:45], v20 offset:55296
 ds_read_b64_tr_b16 v[46:47], v20 offset:55808
 s_waitcnt lgkmcnt(4)
 v_mfma_f32_32x32x16_bf16 v[80:95], v[60:63], v[180:183], v[80:95]
 s_waitcnt vmcnt(7)
 s_barrier
 ds_read_b128 v[184:187], v6 offset:0
 ds_read_b128 v[188:191], v7 offset:0
 ds_read_b64_tr_b16 v[48:49], v21 offset:10240
 ds_read_b64_tr_b16 v[50:51], v21 offset:10752
 s_add_u32 m0, s35, 22528
 s_add_u32 s37, s88, 1769472
 buffer_load_dwordx4 v8, s[40:43], s37 offen lds
 s_waitcnt lgkmcnt(6)
 v_mfma_f32_32x32x16_bf16 v[96:111], v[40:43], v[180:183], v[96:111]
 ds_read_b64_tr_b16 v[52:53], v22 offset:10240
 ds_read_b64_tr_b16 v[54:55], v22 offset:10752
 s_add_u32 m0, s35, 30720
 s_add_u32 s37, s89, 1769472
 buffer_load_dwordx4 v9, s[56:59], s37 offen lds
 s_waitcnt lgkmcnt(6)
 v_mfma_f32_32x32x16_bf16 v[112:127], v[44:47], v[180:183], v[112:127]
 ds_read_b64_tr_b16 v[56:57], v23 offset:10240
 ds_read_b64_tr_b16 v[58:59], v23 offset:10752
 s_add_u32 m0, s36, 32768
 s_movk_i32 s37, 1024
 buffer_load_dwordx4 v2, s[4:7], s37 offen lds
 s_waitcnt lgkmcnt(4)
 v_mfma_f32_32x32x16_bf16 v[64:79], v[48:51], v[184:187], v[64:79]
 ds_read_b64_tr_b16 v[60:61], v24 offset:10240
 ds_read_b64_tr_b16 v[62:63], v24 offset:10752
 s_add_u32 m0, s36, 33792
 s_movk_i32 s37, 1024
 buffer_load_dwordx4 v3, s[4:7], s37 offen lds
 s_waitcnt lgkmcnt(4)
 v_mfma_f32_32x32x16_bf16 v[80:95], v[52:55], v[184:187], v[80:95]
 ds_read_b64_tr_b16 v[40:41], v21 offset:12288
 ds_read_b64_tr_b16 v[42:43], v21 offset:12800
 s_waitcnt lgkmcnt(4)
 v_mfma_f32_32x32x16_bf16 v[96:111], v[56:59], v[184:187], v[96:111]
 ds_read_b64_tr_b16 v[44:45], v22 offset:12288
 ds_read_b64_tr_b16 v[46:47], v22 offset:12800
 s_waitcnt lgkmcnt(4)
 v_mfma_f32_32x32x16_bf16 v[112:127], v[60:63], v[184:187], v[112:127]
 ds_read_b64_tr_b16 v[48:49], v23 offset:12288
 ds_read_b64_tr_b16 v[50:51], v23 offset:12800
 s_waitcnt lgkmcnt(4)
 v_mfma_f32_32x32x16_bf16 v[64:79], v[40:43], v[188:191], v[64:79]
 ds_read_b64_tr_b16 v[52:53], v24 offset:12288
 ds_read_b64_tr_b16 v[54:55], v24 offset:12800
 s_waitcnt lgkmcnt(4)
 v_mfma_f32_32x32x16_bf16 v[80:95], v[44:47], v[188:191], v[80:95]
 s_waitcnt vmcnt(7)
 s_barrier
 ds_read_b128 v[176:179], v4 offset:16384
 ds_read_b128 v[180:183], v5 offset:16384
 ds_read_b64_tr_b16 v[56:57], v21 offset:32768
 ds_read_b64_tr_b16 v[58:59], v21 offset:33280
 s_add_u32 m0, s35, 45056
 s_add_u32 s37, s88, 1880064
 buffer_load_dwordx4 v8, s[40:43], s37 offen lds
 s_waitcnt lgkmcnt(6)
 v_mfma_f32_32x32x16_bf16 v[96:111], v[48:51], v[188:191], v[96:111]
 ds_read_b64_tr_b16 v[60:61], v22 offset:32768
 ds_read_b64_tr_b16 v[62:63], v22 offset:33280
 s_add_u32 m0, s35, 53248
 s_add_u32 s37, s89, 1880064
 buffer_load_dwordx4 v9, s[56:59], s37 offen lds
 s_waitcnt lgkmcnt(6)
 v_mfma_f32_32x32x16_bf16 v[112:127], v[52:55], v[188:191], v[112:127]
 ds_read_b64_tr_b16 v[40:41], v23 offset:32768
 ds_read_b64_tr_b16 v[42:43], v23 offset:33280
 s_waitcnt lgkmcnt(4)
 v_mfma_f32_32x32x16_bf16 v[64:79], v[56:59], v[176:179], v[64:79]
 ds_read_b64_tr_b16 v[44:45], v24 offset:32768
 ds_read_b64_tr_b16 v[46:47], v24 offset:33280
 s_waitcnt lgkmcnt(4)
 v_mfma_f32_32x32x16_bf16 v[80:95], v[60:63], v[176:179], v[80:95]
 ds_read_b64_tr_b16 v[48:49], v21 offset:34816
 ds_read_b64_tr_b16 v[50:51], v21 offset:35328
 s_waitcnt lgkmcnt(4)
 v_mfma_f32_32x32x16_bf16 v[96:111], v[40:43], v[176:179], v[96:111]
 ds_read_b64_tr_b16 v[52:53], v22 offset:34816
 ds_read_b64_tr_b16 v[54:55], v22 offset:35328
 s_waitcnt lgkmcnt(4)
 v_mfma_f32_32x32x16_bf16 v[112:127], v[44:47], v[176:179], v[112:127]
 ds_read_b64_tr_b16 v[56:57], v23 offset:34816
 ds_read_b64_tr_b16 v[58:59], v23 offset:35328
 s_waitcnt lgkmcnt(4)
 v_mfma_f32_32x32x16_bf16 v[64:79], v[48:51], v[180:183], v[64:79]
 ds_read_b64_tr_b16 v[60:61], v24 offset:34816
 ds_read_b64_tr_b16 v[62:63], v24 offset:35328
 s_waitcnt lgkmcnt(4)
 v_mfma_f32_32x32x16_bf16 v[80:95], v[52:55], v[180:183], v[80:95]
 s_waitcnt vmcnt(6)
 s_barrier
 ds_read_b128 v[184:187], v6 offset:16384
 ds_read_b128 v[188:191], v7 offset:16384
 ds_read_b64_tr_b16 v[40:41], v17 offset:8192
 ds_read_b64_tr_b16 v[42:43], v17 offset:8704
 s_add_u32 m0, s35, 67584
 s_add_u32 s37, s88, 1990656
 buffer_load_dwordx4 v8, s[40:43], s37 offen lds
 s_waitcnt lgkmcnt(6)
 v_mfma_f32_32x32x16_bf16 v[96:111], v[56:59], v[180:183], v[96:111]
 ds_read_b64_tr_b16 v[44:45], v18 offset:8192
 ds_read_b64_tr_b16 v[46:47], v18 offset:8704
 s_add_u32 m0, s35, 75776
 s_add_u32 s37, s89, 1990656
 buffer_load_dwordx4 v9, s[56:59], s37 offen lds
 s_waitcnt lgkmcnt(6)
 v_mfma_f32_32x32x16_bf16 v[112:127], v[60:63], v[180:183], v[112:127]
 ds_read_b64_tr_b16 v[48:49], v19 offset:8192
 ds_read_b64_tr_b16 v[50:51], v19 offset:8704
 s_add_u32 m0, s36, 0
 s_movk_i32 s37, 1152
 buffer_load_dwordx4 v2, s[4:7], s37 offen lds
 s_waitcnt lgkmcnt(4)
 v_mfma_f32_32x32x16_bf16 v[64:79], v[40:43], v[184:187], v[64:79]
 ds_read_b64_tr_b16 v[52:53], v20 offset:8192
 ds_read_b64_tr_b16 v[54:55], v20 offset:8704
 s_add_u32 m0, s36, 1024
 s_movk_i32 s37, 1152
 buffer_load_dwordx4 v3, s[4:7], s37 offen lds
 s_waitcnt lgkmcnt(4)
 v_mfma_f32_32x32x16_bf16 v[80:95], v[44:47], v[184:187], v[80:95]
 ds_read_b64_tr_b16 v[56:57], v17 offset:10240
 ds_read_b64_tr_b16 v[58:59], v17 offset:10752
 s_waitcnt lgkmcnt(4)
 v_mfma_f32_32x32x16_bf16 v[96:111], v[48:51], v[184:187], v[96:111]
 ds_read_b64_tr_b16 v[60:61], v18 offset:10240
 ds_read_b64_tr_b16 v[62:63], v18 offset:10752
 s_waitcnt lgkmcnt(4)
 v_mfma_f32_32x32x16_bf16 v[112:127], v[52:55], v[184:187], v[112:127]
 ds_read_b64_tr_b16 v[40:41], v19 offset:10240
 ds_read_b64_tr_b16 v[42:43], v19 offset:10752
 s_waitcnt lgkmcnt(4)
 v_mfma_f32_32x32x16_bf16 v[64:79], v[56:59], v[188:191], v[64:79]
 ds_read_b64_tr_b16 v[44:45], v20 offset:10240
 ds_read_b64_tr_b16 v[46:47], v20 offset:10752
 s_waitcnt lgkmcnt(4)
 v_mfma_f32_32x32x16_bf16 v[80:95], v[60:63], v[188:191], v[80:95]
 s_waitcnt vmcnt(6)
 s_barrier
 ds_read_b128 v[176:179], v4 offset:32768
 ds_read_b128 v[180:183], v5 offset:32768
 ds_read_b64_tr_b16 v[48:49], v17 offset:30720
 ds_read_b64_tr_b16 v[50:51], v17 offset:31232
 s_add_u32 m0, s35, 90112
 s_add_u32 s37, s88, 2101248
 buffer_load_dwordx4 v8, s[40:43], s37 offen lds
 s_waitcnt lgkmcnt(6)
 v_mfma_f32_32x32x16_bf16 v[96:111], v[40:43], v[188:191], v[96:111]
 ds_read_b64_tr_b16 v[52:53], v18 offset:30720
 ds_read_b64_tr_b16 v[54:55], v18 offset:31232
 s_add_u32 m0, s35, 98304
 s_add_u32 s37, s89, 2101248
 buffer_load_dwordx4 v9, s[56:59], s37 offen lds
 s_waitcnt lgkmcnt(6)
 v_mfma_f32_32x32x16_bf16 v[112:127], v[44:47], v[188:191], v[112:127]
 ds_read_b64_tr_b16 v[56:57], v19 offset:30720
 ds_read_b64_tr_b16 v[58:59], v19 offset:31232
 s_waitcnt lgkmcnt(4)
 v_mfma_f32_32x32x16_bf16 v[64:79], v[48:51], v[176:179], v[64:79]
 ds_read_b64_tr_b16 v[60:61], v20 offset:30720
 ds_read_b64_tr_b16 v[62:63], v20 offset:31232
 s_waitcnt lgkmcnt(4)
 v_mfma_f32_32x32x16_bf16 v[80:95], v[52:55], v[176:179], v[80:95]
 ds_read_b64_tr_b16 v[40:41], v17 offset:32768
 ds_read_b64_tr_b16 v[42:43], v17 offset:33280
 s_waitcnt lgkmcnt(4)
 v_mfma_f32_32x32x16_bf16 v[96:111], v[56:59], v[176:179], v[96:111]
 ds_read_b64_tr_b16 v[44:45], v18 offset:32768
 ds_read_b64_tr_b16 v[46:47], v18 offset:33280
 s_waitcnt lgkmcnt(4)
 v_mfma_f32_32x32x16_bf16 v[112:127], v[60:63], v[176:179], v[112:127]
 ds_read_b64_tr_b16 v[48:49], v19 offset:32768
 ds_read_b64_tr_b16 v[50:51], v19 offset:33280
 s_waitcnt lgkmcnt(4)
 v_mfma_f32_32x32x16_bf16 v[64:79], v[40:43], v[180:183], v[64:79]
 ds_read_b64_tr_b16 v[52:53], v20 offset:32768
 ds_read_b64_tr_b16 v[54:55], v20 offset:33280
 s_waitcnt lgkmcnt(4)
 v_mfma_f32_32x32x16_bf16 v[80:95], v[44:47], v[180:183], v[80:95]
 s_waitcnt vmcnt(6)
 s_barrier
 ds_read_b128 v[184:187], v6 offset:32768
 ds_read_b128 v[188:191], v7 offset:32768
 ds_read_b64_tr_b16 v[56:57], v17 offset:53248
 ds_read_b64_tr_b16 v[58:59], v17 offset:53760
 s_waitcnt lgkmcnt(6)
 v_mfma_f32_32x32x16_bf16 v[96:111], v[48:51], v[180:183], v[96:111]
 ds_read_b64_tr_b16 v[60:61], v18 offset:53248
 ds_read_b64_tr_b16 v[62:63], v18 offset:53760
 s_waitcnt lgkmcnt(6)
 v_mfma_f32_32x32x16_bf16 v[112:127], v[52:55], v[180:183], v[112:127]
 ds_read_b64_tr_b16 v[40:41], v19 offset:53248
 ds_read_b64_tr_b16 v[42:43], v19 offset:53760
 s_waitcnt lgkmcnt(4)
 v_mfma_f32_32x32x16_bf16 v[64:79], v[56:59], v[184:187], v[64:79]
 ds_read_b64_tr_b16 v[44:45], v20 offset:53248
 ds_read_b64_tr_b16 v[46:47], v20 offset:53760
 s_waitcnt lgkmcnt(4)
 v_mfma_f32_32x32x16_bf16 v[80:95], v[60:63], v[184:187], v[80:95]
 ds_read_b64_tr_b16 v[48:49], v17 offset:55296
 ds_read_b64_tr_b16 v[50:51], v17 offset:55808
 s_waitcnt lgkmcnt(4)
 v_mfma_f32_32x32x16_bf16 v[96:111], v[40:43], v[184:187], v[96:111]
 ds_read_b64_tr_b16 v[52:53], v18 offset:55296
 ds_read_b64_tr_b16 v[54:55], v18 offset:55808
 s_waitcnt lgkmcnt(4)
 v_mfma_f32_32x32x16_bf16 v[112:127], v[44:47], v[184:187], v[112:127]
 ds_read_b64_tr_b16 v[56:57], v19 offset:55296
 ds_read_b64_tr_b16 v[58:59], v19 offset:55808
 s_waitcnt lgkmcnt(4)
 v_mfma_f32_32x32x16_bf16 v[64:79], v[48:51], v[188:191], v[64:79]
 ds_read_b64_tr_b16 v[60:61], v20 offset:55296
 ds_read_b64_tr_b16 v[62:63], v20 offset:55808
 s_waitcnt lgkmcnt(4)
 v_mfma_f32_32x32x16_bf16 v[80:95], v[52:55], v[188:191], v[80:95]
 s_waitcnt vmcnt(2)
 s_barrier
 ds_read_b128 v[176:179], v4 offset:0
 ds_read_b128 v[180:183], v5 offset:0
 ds_read_b64_tr_b16 v[40:41], v21 offset:10240
 ds_read_b64_tr_b16 v[42:43], v21 offset:10752
 s_waitcnt lgkmcnt(6)
 v_mfma_f32_32x32x16_bf16 v[96:111], v[56:59], v[188:191], v[96:111]
 ds_read_b64_tr_b16 v[44:45], v22 offset:10240
 ds_read_b64_tr_b16 v[46:47], v22 offset:10752
 s_waitcnt lgkmcnt(6)
 v_mfma_f32_32x32x16_bf16 v[112:127], v[60:63], v[188:191], v[112:127]
 ds_read_b64_tr_b16 v[48:49], v23 offset:10240
 ds_read_b64_tr_b16 v[50:51], v23 offset:10752
 s_waitcnt lgkmcnt(4)
 v_mfma_f32_32x32x16_bf16 v[64:79], v[40:43], v[176:179], v[64:79]
 ds_read_b64_tr_b16 v[52:53], v24 offset:10240
 ds_read_b64_tr_b16 v[54:55], v24 offset:10752
 s_waitcnt lgkmcnt(4)
 v_mfma_f32_32x32x16_bf16 v[80:95], v[44:47], v[176:179], v[80:95]
 ds_read_b64_tr_b16 v[56:57], v21 offset:12288
 ds_read_b64_tr_b16 v[58:59], v21 offset:12800
 s_waitcnt lgkmcnt(4)
 v_mfma_f32_32x32x16_bf16 v[96:111], v[48:51], v[176:179], v[96:111]
 ds_read_b64_tr_b16 v[60:61], v22 offset:12288
 ds_read_b64_tr_b16 v[62:63], v22 offset:12800
 s_waitcnt lgkmcnt(4)
 v_mfma_f32_32x32x16_bf16 v[112:127], v[52:55], v[176:179], v[112:127]
 ds_read_b64_tr_b16 v[40:41], v23 offset:12288
 ds_read_b64_tr_b16 v[42:43], v23 offset:12800
 s_waitcnt lgkmcnt(4)
 v_mfma_f32_32x32x16_bf16 v[64:79], v[56:59], v[180:183], v[64:79]
 ds_read_b64_tr_b16 v[44:45], v24 offset:12288
 ds_read_b64_tr_b16 v[46:47], v24 offset:12800
 s_waitcnt lgkmcnt(4)
 v_mfma_f32_32x32x16_bf16 v[80:95], v[60:63], v[180:183], v[80:95]
 s_waitcnt vmcnt(0)
 s_barrier
 ds_read_b128 v[184:187], v6 offset:0
 ds_read_b128 v[188:191], v7 offset:0
 ds_read_b64_tr_b16 v[48:49], v21 offset:32768
 ds_read_b64_tr_b16 v[50:51], v21 offset:33280
 s_waitcnt lgkmcnt(6)
 v_mfma_f32_32x32x16_bf16 v[96:111], v[40:43], v[180:183], v[96:111]
 ds_read_b64_tr_b16 v[52:53], v22 offset:32768
 ds_read_b64_tr_b16 v[54:55], v22 offset:33280
 s_waitcnt lgkmcnt(6)
 v_mfma_f32_32x32x16_bf16 v[112:127], v[44:47], v[180:183], v[112:127]
 ds_read_b64_tr_b16 v[56:57], v23 offset:32768
 ds_read_b64_tr_b16 v[58:59], v23 offset:33280
 s_waitcnt lgkmcnt(4)
 v_mfma_f32_32x32x16_bf16 v[64:79], v[48:51], v[184:187], v[64:79]
 ds_read_b64_tr_b16 v[60:61], v24 offset:32768
 ds_read_b64_tr_b16 v[62:63], v24 offset:33280
 s_waitcnt lgkmcnt(4)
 v_mfma_f32_32x32x16_bf16 v[80:95], v[52:55], v[184:187], v[80:95]
 ds_read_b64_tr_b16 v[40:41], v21 offset:34816
 ds_read_b64_tr_b16 v[42:43], v21 offset:35328
 s_waitcnt lgkmcnt(4)
 v_mfma_f32_32x32x16_bf16 v[96:111], v[56:59], v[184:187], v[96:111]
 ds_read_b64_tr_b16 v[44:45], v22 offset:34816
 ds_read_b64_tr_b16 v[46:47], v22 offset:35328
 s_waitcnt lgkmcnt(4)
 v_mfma_f32_32x32x16_bf16 v[112:127], v[60:63], v[184:187], v[112:127]
 ds_read_b64_tr_b16 v[48:49], v23 offset:34816
 ds_read_b64_tr_b16 v[50:51], v23 offset:35328
 s_waitcnt lgkmcnt(4)
 v_mfma_f32_32x32x16_bf16 v[64:79], v[40:43], v[188:191], v[64:79]
 ds_read_b64_tr_b16 v[52:53], v24 offset:34816
 ds_read_b64_tr_b16 v[54:55], v24 offset:35328
 s_waitcnt lgkmcnt(4)
 v_mfma_f32_32x32x16_bf16 v[80:95], v[44:47], v[188:191], v[80:95]
 s_waitcnt lgkmcnt(2)
 v_mfma_f32_32x32x16_bf16 v[96:111], v[48:51], v[188:191], v[96:111]
 s_waitcnt lgkmcnt(0)
 v_mfma_f32_32x32x16_bf16 v[112:127], v[52:55], v[188:191], v[112:127]
 s_setprio 0
 s_waitcnt lgkmcnt(0)
 s_barrier
 s_nop 0
 v_cvt_pk_bf16_f32 v161, v64, v65
 v_cvt_pk_bf16_f32 v163, v72, v73
 v_lshlrev_b32 v160, 16, v161
 v_and_b32 v161, 0xffff0000, v161
 v_mul_f32 v164, v160, v160
 v_mul_f32 v165, v161, v161
 v_fmamk_f32 v164, v164, 0xbdd2d3e8, v26
 v_fmamk_f32 v165, v165, 0xbdd2d3e8, v26
 v_mul_f32 v164, v164, v160
 v_mul_f32 v165, v165, v161
 v_exp_f32 v164, v164
 v_exp_f32 v165, v165
 v_lshlrev_b32 v162, 16, v163
 v_add_f32 v164, 1.0, v164
 v_add_f32 v165, 1.0, v165
 v_rcp_f32 v164, v164
 v_rcp_f32 v165, v165
 v_and_b32 v163, 0xffff0000, v163
 v_mul_f32 v164, v164, v160
 v_mul_f32 v165, v165, v161
 v_cvt_pk_bf16_f32 v165, v164, v165
 v_lshlrev_b32 v164, 16, v165
 v_and_b32 v165, 0xffff0000, v165
 v_mul_f32 v164, v164, v162
 v_mul_f32 v165, v165, v163
 v_cvt_pk_bf16_f32 v172, v164, v165
 v_cvt_pk_bf16_f32 v161, v66, v67
 v_cvt_pk_bf16_f32 v163, v74, v75
 v_lshlrev_b32 v160, 16, v161
 v_and_b32 v161, 0xffff0000, v161
 v_mul_f32 v164, v160, v160
 v_mul_f32 v165, v161, v161
 v_fmamk_f32 v164, v164, 0xbdd2d3e8, v26
 v_fmamk_f32 v165, v165, 0xbdd2d3e8, v26
 v_mul_f32 v164, v164, v160
 v_mul_f32 v165, v165, v161
 v_exp_f32 v164, v164
 v_exp_f32 v165, v165
 v_lshlrev_b32 v162, 16, v163
 v_add_f32 v164, 1.0, v164
 v_add_f32 v165, 1.0, v165
 v_rcp_f32 v164, v164
 v_rcp_f32 v165, v165
 v_and_b32 v163, 0xffff0000, v163
 v_mul_f32 v164, v164, v160
 v_mul_f32 v165, v165, v161
 v_cvt_pk_bf16_f32 v165, v164, v165
 v_lshlrev_b32 v164, 16, v165
 v_and_b32 v165, 0xffff0000, v165
 v_mul_f32 v164, v164, v162
 v_mul_f32 v165, v165, v163
 v_cvt_pk_bf16_f32 v173, v164, v165
 v_cvt_pk_bf16_f32 v161, v68, v69
 v_cvt_pk_bf16_f32 v163, v76, v77
 v_lshlrev_b32 v160, 16, v161
 v_and_b32 v161, 0xffff0000, v161
 v_mul_f32 v164, v160, v160
 v_mul_f32 v165, v161, v161
 v_fmamk_f32 v164, v164, 0xbdd2d3e8, v26
 v_fmamk_f32 v165, v165, 0xbdd2d3e8, v26
 v_mul_f32 v164, v164, v160
 v_mul_f32 v165, v165, v161
 v_exp_f32 v164, v164
 v_exp_f32 v165, v165
 v_lshlrev_b32 v162, 16, v163
 v_add_f32 v164, 1.0, v164
 v_add_f32 v165, 1.0, v165
 v_rcp_f32 v164, v164
 v_rcp_f32 v165, v165
 v_and_b32 v163, 0xffff0000, v163
 v_mul_f32 v164, v164, v160
 v_mul_f32 v165, v165, v161
 v_cvt_pk_bf16_f32 v165, v164, v165
 v_lshlrev_b32 v164, 16, v165
 v_and_b32 v165, 0xffff0000, v165
 v_mul_f32 v164, v164, v162
 v_mul_f32 v165, v165, v163
 v_cvt_pk_bf16_f32 v174, v164, v165
 v_cvt_pk_bf16_f32 v161, v70, v71
 v_cvt_pk_bf16_f32 v163, v78, v79
 v_lshlrev_b32 v160, 16, v161
 v_and_b32 v161, 0xffff0000, v161
 v_mul_f32 v164, v160, v160
 v_mul_f32 v165, v161, v161
 v_fmamk_f32 v164, v164, 0xbdd2d3e8, v26
 v_fmamk_f32 v165, v165, 0xbdd2d3e8, v26
 v_mul_f32 v164, v164, v160
 v_mul_f32 v165, v165, v161
 v_exp_f32 v164, v164
 v_exp_f32 v165, v165
 v_lshlrev_b32 v162, 16, v163
 v_add_f32 v164, 1.0, v164
 v_add_f32 v165, 1.0, v165
 v_rcp_f32 v164, v164
 v_rcp_f32 v165, v165
 v_and_b32 v163, 0xffff0000, v163
 v_mul_f32 v164, v164, v160
 v_mul_f32 v165, v165, v161
 v_cvt_pk_bf16_f32 v165, v164, v165
 v_lshlrev_b32 v164, 16, v165
 v_and_b32 v165, 0xffff0000, v165
 v_mul_f32 v164, v164, v162
 v_mul_f32 v165, v165, v163
 v_cvt_pk_bf16_f32 v175, v164, v165
 s_add_u32 s38, s34, 2048
 buffer_store_dwordx4 v[172:175], v25, s[16:19], s38 offen sc0 sc1
 v_cvt_pk_bf16_f32 v177, v80, v81
 v_cvt_pk_bf16_f32 v179, v88, v89
 v_lshlrev_b32 v176, 16, v177
 v_and_b32 v177, 0xffff0000, v177
 v_mul_f32 v180, v176, v176
 v_mul_f32 v181, v177, v177
 v_fmamk_f32 v180, v180, 0xbdd2d3e8, v26
 v_fmamk_f32 v181, v181, 0xbdd2d3e8, v26
 v_mul_f32 v180, v180, v176
 v_mul_f32 v181, v181, v177
 v_exp_f32 v180, v180
 v_exp_f32 v181, v181
 v_lshlrev_b32 v178, 16, v179
 v_add_f32 v180, 1.0, v180
 v_add_f32 v181, 1.0, v181
 v_rcp_f32 v180, v180
 v_rcp_f32 v181, v181
 v_and_b32 v179, 0xffff0000, v179
 v_mul_f32 v180, v180, v176
 v_mul_f32 v181, v181, v177
 v_cvt_pk_bf16_f32 v181, v180, v181
 v_lshlrev_b32 v180, 16, v181
 v_and_b32 v181, 0xffff0000, v181
 v_mul_f32 v180, v180, v178
 v_mul_f32 v181, v181, v179
 v_cvt_pk_bf16_f32 v188, v180, v181
 v_cvt_pk_bf16_f32 v177, v82, v83
 v_cvt_pk_bf16_f32 v179, v90, v91
 v_lshlrev_b32 v176, 16, v177
 v_and_b32 v177, 0xffff0000, v177
 v_mul_f32 v180, v176, v176
 v_mul_f32 v181, v177, v177
 v_fmamk_f32 v180, v180, 0xbdd2d3e8, v26
 v_fmamk_f32 v181, v181, 0xbdd2d3e8, v26
 v_mul_f32 v180, v180, v176
 v_mul_f32 v181, v181, v177
 v_exp_f32 v180, v180
 v_exp_f32 v181, v181
 v_lshlrev_b32 v178, 16, v179
 v_add_f32 v180, 1.0, v180
 v_add_f32 v181, 1.0, v181
 v_rcp_f32 v180, v180
 v_rcp_f32 v181, v181
 v_and_b32 v179, 0xffff0000, v179
 v_mul_f32 v180, v180, v176
 v_mul_f32 v181, v181, v177
 v_cvt_pk_bf16_f32 v181, v180, v181
 v_lshlrev_b32 v180, 16, v181
 v_and_b32 v181, 0xffff0000, v181
 v_mul_f32 v180, v180, v178
 v_mul_f32 v181, v181, v179
 v_cvt_pk_bf16_f32 v189, v180, v181
 v_cvt_pk_bf16_f32 v177, v84, v85
 v_cvt_pk_bf16_f32 v179, v92, v93
 v_lshlrev_b32 v176, 16, v177
 v_and_b32 v177, 0xffff0000, v177
 v_mul_f32 v180, v176, v176
 v_mul_f32 v181, v177, v177
 v_fmamk_f32 v180, v180, 0xbdd2d3e8, v26
 v_fmamk_f32 v181, v181, 0xbdd2d3e8, v26
 v_mul_f32 v180, v180, v176
 v_mul_f32 v181, v181, v177
 v_exp_f32 v180, v180
 v_exp_f32 v181, v181
 v_lshlrev_b32 v178, 16, v179
 v_add_f32 v180, 1.0, v180
 v_add_f32 v181, 1.0, v181
 v_rcp_f32 v180, v180
 v_rcp_f32 v181, v181
 v_and_b32 v179, 0xffff0000, v179
 v_mul_f32 v180, v180, v176
 v_mul_f32 v181, v181, v177
 v_cvt_pk_bf16_f32 v181, v180, v181
 v_lshlrev_b32 v180, 16, v181
 v_and_b32 v181, 0xffff0000, v181
 v_mul_f32 v180, v180, v178
 v_mul_f32 v181, v181, v179
 v_cvt_pk_bf16_f32 v190, v180, v181
 v_cvt_pk_bf16_f32 v177, v86, v87
 v_cvt_pk_bf16_f32 v179, v94, v95
 v_lshlrev_b32 v176, 16, v177
 v_and_b32 v177, 0xffff0000, v177
 v_mul_f32 v180, v176, v176
 v_mul_f32 v181, v177, v177
 v_fmamk_f32 v180, v180, 0xbdd2d3e8, v26
 v_fmamk_f32 v181, v181, 0xbdd2d3e8, v26
 v_mul_f32 v180, v180, v176
 v_mul_f32 v181, v181, v177
 v_exp_f32 v180, v180
 v_exp_f32 v181, v181
 v_lshlrev_b32 v178, 16, v179
 v_add_f32 v180, 1.0, v180
 v_add_f32 v181, 1.0, v181
 v_rcp_f32 v180, v180
 v_rcp_f32 v181, v181
 v_and_b32 v179, 0xffff0000, v179
 v_mul_f32 v180, v180, v176
 v_mul_f32 v181, v181, v177
 v_cvt_pk_bf16_f32 v181, v180, v181
 v_lshlrev_b32 v180, 16, v181
 v_and_b32 v181, 0xffff0000, v181
 v_mul_f32 v180, v180, v178
 v_mul_f32 v181, v181, v179
 v_cvt_pk_bf16_f32 v191, v180, v181
 s_add_u32 s38, s34, 2560
 buffer_store_dwordx4 v[188:191], v25, s[16:19], s38 offen sc0 sc1
 v_cvt_pk_bf16_f32 v161, v96, v97
 v_cvt_pk_bf16_f32 v163, v104, v105
 v_lshlrev_b32 v160, 16, v161
 v_and_b32 v161, 0xffff0000, v161
 v_mul_f32 v164, v160, v160
 v_mul_f32 v165, v161, v161
 v_fmamk_f32 v164, v164, 0xbdd2d3e8, v26
 v_fmamk_f32 v165, v165, 0xbdd2d3e8, v26
 v_mul_f32 v164, v164, v160
 v_mul_f32 v165, v165, v161
 v_exp_f32 v164, v164
 v_exp_f32 v165, v165
 v_lshlrev_b32 v162, 16, v163
 v_add_f32 v164, 1.0, v164
 v_add_f32 v165, 1.0, v165
 v_rcp_f32 v164, v164
 v_rcp_f32 v165, v165
 v_and_b32 v163, 0xffff0000, v163
 v_mul_f32 v164, v164, v160
 v_mul_f32 v165, v165, v161
 v_cvt_pk_bf16_f32 v165, v164, v165
 v_lshlrev_b32 v164, 16, v165
 v_and_b32 v165, 0xffff0000, v165
 v_mul_f32 v164, v164, v162
 v_mul_f32 v165, v165, v163
 v_cvt_pk_bf16_f32 v172, v164, v165
 v_cvt_pk_bf16_f32 v161, v98, v99
 v_cvt_pk_bf16_f32 v163, v106, v107
 v_lshlrev_b32 v160, 16, v161
 v_and_b32 v161, 0xffff0000, v161
 v_mul_f32 v164, v160, v160
 v_mul_f32 v165, v161, v161
 v_fmamk_f32 v164, v164, 0xbdd2d3e8, v26
 v_fmamk_f32 v165, v165, 0xbdd2d3e8, v26
 v_mul_f32 v164, v164, v160
 v_mul_f32 v165, v165, v161
 v_exp_f32 v164, v164
 v_exp_f32 v165, v165
 v_lshlrev_b32 v162, 16, v163
 v_add_f32 v164, 1.0, v164
 v_add_f32 v165, 1.0, v165
 v_rcp_f32 v164, v164
 v_rcp_f32 v165, v165
 v_and_b32 v163, 0xffff0000, v163
 v_mul_f32 v164, v164, v160
 v_mul_f32 v165, v165, v161
 v_cvt_pk_bf16_f32 v165, v164, v165
 v_lshlrev_b32 v164, 16, v165
 v_and_b32 v165, 0xffff0000, v165
 v_mul_f32 v164, v164, v162
 v_mul_f32 v165, v165, v163
 v_cvt_pk_bf16_f32 v173, v164, v165
 v_cvt_pk_bf16_f32 v161, v100, v101
 v_cvt_pk_bf16_f32 v163, v108, v109
 v_lshlrev_b32 v160, 16, v161
 v_and_b32 v161, 0xffff0000, v161
 v_mul_f32 v164, v160, v160
 v_mul_f32 v165, v161, v161
 v_fmamk_f32 v164, v164, 0xbdd2d3e8, v26
 v_fmamk_f32 v165, v165, 0xbdd2d3e8, v26
 v_mul_f32 v164, v164, v160
 v_mul_f32 v165, v165, v161
 v_exp_f32 v164, v164
 v_exp_f32 v165, v165
 v_lshlrev_b32 v162, 16, v163
 v_add_f32 v164, 1.0, v164
 v_add_f32 v165, 1.0, v165
 v_rcp_f32 v164, v164
 v_rcp_f32 v165, v165
 v_and_b32 v163, 0xffff0000, v163
 v_mul_f32 v164, v164, v160
 v_mul_f32 v165, v165, v161
 v_cvt_pk_bf16_f32 v165, v164, v165
 v_lshlrev_b32 v164, 16, v165
 v_and_b32 v165, 0xffff0000, v165
 v_mul_f32 v164, v164, v162
 v_mul_f32 v165, v165, v163
 v_cvt_pk_bf16_f32 v174, v164, v165
 v_cvt_pk_bf16_f32 v161, v102, v103
 v_cvt_pk_bf16_f32 v163, v110, v111
 v_lshlrev_b32 v160, 16, v161
 v_and_b32 v161, 0xffff0000, v161
 v_mul_f32 v164, v160, v160
 v_mul_f32 v165, v161, v161
 v_fmamk_f32 v164, v164, 0xbdd2d3e8, v26
 v_fmamk_f32 v165, v165, 0xbdd2d3e8, v26
 v_mul_f32 v164, v164, v160
 v_mul_f32 v165, v165, v161
 v_exp_f32 v164, v164
 v_exp_f32 v165, v165
 v_lshlrev_b32 v162, 16, v163
 v_add_f32 v164, 1.0, v164
 v_add_f32 v165, 1.0, v165
 v_rcp_f32 v164, v164
 v_rcp_f32 v165, v165
 v_and_b32 v163, 0xffff0000, v163
 v_mul_f32 v164, v164, v160
 v_mul_f32 v165, v165, v161
 v_cvt_pk_bf16_f32 v165, v164, v165
 v_lshlrev_b32 v164, 16, v165
 v_and_b32 v165, 0xffff0000, v165
 v_mul_f32 v164, v164, v162
 v_mul_f32 v165, v165, v163
 v_cvt_pk_bf16_f32 v175, v164, v165
 s_add_u32 s38, s34, 3072
 buffer_store_dwordx4 v[172:175], v25, s[16:19], s38 offen sc0 sc1
 v_cvt_pk_bf16_f32 v177, v112, v113
 v_cvt_pk_bf16_f32 v179, v120, v121
 v_lshlrev_b32 v176, 16, v177
 v_and_b32 v177, 0xffff0000, v177
 v_mul_f32 v180, v176, v176
 v_mul_f32 v181, v177, v177
 v_fmamk_f32 v180, v180, 0xbdd2d3e8, v26
 v_fmamk_f32 v181, v181, 0xbdd2d3e8, v26
 v_mul_f32 v180, v180, v176
 v_mul_f32 v181, v181, v177
 v_exp_f32 v180, v180
 v_exp_f32 v181, v181
 v_lshlrev_b32 v178, 16, v179
 v_add_f32 v180, 1.0, v180
 v_add_f32 v181, 1.0, v181
 v_rcp_f32 v180, v180
 v_rcp_f32 v181, v181
 v_and_b32 v179, 0xffff0000, v179
 v_mul_f32 v180, v180, v176
 v_mul_f32 v181, v181, v177
 v_cvt_pk_bf16_f32 v181, v180, v181
 v_lshlrev_b32 v180, 16, v181
 v_and_b32 v181, 0xffff0000, v181
 v_mul_f32 v180, v180, v178
 v_mul_f32 v181, v181, v179
 v_cvt_pk_bf16_f32 v188, v180, v181
 v_cvt_pk_bf16_f32 v177, v114, v115
 v_cvt_pk_bf16_f32 v179, v122, v123
 v_lshlrev_b32 v176, 16, v177
 v_and_b32 v177, 0xffff0000, v177
 v_mul_f32 v180, v176, v176
 v_mul_f32 v181, v177, v177
 v_fmamk_f32 v180, v180, 0xbdd2d3e8, v26
 v_fmamk_f32 v181, v181, 0xbdd2d3e8, v26
 v_mul_f32 v180, v180, v176
 v_mul_f32 v181, v181, v177
 v_exp_f32 v180, v180
 v_exp_f32 v181, v181
 v_lshlrev_b32 v178, 16, v179
 v_add_f32 v180, 1.0, v180
 v_add_f32 v181, 1.0, v181
 v_rcp_f32 v180, v180
 v_rcp_f32 v181, v181
 v_and_b32 v179, 0xffff0000, v179
 v_mul_f32 v180, v180, v176
 v_mul_f32 v181, v181, v177
 v_cvt_pk_bf16_f32 v181, v180, v181
 v_lshlrev_b32 v180, 16, v181
 v_and_b32 v181, 0xffff0000, v181
 v_mul_f32 v180, v180, v178
 v_mul_f32 v181, v181, v179
 v_cvt_pk_bf16_f32 v189, v180, v181
 v_cvt_pk_bf16_f32 v177, v116, v117
 v_cvt_pk_bf16_f32 v179, v124, v125
 v_lshlrev_b32 v176, 16, v177
 v_and_b32 v177, 0xffff0000, v177
 v_mul_f32 v180, v176, v176
 v_mul_f32 v181, v177, v177
 v_fmamk_f32 v180, v180, 0xbdd2d3e8, v26
 v_fmamk_f32 v181, v181, 0xbdd2d3e8, v26
 v_mul_f32 v180, v180, v176
 v_mul_f32 v181, v181, v177
 v_exp_f32 v180, v180
 v_exp_f32 v181, v181
 v_lshlrev_b32 v178, 16, v179
 v_add_f32 v180, 1.0, v180
 v_add_f32 v181, 1.0, v181
 v_rcp_f32 v180, v180
 v_rcp_f32 v181, v181
 v_and_b32 v179, 0xffff0000, v179
 v_mul_f32 v180, v180, v176
 v_mul_f32 v181, v181, v177
 v_cvt_pk_bf16_f32 v181, v180, v181
 v_lshlrev_b32 v180, 16, v181
 v_and_b32 v181, 0xffff0000, v181
 v_mul_f32 v180, v180, v178
 v_mul_f32 v181, v181, v179
 v_cvt_pk_bf16_f32 v190, v180, v181
 v_cvt_pk_bf16_f32 v177, v118, v119
 v_cvt_pk_bf16_f32 v179, v126, v127
 v_lshlrev_b32 v176, 16, v177
 v_and_b32 v177, 0xffff0000, v177
 v_mul_f32 v180, v176, v176
 v_mul_f32 v181, v177, v177
 v_fmamk_f32 v180, v180, 0xbdd2d3e8, v26
 v_fmamk_f32 v181, v181, 0xbdd2d3e8, v26
 v_mul_f32 v180, v180, v176
 v_mul_f32 v181, v181, v177
 v_exp_f32 v180, v180
 v_exp_f32 v181, v181
 v_lshlrev_b32 v178, 16, v179
 v_add_f32 v180, 1.0, v180
 v_add_f32 v181, 1.0, v181
 v_rcp_f32 v180, v180
 v_rcp_f32 v181, v181
 v_and_b32 v179, 0xffff0000, v179
 v_mul_f32 v180, v180, v176
 v_mul_f32 v181, v181, v177
 v_cvt_pk_bf16_f32 v181, v180, v181
 v_lshlrev_b32 v180, 16, v181
 v_and_b32 v181, 0xffff0000, v181
 v_mul_f32 v180, v180, v178
 v_mul_f32 v181, v181, v179
 v_cvt_pk_bf16_f32 v191, v180, v181
 s_add_u32 s38, s34, 3584
 buffer_store_dwordx4 v[188:191], v25, s[16:19], s38 offen sc0 sc1
 s_endpgm
L_k1_done:
 s_endpgm
.text
.globl k2_kernel
.p2align 8
.type k2_kernel,@function
k2_kernel:
 s_cmp_ge_u32 s2, 256
 s_cbranch_scc1 L_k2_done
 s_load_dwordx2 s[40:41], s[0:1], 72
 s_load_dwordx2 s[44:45], s[0:1], 88
 v_lshrrev_b32 v1, 6, v0
 v_and_b32 v3, 63, v0
 v_readfirstlane_b32 s16, v1
 v_lshlrev_b32 v2, 4, v3
 s_lshr_b32 s25, s2, 3
 s_and_b32 s18, s25, 3
 s_and_b32 s24, s2, 1
 s_lshl_b32 s24, s24, 2
 s_add_u32 s18, s18, s24
 s_lshr_b32 s25, s25, 2
 s_bfe_u32 s24, s2, 0x20001
 s_lshl_b32 s17, s24, 3
 s_add_u32 s17, s17, s25
 s_mul_i32 s19, s18, 378880
 s_add_u32 s19, s19, 12582912
 s_waitcnt lgkmcnt(0)
 s_mov_b32 s8, s40
 s_mov_b32 s9, s41
 s_mov_b32 s10, 2621440
 s_mov_b32 s11, 0x00020000
 s_mov_b32 s4, s44
 s_mov_b32 s5, s45
 s_mov_b32 s6, 22020096
 s_mov_b32 s7, 0x00020000
 s_cmp_ge_u32 s16, 4
 s_cbranch_scc1 L_k2_owave
 s_mul_i32 s24, s16, 14
 s_cmp_eq_u32 s16, 3
 s_cselect_b32 s25, 1, 0
 s_sub_u32 s24, s24, s25
 s_cmp_lt_u32 s16, 2
 s_cselect_b32 s30, 1, 0
 s_mul_i32 s25, s24, 5120
 s_add_u32 s19, s19, s25
 s_mul_i32 s20, s17, 221184
 s_lshl_b32 s25, s24, 10
 s_add_u32 s20, s20, s25
 s_add_u32 s20, s20, 0
 s_barrier
 s_add_u32 s24, s19, 0
 buffer_load_dwordx4 v[96:99], v2, s[4:7], s24 offen offset:0
 buffer_load_dwordx4 v[100:103], v2, s[4:7], s24 offen offset:1024
 buffer_load_dwordx4 v[104:107], v2, s[4:7], s24 offen offset:2048
 buffer_load_dwordx4 v[108:111], v2, s[4:7], s24 offen offset:3072
 s_add_u32 s24, s24, 4096
 buffer_load_dwordx4 v[112:115], v2, s[4:7], s24 offen
 s_add_u32 s24, s20, 0
 buffer_load_dwordx4 v[116:119], v2, s[4:7], s24 offen
 s_add_u32 s24, s20, 55296
 buffer_load_dwordx4 v[120:123], v2, s[4:7], s24 offen
 s_add_u32 s24, s20, 110592
 buffer_load_dwordx4 v[124:127], v2, s[4:7], s24 offen
 s_add_u32 s24, s20, 165888
 buffer_load_dwordx4 v[128:131], v2, s[4:7], s24 offen
 s_add_u32 s24, s19, 5120
 buffer_load_dwordx4 v[132:135], v2, s[4:7], s24 offen offset:0
 buffer_load_dwordx4 v[136:139], v2, s[4:7], s24 offen offset:1024
 buffer_load_dwordx4 v[140:143], v2, s[4:7], s24 offen offset:2048
 buffer_load_dwordx4 v[144:147], v2, s[4:7], s24 offen offset:3072
 s_add_u32 s24, s24, 4096
 buffer_load_dwordx4 v[148:151], v2, s[4:7], s24 offen
 s_add_u32 s24, s20, 1024
 buffer_load_dwordx4 v[152:155], v2, s[4:7], s24 offen
 s_add_u32 s24, s20, 56320
 buffer_load_dwordx4 v[156:159], v2, s[4:7], s24 offen
 s_add_u32 s24, s20, 111616
 buffer_load_dwordx4 v[160:163], v2, s[4:7], s24 offen
 s_add_u32 s24, s20, 166912
 buffer_load_dwordx4 v[164:167], v2, s[4:7], s24 offen
 s_add_u32 s24, s19, 10240
 buffer_load_dwordx4 v[168:171], v2, s[4:7], s24 offen offset:0
 buffer_load_dwordx4 v[172:175], v2, s[4:7], s24 offen offset:1024
 buffer_load_dwordx4 v[176:179], v2, s[4:7], s24 offen offset:2048
 buffer_load_dwordx4 v[180:183], v2, s[4:7], s24 offen offset:3072
 s_add_u32 s24, s24, 4096
 buffer_load_dwordx4 v[184:187], v2, s[4:7], s24 offen
 s_add_u32 s24, s20, 2048
 buffer_load_dwordx4 v[188:191], v2, s[4:7], s24 offen
 s_add_u32 s24, s20, 57344
 buffer_load_dwordx4 v[192:195], v2, s[4:7], s24 offen
 s_add_u32 s24, s20, 112640
 buffer_load_dwordx4 v[196:199], v2, s[4:7], s24 offen
 s_add_u32 s24, s20, 167936
 buffer_load_dwordx4 v[200:203], v2, s[4:7], s24 offen
 s_waitcnt vmcnt(18)
 v_mfma_f32_16x16x32_bf16 v[16:19], v[96:99], v[116:119], 0
 v_mfma_f32_16x16x32_bf16 v[20:23], v[96:99], v[120:123], 0
 v_mfma_f32_16x16x32_bf16 v[24:27], v[96:99], v[124:127], 0
 v_mfma_f32_16x16x32_bf16 v[28:31], v[96:99], v[128:131], 0
 v_mfma_f32_16x16x32_bf16 v[32:35], v[100:103], v[116:119], 0
 v_mfma_f32_16x16x32_bf16 v[36:39], v[100:103], v[120:123], 0
 v_mfma_f32_16x16x32_bf16 v[40:43], v[100:103], v[124:127], 0
 v_mfma_f32_16x16x32_bf16 v[44:47], v[100:103], v[128:131], 0
 v_mfma_f32_16x16x32_bf16 v[48:51], v[104:107], v[116:119], 0
 v_mfma_f32_16x16x32_bf16 v[52:55], v[104:107], v[120:123], 0
 v_mfma_f32_16x16x32_bf16 v[56:59], v[104:107], v[124:127], 0
 v_mfma_f32_16x16x32_bf16 v[60:63], v[104:107], v[128:131], 0
 v_mfma_f32_16x16x32_bf16 v[64:67], v[108:111], v[116:119], 0
 v_mfma_f32_16x16x32_bf16 v[68:71], v[108:111], v[120:123], 0
 v_mfma_f32_16x16x32_bf16 v[72:75], v[108:111], v[124:127], 0
 v_mfma_f32_16x16x32_bf16 v[76:79], v[108:111], v[128:131], 0
 v_mfma_f32_16x16x32_bf16 v[80:83], v[112:115], v[116:119], 0
 v_mfma_f32_16x16x32_bf16 v[84:87], v[112:115], v[120:123], 0
 v_mfma_f32_16x16x32_bf16 v[88:91], v[112:115], v[124:127], 0
 v_mfma_f32_16x16x32_bf16 v[92:95], v[112:115], v[128:131], 0
 s_add_u32 s24, s19, 15360
 buffer_load_dwordx4 v[96:99], v2, s[4:7], s24 offen offset:0
 buffer_load_dwordx4 v[100:103], v2, s[4:7], s24 offen offset:1024
 buffer_load_dwordx4 v[104:107], v2, s[4:7], s24 offen offset:2048
 buffer_load_dwordx4 v[108:111], v2, s[4:7], s24 offen offset:3072
 s_add_u32 s24, s24, 4096
 buffer_load_dwordx4 v[112:115], v2, s[4:7], s24 offen
 s_add_u32 s24, s20, 3072
 buffer_load_dwordx4 v[116:119], v2, s[4:7], s24 offen
 s_add_u32 s24, s20, 58368
 buffer_load_dwordx4 v[120:123], v2, s[4:7], s24 offen
 s_add_u32 s24, s20, 113664
 buffer_load_dwordx4 v[124:127], v2, s[4:7], s24 offen
 s_add_u32 s24, s20, 168960
 buffer_load_dwordx4 v[128:131], v2, s[4:7], s24 offen
 s_waitcnt vmcnt(18)
 v_mfma_f32_16x16x32_bf16 v[16:19], v[132:135], v[152:155], v[16:19]
 v_mfma_f32_16x16x32_bf16 v[20:23], v[132:135], v[156:159], v[20:23]
 v_mfma_f32_16x16x32_bf16 v[24:27], v[132:135], v[160:163], v[24:27]
 v_mfma_f32_16x16x32_bf16 v[28:31], v[132:135], v[164:167], v[28:31]
 v_mfma_f32_16x16x32_bf16 v[32:35], v[136:139], v[152:155], v[32:35]
 v_mfma_f32_16x16x32_bf16 v[36:39], v[136:139], v[156:159], v[36:39]
 v_mfma_f32_16x16x32_bf16 v[40:43], v[136:139], v[160:163], v[40:43]
 v_mfma_f32_16x16x32_bf16 v[44:47], v[136:139], v[164:167], v[44:47]
 v_mfma_f32_16x16x32_bf16 v[48:51], v[140:143], v[152:155], v[48:51]
 v_mfma_f32_16x16x32_bf16 v[52:55], v[140:143], v[156:159], v[52:55]
 v_mfma_f32_16x16x32_bf16 v[56:59], v[140:143], v[160:163], v[56:59]
 v_mfma_f32_16x16x32_bf16 v[60:63], v[140:143], v[164:167], v[60:63]
 v_mfma_f32_16x16x32_bf16 v[64:67], v[144:147], v[152:155], v[64:67]
 v_mfma_f32_16x16x32_bf16 v[68:71], v[144:147], v[156:159], v[68:71]
 v_mfma_f32_16x16x32_bf16 v[72:75], v[144:147], v[160:163], v[72:75]
 v_mfma_f32_16x16x32_bf16 v[76:79], v[144:147], v[164:167], v[76:79]
 v_mfma_f32_16x16x32_bf16 v[80:83], v[148:151], v[152:155], v[80:83]
 v_mfma_f32_16x16x32_bf16 v[84:87], v[148:151], v[156:159], v[84:87]
 v_mfma_f32_16x16x32_bf16 v[88:91], v[148:151], v[160:163], v[88:91]
 v_mfma_f32_16x16x32_bf16 v[92:95], v[148:151], v[164:167], v[92:95]
 s_add_u32 s24, s19, 20480
 buffer_load_dwordx4 v[132:135], v2, s[4:7], s24 offen offset:0
 buffer_load_dwordx4 v[136:139], v2, s[4:7], s24 offen offset:1024
 buffer_load_dwordx4 v[140:143], v2, s[4:7], s24 offen offset:2048
 buffer_load_dwordx4 v[144:147], v2, s[4:7], s24 offen offset:3072
 s_add_u32 s24, s24, 4096
 buffer_load_dwordx4 v[148:151], v2, s[4:7], s24 offen
 s_add_u32 s24, s20, 4096
 buffer_load_dwordx4 v[152:155], v2, s[4:7], s24 offen
 s_add_u32 s24, s20, 59392
 buffer_load_dwordx4 v[156:159], v2, s[4:7], s24 offen
 s_add_u32 s24, s20, 114688
 buffer_load_dwordx4 v[160:163], v2, s[4:7], s24 offen
 s_add_u32 s24, s20, 169984
 buffer_load_dwordx4 v[164:167], v2, s[4:7], s24 offen
 s_waitcnt vmcnt(18)
 v_mfma_f32_16x16x32_bf16 v[16:19], v[168:171], v[188:191], v[16:19]
 v_mfma_f32_16x16x32_bf16 v[20:23], v[168:171], v[192:195], v[20:23]
 v_mfma_f32_16x16x32_bf16 v[24:27], v[168:171], v[196:199], v[24:27]
 v_mfma_f32_16x16x32_bf16 v[28:31], v[168:171], v[200:203], v[28:31]
 v_mfma_f32_16x16x32_bf16 v[32:35], v[172:175], v[188:191], v[32:35]
 v_mfma_f32_16x16x32_bf16 v[36:39], v[172:175], v[192:195], v[36:39]
 v_mfma_f32_16x16x32_bf16 v[40:43], v[172:175], v[196:199], v[40:43]
 v_mfma_f32_16x16x32_bf16 v[44:47], v[172:175], v[200:203], v[44:47]
 v_mfma_f32_16x16x32_bf16 v[48:51], v[176:179], v[188:191], v[48:51]
 v_mfma_f32_16x16x32_bf16 v[52:55], v[176:179], v[192:195], v[52:55]
 v_mfma_f32_16x16x32_bf16 v[56:59], v[176:179], v[196:199], v[56:59]
 v_mfma_f32_16x16x32_bf16 v[60:63], v[176:179], v[200:203], v[60:63]
 v_mfma_f32_16x16x32_bf16 v[64:67], v[180:183], v[188:191], v[64:67]
 v_mfma_f32_16x16x32_bf16 v[68:71], v[180:183], v[192:195], v[68:71]
 v_mfma_f32_16x16x32_bf16 v[72:75], v[180:183], v[196:199], v[72:75]
 v_mfma_f32_16x16x32_bf16 v[76:79], v[180:183], v[200:203], v[76:79]
 v_mfma_f32_16x16x32_bf16 v[80:83], v[184:187], v[188:191], v[80:83]
 v_mfma_f32_16x16x32_bf16 v[84:87], v[184:187], v[192:195], v[84:87]
 v_mfma_f32_16x16x32_bf16 v[88:91], v[184:187], v[196:199], v[88:91]
 v_mfma_f32_16x16x32_bf16 v[92:95], v[184:187], v[200:203], v[92:95]
 s_add_u32 s24, s19, 25600
 buffer_load_dwordx4 v[168:171], v2, s[4:7], s24 offen offset:0
 buffer_load_dwordx4 v[172:175], v2, s[4:7], s24 offen offset:1024
 buffer_load_dwordx4 v[176:179], v2, s[4:7], s24 offen offset:2048
 buffer_load_dwordx4 v[180:183], v2, s[4:7], s24 offen offset:3072
 s_add_u32 s24, s24, 4096
 buffer_load_dwordx4 v[184:187], v2, s[4:7], s24 offen
 s_add_u32 s24, s20, 5120
 buffer_load_dwordx4 v[188:191], v2, s[4:7], s24 offen
 s_add_u32 s24, s20, 60416
 buffer_load_dwordx4 v[192:195], v2, s[4:7], s24 offen
 s_add_u32 s24, s20, 115712
 buffer_load_dwordx4 v[196:199], v2, s[4:7], s24 offen
 s_add_u32 s24, s20, 171008
 buffer_load_dwordx4 v[200:203], v2, s[4:7], s24 offen
 s_waitcnt vmcnt(18)
 v_mfma_f32_16x16x32_bf16 v[16:19], v[96:99], v[116:119], v[16:19]
 v_mfma_f32_16x16x32_bf16 v[20:23], v[96:99], v[120:123], v[20:23]
 v_mfma_f32_16x16x32_bf16 v[24:27], v[96:99], v[124:127], v[24:27]
 v_mfma_f32_16x16x32_bf16 v[28:31], v[96:99], v[128:131], v[28:31]
 v_mfma_f32_16x16x32_bf16 v[32:35], v[100:103], v[116:119], v[32:35]
 v_mfma_f32_16x16x32_bf16 v[36:39], v[100:103], v[120:123], v[36:39]
 v_mfma_f32_16x16x32_bf16 v[40:43], v[100:103], v[124:127], v[40:43]
 v_mfma_f32_16x16x32_bf16 v[44:47], v[100:103], v[128:131], v[44:47]
 v_mfma_f32_16x16x32_bf16 v[48:51], v[104:107], v[116:119], v[48:51]
 v_mfma_f32_16x16x32_bf16 v[52:55], v[104:107], v[120:123], v[52:55]
 v_mfma_f32_16x16x32_bf16 v[56:59], v[104:107], v[124:127], v[56:59]
 v_mfma_f32_16x16x32_bf16 v[60:63], v[104:107], v[128:131], v[60:63]
 v_mfma_f32_16x16x32_bf16 v[64:67], v[108:111], v[116:119], v[64:67]
 v_mfma_f32_16x16x32_bf16 v[68:71], v[108:111], v[120:123], v[68:71]
 v_mfma_f32_16x16x32_bf16 v[72:75], v[108:111], v[124:127], v[72:75]
 v_mfma_f32_16x16x32_bf16 v[76:79], v[108:111], v[128:131], v[76:79]
 v_mfma_f32_16x16x32_bf16 v[80:83], v[112:115], v[116:119], v[80:83]
 v_mfma_f32_16x16x32_bf16 v[84:87], v[112:115], v[120:123], v[84:87]
 v_mfma_f32_16x16x32_bf16 v[88:91], v[112:115], v[124:127], v[88:91]
 v_mfma_f32_16x16x32_bf16 v[92:95], v[112:115], v[128:131], v[92:95]
 s_add_u32 s24, s19, 30720
 buffer_load_dwordx4 v[96:99], v2, s[4:7], s24 offen offset:0
 buffer_load_dwordx4 v[100:103], v2, s[4:7], s24 offen offset:1024
 buffer_load_dwordx4 v[104:107], v2, s[4:7], s24 offen offset:2048
 buffer_load_dwordx4 v[108:111], v2, s[4:7], s24 offen offset:3072
 s_add_u32 s24, s24, 4096
 buffer_load_dwordx4 v[112:115], v2, s[4:7], s24 offen
 s_add_u32 s24, s20, 6144
 buffer_load_dwordx4 v[116:119], v2, s[4:7], s24 offen
 s_add_u32 s24, s20, 61440
 buffer_load_dwordx4 v[120:123], v2, s[4:7], s24 offen
 s_add_u32 s24, s20, 116736
 buffer_load_dwordx4 v[124:127], v2, s[4:7], s24 offen
 s_add_u32 s24, s20, 172032
 buffer_load_dwordx4 v[128:131], v2, s[4:7], s24 offen
 s_waitcnt vmcnt(18)
 v_mfma_f32_16x16x32_bf16 v[16:19], v[132:135], v[152:155], v[16:19]
 v_mfma_f32_16x16x32_bf16 v[20:23], v[132:135], v[156:159], v[20:23]
 v_mfma_f32_16x16x32_bf16 v[24:27], v[132:135], v[160:163], v[24:27]
 v_mfma_f32_16x16x32_bf16 v[28:31], v[132:135], v[164:167], v[28:31]
 v_mfma_f32_16x16x32_bf16 v[32:35], v[136:139], v[152:155], v[32:35]
 v_mfma_f32_16x16x32_bf16 v[36:39], v[136:139], v[156:159], v[36:39]
 v_mfma_f32_16x16x32_bf16 v[40:43], v[136:139], v[160:163], v[40:43]
 v_mfma_f32_16x16x32_bf16 v[44:47], v[136:139], v[164:167], v[44:47]
 v_mfma_f32_16x16x32_bf16 v[48:51], v[140:143], v[152:155], v[48:51]
 v_mfma_f32_16x16x32_bf16 v[52:55], v[140:143], v[156:159], v[52:55]
 v_mfma_f32_16x16x32_bf16 v[56:59], v[140:143], v[160:163], v[56:59]
 v_mfma_f32_16x16x32_bf16 v[60:63], v[140:143], v[164:167], v[60:63]
 v_mfma_f32_16x16x32_bf16 v[64:67], v[144:147], v[152:155], v[64:67]
 v_mfma_f32_16x16x32_bf16 v[68:71], v[144:147], v[156:159], v[68:71]
 v_mfma_f32_16x16x32_bf16 v[72:75], v[144:147], v[160:163], v[72:75]
 v_mfma_f32_16x16x32_bf16 v[76:79], v[144:147], v[164:167], v[76:79]
 v_mfma_f32_16x16x32_bf16 v[80:83], v[148:151], v[152:155], v[80:83]
 v_mfma_f32_16x16x32_bf16 v[84:87], v[148:151], v[156:159], v[84:87]
 v_mfma_f32_16x16x32_bf16 v[88:91], v[148:151], v[160:163], v[88:91]
 v_mfma_f32_16x16x32_bf16 v[92:95], v[148:151], v[164:167], v[92:95]
 s_add_u32 s24, s19, 35840
 buffer_load_dwordx4 v[132:135], v2, s[4:7], s24 offen offset:0
 buffer_load_dwordx4 v[136:139], v2, s[4:7], s24 offen offset:1024
 buffer_load_dwordx4 v[140:143], v2, s[4:7], s24 offen offset:2048
 buffer_load_dwordx4 v[144:147], v2, s[4:7], s24 offen offset:3072
 s_add_u32 s24, s24, 4096
 buffer_load_dwordx4 v[148:151], v2, s[4:7], s24 offen
 s_add_u32 s24, s20, 7168
 buffer_load_dwordx4 v[152:155], v2, s[4:7], s24 offen
 s_add_u32 s24, s20, 62464
 buffer_load_dwordx4 v[156:159], v2, s[4:7], s24 offen
 s_add_u32 s24, s20, 117760
 buffer_load_dwordx4 v[160:163], v2, s[4:7], s24 offen
 s_add_u32 s24, s20, 173056
 buffer_load_dwordx4 v[164:167], v2, s[4:7], s24 offen
 s_waitcnt vmcnt(18)
 v_mfma_f32_16x16x32_bf16 v[16:19], v[168:171], v[188:191], v[16:19]
 v_mfma_f32_16x16x32_bf16 v[20:23], v[168:171], v[192:195], v[20:23]
 v_mfma_f32_16x16x32_bf16 v[24:27], v[168:171], v[196:199], v[24:27]
 v_mfma_f32_16x16x32_bf16 v[28:31], v[168:171], v[200:203], v[28:31]
 v_mfma_f32_16x16x32_bf16 v[32:35], v[172:175], v[188:191], v[32:35]
 v_mfma_f32_16x16x32_bf16 v[36:39], v[172:175], v[192:195], v[36:39]
 v_mfma_f32_16x16x32_bf16 v[40:43], v[172:175], v[196:199], v[40:43]
 v_mfma_f32_16x16x32_bf16 v[44:47], v[172:175], v[200:203], v[44:47]
 v_mfma_f32_16x16x32_bf16 v[48:51], v[176:179], v[188:191], v[48:51]
 v_mfma_f32_16x16x32_bf16 v[52:55], v[176:179], v[192:195], v[52:55]
 v_mfma_f32_16x16x32_bf16 v[56:59], v[176:179], v[196:199], v[56:59]
 v_mfma_f32_16x16x32_bf16 v[60:63], v[176:179], v[200:203], v[60:63]
 v_mfma_f32_16x16x32_bf16 v[64:67], v[180:183], v[188:191], v[64:67]
 v_mfma_f32_16x16x32_bf16 v[68:71], v[180:183], v[192:195], v[68:71]
 v_mfma_f32_16x16x32_bf16 v[72:75], v[180:183], v[196:199], v[72:75]
 v_mfma_f32_16x16x32_bf16 v[76:79], v[180:183], v[200:203], v[76:79]
 v_mfma_f32_16x16x32_bf16 v[80:83], v[184:187], v[188:191], v[80:83]
 v_mfma_f32_16x16x32_bf16 v[84:87], v[184:187], v[192:195], v[84:87]
 v_mfma_f32_16x16x32_bf16 v[88:91], v[184:187], v[196:199], v[88:91]
 v_mfma_f32_16x16x32_bf16 v[92:95], v[184:187], v[200:203], v[92:95]
 s_add_u32 s24, s19, 40960
 buffer_load_dwordx4 v[168:171], v2, s[4:7], s24 offen offset:0
 buffer_load_dwordx4 v[172:175], v2, s[4:7], s24 offen offset:1024
 buffer_load_dwordx4 v[176:179], v2, s[4:7], s24 offen offset:2048
 buffer_load_dwordx4 v[180:183], v2, s[4:7], s24 offen offset:3072
 s_add_u32 s24, s24, 4096
 buffer_load_dwordx4 v[184:187], v2, s[4:7], s24 offen
 s_add_u32 s24, s20, 8192
 buffer_load_dwordx4 v[188:191], v2, s[4:7], s24 offen
 s_add_u32 s24, s20, 63488
 buffer_load_dwordx4 v[192:195], v2, s[4:7], s24 offen
 s_add_u32 s24, s20, 118784
 buffer_load_dwordx4 v[196:199], v2, s[4:7], s24 offen
 s_add_u32 s24, s20, 174080
 buffer_load_dwordx4 v[200:203], v2, s[4:7], s24 offen
 s_waitcnt vmcnt(18)
 v_mfma_f32_16x16x32_bf16 v[16:19], v[96:99], v[116:119], v[16:19]
 v_mfma_f32_16x16x32_bf16 v[20:23], v[96:99], v[120:123], v[20:23]
 v_mfma_f32_16x16x32_bf16 v[24:27], v[96:99], v[124:127], v[24:27]
 v_mfma_f32_16x16x32_bf16 v[28:31], v[96:99], v[128:131], v[28:31]
 v_mfma_f32_16x16x32_bf16 v[32:35], v[100:103], v[116:119], v[32:35]
 v_mfma_f32_16x16x32_bf16 v[36:39], v[100:103], v[120:123], v[36:39]
 v_mfma_f32_16x16x32_bf16 v[40:43], v[100:103], v[124:127], v[40:43]
 v_mfma_f32_16x16x32_bf16 v[44:47], v[100:103], v[128:131], v[44:47]
 v_mfma_f32_16x16x32_bf16 v[48:51], v[104:107], v[116:119], v[48:51]
 v_mfma_f32_16x16x32_bf16 v[52:55], v[104:107], v[120:123], v[52:55]
 v_mfma_f32_16x16x32_bf16 v[56:59], v[104:107], v[124:127], v[56:59]
 v_mfma_f32_16x16x32_bf16 v[60:63], v[104:107], v[128:131], v[60:63]
 v_mfma_f32_16x16x32_bf16 v[64:67], v[108:111], v[116:119], v[64:67]
 v_mfma_f32_16x16x32_bf16 v[68:71], v[108:111], v[120:123], v[68:71]
 v_mfma_f32_16x16x32_bf16 v[72:75], v[108:111], v[124:127], v[72:75]
 v_mfma_f32_16x16x32_bf16 v[76:79], v[108:111], v[128:131], v[76:79]
 v_mfma_f32_16x16x32_bf16 v[80:83], v[112:115], v[116:119], v[80:83]
 v_mfma_f32_16x16x32_bf16 v[84:87], v[112:115], v[120:123], v[84:87]
 v_mfma_f32_16x16x32_bf16 v[88:91], v[112:115], v[124:127], v[88:91]
 v_mfma_f32_16x16x32_bf16 v[92:95], v[112:115], v[128:131], v[92:95]
 s_add_u32 s24, s19, 46080
 buffer_load_dwordx4 v[96:99], v2, s[4:7], s24 offen offset:0
 buffer_load_dwordx4 v[100:103], v2, s[4:7], s24 offen offset:1024
 buffer_load_dwordx4 v[104:107], v2, s[4:7], s24 offen offset:2048
 buffer_load_dwordx4 v[108:111], v2, s[4:7], s24 offen offset:3072
 s_add_u32 s24, s24, 4096
 buffer_load_dwordx4 v[112:115], v2, s[4:7], s24 offen
 s_add_u32 s24, s20, 9216
 buffer_load_dwordx4 v[116:119], v2, s[4:7], s24 offen
 s_add_u32 s24, s20, 64512
 buffer_load_dwordx4 v[120:123], v2, s[4:7], s24 offen
 s_add_u32 s24, s20, 119808
 buffer_load_dwordx4 v[124:127], v2, s[4:7], s24 offen
 s_add_u32 s24, s20, 175104
 buffer_load_dwordx4 v[128:131], v2, s[4:7], s24 offen
 s_waitcnt vmcnt(18)
 v_mfma_f32_16x16x32_bf16 v[16:19], v[132:135], v[152:155], v[16:19]
 v_mfma_f32_16x16x32_bf16 v[20:23], v[132:135], v[156:159], v[20:23]
 v_mfma_f32_16x16x32_bf16 v[24:27], v[132:135], v[160:163], v[24:27]
 v_mfma_f32_16x16x32_bf16 v[28:31], v[132:135], v[164:167], v[28:31]
 v_mfma_f32_16x16x32_bf16 v[32:35], v[136:139], v[152:155], v[32:35]
 v_mfma_f32_16x16x32_bf16 v[36:39], v[136:139], v[156:159], v[36:39]
 v_mfma_f32_16x16x32_bf16 v[40:43], v[136:139], v[160:163], v[40:43]
 v_mfma_f32_16x16x32_bf16 v[44:47], v[136:139], v[164:167], v[44:47]
 v_mfma_f32_16x16x32_bf16 v[48:51], v[140:143], v[152:155], v[48:51]
 v_mfma_f32_16x16x32_bf16 v[52:55], v[140:143], v[156:159], v[52:55]
 v_mfma_f32_16x16x32_bf16 v[56:59], v[140:143], v[160:163], v[56:59]
 v_mfma_f32_16x16x32_bf16 v[60:63], v[140:143], v[164:167], v[60:63]
 v_mfma_f32_16x16x32_bf16 v[64:67], v[144:147], v[152:155], v[64:67]
 v_mfma_f32_16x16x32_bf16 v[68:71], v[144:147], v[156:159], v[68:71]
 v_mfma_f32_16x16x32_bf16 v[72:75], v[144:147], v[160:163], v[72:75]
 v_mfma_f32_16x16x32_bf16 v[76:79], v[144:147], v[164:167], v[76:79]
 v_mfma_f32_16x16x32_bf16 v[80:83], v[148:151], v[152:155], v[80:83]
 v_mfma_f32_16x16x32_bf16 v[84:87], v[148:151], v[156:159], v[84:87]
 v_mfma_f32_16x16x32_bf16 v[88:91], v[148:151], v[160:163], v[88:91]
 v_mfma_f32_16x16x32_bf16 v[92:95], v[148:151], v[164:167], v[92:95]
 s_add_u32 s24, s19, 51200
 buffer_load_dwordx4 v[132:135], v2, s[4:7], s24 offen offset:0
 buffer_load_dwordx4 v[136:139], v2, s[4:7], s24 offen offset:1024
 buffer_load_dwordx4 v[140:143], v2, s[4:7], s24 offen offset:2048
 buffer_load_dwordx4 v[144:147], v2, s[4:7], s24 offen offset:3072
 s_add_u32 s24, s24, 4096
 buffer_load_dwordx4 v[148:151], v2, s[4:7], s24 offen
 s_add_u32 s24, s20, 10240
 buffer_load_dwordx4 v[152:155], v2, s[4:7], s24 offen
 s_add_u32 s24, s20, 65536
 buffer_load_dwordx4 v[156:159], v2, s[4:7], s24 offen
 s_add_u32 s24, s20, 120832
 buffer_load_dwordx4 v[160:163], v2, s[4:7], s24 offen
 s_add_u32 s24, s20, 176128
 buffer_load_dwordx4 v[164:167], v2, s[4:7], s24 offen
 s_waitcnt vmcnt(18)
 v_mfma_f32_16x16x32_bf16 v[16:19], v[168:171], v[188:191], v[16:19]
 v_mfma_f32_16x16x32_bf16 v[20:23], v[168:171], v[192:195], v[20:23]
 v_mfma_f32_16x16x32_bf16 v[24:27], v[168:171], v[196:199], v[24:27]
 v_mfma_f32_16x16x32_bf16 v[28:31], v[168:171], v[200:203], v[28:31]
 v_mfma_f32_16x16x32_bf16 v[32:35], v[172:175], v[188:191], v[32:35]
 v_mfma_f32_16x16x32_bf16 v[36:39], v[172:175], v[192:195], v[36:39]
 v_mfma_f32_16x16x32_bf16 v[40:43], v[172:175], v[196:199], v[40:43]
 v_mfma_f32_16x16x32_bf16 v[44:47], v[172:175], v[200:203], v[44:47]
 v_mfma_f32_16x16x32_bf16 v[48:51], v[176:179], v[188:191], v[48:51]
 v_mfma_f32_16x16x32_bf16 v[52:55], v[176:179], v[192:195], v[52:55]
 v_mfma_f32_16x16x32_bf16 v[56:59], v[176:179], v[196:199], v[56:59]
 v_mfma_f32_16x16x32_bf16 v[60:63], v[176:179], v[200:203], v[60:63]
 v_mfma_f32_16x16x32_bf16 v[64:67], v[180:183], v[188:191], v[64:67]
 v_mfma_f32_16x16x32_bf16 v[68:71], v[180:183], v[192:195], v[68:71]
 v_mfma_f32_16x16x32_bf16 v[72:75], v[180:183], v[196:199], v[72:75]
 v_mfma_f32_16x16x32_bf16 v[76:79], v[180:183], v[200:203], v[76:79]
 v_mfma_f32_16x16x32_bf16 v[80:83], v[184:187], v[188:191], v[80:83]
 v_mfma_f32_16x16x32_bf16 v[84:87], v[184:187], v[192:195], v[84:87]
 v_mfma_f32_16x16x32_bf16 v[88:91], v[184:187], v[196:199], v[88:91]
 v_mfma_f32_16x16x32_bf16 v[92:95], v[184:187], v[200:203], v[92:95]
 s_add_u32 s24, s19, 56320
 buffer_load_dwordx4 v[168:171], v2, s[4:7], s24 offen offset:0
 buffer_load_dwordx4 v[172:175], v2, s[4:7], s24 offen offset:1024
 buffer_load_dwordx4 v[176:179], v2, s[4:7], s24 offen offset:2048
 buffer_load_dwordx4 v[180:183], v2, s[4:7], s24 offen offset:3072
 s_add_u32 s24, s24, 4096
 buffer_load_dwordx4 v[184:187], v2, s[4:7], s24 offen
 s_add_u32 s24, s20, 11264
 buffer_load_dwordx4 v[188:191], v2, s[4:7], s24 offen
 s_add_u32 s24, s20, 66560
 buffer_load_dwordx4 v[192:195], v2, s[4:7], s24 offen
 s_add_u32 s24, s20, 121856
 buffer_load_dwordx4 v[196:199], v2, s[4:7], s24 offen
 s_add_u32 s24, s20, 177152
 buffer_load_dwordx4 v[200:203], v2, s[4:7], s24 offen
 s_waitcnt vmcnt(18)
 v_mfma_f32_16x16x32_bf16 v[16:19], v[96:99], v[116:119], v[16:19]
 v_mfma_f32_16x16x32_bf16 v[20:23], v[96:99], v[120:123], v[20:23]
 v_mfma_f32_16x16x32_bf16 v[24:27], v[96:99], v[124:127], v[24:27]
 v_mfma_f32_16x16x32_bf16 v[28:31], v[96:99], v[128:131], v[28:31]
 v_mfma_f32_16x16x32_bf16 v[32:35], v[100:103], v[116:119], v[32:35]
 v_mfma_f32_16x16x32_bf16 v[36:39], v[100:103], v[120:123], v[36:39]
 v_mfma_f32_16x16x32_bf16 v[40:43], v[100:103], v[124:127], v[40:43]
 v_mfma_f32_16x16x32_bf16 v[44:47], v[100:103], v[128:131], v[44:47]
 v_mfma_f32_16x16x32_bf16 v[48:51], v[104:107], v[116:119], v[48:51]
 v_mfma_f32_16x16x32_bf16 v[52:55], v[104:107], v[120:123], v[52:55]
 v_mfma_f32_16x16x32_bf16 v[56:59], v[104:107], v[124:127], v[56:59]
 v_mfma_f32_16x16x32_bf16 v[60:63], v[104:107], v[128:131], v[60:63]
 v_mfma_f32_16x16x32_bf16 v[64:67], v[108:111], v[116:119], v[64:67]
 v_mfma_f32_16x16x32_bf16 v[68:71], v[108:111], v[120:123], v[68:71]
 v_mfma_f32_16x16x32_bf16 v[72:75], v[108:111], v[124:127], v[72:75]
 v_mfma_f32_16x16x32_bf16 v[76:79], v[108:111], v[128:131], v[76:79]
 v_mfma_f32_16x16x32_bf16 v[80:83], v[112:115], v[116:119], v[80:83]
 v_mfma_f32_16x16x32_bf16 v[84:87], v[112:115], v[120:123], v[84:87]
 v_mfma_f32_16x16x32_bf16 v[88:91], v[112:115], v[124:127], v[88:91]
 v_mfma_f32_16x16x32_bf16 v[92:95], v[112:115], v[128:131], v[92:95]
 s_add_u32 s24, s19, 61440
 buffer_load_dwordx4 v[96:99], v2, s[4:7], s24 offen offset:0
 buffer_load_dwordx4 v[100:103], v2, s[4:7], s24 offen offset:1024
 buffer_load_dwordx4 v[104:107], v2, s[4:7], s24 offen offset:2048
 buffer_load_dwordx4 v[108:111], v2, s[4:7], s24 offen offset:3072
 s_add_u32 s24, s24, 4096
 buffer_load_dwordx4 v[112:115], v2, s[4:7], s24 offen
 s_add_u32 s24, s20, 12288
 buffer_load_dwordx4 v[116:119], v2, s[4:7], s24 offen
 s_add_u32 s24, s20, 67584
 buffer_load_dwordx4 v[120:123], v2, s[4:7], s24 offen
 s_add_u32 s24, s20, 122880
 buffer_load_dwordx4 v[124:127], v2, s[4:7], s24 offen
 s_add_u32 s24, s20, 178176
 buffer_load_dwordx4 v[128:131], v2, s[4:7], s24 offen
 s_waitcnt vmcnt(18)
 v_mfma_f32_16x16x32_bf16 v[16:19], v[132:135], v[152:155], v[16:19]
 v_mfma_f32_16x16x32_bf16 v[20:23], v[132:135], v[156:159], v[20:23]
 v_mfma_f32_16x16x32_bf16 v[24:27], v[132:135], v[160:163], v[24:27]
 v_mfma_f32_16x16x32_bf16 v[28:31], v[132:135], v[164:167], v[28:31]
 v_mfma_f32_16x16x32_bf16 v[32:35], v[136:139], v[152:155], v[32:35]
 v_mfma_f32_16x16x32_bf16 v[36:39], v[136:139], v[156:159], v[36:39]
 v_mfma_f32_16x16x32_bf16 v[40:43], v[136:139], v[160:163], v[40:43]
 v_mfma_f32_16x16x32_bf16 v[44:47], v[136:139], v[164:167], v[44:47]
 v_mfma_f32_16x16x32_bf16 v[48:51], v[140:143], v[152:155], v[48:51]
 v_mfma_f32_16x16x32_bf16 v[52:55], v[140:143], v[156:159], v[52:55]
 v_mfma_f32_16x16x32_bf16 v[56:59], v[140:143], v[160:163], v[56:59]
 v_mfma_f32_16x16x32_bf16 v[60:63], v[140:143], v[164:167], v[60:63]
 v_mfma_f32_16x16x32_bf16 v[64:67], v[144:147], v[152:155], v[64:67]
 v_mfma_f32_16x16x32_bf16 v[68:71], v[144:147], v[156:159], v[68:71]
 v_mfma_f32_16x16x32_bf16 v[72:75], v[144:147], v[160:163], v[72:75]
 v_mfma_f32_16x16x32_bf16 v[76:79], v[144:147], v[164:167], v[76:79]
 v_mfma_f32_16x16x32_bf16 v[80:83], v[148:151], v[152:155], v[80:83]
 v_mfma_f32_16x16x32_bf16 v[84:87], v[148:151], v[156:159], v[84:87]
 v_mfma_f32_16x16x32_bf16 v[88:91], v[148:151], v[160:163], v[88:91]
 v_mfma_f32_16x16x32_bf16 v[92:95], v[148:151], v[164:167], v[92:95]
 s_add_u32 s24, s19, 66560
 buffer_load_dwordx4 v[132:135], v2, s[4:7], s24 offen offset:0
 buffer_load_dwordx4 v[136:139], v2, s[4:7], s24 offen offset:1024
 buffer_load_dwordx4 v[140:143], v2, s[4:7], s24 offen offset:2048
 buffer_load_dwordx4 v[144:147], v2, s[4:7], s24 offen offset:3072
 s_add_u32 s24, s24, 4096
 buffer_load_dwordx4 v[148:151], v2, s[4:7], s24 offen
 s_add_u32 s24, s20, 13312
 buffer_load_dwordx4 v[152:155], v2, s[4:7], s24 offen
 s_add_u32 s24, s20, 68608
 buffer_load_dwordx4 v[156:159], v2, s[4:7], s24 offen
 s_add_u32 s24, s20, 123904
 buffer_load_dwordx4 v[160:163], v2, s[4:7], s24 offen
 s_add_u32 s24, s20, 179200
 buffer_load_dwordx4 v[164:167], v2, s[4:7], s24 offen
 s_waitcnt vmcnt(18)
 v_mfma_f32_16x16x32_bf16 v[16:19], v[168:171], v[188:191], v[16:19]
 v_mfma_f32_16x16x32_bf16 v[20:23], v[168:171], v[192:195], v[20:23]
 v_mfma_f32_16x16x32_bf16 v[24:27], v[168:171], v[196:199], v[24:27]
 v_mfma_f32_16x16x32_bf16 v[28:31], v[168:171], v[200:203], v[28:31]
 v_mfma_f32_16x16x32_bf16 v[32:35], v[172:175], v[188:191], v[32:35]
 v_mfma_f32_16x16x32_bf16 v[36:39], v[172:175], v[192:195], v[36:39]
 v_mfma_f32_16x16x32_bf16 v[40:43], v[172:175], v[196:199], v[40:43]
 v_mfma_f32_16x16x32_bf16 v[44:47], v[172:175], v[200:203], v[44:47]
 v_mfma_f32_16x16x32_bf16 v[48:51], v[176:179], v[188:191], v[48:51]
 v_mfma_f32_16x16x32_bf16 v[52:55], v[176:179], v[192:195], v[52:55]
 v_mfma_f32_16x16x32_bf16 v[56:59], v[176:179], v[196:199], v[56:59]
 v_mfma_f32_16x16x32_bf16 v[60:63], v[176:179], v[200:203], v[60:63]
 v_mfma_f32_16x16x32_bf16 v[64:67], v[180:183], v[188:191], v[64:67]
 v_mfma_f32_16x16x32_bf16 v[68:71], v[180:183], v[192:195], v[68:71]
 v_mfma_f32_16x16x32_bf16 v[72:75], v[180:183], v[196:199], v[72:75]
 v_mfma_f32_16x16x32_bf16 v[76:79], v[180:183], v[200:203], v[76:79]
 v_mfma_f32_16x16x32_bf16 v[80:83], v[184:187], v[188:191], v[80:83]
 v_mfma_f32_16x16x32_bf16 v[84:87], v[184:187], v[192:195], v[84:87]
 v_mfma_f32_16x16x32_bf16 v[88:91], v[184:187], v[196:199], v[88:91]
 v_mfma_f32_16x16x32_bf16 v[92:95], v[184:187], v[200:203], v[92:95]
 s_waitcnt vmcnt(9)
 v_mfma_f32_16x16x32_bf16 v[16:19], v[96:99], v[116:119], v[16:19]
 v_mfma_f32_16x16x32_bf16 v[20:23], v[96:99], v[120:123], v[20:23]
 v_mfma_f32_16x16x32_bf16 v[24:27], v[96:99], v[124:127], v[24:27]
 v_mfma_f32_16x16x32_bf16 v[28:31], v[96:99], v[128:131], v[28:31]
 v_mfma_f32_16x16x32_bf16 v[32:35], v[100:103], v[116:119], v[32:35]
 v_mfma_f32_16x16x32_bf16 v[36:39], v[100:103], v[120:123], v[36:39]
 v_mfma_f32_16x16x32_bf16 v[40:43], v[100:103], v[124:127], v[40:43]
 v_mfma_f32_16x16x32_bf16 v[44:47], v[100:103], v[128:131], v[44:47]
 v_mfma_f32_16x16x32_bf16 v[48:51], v[104:107], v[116:119], v[48:51]
 v_mfma_f32_16x16x32_bf16 v[52:55], v[104:107], v[120:123], v[52:55]
 v_mfma_f32_16x16x32_bf16 v[56:59], v[104:107], v[124:127], v[56:59]
 v_mfma_f32_16x16x32_bf16 v[60:63], v[104:107], v[128:131], v[60:63]
 v_mfma_f32_16x16x32_bf16 v[64:67], v[108:111], v[116:119], v[64:67]
 v_mfma_f32_16x16x32_bf16 v[68:71], v[108:111], v[120:123], v[68:71]
 v_mfma_f32_16x16x32_bf16 v[72:75], v[108:111], v[124:127], v[72:75]
 v_mfma_f32_16x16x32_bf16 v[76:79], v[108:111], v[128:131], v[76:79]
 v_mfma_f32_16x16x32_bf16 v[80:83], v[112:115], v[116:119], v[80:83]
 v_mfma_f32_16x16x32_bf16 v[84:87], v[112:115], v[120:123], v[84:87]
 v_mfma_f32_16x16x32_bf16 v[88:91], v[112:115], v[124:127], v[88:91]
 v_mfma_f32_16x16x32_bf16 v[92:95], v[112:115], v[128:131], v[92:95]
 s_cmp_eq_u32 s30, 0
 s_cbranch_scc1 L_k2_final
 s_waitcnt vmcnt(0)
 v_mfma_f32_16x16x32_bf16 v[16:19], v[132:135], v[152:155], v[16:19]
 v_mfma_f32_16x16x32_bf16 v[20:23], v[132:135], v[156:159], v[20:23]
 v_mfma_f32_16x16x32_bf16 v[24:27], v[132:135], v[160:163], v[24:27]
 v_mfma_f32_16x16x32_bf16 v[28:31], v[132:135], v[164:167], v[28:31]
 v_mfma_f32_16x16x32_bf16 v[32:35], v[136:139], v[152:155], v[32:35]
 v_mfma_f32_16x16x32_bf16 v[36:39], v[136:139], v[156:159], v[36:39]
 v_mfma_f32_16x16x32_bf16 v[40:43], v[136:139], v[160:163], v[40:43]
 v_mfma_f32_16x16x32_bf16 v[44:47], v[136:139], v[164:167], v[44:47]
 v_mfma_f32_16x16x32_bf16 v[48:51], v[140:143], v[152:155], v[48:51]
 v_mfma_f32_16x16x32_bf16 v[52:55], v[140:143], v[156:159], v[52:55]
 v_mfma_f32_16x16x32_bf16 v[56:59], v[140:143], v[160:163], v[56:59]
 v_mfma_f32_16x16x32_bf16 v[60:63], v[140:143], v[164:167], v[60:63]
 v_mfma_f32_16x16x32_bf16 v[64:67], v[144:147], v[152:155], v[64:67]
 v_mfma_f32_16x16x32_bf16 v[68:71], v[144:147], v[156:159], v[68:71]
 v_mfma_f32_16x16x32_bf16 v[72:75], v[144:147], v[160:163], v[72:75]
 v_mfma_f32_16x16x32_bf16 v[76:79], v[144:147], v[164:167], v[76:79]
 v_mfma_f32_16x16x32_bf16 v[80:83], v[148:151], v[152:155], v[80:83]
 v_mfma_f32_16x16x32_bf16 v[84:87], v[148:151], v[156:159], v[84:87]
 v_mfma_f32_16x16x32_bf16 v[88:91], v[148:151], v[160:163], v[88:91]
 v_mfma_f32_16x16x32_bf16 v[92:95], v[148:151], v[164:167], v[92:95]
 s_branch L_k2_final
L_k2_owave:
 s_setprio 3
 s_sub_u32 s21, s16, 4
 s_mul_i32 s26, s16, 20480
 s_lshl_b32 s24, s18, 2
 s_add_u32 s24, s24, s21
 s_mul_i32 s24, s24, 3840
 s_add_u32 s24, s24, 18874368
 buffer_load_dwordx4 v[16:19], v2, s[4:7], s24 offen offset:0
 buffer_load_dwordx4 v[20:23], v2, s[4:7], s24 offen offset:1024
 buffer_load_dwordx4 v[24:27], v2, s[4:7], s24 offen offset:2048
 buffer_load_dwordx4 v[28:31], v2, s[4:7], s24 offen offset:3072
 s_mul_i32 s24, s17, 81920
 s_lshl_b32 s25, s18, 2
 s_add_u32 s25, s25, s21
 s_mul_i32 s25, s25, 2560
 s_add_u32 s24, s24, s25
 s_add_u32 s24, s24, 7340032
 v_mul_u32_u24 v8, 40, v3
 buffer_load_dwordx2 v[96:97], v8, s[4:7], s24 offen offset:0
 buffer_load_dwordx2 v[98:99], v8, s[4:7], s24 offen offset:8
 buffer_load_dwordx2 v[100:101], v8, s[4:7], s24 offen offset:16
 buffer_load_dwordx2 v[102:103], v8, s[4:7], s24 offen offset:24
 buffer_load_dwordx2 v[104:105], v8, s[4:7], s24 offen offset:32
 v_mov_b32 v4, 0
 v_mov_b32 v5, 0
 v_mov_b32 v6, 0
 v_mov_b32 v7, 0
 v_add_u32 v9, s26, v2
 ds_write_b128 v9, v[4:7] offset:0
 ds_write_b128 v9, v[4:7] offset:1024
 ds_write_b128 v9, v[4:7] offset:2048
 ds_write_b128 v9, v[4:7] offset:3072
 ds_write_b128 v9, v[4:7] offset:4096
 ds_write_b128 v9, v[4:7] offset:5120
 ds_write_b128 v9, v[4:7] offset:6144
 ds_write_b128 v9, v[4:7] offset:7168
 ds_write_b128 v9, v[4:7] offset:8192
 ds_write_b128 v9, v[4:7] offset:9216
 ds_write_b128 v9, v[4:7] offset:10240
 ds_write_b128 v9, v[4:7] offset:11264
 ds_write_b128 v9, v[4:7] offset:12288
 ds_write_b128 v9, v[4:7] offset:13312
 ds_write_b128 v9, v[4:7] offset:14336
 ds_write_b128 v9, v[4:7] offset:15360
 s_barrier
 s_mov_b32 s28, s26
 v_add_u32 v9, 0, v3
 v_mul_u32_u24 v10, 6554, v9
 v_lshrrev_b32 v10, 16, v10
 v_mul_u32_u24 v11, 10, v10
 v_sub_u32 v11, v9, v11
 v_mul_u32_u24 v12, 144, v10
 v_lshl_add_u32 v12, v11, 3, v12
 v_add_u32 v40, s28, v12
 v_add_u32 v9, 64, v3
 v_mul_u32_u24 v10, 6554, v9
 v_lshrrev_b32 v10, 16, v10
 v_mul_u32_u24 v11, 10, v10
 v_sub_u32 v11, v9, v11
 v_mul_u32_u24 v12, 144, v10
 v_lshl_add_u32 v12, v11, 3, v12
 v_add_u32 v41, s28, v12
 v_add_u32 v9, 128, v3
 v_mul_u32_u24 v10, 6554, v9
 v_lshrrev_b32 v10, 16, v10
 v_mul_u32_u24 v11, 10, v10
 v_sub_u32 v11, v9, v11
 v_mul_u32_u24 v12, 144, v10
 v_lshl_add_u32 v12, v11, 3, v12
 v_add_u32 v42, s28, v12
 v_add_u32 v9, 192, v3
 v_mul_u32_u24 v10, 6554, v9
 v_lshrrev_b32 v10, 16, v10
 v_mul_u32_u24 v11, 10, v10
 v_sub_u32 v11, v9, v11
 v_mul_u32_u24 v12, 144, v10
 v_lshl_add_u32 v12, v11, 3, v12
 v_add_u32 v43, s28, v12
 v_lshlrev_b32 v12, 3, v11
 v_add_u32 v44, s28, v12
 v_cmp_eq_u32 s[46:47], 20, v10
 v_cmp_gt_u32 s[48:49], 20, v10
 v_and_b32 v9, 15, v3
 v_lshrrev_b32 v10, 4, v3
 v_mul_u32_u24 v11, 144, v9
 v_lshl_add_u32 v11, v10, 4, v11
 v_add_u32 v11, s26, v11
 s_mul_i32 s24, s18, 20
 s_mul_i32 s25, s21, 5
 s_add_u32 s24, s24, s25
 v_add_u32 v12, s24, v10
 v_add_u32 v13, 4, v12
 v_lshrrev_b32 v14, 1, v12
 v_lshlrev_b32 v14, 8, v14
 v_and_b32 v12, 1, v12
 v_lshl_add_u32 v12, v12, 3, v14
 v_lshl_add_u32 v12, v9, 4, v12
 v_lshrrev_b32 v14, 1, v13
 v_lshlrev_b32 v14, 8, v14
 v_and_b32 v13, 1, v13
 v_lshl_add_u32 v13, v13, 3, v14
 v_lshl_add_u32 v13, v9, 4, v13
 v_mov_b32 v14, 0x80000000
 v_cmp_eq_u32 vcc, 0, v10
 s_mul_i32 s24, s17, 81920
 s_add_u32 s24, s24, 15728640
 v_cndmask_b32 v13, v14, v13, vcc
 s_waitcnt vmcnt(5)
 v_cvt_pk_bf16_f32 v16, v16, v17
 v_cvt_pk_bf16_f32 v17, v18, v19
 v_cvt_pk_bf16_f32 v20, v20, v21
 v_cvt_pk_bf16_f32 v21, v22, v23
 v_cvt_pk_bf16_f32 v24, v24, v25
 v_cvt_pk_bf16_f32 v25, v26, v27
 v_cvt_pk_bf16_f32 v28, v28, v29
 v_cvt_pk_bf16_f32 v29, v30, v31
 ds_write_b64 v40, v[16:17]
 ds_write_b64 v41, v[20:21]
 ds_write_b64 v42, v[24:25]
 s_mov_b64 s[50:51], exec
 s_mov_b64 exec, s[48:49]
 ds_write_b64 v43, v[28:29]
 s_mov_b64 exec, s[46:47]
 ds_write_b64 v44, v[28:29] offset:4608
 ds_write_b64 v44, v[28:29] offset:4752
 ds_write_b64 v44, v[28:29] offset:4896
 ds_write_b64 v44, v[28:29] offset:5040
 ds_write_b64 v44, v[28:29] offset:5184
 ds_write_b64 v44, v[28:29] offset:5328
 ds_write_b64 v44, v[28:29] offset:5472
 ds_write_b64 v44, v[28:29] offset:5616
 ds_write_b64 v44, v[28:29] offset:5760
 ds_write_b64 v44, v[28:29] offset:5904
 ds_write_b64 v44, v[28:29] offset:6048
 ds_write_b64 v44, v[28:29] offset:6192
 ds_write_b64 v44, v[28:29] offset:6336
 ds_write_b64 v44, v[28:29] offset:6480
 ds_write_b64 v44, v[28:29] offset:6624
 ds_write_b64 v44, v[28:29] offset:6768
 s_mov_b64 exec, s[50:51]
 s_waitcnt lgkmcnt(0)
 ds_read_b128 v[48:51], v11 offset:0
 ds_read_b128 v[52:55], v11 offset:64
 ds_read_b128 v[56:59], v11 offset:2304
 ds_read_b128 v[60:63], v11 offset:2368
 ds_read_b128 v[64:67], v11 offset:4608
 ds_read_b128 v[68:71], v11 offset:4672
 s_waitcnt vmcnt(0)
 s_mov_b32 s32, 0x3fb8aa3b
 v_lshlrev_b32 v106, 16, v96
 v_and_b32 v107, 0xffff0000, v96
 v_lshlrev_b32 v108, 16, v97
 v_and_b32 v109, 0xffff0000, v97
 v_lshlrev_b32 v110, 16, v98
 v_and_b32 v111, 0xffff0000, v98
 v_lshlrev_b32 v112, 16, v99
 v_and_b32 v113, 0xffff0000, v99
 v_lshlrev_b32 v114, 16, v100
 v_and_b32 v115, 0xffff0000, v100
 v_lshlrev_b32 v116, 16, v101
 v_and_b32 v117, 0xffff0000, v101
 v_lshlrev_b32 v118, 16, v102
 v_and_b32 v119, 0xffff0000, v102
 v_lshlrev_b32 v120, 16, v103
 v_and_b32 v121, 0xffff0000, v103
 v_lshlrev_b32 v122, 16, v104
 v_and_b32 v123, 0xffff0000, v104
 v_lshlrev_b32 v124, 16, v105
 v_and_b32 v125, 0xffff0000, v105
 v_max3_f32 v146, v106, v107, v108
 v_min3_f32 v147, v106, v107, v108
 v_max3_f32 v148, v109, v110, v111
 v_min3_f32 v149, v109, v110, v111
 v_max3_f32 v146, v146, v112, v113
 v_min3_f32 v147, v147, v112, v113
 v_max3_f32 v148, v148, v114, v115
 v_min3_f32 v149, v149, v114, v115
 v_max3_f32 v146, v146, v116, v117
 v_min3_f32 v147, v147, v116, v117
 v_max3_f32 v148, v148, v118, v119
 v_min3_f32 v149, v149, v118, v119
 v_max3_f32 v146, v146, v120, v121
 v_min3_f32 v147, v147, v120, v121
 v_max3_f32 v148, v148, v122, v123
 v_min3_f32 v149, v149, v122, v123
 v_max3_f32 v146, v146, v124, v125
 v_min3_f32 v147, v147, v124, v125
 v_max_f32 v146, v146, v148
 v_min_f32 v147, v147, v149
 v_mul_f32 v146, s32, v146
 v_mul_f32 v147, s32, v147
 v_fma_f32 v126, -v106, s32, v147
 v_fma_f32 v106, v106, s32, -v146
 v_fma_f32 v127, -v107, s32, v147
 v_fma_f32 v107, v107, s32, -v146
 v_exp_f32 v126, v126
 v_exp_f32 v106, v106
 v_exp_f32 v127, v127
 v_exp_f32 v107, v107
 v_fma_f32 v128, -v108, s32, v147
 v_fma_f32 v108, v108, s32, -v146
 v_fma_f32 v129, -v109, s32, v147
 v_fma_f32 v109, v109, s32, -v146
 v_exp_f32 v128, v128
 v_exp_f32 v108, v108
 v_exp_f32 v129, v129
 v_exp_f32 v109, v109
 v_fma_f32 v130, -v110, s32, v147
 v_fma_f32 v110, v110, s32, -v146
 v_fma_f32 v131, -v111, s32, v147
 v_fma_f32 v111, v111, s32, -v146
 v_exp_f32 v130, v130
 v_exp_f32 v110, v110
 v_exp_f32 v131, v131
 v_exp_f32 v111, v111
 v_fma_f32 v132, -v112, s32, v147
 v_fma_f32 v112, v112, s32, -v146
 v_fma_f32 v133, -v113, s32, v147
 v_fma_f32 v113, v113, s32, -v146
 v_exp_f32 v132, v132
 v_exp_f32 v112, v112
 v_exp_f32 v133, v133
 v_exp_f32 v113, v113
 v_fma_f32 v134, -v114, s32, v147
 v_fma_f32 v114, v114, s32, -v146
 v_fma_f32 v135, -v115, s32, v147
 v_fma_f32 v115, v115, s32, -v146
 v_exp_f32 v134, v134
 v_exp_f32 v114, v114
 v_exp_f32 v135, v135
 v_exp_f32 v115, v115
 v_fma_f32 v136, -v116, s32, v147
 v_fma_f32 v116, v116, s32, -v146
 v_fma_f32 v137, -v117, s32, v147
 v_fma_f32 v117, v117, s32, -v146
 v_exp_f32 v136, v136
 v_exp_f32 v116, v116
 v_exp_f32 v137, v137
 v_exp_f32 v117, v117
 v_fma_f32 v138, -v118, s32, v147
 v_fma_f32 v118, v118, s32, -v146
 v_fma_f32 v139, -v119, s32, v147
 v_fma_f32 v119, v119, s32, -v146
 v_exp_f32 v138, v138
 v_exp_f32 v118, v118
 v_exp_f32 v139, v139
 v_exp_f32 v119, v119
 v_fma_f32 v140, -v120, s32, v147
 v_fma_f32 v120, v120, s32, -v146
 v_fma_f32 v141, -v121, s32, v147
 v_fma_f32 v121, v121, s32, -v146
 v_exp_f32 v140, v140
 v_exp_f32 v120, v120
 v_exp_f32 v141, v141
 v_exp_f32 v121, v121
 v_fma_f32 v142, -v122, s32, v147
 v_fma_f32 v122, v122, s32, -v146
 v_fma_f32 v143, -v123, s32, v147
 v_fma_f32 v123, v123, s32, -v146
 v_exp_f32 v142, v142
 v_exp_f32 v122, v122
 v_exp_f32 v143, v143
 v_exp_f32 v123, v123
 v_fma_f32 v144, -v124, s32, v147
 v_fma_f32 v124, v124, s32, -v146
 v_fma_f32 v145, -v125, s32, v147
 v_fma_f32 v125, v125, s32, -v146
 v_exp_f32 v144, v144
 v_exp_f32 v124, v124
 v_exp_f32 v145, v145
 v_exp_f32 v125, v125
 v_add_f32 v146, v106, v107
 v_add_f32 v147, v126, v127
 v_add_f32 v148, v108, v109
 v_add_f32 v149, v128, v129
 v_add_f32 v146, v146, v110
 v_add_f32 v147, v147, v130
 v_add_f32 v148, v148, v111
 v_add_f32 v149, v149, v131
 v_add_f32 v146, v146, v112
 v_add_f32 v147, v147, v132
 v_add_f32 v148, v148, v113
 v_add_f32 v149, v149, v133
 v_add_f32 v146, v146, v114
 v_add_f32 v147, v147, v134
 v_add_f32 v148, v148, v115
 v_add_f32 v149, v149, v135
 v_add_f32 v146, v146, v116
 v_add_f32 v147, v147, v136
 v_add_f32 v148, v148, v117
 v_add_f32 v149, v149, v137
 v_add_f32 v146, v146, v118
 v_add_f32 v147, v147, v138
 v_add_f32 v148, v148, v119
 v_add_f32 v149, v149, v139
 v_add_f32 v146, v146, v120
 v_add_f32 v147, v147, v140
 v_add_f32 v148, v148, v121
 v_add_f32 v149, v149, v141
 v_add_f32 v146, v146, v122
 v_add_f32 v147, v147, v142
 v_add_f32 v148, v148, v123
 v_add_f32 v149, v149, v143
 v_add_f32 v146, v146, v124
 v_add_f32 v147, v147, v144
 v_add_f32 v148, v148, v125
 v_add_f32 v149, v149, v145
 v_add_f32 v146, v146, v148
 v_add_f32 v147, v147, v149
 v_rcp_f32 v146, v146
 v_rcp_f32 v147, v147
 v_mul_f32 v106, v106, v146
 v_mul_f32 v107, v107, v146
 v_mul_f32 v126, v126, v147
 v_mul_f32 v127, v127, v147
 v_cvt_pk_bf16_f32 v152, v106, v107
 v_cvt_pk_bf16_f32 v162, v126, v127
 v_mul_f32 v108, v108, v146
 v_mul_f32 v109, v109, v146
 v_mul_f32 v128, v128, v147
 v_mul_f32 v129, v129, v147
 v_cvt_pk_bf16_f32 v153, v108, v109
 v_cvt_pk_bf16_f32 v163, v128, v129
 v_mul_f32 v110, v110, v146
 v_mul_f32 v111, v111, v146
 v_mul_f32 v130, v130, v147
 v_mul_f32 v131, v131, v147
 v_cvt_pk_bf16_f32 v154, v110, v111
 v_cvt_pk_bf16_f32 v164, v130, v131
 v_mul_f32 v112, v112, v146
 v_mul_f32 v113, v113, v146
 v_mul_f32 v132, v132, v147
 v_mul_f32 v133, v133, v147
 v_cvt_pk_bf16_f32 v155, v112, v113
 v_cvt_pk_bf16_f32 v165, v132, v133
 v_mul_f32 v114, v114, v146
 v_mul_f32 v115, v115, v146
 v_mul_f32 v134, v134, v147
 v_mul_f32 v135, v135, v147
 v_cvt_pk_bf16_f32 v156, v114, v115
 v_cvt_pk_bf16_f32 v166, v134, v135
 v_mul_f32 v116, v116, v146
 v_mul_f32 v117, v117, v146
 v_mul_f32 v136, v136, v147
 v_mul_f32 v137, v137, v147
 v_cvt_pk_bf16_f32 v157, v116, v117
 v_cvt_pk_bf16_f32 v167, v136, v137
 v_mul_f32 v118, v118, v146
 v_mul_f32 v119, v119, v146
 v_mul_f32 v138, v138, v147
 v_mul_f32 v139, v139, v147
 v_cvt_pk_bf16_f32 v158, v118, v119
 v_cvt_pk_bf16_f32 v168, v138, v139
 v_mul_f32 v120, v120, v146
 v_mul_f32 v121, v121, v146
 v_mul_f32 v140, v140, v147
 v_mul_f32 v141, v141, v147
 v_cvt_pk_bf16_f32 v159, v120, v121
 v_cvt_pk_bf16_f32 v169, v140, v141
 v_mul_f32 v122, v122, v146
 v_mul_f32 v123, v123, v146
 v_mul_f32 v142, v142, v147
 v_mul_f32 v143, v143, v147
 v_cvt_pk_bf16_f32 v160, v122, v123
 v_cvt_pk_bf16_f32 v170, v142, v143
 v_mul_f32 v124, v124, v146
 v_mul_f32 v125, v125, v146
 v_mul_f32 v144, v144, v147
 v_mul_f32 v145, v145, v147
 v_cvt_pk_bf16_f32 v161, v124, v125
 v_cvt_pk_bf16_f32 v171, v144, v145
 v_mul_u32_u24 v8, 144, v3
 v_add_u32 v8, s26, v8
 ds_write_b128 v8, v[152:155] offset:6912
 ds_write_b128 v8, v[156:159] offset:6928
 ds_write_b128 v8, v[160:163] offset:6944
 ds_write_b128 v8, v[164:167] offset:6960
 ds_write_b128 v8, v[168:171] offset:6976
 s_waitcnt lgkmcnt(0)
 ds_read_b128 v[176:179], v11 offset:6912
 ds_read_b128 v[180:183], v11 offset:6976
 ds_read_b128 v[184:187], v11 offset:9216
 ds_read_b128 v[188:191], v11 offset:9280
 ds_read_b128 v[192:195], v11 offset:11520
 ds_read_b128 v[196:199], v11 offset:11584
 ds_read_b128 v[200:203], v11 offset:13824
 ds_read_b128 v[204:207], v11 offset:13888
 s_waitcnt lgkmcnt(0)
 v_mfma_f32_16x16x32_bf16 v[72:75], v[48:51], v[176:179], 0
 v_mfma_f32_16x16x32_bf16 v[72:75], v[52:55], v[180:183], v[72:75]
 v_mfma_f32_16x16x32_bf16 v[76:79], v[56:59], v[176:179], 0
 v_mfma_f32_16x16x32_bf16 v[76:79], v[60:63], v[180:183], v[76:79]
 v_mfma_f32_16x16x32_bf16 v[80:83], v[64:67], v[176:179], 0
 v_mfma_f32_16x16x32_bf16 v[80:83], v[68:71], v[180:183], v[80:83]
 v_mfma_f32_16x16x32_bf16 v[84:87], v[48:51], v[184:187], 0
 v_mfma_f32_16x16x32_bf16 v[84:87], v[52:55], v[188:191], v[84:87]
 v_mfma_f32_16x16x32_bf16 v[88:91], v[56:59], v[184:187], 0
 v_mfma_f32_16x16x32_bf16 v[88:91], v[60:63], v[188:191], v[88:91]
 v_mfma_f32_16x16x32_bf16 v[92:95], v[64:67], v[184:187], 0
 v_mfma_f32_16x16x32_bf16 v[92:95], v[68:71], v[188:191], v[92:95]
 v_mfma_f32_16x16x32_bf16 v[96:99], v[48:51], v[192:195], 0
 v_mfma_f32_16x16x32_bf16 v[96:99], v[52:55], v[196:199], v[96:99]
 v_mfma_f32_16x16x32_bf16 v[100:103], v[56:59], v[192:195], 0
 v_mfma_f32_16x16x32_bf16 v[100:103], v[60:63], v[196:199], v[100:103]
 v_mfma_f32_16x16x32_bf16 v[104:107], v[64:67], v[192:195], 0
 v_mfma_f32_16x16x32_bf16 v[104:107], v[68:71], v[196:199], v[104:107]
 v_mfma_f32_16x16x32_bf16 v[108:111], v[48:51], v[200:203], 0
 v_mfma_f32_16x16x32_bf16 v[108:111], v[52:55], v[204:207], v[108:111]
 v_mfma_f32_16x16x32_bf16 v[112:115], v[56:59], v[200:203], 0
 v_mfma_f32_16x16x32_bf16 v[112:115], v[60:63], v[204:207], v[112:115]
 v_mfma_f32_16x16x32_bf16 v[116:119], v[64:67], v[200:203], 0
 v_mfma_f32_16x16x32_bf16 v[116:119], v[68:71], v[204:207], v[116:119]
 v_cvt_pk_bf16_f32 v6, v80, v80
 v_lshlrev_b32 v6, 16, v6
 v_add_f32 v6, 0x358637bd, v6
 v_cvt_pk_bf16_f32 v6, v6, v6
 v_lshlrev_b32 v6, 16, v6
 v_rcp_f32 v6, v6
 v_cvt_pk_bf16_f32 v4, v72, v73
 v_cvt_pk_bf16_f32 v5, v74, v75
 v_lshlrev_b32 v72, 16, v4
 v_and_b32 v73, 0xffff0000, v4
 v_lshlrev_b32 v74, 16, v5
 v_and_b32 v75, 0xffff0000, v5
 v_mul_f32 v72, v72, v6
 v_mul_f32 v73, v73, v6
 v_mul_f32 v74, v74, v6
 v_mul_f32 v75, v75, v6
 v_cvt_pk_bf16_f32 v72, v72, v73
 v_cvt_pk_bf16_f32 v73, v74, v75
 buffer_store_dwordx2 v[72:73], v12, s[4:7], s24 offen sc1
 v_cvt_pk_bf16_f32 v4, v76, v77
 v_cvt_pk_bf16_f32 v5, v78, v79
 v_lshlrev_b32 v76, 16, v4
 v_and_b32 v77, 0xffff0000, v4
 v_lshlrev_b32 v78, 16, v5
 v_and_b32 v79, 0xffff0000, v5
 v_mul_f32 v76, v76, v6
 v_mul_f32 v77, v77, v6
 v_mul_f32 v78, v78, v6
 v_mul_f32 v79, v79, v6
 v_cvt_pk_bf16_f32 v76, v76, v77
 v_cvt_pk_bf16_f32 v77, v78, v79
 buffer_store_dwordx2 v[76:77], v13, s[4:7], s24 offen sc1
 s_add_u32 s24, s24, 20480
 v_cvt_pk_bf16_f32 v6, v92, v92
 v_lshlrev_b32 v6, 16, v6
 v_add_f32 v6, 0x358637bd, v6
 v_cvt_pk_bf16_f32 v6, v6, v6
 v_lshlrev_b32 v6, 16, v6
 v_rcp_f32 v6, v6
 v_cvt_pk_bf16_f32 v4, v84, v85
 v_cvt_pk_bf16_f32 v5, v86, v87
 v_lshlrev_b32 v84, 16, v4
 v_and_b32 v85, 0xffff0000, v4
 v_lshlrev_b32 v86, 16, v5
 v_and_b32 v87, 0xffff0000, v5
 v_mul_f32 v84, v84, v6
 v_mul_f32 v85, v85, v6
 v_mul_f32 v86, v86, v6
 v_mul_f32 v87, v87, v6
 v_cvt_pk_bf16_f32 v84, v84, v85
 v_cvt_pk_bf16_f32 v85, v86, v87
 buffer_store_dwordx2 v[84:85], v12, s[4:7], s24 offen sc1
 v_cvt_pk_bf16_f32 v4, v88, v89
 v_cvt_pk_bf16_f32 v5, v90, v91
 v_lshlrev_b32 v88, 16, v4
 v_and_b32 v89, 0xffff0000, v4
 v_lshlrev_b32 v90, 16, v5
 v_and_b32 v91, 0xffff0000, v5
 v_mul_f32 v88, v88, v6
 v_mul_f32 v89, v89, v6
 v_mul_f32 v90, v90, v6
 v_mul_f32 v91, v91, v6
 v_cvt_pk_bf16_f32 v88, v88, v89
 v_cvt_pk_bf16_f32 v89, v90, v91
 buffer_store_dwordx2 v[88:89], v13, s[4:7], s24 offen sc1
 s_add_u32 s24, s24, 20480
 v_cvt_pk_bf16_f32 v6, v104, v104
 v_lshlrev_b32 v6, 16, v6
 v_add_f32 v6, 0x358637bd, v6
 v_cvt_pk_bf16_f32 v6, v6, v6
 v_lshlrev_b32 v6, 16, v6
 v_rcp_f32 v6, v6
 v_cvt_pk_bf16_f32 v4, v96, v97
 v_cvt_pk_bf16_f32 v5, v98, v99
 v_lshlrev_b32 v96, 16, v4
 v_and_b32 v97, 0xffff0000, v4
 v_lshlrev_b32 v98, 16, v5
 v_and_b32 v99, 0xffff0000, v5
 v_mul_f32 v96, v96, v6
 v_mul_f32 v97, v97, v6
 v_mul_f32 v98, v98, v6
 v_mul_f32 v99, v99, v6
 v_cvt_pk_bf16_f32 v96, v96, v97
 v_cvt_pk_bf16_f32 v97, v98, v99
 buffer_store_dwordx2 v[96:97], v12, s[4:7], s24 offen sc1
 v_cvt_pk_bf16_f32 v4, v100, v101
 v_cvt_pk_bf16_f32 v5, v102, v103
 v_lshlrev_b32 v100, 16, v4
 v_and_b32 v101, 0xffff0000, v4
 v_lshlrev_b32 v102, 16, v5
 v_and_b32 v103, 0xffff0000, v5
 v_mul_f32 v100, v100, v6
 v_mul_f32 v101, v101, v6
 v_mul_f32 v102, v102, v6
 v_mul_f32 v103, v103, v6
 v_cvt_pk_bf16_f32 v100, v100, v101
 v_cvt_pk_bf16_f32 v101, v102, v103
 buffer_store_dwordx2 v[100:101], v13, s[4:7], s24 offen sc1
 s_add_u32 s24, s24, 20480
 v_cvt_pk_bf16_f32 v6, v116, v116
 v_lshlrev_b32 v6, 16, v6
 v_add_f32 v6, 0x358637bd, v6
 v_cvt_pk_bf16_f32 v6, v6, v6
 v_lshlrev_b32 v6, 16, v6
 v_rcp_f32 v6, v6
 v_cvt_pk_bf16_f32 v4, v108, v109
 v_cvt_pk_bf16_f32 v5, v110, v111
 v_lshlrev_b32 v108, 16, v4
 v_and_b32 v109, 0xffff0000, v4
 v_lshlrev_b32 v110, 16, v5
 v_and_b32 v111, 0xffff0000, v5
 v_mul_f32 v108, v108, v6
 v_mul_f32 v109, v109, v6
 v_mul_f32 v110, v110, v6
 v_mul_f32 v111, v111, v6
 v_cvt_pk_bf16_f32 v108, v108, v109
 v_cvt_pk_bf16_f32 v109, v110, v111
 buffer_store_dwordx2 v[108:109], v12, s[4:7], s24 offen sc1
 v_cvt_pk_bf16_f32 v4, v112, v113
 v_cvt_pk_bf16_f32 v5, v114, v115
 v_lshlrev_b32 v112, 16, v4
 v_and_b32 v113, 0xffff0000, v4
 v_lshlrev_b32 v114, 16, v5
 v_and_b32 v115, 0xffff0000, v5
 v_mul_f32 v112, v112, v6
 v_mul_f32 v113, v113, v6
 v_mul_f32 v114, v114, v6
 v_mul_f32 v115, v115, v6
 v_cvt_pk_bf16_f32 v112, v112, v113
 v_cvt_pk_bf16_f32 v113, v114, v115
 buffer_store_dwordx2 v[112:113], v13, s[4:7], s24 offen sc1
 s_add_u32 s24, s24, 20480
 s_mul_i32 s24, s21, 25600
 s_add_u32 s19, s19, s24
 s_add_u32 s19, s19, 276480
 s_mul_i32 s20, s17, 81920
 s_mul_i32 s24, s21, 5120
 s_add_u32 s20, s20, s24
 s_add_u32 s20, s20, 15728640
 s_nop 1
 s_setprio 0
 s_add_u32 s24, s19, 0
 buffer_load_dwordx4 v[176:179], v2, s[4:7], s24 offen offset:0
 buffer_load_dwordx4 v[180:183], v2, s[4:7], s24 offen offset:1024
 buffer_load_dwordx4 v[184:187], v2, s[4:7], s24 offen offset:2048
 buffer_load_dwordx4 v[188:191], v2, s[4:7], s24 offen offset:3072
 s_add_u32 s24, s24, 4096
 buffer_load_dwordx4 v[192:195], v2, s[4:7], s24 offen
 s_add_u32 s24, s19, 5120
 buffer_load_dwordx4 v[196:199], v2, s[4:7], s24 offen offset:0
 buffer_load_dwordx4 v[200:203], v2, s[4:7], s24 offen offset:1024
 buffer_load_dwordx4 v[204:207], v2, s[4:7], s24 offen offset:2048
 buffer_load_dwordx4 v[208:211], v2, s[4:7], s24 offen offset:3072
 s_add_u32 s24, s24, 4096
 buffer_load_dwordx4 v[212:215], v2, s[4:7], s24 offen
 s_add_u32 s24, s19, 10240
 buffer_load_dwordx4 v[216:219], v2, s[4:7], s24 offen offset:0
 buffer_load_dwordx4 v[220:223], v2, s[4:7], s24 offen offset:1024
 buffer_load_dwordx4 v[224:227], v2, s[4:7], s24 offen offset:2048
 buffer_load_dwordx4 v[228:231], v2, s[4:7], s24 offen offset:3072
 s_add_u32 s24, s24, 4096
 buffer_load_dwordx4 v[232:235], v2, s[4:7], s24 offen
 s_add_u32 s24, s19, 15360
 buffer_load_dwordx4 v[236:239], v2, s[4:7], s24 offen offset:0
 buffer_load_dwordx4 v[240:243], v2, s[4:7], s24 offen offset:1024
 buffer_load_dwordx4 v[244:247], v2, s[4:7], s24 offen offset:2048
 buffer_load_dwordx4 v[248:251], v2, s[4:7], s24 offen offset:3072
 s_add_u32 s24, s24, 4096
 buffer_load_dwordx4 v[252:255], v2, s[4:7], s24 offen
 s_mov_b32 s33, 0x80000
L_k2_prepoll:
 s_add_u32 s24, s20, 61440
 buffer_load_dwordx4 v[108:111], v2, s[4:7], s24 offen offset:0 sc1
 buffer_load_dwordx4 v[124:127], v2, s[4:7], s24 offen offset:1024 sc1
 buffer_load_dwordx4 v[140:143], v2, s[4:7], s24 offen offset:2048 sc1
 buffer_load_dwordx4 v[156:159], v2, s[4:7], s24 offen offset:3072 sc1
 s_add_u32 s24, s24, 4096
 buffer_load_dwordx4 v[172:175], v2, s[4:7], s24 offen sc1
 s_waitcnt vmcnt(0)
 v_max_u32 v4, v108, v110
 v_max3_u32 v4, v4, v124, v126
 v_max3_u32 v4, v4, v140, v142
 v_max3_u32 v4, v4, v156, v158
 v_max3_u32 v4, v4, v172, v174
 v_cmp_eq_u32 vcc, -1, v4
 s_nop 1
 s_cmp_eq_u64 vcc, 0
 s_cbranch_scc1 L_k2_poll
 s_sleep 8
 s_sub_u32 s33, s33, 1
 s_cmp_lg_u32 s33, 0
 s_cbranch_scc1 L_k2_prepoll
 s_mov_b32 s33, 1
L_k2_poll:
 s_add_u32 s24, s20, 0
 buffer_load_dwordx4 v[96:99], v2, s[4:7], s24 offen offset:0
 buffer_load_dwordx4 v[112:115], v2, s[4:7], s24 offen offset:1024
 buffer_load_dwordx4 v[128:131], v2, s[4:7], s24 offen offset:2048
 buffer_load_dwordx4 v[144:147], v2, s[4:7], s24 offen offset:3072
 s_add_u32 s24, s24, 4096
 buffer_load_dwordx4 v[160:163], v2, s[4:7], s24 offen
 s_add_u32 s24, s20, 20480
 buffer_load_dwordx4 v[100:103], v2, s[4:7], s24 offen offset:0
 buffer_load_dwordx4 v[116:119], v2, s[4:7], s24 offen offset:1024
 buffer_load_dwordx4 v[132:135], v2, s[4:7], s24 offen offset:2048
 buffer_load_dwordx4 v[148:151], v2, s[4:7], s24 offen offset:3072
 s_add_u32 s24, s24, 4096
 buffer_load_dwordx4 v[164:167], v2, s[4:7], s24 offen
 s_add_u32 s24, s20, 40960
 buffer_load_dwordx4 v[104:107], v2, s[4:7], s24 offen offset:0
 buffer_load_dwordx4 v[120:123], v2, s[4:7], s24 offen offset:1024
 buffer_load_dwordx4 v[136:139], v2, s[4:7], s24 offen offset:2048
 buffer_load_dwordx4 v[152:155], v2, s[4:7], s24 offen offset:3072
 s_add_u32 s24, s24, 4096
 buffer_load_dwordx4 v[168:171], v2, s[4:7], s24 offen
 s_waitcnt vmcnt(0)
 v_max_u32 v4, v96, v98
 v_max_u32 v5, v100, v102
 v_max3_u32 v4, v4, v104, v106
 v_max3_u32 v5, v5, v108, v110
 v_max3_u32 v4, v4, v112, v114
 v_max3_u32 v5, v5, v116, v118
 v_max3_u32 v4, v4, v120, v122
 v_max3_u32 v5, v5, v124, v126
 v_max3_u32 v4, v4, v128, v130
 v_max3_u32 v5, v5, v132, v134
 v_max3_u32 v4, v4, v136, v138
 v_max3_u32 v5, v5, v140, v142
 v_max3_u32 v4, v4, v144, v146
 v_max3_u32 v5, v5, v148, v150
 v_max3_u32 v4, v4, v152, v154
 v_max3_u32 v5, v5, v156, v158
 v_max3_u32 v4, v4, v160, v162
 v_max3_u32 v5, v5, v164, v166
 v_max3_u32 v4, v4, v168, v170
 v_max3_u32 v5, v5, v172, v174
 v_max_u32 v4, v4, v5
 v_cmp_eq_u32 vcc, -1, v4
 s_nop 1
 s_cmp_eq_u64 vcc, 0
 s_cbranch_scc1 L_k2_go
L_k2_poll2:
 s_add_u32 s24, s20, 0
 buffer_load_dwordx4 v[96:99], v2, s[4:7], s24 offen offset:0 sc1
 buffer_load_dwordx4 v[112:115], v2, s[4:7], s24 offen offset:1024 sc1
 buffer_load_dwordx4 v[128:131], v2, s[4:7], s24 offen offset:2048 sc1
 buffer_load_dwordx4 v[144:147], v2, s[4:7], s24 offen offset:3072 sc1
 s_add_u32 s24, s24, 4096
 buffer_load_dwordx4 v[160:163], v2, s[4:7], s24 offen sc1
 s_add_u32 s24, s20, 20480
 buffer_load_dwordx4 v[100:103], v2, s[4:7], s24 offen offset:0 sc1
 buffer_load_dwordx4 v[116:119], v2, s[4:7], s24 offen offset:1024 sc1
 buffer_load_dwordx4 v[132:135], v2, s[4:7], s24 offen offset:2048 sc1
 buffer_load_dwordx4 v[148:151], v2, s[4:7], s24 offen offset:3072 sc1
 s_add_u32 s24, s24, 4096
 buffer_load_dwordx4 v[164:167], v2, s[4:7], s24 offen sc1
 s_add_u32 s24, s20, 40960
 buffer_load_dwordx4 v[104:107], v2, s[4:7], s24 offen offset:0 sc1
 buffer_load_dwordx4 v[120:123], v2, s[4:7], s24 offen offset:1024 sc1
 buffer_load_dwordx4 v[136:139], v2, s[4:7], s24 offen offset:2048 sc1
 buffer_load_dwordx4 v[152:155], v2, s[4:7], s24 offen offset:3072 sc1
 s_add_u32 s24, s24, 4096
 buffer_load_dwordx4 v[168:171], v2, s[4:7], s24 offen sc1
 s_waitcnt vmcnt(0)
 v_max_u32 v4, v96, v98
 v_max_u32 v5, v100, v102
 v_max3_u32 v4, v4, v104, v106
 v_max3_u32 v5, v5, v108, v110
 v_max3_u32 v4, v4, v112, v114
 v_max3_u32 v5, v5, v116, v118
 v_max3_u32 v4, v4, v120, v122
 v_max3_u32 v5, v5, v124, v126
 v_max3_u32 v4, v4, v128, v130
 v_max3_u32 v5, v5, v132, v134
 v_max3_u32 v4, v4, v136, v138
 v_max3_u32 v5, v5, v140, v142
 v_max3_u32 v4, v4, v144, v146
 v_max3_u32 v5, v5, v148, v150
 v_max3_u32 v4, v4, v152, v154
 v_max3_u32 v5, v5, v156, v158
 v_max3_u32 v4, v4, v160, v162
 v_max3_u32 v5, v5, v164, v166
 v_max3_u32 v4, v4, v168, v170
 v_max3_u32 v5, v5, v172, v174
 v_max_u32 v4, v4, v5
 v_cmp_eq_u32 vcc, -1, v4
 s_nop 1
 s_cmp_eq_u64 vcc, 0
 s_cbranch_scc1 L_k2_go
 s_sleep 2
 s_sub_u32 s33, s33, 1
 s_cmp_lg_u32 s33, 0
 s_cbranch_scc1 L_k2_poll2
L_k2_go:
 v_mfma_f32_16x16x32_bf16 v[16:19], v[176:179], v[96:99], 0
 v_mfma_f32_16x16x32_bf16 v[20:23], v[176:179], v[100:103], 0
 v_mfma_f32_16x16x32_bf16 v[24:27], v[176:179], v[104:107], 0
 v_mfma_f32_16x16x32_bf16 v[28:31], v[176:179], v[108:111], 0
 v_mfma_f32_16x16x32_bf16 v[32:35], v[180:183], v[96:99], 0
 v_mfma_f32_16x16x32_bf16 v[36:39], v[180:183], v[100:103], 0
 v_mfma_f32_16x16x32_bf16 v[40:43], v[180:183], v[104:107], 0
 v_mfma_f32_16x16x32_bf16 v[44:47], v[180:183], v[108:111], 0
 v_mfma_f32_16x16x32_bf16 v[48:51], v[184:187], v[96:99], 0
 v_mfma_f32_16x16x32_bf16 v[52:55], v[184:187], v[100:103], 0
 v_mfma_f32_16x16x32_bf16 v[56:59], v[184:187], v[104:107], 0
 v_mfma_f32_16x16x32_bf16 v[60:63], v[184:187], v[108:111], 0
 v_mfma_f32_16x16x32_bf16 v[64:67], v[188:191], v[96:99], 0
 v_mfma_f32_16x16x32_bf16 v[68:71], v[188:191], v[100:103], 0
 v_mfma_f32_16x16x32_bf16 v[72:75], v[188:191], v[104:107], 0
 v_mfma_f32_16x16x32_bf16 v[76:79], v[188:191], v[108:111], 0
 v_mfma_f32_16x16x32_bf16 v[80:83], v[192:195], v[96:99], 0
 v_mfma_f32_16x16x32_bf16 v[84:87], v[192:195], v[100:103], 0
 v_mfma_f32_16x16x32_bf16 v[88:91], v[192:195], v[104:107], 0
 v_mfma_f32_16x16x32_bf16 v[92:95], v[192:195], v[108:111], 0
 s_add_u32 s24, s19, 20480
 buffer_load_dwordx4 v[176:179], v2, s[4:7], s24 offen offset:0
 buffer_load_dwordx4 v[180:183], v2, s[4:7], s24 offen offset:1024
 buffer_load_dwordx4 v[184:187], v2, s[4:7], s24 offen offset:2048
 buffer_load_dwordx4 v[188:191], v2, s[4:7], s24 offen offset:3072
 s_add_u32 s24, s24, 4096
 buffer_load_dwordx4 v[192:195], v2, s[4:7], s24 offen
 v_mfma_f32_16x16x32_bf16 v[16:19], v[196:199], v[112:115], v[16:19]
 v_mfma_f32_16x16x32_bf16 v[20:23], v[196:199], v[116:119], v[20:23]
 v_mfma_f32_16x16x32_bf16 v[24:27], v[196:199], v[120:123], v[24:27]
 v_mfma_f32_16x16x32_bf16 v[28:31], v[196:199], v[124:127], v[28:31]
 v_mfma_f32_16x16x32_bf16 v[32:35], v[200:203], v[112:115], v[32:35]
 v_mfma_f32_16x16x32_bf16 v[36:39], v[200:203], v[116:119], v[36:39]
 v_mfma_f32_16x16x32_bf16 v[40:43], v[200:203], v[120:123], v[40:43]
 v_mfma_f32_16x16x32_bf16 v[44:47], v[200:203], v[124:127], v[44:47]
 v_mfma_f32_16x16x32_bf16 v[48:51], v[204:207], v[112:115], v[48:51]
 v_mfma_f32_16x16x32_bf16 v[52:55], v[204:207], v[116:119], v[52:55]
 v_mfma_f32_16x16x32_bf16 v[56:59], v[204:207], v[120:123], v[56:59]
 v_mfma_f32_16x16x32_bf16 v[60:63], v[204:207], v[124:127], v[60:63]
 v_mfma_f32_16x16x32_bf16 v[64:67], v[208:211], v[112:115], v[64:67]
 v_mfma_f32_16x16x32_bf16 v[68:71], v[208:211], v[116:119], v[68:71]
 v_mfma_f32_16x16x32_bf16 v[72:75], v[208:211], v[120:123], v[72:75]
 v_mfma_f32_16x16x32_bf16 v[76:79], v[208:211], v[124:127], v[76:79]
 v_mfma_f32_16x16x32_bf16 v[80:83], v[212:215], v[112:115], v[80:83]
 v_mfma_f32_16x16x32_bf16 v[84:87], v[212:215], v[116:119], v[84:87]
 v_mfma_f32_16x16x32_bf16 v[88:91], v[212:215], v[120:123], v[88:91]
 v_mfma_f32_16x16x32_bf16 v[92:95], v[212:215], v[124:127], v[92:95]
 v_mfma_f32_16x16x32_bf16 v[16:19], v[216:219], v[128:131], v[16:19]
 v_mfma_f32_16x16x32_bf16 v[20:23], v[216:219], v[132:135], v[20:23]
 v_mfma_f32_16x16x32_bf16 v[24:27], v[216:219], v[136:139], v[24:27]
 v_mfma_f32_16x16x32_bf16 v[28:31], v[216:219], v[140:143], v[28:31]
 v_mfma_f32_16x16x32_bf16 v[32:35], v[220:223], v[128:131], v[32:35]
 v_mfma_f32_16x16x32_bf16 v[36:39], v[220:223], v[132:135], v[36:39]
 v_mfma_f32_16x16x32_bf16 v[40:43], v[220:223], v[136:139], v[40:43]
 v_mfma_f32_16x16x32_bf16 v[44:47], v[220:223], v[140:143], v[44:47]
 v_mfma_f32_16x16x32_bf16 v[48:51], v[224:227], v[128:131], v[48:51]
 v_mfma_f32_16x16x32_bf16 v[52:55], v[224:227], v[132:135], v[52:55]
 v_mfma_f32_16x16x32_bf16 v[56:59], v[224:227], v[136:139], v[56:59]
 v_mfma_f32_16x16x32_bf16 v[60:63], v[224:227], v[140:143], v[60:63]
 v_mfma_f32_16x16x32_bf16 v[64:67], v[228:231], v[128:131], v[64:67]
 v_mfma_f32_16x16x32_bf16 v[68:71], v[228:231], v[132:135], v[68:71]
 v_mfma_f32_16x16x32_bf16 v[72:75], v[228:231], v[136:139], v[72:75]
 v_mfma_f32_16x16x32_bf16 v[76:79], v[228:231], v[140:143], v[76:79]
 v_mfma_f32_16x16x32_bf16 v[80:83], v[232:235], v[128:131], v[80:83]
 v_mfma_f32_16x16x32_bf16 v[84:87], v[232:235], v[132:135], v[84:87]
 v_mfma_f32_16x16x32_bf16 v[88:91], v[232:235], v[136:139], v[88:91]
 v_mfma_f32_16x16x32_bf16 v[92:95], v[232:235], v[140:143], v[92:95]
 v_mfma_f32_16x16x32_bf16 v[16:19], v[236:239], v[144:147], v[16:19]
 v_mfma_f32_16x16x32_bf16 v[20:23], v[236:239], v[148:151], v[20:23]
 v_mfma_f32_16x16x32_bf16 v[24:27], v[236:239], v[152:155], v[24:27]
 v_mfma_f32_16x16x32_bf16 v[28:31], v[236:239], v[156:159], v[28:31]
 v_mfma_f32_16x16x32_bf16 v[32:35], v[240:243], v[144:147], v[32:35]
 v_mfma_f32_16x16x32_bf16 v[36:39], v[240:243], v[148:151], v[36:39]
 v_mfma_f32_16x16x32_bf16 v[40:43], v[240:243], v[152:155], v[40:43]
 v_mfma_f32_16x16x32_bf16 v[44:47], v[240:243], v[156:159], v[44:47]
 v_mfma_f32_16x16x32_bf16 v[48:51], v[244:247], v[144:147], v[48:51]
 v_mfma_f32_16x16x32_bf16 v[52:55], v[244:247], v[148:151], v[52:55]
 v_mfma_f32_16x16x32_bf16 v[56:59], v[244:247], v[152:155], v[56:59]
 v_mfma_f32_16x16x32_bf16 v[60:63], v[244:247], v[156:159], v[60:63]
 v_mfma_f32_16x16x32_bf16 v[64:67], v[248:251], v[144:147], v[64:67]
 v_mfma_f32_16x16x32_bf16 v[68:71], v[248:251], v[148:151], v[68:71]
 v_mfma_f32_16x16x32_bf16 v[72:75], v[248:251], v[152:155], v[72:75]
 v_mfma_f32_16x16x32_bf16 v[76:79], v[248:251], v[156:159], v[76:79]
 v_mfma_f32_16x16x32_bf16 v[80:83], v[252:255], v[144:147], v[80:83]
 v_mfma_f32_16x16x32_bf16 v[84:87], v[252:255], v[148:151], v[84:87]
 v_mfma_f32_16x16x32_bf16 v[88:91], v[252:255], v[152:155], v[88:91]
 v_mfma_f32_16x16x32_bf16 v[92:95], v[252:255], v[156:159], v[92:95]
 s_waitcnt vmcnt(0)
 v_mfma_f32_16x16x32_bf16 v[16:19], v[176:179], v[160:163], v[16:19]
 v_mfma_f32_16x16x32_bf16 v[20:23], v[176:179], v[164:167], v[20:23]
 v_mfma_f32_16x16x32_bf16 v[24:27], v[176:179], v[168:171], v[24:27]
 v_mfma_f32_16x16x32_bf16 v[28:31], v[176:179], v[172:175], v[28:31]
 v_mfma_f32_16x16x32_bf16 v[32:35], v[180:183], v[160:163], v[32:35]
 v_mfma_f32_16x16x32_bf16 v[36:39], v[180:183], v[164:167], v[36:39]
 v_mfma_f32_16x16x32_bf16 v[40:43], v[180:183], v[168:171], v[40:43]
 v_mfma_f32_16x16x32_bf16 v[44:47], v[180:183], v[172:175], v[44:47]
 v_mfma_f32_16x16x32_bf16 v[48:51], v[184:187], v[160:163], v[48:51]
 v_mfma_f32_16x16x32_bf16 v[52:55], v[184:187], v[164:167], v[52:55]
 v_mfma_f32_16x16x32_bf16 v[56:59], v[184:187], v[168:171], v[56:59]
 v_mfma_f32_16x16x32_bf16 v[60:63], v[184:187], v[172:175], v[60:63]
 v_mfma_f32_16x16x32_bf16 v[64:67], v[188:191], v[160:163], v[64:67]
 v_mfma_f32_16x16x32_bf16 v[68:71], v[188:191], v[164:167], v[68:71]
 v_mfma_f32_16x16x32_bf16 v[72:75], v[188:191], v[168:171], v[72:75]
 v_mfma_f32_16x16x32_bf16 v[76:79], v[188:191], v[172:175], v[76:79]
 v_mfma_f32_16x16x32_bf16 v[80:83], v[192:195], v[160:163], v[80:83]
 v_mfma_f32_16x16x32_bf16 v[84:87], v[192:195], v[164:167], v[84:87]
 v_mfma_f32_16x16x32_bf16 v[88:91], v[192:195], v[168:171], v[88:91]
 v_mfma_f32_16x16x32_bf16 v[92:95], v[192:195], v[172:175], v[92:95]
L_k2_final:
 s_nop 7
 s_nop 7
 s_waitcnt vmcnt(0)
 s_mul_i32 s24, s16, 20480
 v_add_u32 v8, s24, v2
 ds_write_b128 v8, v[16:19] offset:0
 ds_write_b128 v8, v[20:23] offset:1024
 ds_write_b128 v8, v[24:27] offset:2048
 ds_write_b128 v8, v[28:31] offset:3072
 ds_write_b128 v8, v[32:35] offset:4096
 ds_write_b128 v8, v[36:39] offset:5120
 ds_write_b128 v8, v[40:43] offset:6144
 ds_write_b128 v8, v[44:47] offset:7168
 ds_write_b128 v8, v[48:51] offset:8192
 ds_write_b128 v8, v[52:55] offset:9216
 ds_write_b128 v8, v[56:59] offset:10240
 ds_write_b128 v8, v[60:63] offset:11264
 ds_write_b128 v8, v[64:67] offset:12288
 ds_write_b128 v8, v[68:71] offset:13312
 ds_write_b128 v8, v[72:75] offset:14336
 ds_write_b128 v8, v[76:79] offset:15360
 ds_write_b128 v8, v[80:83] offset:16384
 ds_write_b128 v8, v[84:87] offset:17408
 ds_write_b128 v8, v[88:91] offset:18432
 ds_write_b128 v8, v[92:95] offset:19456
 v_and_b32 v9, 15, v3
 v_lshrrev_b32 v10, 4, v3
 s_and_b32 s31, s16, 3
 s_lshl_b32 s24, s17, 6
 s_lshl_b32 s25, s31, 4
 s_add_u32 s24, s24, s25
 v_add_u32 v11, s24, v9
 v_lshlrev_b32 v12, 2, v11
 s_mov_b32 s26, 20971520
 buffer_load_dword v13, v12, s[4:7], s26 offen
 s_waitcnt lgkmcnt(0)
 s_barrier
 s_lshl_b32 s25, s31, 10
 s_cmp_ge_u32 s16, 4
 s_cselect_b32 s27, 12288, 0
 s_cselect_b32 s29, 96, 0
 s_add_u32 s25, s25, s27
 v_add_u32 v8, s25, v2
 v_add_u32 v14, 61440, v8
 v_add_u32 v15, 122880, v8
 s_movk_i32 s27, 1280
 v_mul_lo_u32 v11, v11, s27
 v_lshl_add_u32 v11, v10, 3, v11
 s_mul_i32 s28, s18, 160
 s_add_u32 s28, s28, s29
 ds_read_b128 v[16:19], v8 offset:0
 ds_read_b128 v[20:23], v8 offset:20480
 ds_read_b128 v[24:27], v8 offset:40960
 ds_read_b128 v[28:31], v14 offset:0
 ds_read_b128 v[32:35], v14 offset:20480
 ds_read_b128 v[36:39], v14 offset:40960
 ds_read_b128 v[40:43], v15 offset:0
 ds_read_b128 v[44:47], v15 offset:20480
 s_waitcnt vmcnt(0)
 v_sub_f32 v12, 1.0, v13
 v_cvt_pk_bf16_f32 v12, v12, v12
 v_lshlrev_b32 v12, 16, v12
 ds_read_b128 v[48:51], v8 offset:4096
 ds_read_b128 v[52:55], v8 offset:24576
 ds_read_b128 v[56:59], v8 offset:45056
 ds_read_b128 v[60:63], v14 offset:4096
 ds_read_b128 v[64:67], v14 offset:24576
 ds_read_b128 v[68:71], v14 offset:45056
 ds_read_b128 v[72:75], v15 offset:4096
 ds_read_b128 v[76:79], v15 offset:24576
 s_waitcnt lgkmcnt(8)
 v_add_f32 v16, v16, v20
 v_add_f32 v24, v24, v28
 v_add_f32 v32, v32, v36
 v_add_f32 v40, v40, v44
 v_add_f32 v17, v17, v21
 v_add_f32 v25, v25, v29
 v_add_f32 v33, v33, v37
 v_add_f32 v41, v41, v45
 v_add_f32 v18, v18, v22
 v_add_f32 v26, v26, v30
 v_add_f32 v34, v34, v38
 v_add_f32 v42, v42, v46
 v_add_f32 v19, v19, v23
 v_add_f32 v27, v27, v31
 v_add_f32 v35, v35, v39
 v_add_f32 v43, v43, v47
 v_add_f32 v16, v16, v24
 v_add_f32 v40, v40, v32
 v_add_f32 v17, v17, v25
 v_add_f32 v41, v41, v33
 v_add_f32 v18, v18, v26
 v_add_f32 v42, v42, v34
 v_add_f32 v19, v19, v27
 v_add_f32 v43, v43, v35
 v_cvt_pk_bf16_f32 v4, v16, v17
 v_cvt_pk_bf16_f32 v5, v40, v41
 v_lshlrev_b32 v16, 16, v4
 v_and_b32 v17, 0xffff0000, v4
 v_lshlrev_b32 v40, 16, v5
 v_and_b32 v41, 0xffff0000, v5
 v_mul_f32 v16, v16, v12
 v_mul_f32 v17, v17, v12
 v_mul_f32 v40, v40, v13
 v_mul_f32 v41, v41, v13
 v_cvt_pk_bf16_f32 v4, v16, v17
 v_cvt_pk_bf16_f32 v5, v40, v41
 v_lshlrev_b32 v16, 16, v4
 v_and_b32 v17, 0xffff0000, v4
 v_lshlrev_b32 v40, 16, v5
 v_and_b32 v41, 0xffff0000, v5
 v_add_f32 v16, v16, v40
 v_add_f32 v17, v17, v41
 v_cvt_pk_bf16_f32 v20, v16, v17
 v_cvt_pk_bf16_f32 v4, v18, v19
 v_cvt_pk_bf16_f32 v5, v42, v43
 v_lshlrev_b32 v18, 16, v4
 v_and_b32 v19, 0xffff0000, v4
 v_lshlrev_b32 v42, 16, v5
 v_and_b32 v43, 0xffff0000, v5
 v_mul_f32 v18, v18, v12
 v_mul_f32 v19, v19, v12
 v_mul_f32 v42, v42, v13
 v_mul_f32 v43, v43, v13
 v_cvt_pk_bf16_f32 v4, v18, v19
 v_cvt_pk_bf16_f32 v5, v42, v43
 v_lshlrev_b32 v18, 16, v4
 v_and_b32 v19, 0xffff0000, v4
 v_lshlrev_b32 v42, 16, v5
 v_and_b32 v43, 0xffff0000, v5
 v_add_f32 v18, v18, v42
 v_add_f32 v19, v19, v43
 v_cvt_pk_bf16_f32 v21, v18, v19
 buffer_store_dwordx2 v[20:21], v11, s[8:11], s28 offen offset:0
 s_waitcnt lgkmcnt(0)
 v_add_f32 v48, v48, v52
 v_add_f32 v56, v56, v60
 v_add_f32 v64, v64, v68
 v_add_f32 v72, v72, v76
 v_add_f32 v49, v49, v53
 v_add_f32 v57, v57, v61
 v_add_f32 v65, v65, v69
 v_add_f32 v73, v73, v77
 v_add_f32 v50, v50, v54
 v_add_f32 v58, v58, v62
 v_add_f32 v66, v66, v70
 v_add_f32 v74, v74, v78
 v_add_f32 v51, v51, v55
 v_add_f32 v59, v59, v63
 v_add_f32 v67, v67, v71
 v_add_f32 v75, v75, v79
 v_add_f32 v48, v48, v56
 v_add_f32 v72, v72, v64
 v_add_f32 v49, v49, v57
 v_add_f32 v73, v73, v65
 v_add_f32 v50, v50, v58
 v_add_f32 v74, v74, v66
 v_add_f32 v51, v51, v59
 v_add_f32 v75, v75, v67
 v_cvt_pk_bf16_f32 v4, v48, v49
 v_cvt_pk_bf16_f32 v5, v72, v73
 v_lshlrev_b32 v48, 16, v4
 v_and_b32 v49, 0xffff0000, v4
 v_lshlrev_b32 v72, 16, v5
 v_and_b32 v73, 0xffff0000, v5
 v_mul_f32 v48, v48, v12
 v_mul_f32 v49, v49, v12
 v_mul_f32 v72, v72, v13
 v_mul_f32 v73, v73, v13
 v_cvt_pk_bf16_f32 v4, v48, v49
 v_cvt_pk_bf16_f32 v5, v72, v73
 v_lshlrev_b32 v48, 16, v4
 v_and_b32 v49, 0xffff0000, v4
 v_lshlrev_b32 v72, 16, v5
 v_and_b32 v73, 0xffff0000, v5
 v_add_f32 v48, v48, v72
 v_add_f32 v49, v49, v73
 v_cvt_pk_bf16_f32 v52, v48, v49
 v_cvt_pk_bf16_f32 v4, v50, v51
 v_cvt_pk_bf16_f32 v5, v74, v75
 v_lshlrev_b32 v50, 16, v4
 v_and_b32 v51, 0xffff0000, v4
 v_lshlrev_b32 v74, 16, v5
 v_and_b32 v75, 0xffff0000, v5
 v_mul_f32 v50, v50, v12
 v_mul_f32 v51, v51, v12
 v_mul_f32 v74, v74, v13
 v_mul_f32 v75, v75, v13
 v_cvt_pk_bf16_f32 v4, v50, v51
 v_cvt_pk_bf16_f32 v5, v74, v75
 v_lshlrev_b32 v50, 16, v4
 v_and_b32 v51, 0xffff0000, v4
 v_lshlrev_b32 v74, 16, v5
 v_and_b32 v75, 0xffff0000, v5
 v_add_f32 v50, v50, v74
 v_add_f32 v51, v51, v75
 v_cvt_pk_bf16_f32 v53, v50, v51
 buffer_store_dwordx2 v[52:53], v11, s[8:11], s28 offen offset:32
 s_cmp_ge_u32 s16, 4
 s_cbranch_scc1 L_k2_done
 ds_read_b128 v[80:83], v8 offset:8192
 ds_read_b128 v[84:87], v8 offset:28672
 ds_read_b128 v[88:91], v8 offset:49152
 ds_read_b128 v[92:95], v14 offset:8192
 ds_read_b128 v[96:99], v14 offset:28672
 ds_read_b128 v[100:103], v14 offset:49152
 ds_read_b128 v[104:107], v15 offset:8192
 ds_read_b128 v[108:111], v15 offset:28672
 s_waitcnt lgkmcnt(0)
 v_add_f32 v80, v80, v84
 v_add_f32 v88, v88, v92
 v_add_f32 v96, v96, v100
 v_add_f32 v104, v104, v108
 v_add_f32 v81, v81, v85
 v_add_f32 v89, v89, v93
 v_add_f32 v97, v97, v101
 v_add_f32 v105, v105, v109
 v_add_f32 v82, v82, v86
 v_add_f32 v90, v90, v94
 v_add_f32 v98, v98, v102
 v_add_f32 v106, v106, v110
 v_add_f32 v83, v83, v87
 v_add_f32 v91, v91, v95
 v_add_f32 v99, v99, v103
 v_add_f32 v107, v107, v111
 v_add_f32 v80, v80, v88
 v_add_f32 v104, v104, v96
 v_add_f32 v81, v81, v89
 v_add_f32 v105, v105, v97
 v_add_f32 v82, v82, v90
 v_add_f32 v106, v106, v98
 v_add_f32 v83, v83, v91
 v_add_f32 v107, v107, v99
 v_cvt_pk_bf16_f32 v4, v80, v81
 v_cvt_pk_bf16_f32 v5, v104, v105
 v_lshlrev_b32 v80, 16, v4
 v_and_b32 v81, 0xffff0000, v4
 v_lshlrev_b32 v104, 16, v5
 v_and_b32 v105, 0xffff0000, v5
 v_mul_f32 v80, v80, v12
 v_mul_f32 v81, v81, v12
 v_mul_f32 v104, v104, v13
 v_mul_f32 v105, v105, v13
 v_cvt_pk_bf16_f32 v4, v80, v81
 v_cvt_pk_bf16_f32 v5, v104, v105
 v_lshlrev_b32 v80, 16, v4
 v_and_b32 v81, 0xffff0000, v4
 v_lshlrev_b32 v104, 16, v5
 v_and_b32 v105, 0xffff0000, v5
 v_add_f32 v80, v80, v104
 v_add_f32 v81, v81, v105
 v_cvt_pk_bf16_f32 v84, v80, v81
 v_cvt_pk_bf16_f32 v4, v82, v83
 v_cvt_pk_bf16_f32 v5, v106, v107
 v_lshlrev_b32 v82, 16, v4
 v_and_b32 v83, 0xffff0000, v4
 v_lshlrev_b32 v106, 16, v5
 v_and_b32 v107, 0xffff0000, v5
 v_mul_f32 v82, v82, v12
 v_mul_f32 v83, v83, v12
 v_mul_f32 v106, v106, v13
 v_mul_f32 v107, v107, v13
 v_cvt_pk_bf16_f32 v4, v82, v83
 v_cvt_pk_bf16_f32 v5, v106, v107
 v_lshlrev_b32 v82, 16, v4
 v_and_b32 v83, 0xffff0000, v4
 v_lshlrev_b32 v106, 16, v5
 v_and_b32 v107, 0xffff0000, v5
 v_add_f32 v82, v82, v106
 v_add_f32 v83, v83, v107
 v_cvt_pk_bf16_f32 v85, v82, v83
 buffer_store_dwordx2 v[84:85], v11, s[8:11], s28 offen offset:64
L_k2_done:
 s_endpgm
L_text_end:
.section .rodata,"a"
.p2align 6
.amdhsa_kernel k1_kernel
  .amdhsa_next_free_vgpr 256
  .amdhsa_next_free_sgpr 102
  .amdhsa_accum_offset 256
  .amdhsa_group_segment_fixed_size 0
  .amdhsa_kernarg_size 96
  .amdhsa_user_sgpr_count 2
  .amdhsa_user_sgpr_kernarg_segment_ptr 1
  .amdhsa_system_sgpr_workgroup_id_x 1
.end_amdhsa_kernel
.section .rodata,"a"
.p2align 6
.amdhsa_kernel k2_kernel
  .amdhsa_next_free_vgpr 256
  .amdhsa_next_free_sgpr 102
  .amdhsa_accum_offset 256
  .amdhsa_group_segment_fixed_size 0
  .amdhsa_kernarg_size 96
  .amdhsa_user_sgpr_count 2
  .amdhsa_user_sgpr_kernarg_segment_ptr 1
  .amdhsa_system_sgpr_workgroup_id_x 1
.end_amdhsa_kernel
```
